```python
import torch

def _softmax(x, axis=-1):
    return torch.softmax(x, dim=axis)

def _gelu(x):
    return torch.nn.functional.gelu(x, approximate='tanh')

def _silu(x):
    return torch.nn.functional.silu(x)

def _sigmoid(x):
    return torch.sigmoid(x)

def _layernorm(x, axis=-1, eps=1e-05):
    m = x.mean(dim=axis, keepdim=True)
    v = x.var(dim=axis, keepdim=True, unbiased=False)
    return (x - m) / torch.sqrt(v + eps)

def _scatter_add(tgt, idx, src, axis=0):
    return tgt.clone().index_add_(axis, idx, src)

def _segment_sum(src, seg, n):
    out = torch.zeros((n,) + src.shape[1:], dtype=src.dtype)
    return out.index_add_(0, seg, src)

def _pad(x, pw):
    flat = tuple((v for pair in reversed(pw) for v in pair))
    return torch.nn.functional.pad(x, flat)
kernel_name = 'gated_mix__ssm_conv_s5__memory_aug_recurrent_mem_tr__prompt'

def setup_inputs():

    _w = lambda a: (lambda t: t.to(torch.bfloat16) if t.is_floating_point() else t)(torch.as_tensor(a))

    def _A_setup():
        B, S, D = (1, 2048, 512)
        P = D
        Lambda_re = -0.5 * (lambda _x: torch.exp(torch.as_tensor(_x)))((lambda *s: torch.randn(*s, dtype=torch.bfloat16) * 0.8)(P))
        Lambda_im = (lambda *s: torch.randn(*s, dtype=torch.bfloat16) * 0.8)(P) * 1.0
        B_re = (lambda *s: torch.randn(*s, dtype=torch.bfloat16) * 0.8)(P, D) * D ** (-0.5)
        B_im = (lambda *s: torch.randn(*s, dtype=torch.bfloat16) * 0.8)(P, D) * D ** (-0.5)
        C_re = (lambda *s: torch.randn(*s, dtype=torch.bfloat16) * 0.8)(D, P) * P ** (-0.5)
        C_im = (lambda *s: torch.randn(*s, dtype=torch.bfloat16) * 0.8)(D, P) * P ** (-0.5)
        log_dt = (lambda *s: torch.randn(*s, dtype=torch.bfloat16) * 0.8)(P) * 0.3 - 2.0
        Dskip = (lambda *s: torch.randn(*s, dtype=torch.bfloat16) * 0.8)(D)
        return {'x': _w((lambda *s: torch.randn(*s, dtype=torch.bfloat16) * 0.05)(B, S, D)), 'Lambda_re': _w(Lambda_re), 'Lambda_im': _w(Lambda_im), 'B_re': _w(B_re), 'B_im': _w(B_im), 'C_re': _w(C_re), 'C_im': _w(C_im), 'log_dt': _w(log_dt), 'Dskip': _w(Dskip)}
    _A_in = _A_setup()

    def _B_setup():
        B, S, Dm = (1, 2048, 512)
        H, Dh = (32, 128)
        M, seg = (8, 32)
        seg = min(seg, S)
        S = S // seg * seg
        return {'x': _w((lambda *s: torch.randn(*s, dtype=torch.bfloat16) * 0.05)(B, S, Dm)), 'mem0': _w((lambda *s: torch.randn(*s, dtype=torch.bfloat16) * 0.8)(B, M, Dm)), 'Wq': _w((lambda *s: torch.randn(*s, dtype=torch.bfloat16) * 3.2)(Dm, H, Dh) * Dm ** (-0.5)), 'Wk': _w((lambda *s: torch.randn(*s, dtype=torch.bfloat16) * 3.2)(Dm, H, Dh) * Dm ** (-0.5)), 'Wv': _w((lambda *s: torch.randn(*s, dtype=torch.bfloat16) * 0.8)(Dm, H, Dh) * Dm ** (-0.5)), 'Wo': _w((lambda *s: torch.randn(*s, dtype=torch.bfloat16) * 0.8)(H, Dh, Dm) * (H * Dh) ** (-0.5)), 'seg_len': seg}
    _B_in = _B_setup()
    return {'A_x': _A_in['x'], 'A_Lambda_re': _A_in['Lambda_re'], 'A_Lambda_im': _A_in['Lambda_im'], 'A_B_re': _A_in['B_re'], 'A_B_im': _A_in['B_im'], 'A_C_re': _A_in['C_re'], 'A_C_im': _A_in['C_im'], 'A_log_dt': _A_in['log_dt'], 'A_Dskip': _A_in['Dskip'], 'B_x': _B_in['x'], 'B_mem0': _B_in['mem0'], 'B_Wq': _B_in['Wq'], 'B_Wk': _B_in['Wk'], 'B_Wv': _B_in['Wv'], 'B_Wo': _B_in['Wo'], 'B_seg_len': _B_in['seg_len'], 'gate_w': _w((lambda *s: torch.randn(*s, dtype=torch.bfloat16) * 0.05)(512) * 16.0)}

def reference(A_x, A_Lambda_re, A_Lambda_im, A_B_re, A_B_im, A_C_re, A_C_im, A_log_dt, A_Dskip, B_x, B_mem0, B_Wq, B_Wk, B_Wv, B_Wo, B_seg_len, gate_w):

    def _A_ref(x, Lambda_re, Lambda_im, B_re, B_im, C_re, C_im, log_dt, Dskip):
        Bsz, L, H = x.shape
        Lam = Lambda_re + 1j * Lambda_im
        Bmat = B_re + 1j * B_im
        Cmat = C_re + 1j * C_im
        dt = torch.exp(log_dt)
        Lam_bar = torch.exp(dt * Lam)
        B_bar = ((Lam_bar - 1.0) / Lam)[:, None] * Bmat
        Bu = torch.einsum('bld,pd->blp', x + 0j, B_bar)
        h = torch.zeros_like(Bu[:, 0, :])
        hs = []
        for t in range(L):
            h = Lam_bar[None, :] * h + Bu[:, t, :]
            hs.append(h)
        hseq = torch.stack(hs, 1)
        y = 2.0 * torch.einsum('blp,dp->bld', hseq, Cmat).real + x * Dskip[None, None, :]
        return y

    def _B_ref(x, mem0, Wq, Wk, Wv, Wo, seg_len):
        B, S, Dm = x.shape
        H, Dh = (Wq.shape[1], Wq.shape[2])
        M = mem0.shape[1]
        scale = Dh ** (-0.5)
        n_seg = S // seg_len
        L = M + seg_len
        idx = torch.arange(L)
        mask = (idx[:, None] < M) | (idx[:, None] >= idx[None, :])
        mem = mem0
        outs = []
        for s in range(n_seg):
            xs = x[:, s * seg_len:(s + 1) * seg_len, :].clone()
            h = torch.concatenate([mem, xs], axis=1)
            q = torch.einsum('btd,dhe->bhte', h, Wq)
            k = torch.einsum('btd,dhe->bhte', h, Wk)
            v = torch.einsum('btd,dhe->bhte', h, Wv)
            scores = torch.einsum('bhqe,bhke->bhqk', q, k) * scale
            scores = torch.where(mask[None, None], scores, -1000000000.0)
            p = _softmax(scores, axis=-1)
            o = torch.einsum('bhqk,bhke->bhqe', p, v)
            o = torch.einsum('bhte,hed->btd', o, Wo)
            mem = o[:, :M, :].clone()
            outs.append(o[:, M:, :])
        return torch.concatenate(outs, axis=1)
    x = A_x
    g = _sigmoid((x * gate_w).sum(-1, keepdims=True))
    a = _A_ref(x, A_Lambda_re, A_Lambda_im, A_B_re, A_B_im, A_C_re, A_C_im, A_log_dt, A_Dskip)
    b = _B_ref(x, B_mem0, B_Wq, B_Wk, B_Wv, B_Wo, B_seg_len)
    return g * a + (1 - g) * b
```

```asm
; @launch grid=(256,1,1) block=(256,1,1) lds=163840
.amdgcn_target "amdgcn-amd-amdhsa--gfx950"
.text
.globl gated_mix__ssm_conv_s5__memory_aug_recurrent_mem_tr__prompt_kernel
.p2align 8
.type gated_mix__ssm_conv_s5__memory_aug_recurrent_mem_tr__prompt_kernel,@function
gated_mix__ssm_conv_s5__memory_aug_recurrent_mem_tr__prompt_kernel:
    s_cmp_ge_u32 s2, 256
    s_cbranch_scc1 L_end
    s_load_dwordx2 s[24:25], s[0:1], 144
    s_mov_b32 s26, 256
    s_mov_b32 s27, 0x20000
    s_load_dwordx2 s[4:5], s[0:1], 152
    s_mov_b32 s6, 268435456
    s_mov_b32 s7, 0x20000
    s_getreg_b32 s50, hwreg(HW_REG_XCC_ID, 0, 3)
    v_lshrrev_b32 v1, 6, v0
    s_bfe_u32 s3, s2, 0x50003
    s_xor_b32 s50, s50, 3
    v_readfirstlane_b32 s33, v1
    s_cmp_eq_u32 s50, 0
    s_cbranch_scc0 L_helper
    s_load_dwordx2 s[16:17], s[0:1], 104
    s_mov_b32 s18, 4194304
    s_mov_b32 s19, 0x20000
    s_load_dwordx2 s[12:13], s[0:1], 96
    s_mov_b32 s14, 4194304
    s_mov_b32 s15, 0x20000
    s_load_dwordx2 s[8:9], s[0:1], 88
    s_mov_b32 s10, 4194304
    s_mov_b32 s11, 0x20000
    s_load_dwordx2 s[20:21], s[0:1], 112
    s_mov_b32 s22, 4194304
    s_mov_b32 s23, 0x20000
    s_load_dwordx2 s[28:29], s[0:1], 80
    s_mov_b32 s30, 8192
    s_mov_b32 s31, 0x20000
    s_waitcnt lgkmcnt(0)
    s_cmp_lg_u32 s33, 0
    s_cbranch_scc1 L_tk_c
    s_mov_b64 exec, 1
    v_mov_b32 v126, 1
    buffer_atomic_add v126, off, s[24:27], 0 sc0
    s_mov_b64 exec, -1
L_tk_c:
    v_lshrrev_b32 v1, 1, v0
    v_and_b32 v2, 1, v0
    v_lshlrev_b32 v2, 7, v2
    v_lshl_add_u32 v1, v1, 13, v2
    s_lshl_b32 s52, s3, 8
    buffer_load_dword v127, v1, s[16:19], s52 offen
    v_mov_b32 v125, 16368
    s_cmp_lg_u32 s33, 0
    s_cbranch_scc1 L_tg_c
    s_waitcnt vmcnt(1)
    s_mov_b64 exec, 1
    ds_write_b32 v125, v126
    s_mov_b64 exec, -1
    s_waitcnt lgkmcnt(0)
L_tg_c:
    s_barrier
    ds_read_b32 v126, v125
    s_waitcnt lgkmcnt(0)
    v_readfirstlane_b32 s51, v126
    s_cmp_ge_u32 s51, 32
    s_cbranch_scc1 L_end
    s_mov_b32 s32, s51
    s_mov_b32 s2, 0
L_chain2:
    v_bfe_u32 v96, v0, 4, 2
    v_and_b32 v97, 15, v0
    v_bfe_u32 v98, v0, 4, 1
    v_lshlrev_b32 v98, 2, v98
    v_xor_b32 v97, v97, v98
    v_lshlrev_b32 v97, 4, v97
    v_lshl_add_u32 v56, v96, 13, v97
    v_lshl_add_u32 v57, v96, 10, v97
    v_xor_b32 v52, 128, v56
    v_xor_b32 v53, 128, v57
    s_lshl_b32 s54, s33, 15
    s_add_u32 s54, s54, 32768
    s_lshl_b32 s56, s32, 8
    s_lshl_b32 s52, s33, 17
    s_add_u32 s56, s56, s52
    s_lshl_b32 s57, s32, 17
    s_lshl_b32 s52, s33, 14
    s_add_u32 s57, s57, s52
    s_add_u32 m0, s54, 0
    s_add_u32 s55, s56, 0
    buffer_load_dwordx4 v56, s[16:19], s55 offen sc1 lds
    s_add_u32 m0, s54, 1024
    s_add_u32 s55, s56, 32768
    buffer_load_dwordx4 v52, s[16:19], s55 offen sc1 lds
    s_add_u32 m0, s54, 2048
    s_add_u32 s55, s56, 65536
    buffer_load_dwordx4 v56, s[16:19], s55 offen sc1 lds
    s_add_u32 m0, s54, 3072
    s_add_u32 s55, s56, 98304
    buffer_load_dwordx4 v52, s[16:19], s55 offen sc1 lds
    s_add_u32 m0, s54, 4096
    s_add_u32 s55, s56, 524288
    buffer_load_dwordx4 v56, s[16:19], s55 offen sc1 lds
    s_add_u32 m0, s54, 5120
    s_add_u32 s55, s56, 557056
    buffer_load_dwordx4 v52, s[16:19], s55 offen sc1 lds
    s_add_u32 m0, s54, 6144
    s_add_u32 s55, s56, 589824
    buffer_load_dwordx4 v56, s[16:19], s55 offen sc1 lds
    s_add_u32 m0, s54, 7168
    s_add_u32 s55, s56, 622592
    buffer_load_dwordx4 v52, s[16:19], s55 offen sc1 lds
    s_add_u32 m0, s54, 8192
    s_add_u32 s55, s56, 1048576
    buffer_load_dwordx4 v56, s[16:19], s55 offen sc1 lds
    s_add_u32 m0, s54, 9216
    s_add_u32 s55, s56, 1081344
    buffer_load_dwordx4 v52, s[16:19], s55 offen sc1 lds
    s_add_u32 m0, s54, 10240
    s_add_u32 s55, s56, 1114112
    buffer_load_dwordx4 v56, s[16:19], s55 offen sc1 lds
    s_add_u32 m0, s54, 11264
    s_add_u32 s55, s56, 1146880
    buffer_load_dwordx4 v52, s[16:19], s55 offen sc1 lds
    s_add_u32 m0, s54, 12288
    s_add_u32 s55, s56, 1572864
    buffer_load_dwordx4 v56, s[16:19], s55 offen sc1 lds
    s_add_u32 m0, s54, 13312
    s_add_u32 s55, s56, 1605632
    buffer_load_dwordx4 v52, s[16:19], s55 offen sc1 lds
    s_add_u32 m0, s54, 14336
    s_add_u32 s55, s56, 1638400
    buffer_load_dwordx4 v56, s[16:19], s55 offen sc1 lds
    s_add_u32 m0, s54, 15360
    s_add_u32 s55, s56, 1671168
    buffer_load_dwordx4 v52, s[16:19], s55 offen sc1 lds
    s_add_u32 m0, s54, 16384
    s_add_u32 s55, s56, 2097152
    buffer_load_dwordx4 v56, s[16:19], s55 offen sc1 lds
    s_add_u32 m0, s54, 17408
    s_add_u32 s55, s56, 2129920
    buffer_load_dwordx4 v52, s[16:19], s55 offen sc1 lds
    s_add_u32 m0, s54, 18432
    s_add_u32 s55, s56, 2162688
    buffer_load_dwordx4 v56, s[16:19], s55 offen sc1 lds
    s_add_u32 m0, s54, 19456
    s_add_u32 s55, s56, 2195456
    buffer_load_dwordx4 v52, s[16:19], s55 offen sc1 lds
    s_add_u32 m0, s54, 20480
    s_add_u32 s55, s56, 2621440
    buffer_load_dwordx4 v56, s[16:19], s55 offen sc1 lds
    s_add_u32 m0, s54, 21504
    s_add_u32 s55, s56, 2654208
    buffer_load_dwordx4 v52, s[16:19], s55 offen sc1 lds
    s_add_u32 m0, s54, 22528
    s_add_u32 s55, s56, 2686976
    buffer_load_dwordx4 v56, s[16:19], s55 offen sc1 lds
    s_add_u32 m0, s54, 23552
    s_add_u32 s55, s56, 2719744
    buffer_load_dwordx4 v52, s[16:19], s55 offen sc1 lds
    s_add_u32 m0, s54, 24576
    s_add_u32 s55, s56, 3145728
    buffer_load_dwordx4 v56, s[16:19], s55 offen sc1 lds
    s_add_u32 m0, s54, 25600
    s_add_u32 s55, s56, 3178496
    buffer_load_dwordx4 v52, s[16:19], s55 offen sc1 lds
    s_add_u32 m0, s54, 26624
    s_add_u32 s55, s56, 3211264
    buffer_load_dwordx4 v56, s[16:19], s55 offen sc1 lds
    s_add_u32 m0, s54, 27648
    s_add_u32 s55, s56, 3244032
    buffer_load_dwordx4 v52, s[16:19], s55 offen sc1 lds
    s_add_u32 m0, s54, 28672
    s_add_u32 s55, s56, 3670016
    buffer_load_dwordx4 v56, s[16:19], s55 offen sc1 lds
    s_add_u32 m0, s54, 29696
    s_add_u32 s55, s56, 3702784
    buffer_load_dwordx4 v52, s[16:19], s55 offen sc1 lds
    s_add_u32 m0, s54, 30720
    s_add_u32 s55, s56, 3735552
    buffer_load_dwordx4 v56, s[16:19], s55 offen sc1 lds
    s_add_u32 m0, s54, 31744
    s_add_u32 s55, s56, 3768320
    buffer_load_dwordx4 v52, s[16:19], s55 offen sc1 lds
    v_and_b32 v97, 63, v0
    v_and_b32 v98, 15, v97
    v_lshrrev_b32 v99, 4, v97
    v_lshlrev_b32 v1, 4, v97
    v_lshrrev_b32 v102, 1, v99
    v_and_b32 v103, 1, v99
    v_lshrrev_b32 v104, 3, v98
    v_and_b32 v105, 3, v98
    v_lshrrev_b32 v106, 2, v98
    s_lshl_b32 s51, s33, 15
    s_add_u32 s51, s51, 32768
    v_add_u32 v2, s51, v1
    v_lshl_add_u32 v108, v104, 1, v103
    v_and_b32 v101, 7, v98
    v_lshl_add_u32 v101, v108, 4, v101
    v_lshlrev_b32 v101, 4, v101
    v_add_u32 v108, s33, v108
    v_and_b32 v108, 3, v108
    v_lshl_add_u32 v101, v108, 2, v101
    v_xor_b32 v108, 1, v102
    v_lshl_add_u32 v101, v108, 11, v101
    v_add_u32 v3, 9216, v101
    v_mov_b32 v10, 0x3f803f80
    v_mov_b32 v11, 0
    v_mov_b32 v4, -1
    v_and_b32 v5, 0x37f, v1
    v_lshlrev_b32 v108, 7, v103
    v_or_b32 v5, v5, v108
    v_xor_b32 v8, v1, v108
    v_mov_b32 v9, 0
    v_cmp_lt_u32 vcc, 7, v98
    v_mov_b32 v108, 0x4444
    v_mov_b32 v109, 0xeeee
    v_cndmask_b32 v107, v108, v109, vcc
    v_lshlrev_b32 v101, 2, v102
    v_lshl_add_u32 v101, v104, 1, v101
    v_add_u32 v101, v101, v103
    v_lshlrev_b32 v101, 11, v101
    v_and_b32 v108, 7, v98
    v_lshl_add_u32 v101, v108, 3, v101
    s_lshl_b32 s52, s33, 14
    s_lshl_b32 s53, s32, 6
    s_add_u32 s52, s52, s53
    v_add_u32 v6, s52, v101
    s_lshl_b32 s52, s33, 5
    s_add_u32 s52, s52, s32
    s_lshl_b32 s52, s52, 6
    v_lshlrev_b32 v101, 4, v99
    v_lshl_add_u32 v101, v98, 2, v101
    v_add_u32 v101, s52, v101
    v_cmp_gt_u32 vcc, 4, v98
    v_bfrev_b32 v109, 1
    s_nop 0
    v_cndmask_b32 v7, v109, v101, vcc
    v_lshl_add_u32 v101, v104, 2, v105
    v_and_b32 v108, 1, v106
    v_cmp_eq_u32 vcc, v108, v103
    v_mov_b32 v109, 64
    s_nop 0
    v_cndmask_b32 v101, v109, v101, vcc
    v_and_b32 v108, 1, v98
    v_lshl_add_u32 v110, v108, 2, v106
    v_cmp_gt_u32 vcc, 2, v105
    s_mov_b32 s53, 0x3f80
    s_nop 0
    v_cndmask_b32 v110, v109, v110, vcc
    v_and_b32 v111, 1, v101
    v_lshlrev_b32 v111, 4, v111
    v_lshlrev_b32 v111, v111, s53
    v_lshrrev_b32 v112, 1, v101
    v_cmp_eq_u32 vcc, 0, v112
    s_nop 1
    v_cndmask_b32 v12, 0, v111, vcc
    v_cmp_eq_u32 vcc, 1, v112
    s_nop 1
    v_cndmask_b32 v13, 0, v111, vcc
    v_cmp_eq_u32 vcc, 2, v112
    s_nop 1
    v_cndmask_b32 v14, 0, v111, vcc
    v_cmp_eq_u32 vcc, 3, v112
    s_nop 1
    v_cndmask_b32 v15, 0, v111, vcc
    v_and_b32 v111, 1, v110
    v_lshlrev_b32 v111, 4, v111
    v_lshlrev_b32 v111, v111, s53
    v_lshrrev_b32 v112, 1, v110
    v_cmp_eq_u32 vcc, 0, v112
    s_nop 1
    v_cndmask_b32 v16, 0, v111, vcc
    v_cmp_eq_u32 vcc, 1, v112
    s_nop 1
    v_cndmask_b32 v17, 0, v111, vcc
    v_cmp_eq_u32 vcc, 2, v112
    s_nop 1
    v_cndmask_b32 v18, 0, v111, vcc
    v_cmp_eq_u32 vcc, 3, v112
    s_nop 1
    v_cndmask_b32 v19, 0, v111, vcc
    v_and_b32 v112, 1, v106
    v_lshl_add_u32 v110, v103, 2, v112
    v_lshl_add_u32 v112, v103, 1, v112
    v_xor_b32 v112, s33, v112
    v_lshlrev_b32 v112, 6, v112
    v_add_u32 v112, 32768, v112
    v_lshl_add_u32 v111, v104, 3, v110
    v_lshl_add_u32 v111, v111, 8, v112
    v_lshl_add_u32 v111, v102, 15, v111
    v_lshl_add_u32 v58, v105, 4, v111
    v_add_u32 v61, 0x10000, v58
    v_lshl_add_u32 v111, v102, 3, v110
    v_lshl_add_u32 v111, v111, 8, v112
    v_lshl_add_u32 v111, v104, 5, v111
    v_lshl_add_u32 v59, v105, 3, v111
    v_add_u32 v62, 0x10000, v59
    v_and_b32 v101, 7, v98
    v_lshlrev_b32 v101, 10, v101
    v_lshl_add_u32 v101, v99, 5, v101
    v_lshl_add_u32 v101, v104, 4, v101
    s_lshl_b32 s52, s33, 7
    v_add_u32 v60, s52, v101
    v_mov_b32 v0, v107
    v_mov_b32 v64, -1
    v_mov_b32 v65, -1
    v_mov_b32 v66, -1
    v_mov_b32 v67, -1
    s_mov_b32 s34, 0
    s_lshl_b32 s50, s32, 2
    s_add_u32 s50, s50, s33
    s_lshl_b32 s35, s50, 12
    s_add_u32 s35, s35, 65536
    s_lshl_b32 s36, s50, 10
    s_mov_b32 s3, 140
    s_add_u32 s36, s36, 35717120
    s_mov_b32 s40, 50331648
    s_mov_b32 s41, 50397184
    s_mov_b32 s42, 50462720
    s_mov_b32 s43, 50528256
    s_lshl_b32 s50, s33, 5
    s_add_u32 s50, s50, s32
    s_lshl_b32 s50, s50, 11
    s_add_u32 s37, s50, 50331648
    s_mov_b32 s38, 0
    s_mov_b32 s44, 50864128
    s_mov_b32 s45, 50872320
    s_mov_b32 s39, 50855936
    s_mov_b32 s59, 50855936
    s_mov_b32 s58, 0x70000000
    s_mov_b32 s84, 0x3f803f80
    s_mov_b32 s85, 0x3f803f80
    s_mov_b32 s86, 0x00ff00ff
    s_mov_b32 s87, 0x00ff00ff
    s_mov_b32 s48, 0x3e0293ee
    s_mov_b32 s49, 0x3e0293ee
    s_cmp_lg_u32 s2, 0
    s_cbranch_scc1 L_c_b0
    s_mov_b32 s34, 1
    s_add_u32 s35, s35, 0x80000
    s_add_u32 s36, s36, 0x20000
    s_branch L_c_b1
L_c_b0:
    s_mov_b32 s40, 50593792
    s_mov_b32 s41, 50659328
    s_mov_b32 s42, 50724864
    s_mov_b32 s43, 50790400
    s_mov_b32 s45, 0x70000000
    s_add_u32 s37, s37, 262144
    s_mov_b32 s44, 50987008
    buffer_store_dwordx4 v[64:67], v1, s[4:7], s35 offen offset:0 sc1
    buffer_store_dwordx4 v[64:67], v1, s[4:7], s35 offen offset:1024 sc1
    buffer_store_dwordx4 v[64:67], v1, s[4:7], s35 offen offset:2048 sc1
    buffer_store_dwordx4 v[64:67], v1, s[4:7], s35 offen offset:3072 sc1
L_c_b1:
    buffer_store_dwordx4 v[64:67], v1, s[4:7], s37 offen sc1
    buffer_store_dwordx4 v[64:67], v1, s[4:7], s37 offen offset:1024 sc1
    buffer_store_dword v64, v7, s[4:7], s44 offen sc1
    v_xor_b32 v63, 256, v60
    buffer_load_dwordx4 v[24:27], v63, s[28:31], 0 offen
    buffer_load_dwordx4 v[40:43], v63, s[28:31], 0 offen offset:512
    s_cmp_eq_u32 s33, 0
    s_cbranch_scc1 L_cp_0
    s_cmp_eq_u32 s33, 1
    s_cbranch_scc1 L_cp_1
    s_cmp_eq_u32 s33, 2
    s_cbranch_scc1 L_cp_2
    s_branch L_cp_3
L_cp_0:
    s_waitcnt vmcnt(33)
    s_barrier
    ds_read_b64_tr_b16 a[224:225], v58 offset:0
    ds_read_b64_tr_b16 a[226:227], v58 offset:512
    ds_read_b64_tr_b16 a[228:229], v61 offset:0
    ds_read_b64_tr_b16 a[230:231], v61 offset:512
    ds_read_b64_tr_b16 a[232:233], v58 offset:8
    ds_read_b64_tr_b16 a[234:235], v58 offset:520
    ds_read_b64_tr_b16 a[236:237], v61 offset:8
    ds_read_b64_tr_b16 a[238:239], v61 offset:520
    s_waitcnt lgkmcnt(0)
    s_waitcnt vmcnt(29)
    s_barrier
    ds_read_b64_tr_b16 a[240:241], v58 offset:4096
    ds_read_b64_tr_b16 a[242:243], v58 offset:4608
    s_add_u32 m0, s54, 0
    s_add_u32 s55, s56, 0
    buffer_load_dwordx4 v56, s[12:15], s55 offen sc1 lds
    ds_read_b64_tr_b16 a[244:245], v61 offset:4096
    ds_read_b64_tr_b16 a[246:247], v61 offset:4608
    s_add_u32 m0, s54, 1024
    s_add_u32 s55, s56, 32768
    buffer_load_dwordx4 v52, s[12:15], s55 offen sc1 lds
    ds_read_b64_tr_b16 a[248:249], v58 offset:4104
    ds_read_b64_tr_b16 a[250:251], v58 offset:4616
    s_add_u32 m0, s54, 2048
    s_add_u32 s55, s56, 65536
    buffer_load_dwordx4 v56, s[12:15], s55 offen sc1 lds
    ds_read_b64_tr_b16 a[252:253], v61 offset:4104
    ds_read_b64_tr_b16 a[254:255], v61 offset:4616
    s_add_u32 m0, s54, 3072
    s_add_u32 s55, s56, 98304
    buffer_load_dwordx4 v52, s[12:15], s55 offen sc1 lds
    s_waitcnt lgkmcnt(0)
    s_waitcnt vmcnt(29)
    s_barrier
    ds_read_b64_tr_b16 a[192:193], v58 offset:8192
    ds_read_b64_tr_b16 a[194:195], v58 offset:8704
    s_add_u32 m0, s54, 4096
    s_add_u32 s55, s56, 524288
    buffer_load_dwordx4 v56, s[12:15], s55 offen sc1 lds
    ds_read_b64_tr_b16 a[196:197], v61 offset:8192
    ds_read_b64_tr_b16 a[198:199], v61 offset:8704
    s_add_u32 m0, s54, 5120
    s_add_u32 s55, s56, 557056
    buffer_load_dwordx4 v52, s[12:15], s55 offen sc1 lds
    ds_read_b64_tr_b16 a[200:201], v58 offset:8200
    ds_read_b64_tr_b16 a[202:203], v58 offset:8712
    s_add_u32 m0, s54, 6144
    s_add_u32 s55, s56, 589824
    buffer_load_dwordx4 v56, s[12:15], s55 offen sc1 lds
    ds_read_b64_tr_b16 a[204:205], v61 offset:8200
    ds_read_b64_tr_b16 a[206:207], v61 offset:8712
    s_add_u32 m0, s54, 7168
    s_add_u32 s55, s56, 622592
    buffer_load_dwordx4 v52, s[12:15], s55 offen sc1 lds
    s_waitcnt lgkmcnt(0)
    s_waitcnt vmcnt(29)
    s_barrier
    ds_read_b64_tr_b16 a[208:209], v58 offset:12288
    ds_read_b64_tr_b16 a[210:211], v58 offset:12800
    s_add_u32 m0, s54, 8192
    s_add_u32 s55, s56, 1048576
    buffer_load_dwordx4 v56, s[12:15], s55 offen sc1 lds
    ds_read_b64_tr_b16 a[212:213], v61 offset:12288
    ds_read_b64_tr_b16 a[214:215], v61 offset:12800
    s_add_u32 m0, s54, 9216
    s_add_u32 s55, s56, 1081344
    buffer_load_dwordx4 v52, s[12:15], s55 offen sc1 lds
    ds_read_b64_tr_b16 a[216:217], v58 offset:12296
    ds_read_b64_tr_b16 a[218:219], v58 offset:12808
    s_add_u32 m0, s54, 10240
    s_add_u32 s55, s56, 1114112
    buffer_load_dwordx4 v56, s[12:15], s55 offen sc1 lds
    ds_read_b64_tr_b16 a[220:221], v61 offset:12296
    ds_read_b64_tr_b16 a[222:223], v61 offset:12808
    s_add_u32 m0, s54, 11264
    s_add_u32 s55, s56, 1146880
    buffer_load_dwordx4 v52, s[12:15], s55 offen sc1 lds
    s_waitcnt lgkmcnt(0)
    s_waitcnt vmcnt(29)
    s_barrier
    ds_read_b64_tr_b16 v[160:161], v58 offset:16384
    ds_read_b64_tr_b16 v[162:163], v58 offset:16896
    s_add_u32 m0, s54, 12288
    s_add_u32 s55, s56, 1572864
    buffer_load_dwordx4 v56, s[12:15], s55 offen sc1 lds
    ds_read_b64_tr_b16 v[164:165], v61 offset:16384
    ds_read_b64_tr_b16 v[166:167], v61 offset:16896
    s_add_u32 m0, s54, 13312
    s_add_u32 s55, s56, 1605632
    buffer_load_dwordx4 v52, s[12:15], s55 offen sc1 lds
    ds_read_b64_tr_b16 v[168:169], v58 offset:16392
    ds_read_b64_tr_b16 v[170:171], v58 offset:16904
    s_add_u32 m0, s54, 14336
    s_add_u32 s55, s56, 1638400
    buffer_load_dwordx4 v56, s[12:15], s55 offen sc1 lds
    ds_read_b64_tr_b16 v[172:173], v61 offset:16392
    ds_read_b64_tr_b16 v[174:175], v61 offset:16904
    s_add_u32 m0, s54, 15360
    s_add_u32 s55, s56, 1671168
    buffer_load_dwordx4 v52, s[12:15], s55 offen sc1 lds
    s_waitcnt lgkmcnt(0)
    s_waitcnt vmcnt(29)
    s_barrier
    ds_read_b64_tr_b16 v[176:177], v58 offset:20480
    ds_read_b64_tr_b16 v[178:179], v58 offset:20992
    s_add_u32 m0, s54, 16384
    s_add_u32 s55, s56, 2097152
    buffer_load_dwordx4 v56, s[12:15], s55 offen sc1 lds
    ds_read_b64_tr_b16 v[180:181], v61 offset:20480
    ds_read_b64_tr_b16 v[182:183], v61 offset:20992
    s_add_u32 m0, s54, 17408
    s_add_u32 s55, s56, 2129920
    buffer_load_dwordx4 v52, s[12:15], s55 offen sc1 lds
    ds_read_b64_tr_b16 v[184:185], v58 offset:20488
    ds_read_b64_tr_b16 v[186:187], v58 offset:21000
    s_add_u32 m0, s54, 18432
    s_add_u32 s55, s56, 2162688
    buffer_load_dwordx4 v56, s[12:15], s55 offen sc1 lds
    ds_read_b64_tr_b16 v[188:189], v61 offset:20488
    ds_read_b64_tr_b16 v[190:191], v61 offset:21000
    s_add_u32 m0, s54, 19456
    s_add_u32 s55, s56, 2195456
    buffer_load_dwordx4 v52, s[12:15], s55 offen sc1 lds
    s_waitcnt lgkmcnt(0)
    s_waitcnt vmcnt(29)
    s_barrier
    ds_read_b64_tr_b16 v[128:129], v58 offset:24576
    ds_read_b64_tr_b16 v[130:131], v58 offset:25088
    s_add_u32 m0, s54, 20480
    s_add_u32 s55, s56, 2621440
    buffer_load_dwordx4 v56, s[12:15], s55 offen sc1 lds
    ds_read_b64_tr_b16 v[132:133], v61 offset:24576
    ds_read_b64_tr_b16 v[134:135], v61 offset:25088
    s_add_u32 m0, s54, 21504
    s_add_u32 s55, s56, 2654208
    buffer_load_dwordx4 v52, s[12:15], s55 offen sc1 lds
    ds_read_b64_tr_b16 v[136:137], v58 offset:24584
    ds_read_b64_tr_b16 v[138:139], v58 offset:25096
    s_add_u32 m0, s54, 22528
    s_add_u32 s55, s56, 2686976
    buffer_load_dwordx4 v56, s[12:15], s55 offen sc1 lds
    ds_read_b64_tr_b16 v[140:141], v61 offset:24584
    ds_read_b64_tr_b16 v[142:143], v61 offset:25096
    s_add_u32 m0, s54, 23552
    s_add_u32 s55, s56, 2719744
    buffer_load_dwordx4 v52, s[12:15], s55 offen sc1 lds
    s_waitcnt lgkmcnt(0)
    s_waitcnt vmcnt(29)
    s_barrier
    ds_read_b64_tr_b16 v[144:145], v58 offset:28672
    ds_read_b64_tr_b16 v[146:147], v58 offset:29184
    s_add_u32 m0, s54, 24576
    s_add_u32 s55, s56, 3145728
    buffer_load_dwordx4 v56, s[12:15], s55 offen sc1 lds
    ds_read_b64_tr_b16 v[148:149], v61 offset:28672
    ds_read_b64_tr_b16 v[150:151], v61 offset:29184
    s_add_u32 m0, s54, 25600
    s_add_u32 s55, s56, 3178496
    buffer_load_dwordx4 v52, s[12:15], s55 offen sc1 lds
    ds_read_b64_tr_b16 v[152:153], v58 offset:28680
    ds_read_b64_tr_b16 v[154:155], v58 offset:29192
    s_add_u32 m0, s54, 26624
    s_add_u32 s55, s56, 3211264
    buffer_load_dwordx4 v56, s[12:15], s55 offen sc1 lds
    ds_read_b64_tr_b16 v[156:157], v61 offset:28680
    ds_read_b64_tr_b16 v[158:159], v61 offset:29192
    s_add_u32 m0, s54, 27648
    s_add_u32 s55, s56, 3244032
    buffer_load_dwordx4 v52, s[12:15], s55 offen sc1 lds
    s_waitcnt lgkmcnt(0)
    s_waitcnt vmcnt(24)
    s_barrier
    ds_read_b64_tr_b16 a[40:41], v58 offset:0
    ds_read_b64_tr_b16 a[42:43], v58 offset:512
    s_add_u32 m0, s54, 28672
    s_add_u32 s55, s56, 3670016
    buffer_load_dwordx4 v56, s[12:15], s55 offen sc1 lds
    ds_read_b64_tr_b16 a[44:45], v61 offset:0
    ds_read_b64_tr_b16 a[46:47], v61 offset:512
    s_add_u32 m0, s54, 29696
    s_add_u32 s55, s56, 3702784
    buffer_load_dwordx4 v52, s[12:15], s55 offen sc1 lds
    ds_read_b64_tr_b16 a[56:57], v58 offset:8
    ds_read_b64_tr_b16 a[58:59], v58 offset:520
    s_add_u32 m0, s54, 30720
    s_add_u32 s55, s56, 3735552
    buffer_load_dwordx4 v56, s[12:15], s55 offen sc1 lds
    ds_read_b64_tr_b16 a[60:61], v61 offset:8
    ds_read_b64_tr_b16 a[62:63], v61 offset:520
    s_add_u32 m0, s54, 31744
    s_add_u32 s55, s56, 3768320
    buffer_load_dwordx4 v52, s[12:15], s55 offen sc1 lds
    s_waitcnt lgkmcnt(0)
    s_waitcnt vmcnt(24)
    s_barrier
    v_min_u32 v24, -2, v24
    v_min_u32 v25, -2, v25
    v_min_u32 v26, -2, v26
    v_min_u32 v27, -2, v27
    v_min_u32 v40, -2, v40
    v_min_u32 v41, -2, v41
    v_min_u32 v42, -2, v42
    v_min_u32 v43, -2, v43
    s_cmp_lg_u32 s2, 0
    s_cselect_b32 s52, 132, 4
    s_mov_b64 exec, 1
    v_mov_b32 v38, 1
    buffer_atomic_add v38, off, s[24:27], s52
    s_mov_b64 exec, -1
    ds_read_b64_tr_b16 a[72:73], v58 offset:4096
    ds_read_b64_tr_b16 a[74:75], v58 offset:4608
    s_add_u32 m0, s54, 0
    s_add_u32 s55, s56, 0
    buffer_load_dwordx4 v56, s[8:11], s55 offen sc1 lds
    ds_read_b64_tr_b16 a[76:77], v61 offset:4096
    ds_read_b64_tr_b16 a[78:79], v61 offset:4608
    s_add_u32 m0, s54, 1024
    s_add_u32 s55, s56, 32768
    buffer_load_dwordx4 v52, s[8:11], s55 offen sc1 lds
    ds_read_b64_tr_b16 a[88:89], v58 offset:4104
    ds_read_b64_tr_b16 a[90:91], v58 offset:4616
    s_add_u32 m0, s54, 2048
    s_add_u32 s55, s56, 65536
    buffer_load_dwordx4 v56, s[8:11], s55 offen sc1 lds
    ds_read_b64_tr_b16 a[92:93], v61 offset:4104
    ds_read_b64_tr_b16 a[94:95], v61 offset:4616
    s_add_u32 m0, s54, 3072
    s_add_u32 s55, s56, 98304
    buffer_load_dwordx4 v52, s[8:11], s55 offen sc1 lds
    s_waitcnt lgkmcnt(0)
    s_waitcnt vmcnt(25)
    s_barrier
    ds_read_b64_tr_b16 v[104:105], v58 offset:8192
    ds_read_b64_tr_b16 v[106:107], v58 offset:8704
    s_add_u32 m0, s54, 4096
    s_add_u32 s55, s56, 524288
    buffer_load_dwordx4 v56, s[8:11], s55 offen sc1 lds
    ds_read_b64_tr_b16 v[108:109], v61 offset:8192
    ds_read_b64_tr_b16 v[110:111], v61 offset:8704
    s_add_u32 m0, s54, 5120
    s_add_u32 s55, s56, 557056
    buffer_load_dwordx4 v52, s[8:11], s55 offen sc1 lds
    ds_read_b64_tr_b16 v[120:121], v58 offset:8200
    ds_read_b64_tr_b16 v[122:123], v58 offset:8712
    s_add_u32 m0, s54, 6144
    s_add_u32 s55, s56, 589824
    buffer_load_dwordx4 v56, s[8:11], s55 offen sc1 lds
    ds_read_b64_tr_b16 v[124:125], v61 offset:8200
    ds_read_b64_tr_b16 v[126:127], v61 offset:8712
    s_add_u32 m0, s54, 7168
    s_add_u32 s55, s56, 622592
    buffer_load_dwordx4 v52, s[8:11], s55 offen sc1 lds
    s_waitcnt lgkmcnt(0)
    s_waitcnt vmcnt(25)
    s_barrier
    ds_read_b64_tr_b16 a[8:9], v58 offset:12288
    ds_read_b64_tr_b16 a[10:11], v58 offset:12800
    s_add_u32 m0, s54, 8192
    s_add_u32 s55, s56, 1048576
    buffer_load_dwordx4 v56, s[8:11], s55 offen sc1 lds
    ds_read_b64_tr_b16 a[12:13], v61 offset:12288
    ds_read_b64_tr_b16 a[14:15], v61 offset:12800
    s_add_u32 m0, s54, 9216
    s_add_u32 s55, s56, 1081344
    buffer_load_dwordx4 v52, s[8:11], s55 offen sc1 lds
    ds_read_b64_tr_b16 a[24:25], v58 offset:12296
    ds_read_b64_tr_b16 a[26:27], v58 offset:12808
    s_add_u32 m0, s54, 10240
    s_add_u32 s55, s56, 1114112
    buffer_load_dwordx4 v56, s[8:11], s55 offen sc1 lds
    ds_read_b64_tr_b16 a[28:29], v61 offset:12296
    ds_read_b64_tr_b16 a[30:31], v61 offset:12808
    s_add_u32 m0, s54, 11264
    s_add_u32 s55, s56, 1146880
    buffer_load_dwordx4 v52, s[8:11], s55 offen sc1 lds
    s_waitcnt lgkmcnt(0)
    s_waitcnt vmcnt(25)
    s_barrier
    ds_read_b64_tr_b16 a[136:137], v58 offset:16384
    ds_read_b64_tr_b16 a[138:139], v58 offset:16896
    s_add_u32 m0, s54, 12288
    s_add_u32 s55, s56, 1572864
    buffer_load_dwordx4 v56, s[8:11], s55 offen sc1 lds
    ds_read_b64_tr_b16 a[140:141], v61 offset:16384
    ds_read_b64_tr_b16 a[142:143], v61 offset:16896
    s_add_u32 m0, s54, 13312
    s_add_u32 s55, s56, 1605632
    buffer_load_dwordx4 v52, s[8:11], s55 offen sc1 lds
    ds_read_b64_tr_b16 a[152:153], v58 offset:16392
    ds_read_b64_tr_b16 a[154:155], v58 offset:16904
    s_add_u32 m0, s54, 14336
    s_add_u32 s55, s56, 1638400
    buffer_load_dwordx4 v56, s[8:11], s55 offen sc1 lds
    ds_read_b64_tr_b16 a[156:157], v61 offset:16392
    ds_read_b64_tr_b16 a[158:159], v61 offset:16904
    s_add_u32 m0, s54, 15360
    s_add_u32 s55, s56, 1671168
    buffer_load_dwordx4 v52, s[8:11], s55 offen sc1 lds
    s_waitcnt lgkmcnt(0)
    s_waitcnt vmcnt(25)
    s_barrier
    ds_read_b64_tr_b16 a[168:169], v58 offset:20480
    ds_read_b64_tr_b16 a[170:171], v58 offset:20992
    s_add_u32 m0, s54, 16384
    s_add_u32 s55, s56, 2097152
    buffer_load_dwordx4 v56, s[8:11], s55 offen sc1 lds
    ds_read_b64_tr_b16 a[172:173], v61 offset:20480
    ds_read_b64_tr_b16 a[174:175], v61 offset:20992
    s_add_u32 m0, s54, 17408
    s_add_u32 s55, s56, 2129920
    buffer_load_dwordx4 v52, s[8:11], s55 offen sc1 lds
    ds_read_b64_tr_b16 a[184:185], v58 offset:20488
    ds_read_b64_tr_b16 a[186:187], v58 offset:21000
    s_add_u32 m0, s54, 18432
    s_add_u32 s55, s56, 2162688
    buffer_load_dwordx4 v56, s[8:11], s55 offen sc1 lds
    ds_read_b64_tr_b16 a[188:189], v61 offset:20488
    ds_read_b64_tr_b16 a[190:191], v61 offset:21000
    s_add_u32 m0, s54, 19456
    s_add_u32 s55, s56, 2195456
    buffer_load_dwordx4 v52, s[8:11], s55 offen sc1 lds
    s_waitcnt lgkmcnt(0)
    s_waitcnt vmcnt(25)
    s_barrier
    ds_read_b64_tr_b16 v[72:73], v58 offset:24576
    ds_read_b64_tr_b16 v[74:75], v58 offset:25088
    s_add_u32 m0, s54, 20480
    s_add_u32 s55, s56, 2621440
    buffer_load_dwordx4 v56, s[8:11], s55 offen sc1 lds
    ds_read_b64_tr_b16 v[76:77], v61 offset:24576
    ds_read_b64_tr_b16 v[78:79], v61 offset:25088
    s_add_u32 m0, s54, 21504
    s_add_u32 s55, s56, 2654208
    buffer_load_dwordx4 v52, s[8:11], s55 offen sc1 lds
    ds_read_b64_tr_b16 v[88:89], v58 offset:24584
    ds_read_b64_tr_b16 v[90:91], v58 offset:25096
    s_add_u32 m0, s54, 22528
    s_add_u32 s55, s56, 2686976
    buffer_load_dwordx4 v56, s[8:11], s55 offen sc1 lds
    ds_read_b64_tr_b16 v[92:93], v61 offset:24584
    ds_read_b64_tr_b16 v[94:95], v61 offset:25096
    s_add_u32 m0, s54, 23552
    s_add_u32 s55, s56, 2719744
    buffer_load_dwordx4 v52, s[8:11], s55 offen sc1 lds
    s_waitcnt lgkmcnt(0)
    s_waitcnt vmcnt(25)
    s_barrier
    ds_read_b64_tr_b16 a[104:105], v58 offset:28672
    ds_read_b64_tr_b16 a[106:107], v58 offset:29184
    s_add_u32 m0, s54, 24576
    s_add_u32 s55, s56, 3145728
    buffer_load_dwordx4 v56, s[8:11], s55 offen sc1 lds
    ds_read_b64_tr_b16 a[108:109], v61 offset:28672
    ds_read_b64_tr_b16 a[110:111], v61 offset:29184
    s_add_u32 m0, s54, 25600
    s_add_u32 s55, s56, 3178496
    buffer_load_dwordx4 v52, s[8:11], s55 offen sc1 lds
    ds_read_b64_tr_b16 a[120:121], v58 offset:28680
    ds_read_b64_tr_b16 a[122:123], v58 offset:29192
    s_add_u32 m0, s54, 26624
    s_add_u32 s55, s56, 3211264
    buffer_load_dwordx4 v56, s[8:11], s55 offen sc1 lds
    ds_read_b64_tr_b16 a[124:125], v61 offset:28680
    ds_read_b64_tr_b16 a[126:127], v61 offset:29192
    s_add_u32 m0, s54, 27648
    s_add_u32 s55, s56, 3244032
    buffer_load_dwordx4 v52, s[8:11], s55 offen sc1 lds
    s_waitcnt lgkmcnt(0)
    s_waitcnt vmcnt(24)
    s_barrier
    ds_read_b64_tr_b16 a[32:33], v58 offset:0
    ds_read_b64_tr_b16 a[34:35], v58 offset:512
    s_add_u32 m0, s54, 28672
    s_add_u32 s55, s56, 3670016
    buffer_load_dwordx4 v56, s[8:11], s55 offen sc1 lds
    ds_read_b64_tr_b16 a[36:37], v61 offset:0
    ds_read_b64_tr_b16 a[38:39], v61 offset:512
    s_add_u32 m0, s54, 29696
    s_add_u32 s55, s56, 3702784
    buffer_load_dwordx4 v52, s[8:11], s55 offen sc1 lds
    ds_read_b64_tr_b16 a[48:49], v58 offset:8
    ds_read_b64_tr_b16 a[50:51], v58 offset:520
    s_add_u32 m0, s54, 30720
    s_add_u32 s55, s56, 3735552
    buffer_load_dwordx4 v56, s[8:11], s55 offen sc1 lds
    ds_read_b64_tr_b16 a[52:53], v61 offset:8
    ds_read_b64_tr_b16 a[54:55], v61 offset:520
    s_add_u32 m0, s54, 31744
    s_add_u32 s55, s56, 3768320
    buffer_load_dwordx4 v52, s[8:11], s55 offen sc1 lds
    s_waitcnt lgkmcnt(0)
    s_waitcnt vmcnt(24)
    s_barrier
    ds_read_b64_tr_b16 a[64:65], v58 offset:4096
    ds_read_b64_tr_b16 a[66:67], v58 offset:4608
    s_add_u32 m0, s54, 0
    s_add_u32 s55, s57, 0
    buffer_load_dwordx4 v57, s[20:23], s55 offen sc1 lds
    ds_read_b64_tr_b16 a[68:69], v61 offset:4096
    ds_read_b64_tr_b16 a[70:71], v61 offset:4608
    s_add_u32 m0, s54, 1024
    s_add_u32 s55, s57, 4096
    buffer_load_dwordx4 v53, s[20:23], s55 offen sc1 lds
    ds_read_b64_tr_b16 a[80:81], v58 offset:4104
    ds_read_b64_tr_b16 a[82:83], v58 offset:4616
    s_add_u32 m0, s54, 2048
    s_add_u32 s55, s57, 8192
    buffer_load_dwordx4 v57, s[20:23], s55 offen sc1 lds
    ds_read_b64_tr_b16 a[84:85], v61 offset:4104
    ds_read_b64_tr_b16 a[86:87], v61 offset:4616
    s_add_u32 m0, s54, 3072
    s_add_u32 s55, s57, 12288
    buffer_load_dwordx4 v53, s[20:23], s55 offen sc1 lds
    s_waitcnt lgkmcnt(0)
    s_waitcnt vmcnt(24)
    s_barrier
    ds_read_b64_tr_b16 v[96:97], v58 offset:8192
    ds_read_b64_tr_b16 v[98:99], v58 offset:8704
    s_add_u32 m0, s54, 4096
    s_add_u32 s55, s57, 65536
    buffer_load_dwordx4 v57, s[20:23], s55 offen sc1 lds
    ds_read_b64_tr_b16 v[100:101], v61 offset:8192
    ds_read_b64_tr_b16 v[102:103], v61 offset:8704
    s_add_u32 m0, s54, 5120
    s_add_u32 s55, s57, 69632
    buffer_load_dwordx4 v53, s[20:23], s55 offen sc1 lds
    ds_read_b64_tr_b16 v[112:113], v58 offset:8200
    ds_read_b64_tr_b16 v[114:115], v58 offset:8712
    s_add_u32 m0, s54, 6144
    s_add_u32 s55, s57, 73728
    buffer_load_dwordx4 v57, s[20:23], s55 offen sc1 lds
    ds_read_b64_tr_b16 v[116:117], v61 offset:8200
    ds_read_b64_tr_b16 v[118:119], v61 offset:8712
    s_add_u32 m0, s54, 7168
    s_add_u32 s55, s57, 77824
    buffer_load_dwordx4 v53, s[20:23], s55 offen sc1 lds
    s_waitcnt lgkmcnt(0)
    s_waitcnt vmcnt(24)
    s_barrier
    ds_read_b64_tr_b16 a[0:1], v58 offset:12288
    ds_read_b64_tr_b16 a[2:3], v58 offset:12800
    s_add_u32 m0, s54, 8192
    s_add_u32 s55, s57, 256
    buffer_load_dwordx4 v57, s[20:23], s55 offen sc1 lds
    ds_read_b64_tr_b16 a[4:5], v61 offset:12288
    ds_read_b64_tr_b16 a[6:7], v61 offset:12800
    s_add_u32 m0, s54, 9216
    s_add_u32 s55, s57, 4352
    buffer_load_dwordx4 v53, s[20:23], s55 offen sc1 lds
    ds_read_b64_tr_b16 a[16:17], v58 offset:12296
    ds_read_b64_tr_b16 a[18:19], v58 offset:12808
    s_add_u32 m0, s54, 10240
    s_add_u32 s55, s57, 8448
    buffer_load_dwordx4 v57, s[20:23], s55 offen sc1 lds
    ds_read_b64_tr_b16 a[20:21], v61 offset:12296
    ds_read_b64_tr_b16 a[22:23], v61 offset:12808
    s_add_u32 m0, s54, 11264
    s_add_u32 s55, s57, 12544
    buffer_load_dwordx4 v53, s[20:23], s55 offen sc1 lds
    s_waitcnt lgkmcnt(0)
    s_waitcnt vmcnt(24)
    s_barrier
    ds_read_b64_tr_b16 a[128:129], v58 offset:16384
    ds_read_b64_tr_b16 a[130:131], v58 offset:16896
    s_add_u32 m0, s54, 12288
    s_add_u32 s55, s57, 65792
    buffer_load_dwordx4 v57, s[20:23], s55 offen sc1 lds
    ds_read_b64_tr_b16 a[132:133], v61 offset:16384
    ds_read_b64_tr_b16 a[134:135], v61 offset:16896
    s_add_u32 m0, s54, 13312
    s_add_u32 s55, s57, 69888
    buffer_load_dwordx4 v53, s[20:23], s55 offen sc1 lds
    ds_read_b64_tr_b16 a[144:145], v58 offset:16392
    ds_read_b64_tr_b16 a[146:147], v58 offset:16904
    s_add_u32 m0, s54, 14336
    s_add_u32 s55, s57, 73984
    buffer_load_dwordx4 v57, s[20:23], s55 offen sc1 lds
    ds_read_b64_tr_b16 a[148:149], v61 offset:16392
    ds_read_b64_tr_b16 a[150:151], v61 offset:16904
    s_add_u32 m0, s54, 15360
    s_add_u32 s55, s57, 78080
    buffer_load_dwordx4 v53, s[20:23], s55 offen sc1 lds
    s_waitcnt lgkmcnt(0)
    s_waitcnt vmcnt(24)
    s_barrier
    ds_read_b64_tr_b16 a[160:161], v58 offset:20480
    ds_read_b64_tr_b16 a[162:163], v58 offset:20992
    s_add_u32 m0, s54, 16384
    s_add_u32 s55, s57, 512
    buffer_load_dwordx4 v57, s[20:23], s55 offen sc1 lds
    ds_read_b64_tr_b16 a[164:165], v61 offset:20480
    ds_read_b64_tr_b16 a[166:167], v61 offset:20992
    s_add_u32 m0, s54, 17408
    s_add_u32 s55, s57, 4608
    buffer_load_dwordx4 v53, s[20:23], s55 offen sc1 lds
    ds_read_b64_tr_b16 a[176:177], v58 offset:20488
    ds_read_b64_tr_b16 a[178:179], v58 offset:21000
    s_add_u32 m0, s54, 18432
    s_add_u32 s55, s57, 8704
    buffer_load_dwordx4 v57, s[20:23], s55 offen sc1 lds
    ds_read_b64_tr_b16 a[180:181], v61 offset:20488
    ds_read_b64_tr_b16 a[182:183], v61 offset:21000
    s_add_u32 m0, s54, 19456
    s_add_u32 s55, s57, 12800
    buffer_load_dwordx4 v53, s[20:23], s55 offen sc1 lds
    s_waitcnt lgkmcnt(0)
    s_waitcnt vmcnt(24)
    s_barrier
    ds_read_b64_tr_b16 v[64:65], v58 offset:24576
    ds_read_b64_tr_b16 v[66:67], v58 offset:25088
    s_add_u32 m0, s54, 20480
    s_add_u32 s55, s57, 66048
    buffer_load_dwordx4 v57, s[20:23], s55 offen sc1 lds
    ds_read_b64_tr_b16 v[68:69], v61 offset:24576
    ds_read_b64_tr_b16 v[70:71], v61 offset:25088
    s_add_u32 m0, s54, 21504
    s_add_u32 s55, s57, 70144
    buffer_load_dwordx4 v53, s[20:23], s55 offen sc1 lds
    ds_read_b64_tr_b16 v[80:81], v58 offset:24584
    ds_read_b64_tr_b16 v[82:83], v58 offset:25096
    s_add_u32 m0, s54, 22528
    s_add_u32 s55, s57, 74240
    buffer_load_dwordx4 v57, s[20:23], s55 offen sc1 lds
    ds_read_b64_tr_b16 v[84:85], v61 offset:24584
    ds_read_b64_tr_b16 v[86:87], v61 offset:25096
    s_add_u32 m0, s54, 23552
    s_add_u32 s55, s57, 78336
    buffer_load_dwordx4 v53, s[20:23], s55 offen sc1 lds
    s_waitcnt lgkmcnt(0)
    s_waitcnt vmcnt(24)
    s_barrier
    ds_read_b64_tr_b16 a[96:97], v58 offset:28672
    ds_read_b64_tr_b16 a[98:99], v58 offset:29184
    s_add_u32 m0, s54, 24576
    s_add_u32 s55, s57, 768
    buffer_load_dwordx4 v57, s[20:23], s55 offen sc1 lds
    ds_read_b64_tr_b16 a[100:101], v61 offset:28672
    ds_read_b64_tr_b16 a[102:103], v61 offset:29184
    s_add_u32 m0, s54, 25600
    s_add_u32 s55, s57, 4864
    buffer_load_dwordx4 v53, s[20:23], s55 offen sc1 lds
    ds_read_b64_tr_b16 a[112:113], v58 offset:28680
    ds_read_b64_tr_b16 a[114:115], v58 offset:29192
    s_add_u32 m0, s54, 26624
    s_add_u32 s55, s57, 8960
    buffer_load_dwordx4 v57, s[20:23], s55 offen sc1 lds
    ds_read_b64_tr_b16 a[116:117], v61 offset:28680
    ds_read_b64_tr_b16 a[118:119], v61 offset:29192
    s_add_u32 m0, s54, 27648
    s_add_u32 s55, s57, 13056
    buffer_load_dwordx4 v53, s[20:23], s55 offen sc1 lds
    s_waitcnt lgkmcnt(0)
    s_waitcnt vmcnt(24)
    s_barrier
    s_lshl_b32 s52, s2, 12
    buffer_load_dword v39, off, s[24:27], s52 offset:12 sc1
    ds_read_b64_tr_b16 v[192:193], v59 offset:0
    ds_read_b64_tr_b16 v[194:195], v59 offset:512
    s_add_u32 m0, s54, 28672
    s_add_u32 s55, s57, 66304
    buffer_load_dwordx4 v57, s[20:23], s55 offen sc1 lds
    ds_read_b64_tr_b16 v[196:197], v59 offset:32768
    ds_read_b64_tr_b16 v[198:199], v59 offset:33280
    s_add_u32 m0, s54, 29696
    s_add_u32 s55, s57, 70400
    buffer_load_dwordx4 v53, s[20:23], s55 offen sc1 lds
    ds_read_b64_tr_b16 v[200:201], v62 offset:0
    ds_read_b64_tr_b16 v[202:203], v62 offset:512
    s_add_u32 m0, s54, 30720
    s_add_u32 s55, s57, 74496
    buffer_load_dwordx4 v57, s[20:23], s55 offen sc1 lds
    ds_read_b64_tr_b16 v[204:205], v62 offset:32768
    ds_read_b64_tr_b16 v[206:207], v62 offset:33280
    s_add_u32 m0, s54, 31744
    s_add_u32 s55, s57, 78592
    buffer_load_dwordx4 v53, s[20:23], s55 offen sc1 lds
    s_waitcnt lgkmcnt(0)
    s_waitcnt vmcnt(25)
    s_barrier
    s_getpc_b64 s[50:51]
L_cpc_0:
    v_lshlrev_b32 v63, 3, v1
    s_cmp_lg_u32 s2, 0
    s_cselect_b32 s52, s45, 50855936
    s_cselect_b32 s53, s45, s37
    buffer_load_dword v36, v63, s[4:7], s52 offen sc1
    v_and_b32 v37, 0x780, v63
    v_min_u32 v63, L_step_0-L_top_0, v63
    v_add_u32 v63, L_top_0-L_cpc_0, v63
    s_mul_i32 s52, s2, L_bstep_0-L_top_0
    v_add_u32 v63, s52, v63
    buffer_load_dword v36, v37, s[4:7], s53 offen sc1
    global_load_dword v36, v63, s[50:51]
    s_mov_b32 s52, 61440
    buffer_load_dword v36, off, s[4:7], s52 sc1
    ds_read_b64_tr_b16 v[208:209], v59 offset:4096
    ds_read_b64_tr_b16 v[210:211], v59 offset:4608
    ds_read_b64_tr_b16 v[212:213], v59 offset:36864
    ds_read_b64_tr_b16 v[214:215], v59 offset:37376
    ds_read_b64_tr_b16 v[216:217], v62 offset:4096
    ds_read_b64_tr_b16 v[218:219], v62 offset:4608
    ds_read_b64_tr_b16 v[220:221], v62 offset:36864
    ds_read_b64_tr_b16 v[222:223], v62 offset:37376
    s_waitcnt lgkmcnt(0)
    s_waitcnt vmcnt(25)
    s_barrier
    ds_read_b64_tr_b16 v[224:225], v59 offset:8192
    ds_read_b64_tr_b16 v[226:227], v59 offset:8704
    ds_read_b64_tr_b16 v[228:229], v59 offset:40960
    ds_read_b64_tr_b16 v[230:231], v59 offset:41472
    ds_read_b64_tr_b16 v[232:233], v62 offset:8192
    ds_read_b64_tr_b16 v[234:235], v62 offset:8704
    ds_read_b64_tr_b16 v[236:237], v62 offset:40960
    ds_read_b64_tr_b16 v[238:239], v62 offset:41472
    s_waitcnt lgkmcnt(0)
    s_waitcnt vmcnt(21)
    s_barrier
    ds_read_b64_tr_b16 v[240:241], v59 offset:12288
    ds_read_b64_tr_b16 v[242:243], v59 offset:12800
    ds_read_b64_tr_b16 v[244:245], v59 offset:45056
    ds_read_b64_tr_b16 v[246:247], v59 offset:45568
    ds_read_b64_tr_b16 v[248:249], v62 offset:12288
    ds_read_b64_tr_b16 v[250:251], v62 offset:12800
    ds_read_b64_tr_b16 v[252:253], v62 offset:45056
    ds_read_b64_tr_b16 v[254:255], v62 offset:45568
    s_waitcnt lgkmcnt(0)
    s_waitcnt vmcnt(17)
    s_barrier
    ds_write_b128 v2, v[96:99] offset:0
    ds_write_b128 v2, v[100:103] offset:1024
    ds_write_b128 v2, v[104:107] offset:4096
    ds_write_b128 v2, v[108:111] offset:5120
    ds_write_b128 v2, v[112:115] offset:2048
    ds_write_b128 v2, v[116:119] offset:3072
    ds_write_b128 v2, v[120:123] offset:6144
    ds_write_b128 v2, v[124:127] offset:7168
    s_waitcnt lgkmcnt(0)
    ds_write_b128 v2, v[64:67] offset:8192
    ds_write_b128 v2, v[68:71] offset:9216
    ds_write_b128 v2, v[72:75] offset:12288
    ds_write_b128 v2, v[76:79] offset:13312
    ds_write_b128 v2, v[80:83] offset:10240
    ds_write_b128 v2, v[84:87] offset:11264
    ds_write_b128 v2, v[88:91] offset:14336
    ds_write_b128 v2, v[92:95] offset:15360
    s_waitcnt lgkmcnt(0)
    ds_read_b64_tr_b16 v[28:29], v59 offset:16384
    ds_read_b64_tr_b16 v[30:31], v59 offset:16896
    ds_read_b64_tr_b16 v[32:33], v59 offset:49152
    ds_read_b64_tr_b16 v[34:35], v59 offset:49664
    ds_read_b64_tr_b16 v[44:45], v62 offset:16384
    ds_read_b64_tr_b16 v[46:47], v62 offset:16896
    ds_read_b64_tr_b16 v[48:49], v62 offset:49152
    ds_read_b64_tr_b16 v[50:51], v62 offset:49664
    s_waitcnt lgkmcnt(0)
    s_waitcnt vmcnt(13)
    s_barrier
    ds_write_b128 v2, v[28:31] offset:16384
    ds_write_b128 v2, v[32:35] offset:17408
    ds_write_b128 v2, v[44:47] offset:18432
    ds_write_b128 v2, v[48:51] offset:19456
    ds_read_b64_tr_b16 v[28:29], v59 offset:20480
    ds_read_b64_tr_b16 v[30:31], v59 offset:20992
    ds_read_b64_tr_b16 v[32:33], v59 offset:53248
    ds_read_b64_tr_b16 v[34:35], v59 offset:53760
    ds_read_b64_tr_b16 v[44:45], v62 offset:20480
    ds_read_b64_tr_b16 v[46:47], v62 offset:20992
    ds_read_b64_tr_b16 v[48:49], v62 offset:53248
    ds_read_b64_tr_b16 v[50:51], v62 offset:53760
    s_waitcnt lgkmcnt(0)
    s_waitcnt vmcnt(9)
    s_barrier
    s_waitcnt vmcnt(8)
    v_readfirstlane_b32 s53, v39
    s_cmp_ge_u32 s53, 32
    s_cselect_b32 s52, s35, 0x70000000
    s_mov_b32 s39, 50989056
    s_mov_b32 s59, 50993152
    s_cselect_b32 s39, s39, s52
    s_cselect_b32 s59, s59, s52
    s_cmp_lg_u32 s2, 0
    s_cselect_b32 s52, s35, s52
    buffer_load_dwordx4 v[80:83], v1, s[4:7], s52 offen offset:0 sc1
    buffer_load_dwordx4 v[84:87], v1, s[4:7], s52 offen offset:1024 sc1
    buffer_load_dwordx4 v[88:91], v1, s[4:7], s52 offen offset:2048 sc1
    buffer_load_dwordx4 v[92:95], v1, s[4:7], s52 offen offset:3072 sc1
    buffer_load_dwordx4 v[64:67], v1, s[4:7], s39 offen sc1
    buffer_load_dwordx4 v[68:71], v1, s[4:7], s59 offen sc1
    s_mul_i32 s50, s2, 128
    s_mul_i32 s51, s2, 120
    buffer_load_dword v36, off, s[24:27], s50 offset:4 sc1
    buffer_load_dword v37, off, s[24:27], s51 offset:12 sc1
    ds_write_b128 v2, v[28:31] offset:20480
    ds_write_b128 v2, v[32:35] offset:21504
    ds_write_b128 v2, v[44:47] offset:22528
    ds_write_b128 v2, v[48:51] offset:23552
    ds_read_b64_tr_b16 v[28:29], v59 offset:24576
    ds_read_b64_tr_b16 v[30:31], v59 offset:25088
    ds_read_b64_tr_b16 v[32:33], v59 offset:57344
    ds_read_b64_tr_b16 v[34:35], v59 offset:57856
    ds_read_b64_tr_b16 v[44:45], v62 offset:24576
    ds_read_b64_tr_b16 v[46:47], v62 offset:25088
    ds_read_b64_tr_b16 v[48:49], v62 offset:57344
    ds_read_b64_tr_b16 v[50:51], v62 offset:57856
    s_waitcnt lgkmcnt(0)
    s_waitcnt vmcnt(12)
    s_barrier
    ds_write_b128 v2, v[28:31] offset:24576
    ds_write_b128 v2, v[32:35] offset:25600
    ds_write_b128 v2, v[44:47] offset:26624
    ds_write_b128 v2, v[48:51] offset:27648
    ds_read_b64_tr_b16 v[28:29], v59 offset:28672
    ds_read_b64_tr_b16 v[30:31], v59 offset:29184
    ds_read_b64_tr_b16 v[32:33], v59 offset:61440
    ds_read_b64_tr_b16 v[34:35], v59 offset:61952
    ds_read_b64_tr_b16 v[44:45], v62 offset:28672
    ds_read_b64_tr_b16 v[46:47], v62 offset:29184
    ds_read_b64_tr_b16 v[48:49], v62 offset:61440
    ds_read_b64_tr_b16 v[50:51], v62 offset:61952
    s_waitcnt lgkmcnt(0)
    s_barrier
    ds_write_b128 v2, v[28:31] offset:28672
    ds_write_b128 v2, v[32:35] offset:29696
    ds_write_b128 v2, v[44:47] offset:30720
    ds_write_b128 v2, v[48:51] offset:31744
    s_waitcnt lgkmcnt(0)
    s_mov_b32 s47, 0
    s_mov_b32 m0, 16384
    s_lshl_b32 s52, s2, 5
    s_add_u32 s52, s52, 32
    s_branch L_c_w1
L_c_w0:
    s_add_u32 s47, s47, 1
    s_cmp_gt_u32 s47, 1000000
    s_cbranch_scc1 L_exit
    s_sleep 4
    s_mul_i32 s50, s2, 128
    s_mul_i32 s51, s2, 120
    buffer_load_dword v36, off, s[24:27], s50 offset:4 sc1
    buffer_load_dword v37, off, s[24:27], s51 offset:12 sc1
L_c_w1:
    s_waitcnt vmcnt(0)
    v_cmp_gt_u32 vcc, 32, v36
    s_cbranch_vccnz L_c_w0
    v_cmp_gt_u32 vcc, s52, v37
    s_cbranch_vccnz L_c_w0
    s_barrier
    s_cmp_ge_u32 s53, 32
    s_cbranch_scc1 L_c_kv_0
    s_cmp_lg_u32 s2, 0
    s_cbranch_scc1 L_c_m3_0
    buffer_load_dwordx4 v[80:83], v1, s[4:7], s35 offen offset:0 sc1
    buffer_load_dwordx4 v[84:87], v1, s[4:7], s35 offen offset:1024 sc1
    buffer_load_dwordx4 v[88:91], v1, s[4:7], s35 offen offset:2048 sc1
    buffer_load_dwordx4 v[92:95], v1, s[4:7], s35 offen offset:3072 sc1
L_c_m1_0:
    s_mov_b32 s39, 50989056
    s_mov_b32 s59, 50993152
    s_sleep 4
    buffer_load_dwordx4 v[64:67], v1, s[4:7], s39 offen sc1
    buffer_load_dwordx4 v[68:71], v1, s[4:7], s59 offen sc1
    s_add_u32 s47, s47, 1
    s_cmp_gt_u32 s47, 1000000
    s_cbranch_scc1 L_exit
L_c_kv_0:
    s_cmp_lg_u32 s2, 0
    s_cbranch_scc1 L_c_m3_0
    s_waitcnt vmcnt(0)
    v_max3_u32 v36, v64, v65, v66
    v_max3_u32 v37, v67, v68, v69
    v_max3_u32 v36, v36, v70, v71
    v_max_u32 v36, v36, v37
    v_cmp_eq_u32 vcc, -1, v36
    v_mov_b64 v[24:25], v[64:65]
    v_mov_b64 v[26:27], v[66:67]
    v_mov_b64 v[40:41], v[68:69]
    v_mov_b64 v[42:43], v[70:71]
    s_cbranch_vccnz L_c_m1_0
    s_branch L_c_m4_0
L_c_m2_0:
    s_add_u32 s47, s47, 1
    s_cmp_gt_u32 s47, 1000000
    s_cbranch_scc1 L_end
    s_sleep 4
    buffer_load_dword v9, off, s[4:7], s81 offset:4092 sc1
    s_waitcnt vmcnt(0)
    v_cmp_eq_u32 vcc, -1, v9
    s_cbranch_vccnz L_c_m2_0
    s_branch L_c_m5_0
L_c_m7_0:
    s_add_u32 s47, s47, 1
    s_cmp_gt_u32 s47, 1000000
    s_cbranch_scc1 L_end
    s_sleep 4
L_c_m5_0:
    buffer_load_dwordx4 v[80:83], v1, s[4:7], s81 offen offset:0 sc1
    buffer_load_dwordx4 v[84:87], v1, s[4:7], s81 offen offset:1024 sc1
    buffer_load_dwordx4 v[88:91], v1, s[4:7], s81 offen offset:2048 sc1
    buffer_load_dwordx4 v[92:95], v1, s[4:7], s81 offen offset:3072 sc1
L_c_m6_0:
    s_waitcnt vmcnt(0)
    v_max3_u32 v9, v80, v81, v82
    v_max3_u32 v9, v9, v83, v84
    v_max3_u32 v9, v9, v85, v86
    v_max3_u32 v9, v9, v87, v88
    v_max3_u32 v9, v9, v89, v90
    v_max3_u32 v9, v9, v91, v92
    v_max3_u32 v9, v9, v93, v94
    v_max_u32 v9, v9, v95
    v_cmp_eq_u32 vcc, -1, v9
    s_cbranch_vccnz L_c_m7_0
    s_branch L_bk_0
L_c_m3_0:
    s_waitcnt vmcnt(0)
    s_mov_b32 s81, s35
    s_mov_b32 s35, 0x70000000
L_c_m4_0:
    s_add_u32 s35, s35, 0x80000
    s_mov_b32 s46, 140
    s_mov_b64 s[54:55], 0
    v_mov_b32 v9, 32
    s_mov_b32 s47, 0
    v_mov_b64 v[56:57], 0
    v_mov_b64 v[58:59], 0
    v_mov_b64 v[60:61], 0
    v_mov_b64 v[62:63], 0
    v_mov_b64 v[64:65], 0
    v_mov_b64 v[66:67], 0
    v_mov_b64 v[68:69], 0
    v_mov_b64 v[70:71], 0
    v_mov_b64 v[72:73], 0
    v_mov_b64 v[74:75], 0
    v_mov_b64 v[76:77], 0
    v_mov_b64 v[78:79], 0
    s_waitcnt lgkmcnt(0)
L_cpe_0:
    s_cmp_lg_u32 s2, 0
    s_cbranch_scc1 L_bstep_0
    s_branch L_step_0
L_cp_1:
    s_waitcnt vmcnt(33)
    s_barrier
    ds_read_b64_tr_b16 a[208:209], v58 offset:0
    ds_read_b64_tr_b16 a[210:211], v58 offset:512
    ds_read_b64_tr_b16 a[212:213], v61 offset:0
    ds_read_b64_tr_b16 a[214:215], v61 offset:512
    ds_read_b64_tr_b16 a[216:217], v58 offset:8
    ds_read_b64_tr_b16 a[218:219], v58 offset:520
    ds_read_b64_tr_b16 a[220:221], v61 offset:8
    ds_read_b64_tr_b16 a[222:223], v61 offset:520
    s_waitcnt lgkmcnt(0)
    s_waitcnt vmcnt(29)
    s_barrier
    ds_read_b64_tr_b16 a[224:225], v58 offset:4096
    ds_read_b64_tr_b16 a[226:227], v58 offset:4608
    s_add_u32 m0, s54, 0
    s_add_u32 s55, s56, 0
    buffer_load_dwordx4 v56, s[12:15], s55 offen sc1 lds
    ds_read_b64_tr_b16 a[228:229], v61 offset:4096
    ds_read_b64_tr_b16 a[230:231], v61 offset:4608
    s_add_u32 m0, s54, 1024
    s_add_u32 s55, s56, 32768
    buffer_load_dwordx4 v52, s[12:15], s55 offen sc1 lds
    ds_read_b64_tr_b16 a[232:233], v58 offset:4104
    ds_read_b64_tr_b16 a[234:235], v58 offset:4616
    s_add_u32 m0, s54, 2048
    s_add_u32 s55, s56, 65536
    buffer_load_dwordx4 v56, s[12:15], s55 offen sc1 lds
    ds_read_b64_tr_b16 a[236:237], v61 offset:4104
    ds_read_b64_tr_b16 a[238:239], v61 offset:4616
    s_add_u32 m0, s54, 3072
    s_add_u32 s55, s56, 98304
    buffer_load_dwordx4 v52, s[12:15], s55 offen sc1 lds
    s_waitcnt lgkmcnt(0)
    s_waitcnt vmcnt(29)
    s_barrier
    ds_read_b64_tr_b16 a[240:241], v58 offset:8192
    ds_read_b64_tr_b16 a[242:243], v58 offset:8704
    s_add_u32 m0, s54, 4096
    s_add_u32 s55, s56, 524288
    buffer_load_dwordx4 v56, s[12:15], s55 offen sc1 lds
    ds_read_b64_tr_b16 a[244:245], v61 offset:8192
    ds_read_b64_tr_b16 a[246:247], v61 offset:8704
    s_add_u32 m0, s54, 5120
    s_add_u32 s55, s56, 557056
    buffer_load_dwordx4 v52, s[12:15], s55 offen sc1 lds
    ds_read_b64_tr_b16 a[248:249], v58 offset:8200
    ds_read_b64_tr_b16 a[250:251], v58 offset:8712
    s_add_u32 m0, s54, 6144
    s_add_u32 s55, s56, 589824
    buffer_load_dwordx4 v56, s[12:15], s55 offen sc1 lds
    ds_read_b64_tr_b16 a[252:253], v61 offset:8200
    ds_read_b64_tr_b16 a[254:255], v61 offset:8712
    s_add_u32 m0, s54, 7168
    s_add_u32 s55, s56, 622592
    buffer_load_dwordx4 v52, s[12:15], s55 offen sc1 lds
    s_waitcnt lgkmcnt(0)
    s_waitcnt vmcnt(29)
    s_barrier
    ds_read_b64_tr_b16 a[192:193], v58 offset:12288
    ds_read_b64_tr_b16 a[194:195], v58 offset:12800
    s_add_u32 m0, s54, 8192
    s_add_u32 s55, s56, 1048576
    buffer_load_dwordx4 v56, s[12:15], s55 offen sc1 lds
    ds_read_b64_tr_b16 a[196:197], v61 offset:12288
    ds_read_b64_tr_b16 a[198:199], v61 offset:12800
    s_add_u32 m0, s54, 9216
    s_add_u32 s55, s56, 1081344
    buffer_load_dwordx4 v52, s[12:15], s55 offen sc1 lds
    ds_read_b64_tr_b16 a[200:201], v58 offset:12296
    ds_read_b64_tr_b16 a[202:203], v58 offset:12808
    s_add_u32 m0, s54, 10240
    s_add_u32 s55, s56, 1114112
    buffer_load_dwordx4 v56, s[12:15], s55 offen sc1 lds
    ds_read_b64_tr_b16 a[204:205], v61 offset:12296
    ds_read_b64_tr_b16 a[206:207], v61 offset:12808
    s_add_u32 m0, s54, 11264
    s_add_u32 s55, s56, 1146880
    buffer_load_dwordx4 v52, s[12:15], s55 offen sc1 lds
    s_waitcnt lgkmcnt(0)
    s_waitcnt vmcnt(29)
    s_barrier
    ds_read_b64_tr_b16 v[144:145], v58 offset:16384
    ds_read_b64_tr_b16 v[146:147], v58 offset:16896
    s_add_u32 m0, s54, 12288
    s_add_u32 s55, s56, 1572864
    buffer_load_dwordx4 v56, s[12:15], s55 offen sc1 lds
    ds_read_b64_tr_b16 v[148:149], v61 offset:16384
    ds_read_b64_tr_b16 v[150:151], v61 offset:16896
    s_add_u32 m0, s54, 13312
    s_add_u32 s55, s56, 1605632
    buffer_load_dwordx4 v52, s[12:15], s55 offen sc1 lds
    ds_read_b64_tr_b16 v[152:153], v58 offset:16392
    ds_read_b64_tr_b16 v[154:155], v58 offset:16904
    s_add_u32 m0, s54, 14336
    s_add_u32 s55, s56, 1638400
    buffer_load_dwordx4 v56, s[12:15], s55 offen sc1 lds
    ds_read_b64_tr_b16 v[156:157], v61 offset:16392
    ds_read_b64_tr_b16 v[158:159], v61 offset:16904
    s_add_u32 m0, s54, 15360
    s_add_u32 s55, s56, 1671168
    buffer_load_dwordx4 v52, s[12:15], s55 offen sc1 lds
    s_waitcnt lgkmcnt(0)
    s_waitcnt vmcnt(29)
    s_barrier
    ds_read_b64_tr_b16 v[160:161], v58 offset:20480
    ds_read_b64_tr_b16 v[162:163], v58 offset:20992
    s_add_u32 m0, s54, 16384
    s_add_u32 s55, s56, 2097152
    buffer_load_dwordx4 v56, s[12:15], s55 offen sc1 lds
    ds_read_b64_tr_b16 v[164:165], v61 offset:20480
    ds_read_b64_tr_b16 v[166:167], v61 offset:20992
    s_add_u32 m0, s54, 17408
    s_add_u32 s55, s56, 2129920
    buffer_load_dwordx4 v52, s[12:15], s55 offen sc1 lds
    ds_read_b64_tr_b16 v[168:169], v58 offset:20488
    ds_read_b64_tr_b16 v[170:171], v58 offset:21000
    s_add_u32 m0, s54, 18432
    s_add_u32 s55, s56, 2162688
    buffer_load_dwordx4 v56, s[12:15], s55 offen sc1 lds
    ds_read_b64_tr_b16 v[172:173], v61 offset:20488
    ds_read_b64_tr_b16 v[174:175], v61 offset:21000
    s_add_u32 m0, s54, 19456
    s_add_u32 s55, s56, 2195456
    buffer_load_dwordx4 v52, s[12:15], s55 offen sc1 lds
    s_waitcnt lgkmcnt(0)
    s_waitcnt vmcnt(29)
    s_barrier
    ds_read_b64_tr_b16 v[176:177], v58 offset:24576
    ds_read_b64_tr_b16 v[178:179], v58 offset:25088
    s_add_u32 m0, s54, 20480
    s_add_u32 s55, s56, 2621440
    buffer_load_dwordx4 v56, s[12:15], s55 offen sc1 lds
    ds_read_b64_tr_b16 v[180:181], v61 offset:24576
    ds_read_b64_tr_b16 v[182:183], v61 offset:25088
    s_add_u32 m0, s54, 21504
    s_add_u32 s55, s56, 2654208
    buffer_load_dwordx4 v52, s[12:15], s55 offen sc1 lds
    ds_read_b64_tr_b16 v[184:185], v58 offset:24584
    ds_read_b64_tr_b16 v[186:187], v58 offset:25096
    s_add_u32 m0, s54, 22528
    s_add_u32 s55, s56, 2686976
    buffer_load_dwordx4 v56, s[12:15], s55 offen sc1 lds
    ds_read_b64_tr_b16 v[188:189], v61 offset:24584
    ds_read_b64_tr_b16 v[190:191], v61 offset:25096
    s_add_u32 m0, s54, 23552
    s_add_u32 s55, s56, 2719744
    buffer_load_dwordx4 v52, s[12:15], s55 offen sc1 lds
    s_waitcnt lgkmcnt(0)
    s_waitcnt vmcnt(29)
    s_barrier
    ds_read_b64_tr_b16 v[128:129], v58 offset:28672
    ds_read_b64_tr_b16 v[130:131], v58 offset:29184
    s_add_u32 m0, s54, 24576
    s_add_u32 s55, s56, 3145728
    buffer_load_dwordx4 v56, s[12:15], s55 offen sc1 lds
    ds_read_b64_tr_b16 v[132:133], v61 offset:28672
    ds_read_b64_tr_b16 v[134:135], v61 offset:29184
    s_add_u32 m0, s54, 25600
    s_add_u32 s55, s56, 3178496
    buffer_load_dwordx4 v52, s[12:15], s55 offen sc1 lds
    ds_read_b64_tr_b16 v[136:137], v58 offset:28680
    ds_read_b64_tr_b16 v[138:139], v58 offset:29192
    s_add_u32 m0, s54, 26624
    s_add_u32 s55, s56, 3211264
    buffer_load_dwordx4 v56, s[12:15], s55 offen sc1 lds
    ds_read_b64_tr_b16 v[140:141], v61 offset:28680
    ds_read_b64_tr_b16 v[142:143], v61 offset:29192
    s_add_u32 m0, s54, 27648
    s_add_u32 s55, s56, 3244032
    buffer_load_dwordx4 v52, s[12:15], s55 offen sc1 lds
    s_waitcnt lgkmcnt(0)
    s_waitcnt vmcnt(24)
    s_barrier
    ds_read_b64_tr_b16 a[8:9], v58 offset:0
    ds_read_b64_tr_b16 a[10:11], v58 offset:512
    s_add_u32 m0, s54, 28672
    s_add_u32 s55, s56, 3670016
    buffer_load_dwordx4 v56, s[12:15], s55 offen sc1 lds
    ds_read_b64_tr_b16 a[12:13], v61 offset:0
    ds_read_b64_tr_b16 a[14:15], v61 offset:512
    s_add_u32 m0, s54, 29696
    s_add_u32 s55, s56, 3702784
    buffer_load_dwordx4 v52, s[12:15], s55 offen sc1 lds
    ds_read_b64_tr_b16 a[24:25], v58 offset:8
    ds_read_b64_tr_b16 a[26:27], v58 offset:520
    s_add_u32 m0, s54, 30720
    s_add_u32 s55, s56, 3735552
    buffer_load_dwordx4 v56, s[12:15], s55 offen sc1 lds
    ds_read_b64_tr_b16 a[28:29], v61 offset:8
    ds_read_b64_tr_b16 a[30:31], v61 offset:520
    s_add_u32 m0, s54, 31744
    s_add_u32 s55, s56, 3768320
    buffer_load_dwordx4 v52, s[12:15], s55 offen sc1 lds
    s_waitcnt lgkmcnt(0)
    s_waitcnt vmcnt(24)
    s_barrier
    v_min_u32 v24, -2, v24
    v_min_u32 v25, -2, v25
    v_min_u32 v26, -2, v26
    v_min_u32 v27, -2, v27
    v_min_u32 v40, -2, v40
    v_min_u32 v41, -2, v41
    v_min_u32 v42, -2, v42
    v_min_u32 v43, -2, v43
    ds_read_b64_tr_b16 a[40:41], v58 offset:4096
    ds_read_b64_tr_b16 a[42:43], v58 offset:4608
    s_add_u32 m0, s54, 0
    s_add_u32 s55, s56, 0
    buffer_load_dwordx4 v56, s[8:11], s55 offen sc1 lds
    ds_read_b64_tr_b16 a[44:45], v61 offset:4096
    ds_read_b64_tr_b16 a[46:47], v61 offset:4608
    s_add_u32 m0, s54, 1024
    s_add_u32 s55, s56, 32768
    buffer_load_dwordx4 v52, s[8:11], s55 offen sc1 lds
    ds_read_b64_tr_b16 a[56:57], v58 offset:4104
    ds_read_b64_tr_b16 a[58:59], v58 offset:4616
    s_add_u32 m0, s54, 2048
    s_add_u32 s55, s56, 65536
    buffer_load_dwordx4 v56, s[8:11], s55 offen sc1 lds
    ds_read_b64_tr_b16 a[60:61], v61 offset:4104
    ds_read_b64_tr_b16 a[62:63], v61 offset:4616
    s_add_u32 m0, s54, 3072
    s_add_u32 s55, s56, 98304
    buffer_load_dwordx4 v52, s[8:11], s55 offen sc1 lds
    s_waitcnt lgkmcnt(0)
    s_waitcnt vmcnt(24)
    s_barrier
    ds_read_b64_tr_b16 a[72:73], v58 offset:8192
    ds_read_b64_tr_b16 a[74:75], v58 offset:8704
    s_add_u32 m0, s54, 4096
    s_add_u32 s55, s56, 524288
    buffer_load_dwordx4 v56, s[8:11], s55 offen sc1 lds
    ds_read_b64_tr_b16 a[76:77], v61 offset:8192
    ds_read_b64_tr_b16 a[78:79], v61 offset:8704
    s_add_u32 m0, s54, 5120
    s_add_u32 s55, s56, 557056
    buffer_load_dwordx4 v52, s[8:11], s55 offen sc1 lds
    ds_read_b64_tr_b16 a[88:89], v58 offset:8200
    ds_read_b64_tr_b16 a[90:91], v58 offset:8712
    s_add_u32 m0, s54, 6144
    s_add_u32 s55, s56, 589824
    buffer_load_dwordx4 v56, s[8:11], s55 offen sc1 lds
    ds_read_b64_tr_b16 a[92:93], v61 offset:8200
    ds_read_b64_tr_b16 a[94:95], v61 offset:8712
    s_add_u32 m0, s54, 7168
    s_add_u32 s55, s56, 622592
    buffer_load_dwordx4 v52, s[8:11], s55 offen sc1 lds
    s_waitcnt lgkmcnt(0)
    s_waitcnt vmcnt(24)
    s_barrier
    ds_read_b64_tr_b16 v[104:105], v58 offset:12288
    ds_read_b64_tr_b16 v[106:107], v58 offset:12800
    s_add_u32 m0, s54, 8192
    s_add_u32 s55, s56, 1048576
    buffer_load_dwordx4 v56, s[8:11], s55 offen sc1 lds
    ds_read_b64_tr_b16 v[108:109], v61 offset:12288
    ds_read_b64_tr_b16 v[110:111], v61 offset:12800
    s_add_u32 m0, s54, 9216
    s_add_u32 s55, s56, 1081344
    buffer_load_dwordx4 v52, s[8:11], s55 offen sc1 lds
    ds_read_b64_tr_b16 v[120:121], v58 offset:12296
    ds_read_b64_tr_b16 v[122:123], v58 offset:12808
    s_add_u32 m0, s54, 10240
    s_add_u32 s55, s56, 1114112
    buffer_load_dwordx4 v56, s[8:11], s55 offen sc1 lds
    ds_read_b64_tr_b16 v[124:125], v61 offset:12296
    ds_read_b64_tr_b16 v[126:127], v61 offset:12808
    s_add_u32 m0, s54, 11264
    s_add_u32 s55, s56, 1146880
    buffer_load_dwordx4 v52, s[8:11], s55 offen sc1 lds
    s_waitcnt lgkmcnt(0)
    s_waitcnt vmcnt(24)
    s_barrier
    ds_read_b64_tr_b16 a[104:105], v58 offset:16384
    ds_read_b64_tr_b16 a[106:107], v58 offset:16896
    s_add_u32 m0, s54, 12288
    s_add_u32 s55, s56, 1572864
    buffer_load_dwordx4 v56, s[8:11], s55 offen sc1 lds
    ds_read_b64_tr_b16 a[108:109], v61 offset:16384
    ds_read_b64_tr_b16 a[110:111], v61 offset:16896
    s_add_u32 m0, s54, 13312
    s_add_u32 s55, s56, 1605632
    buffer_load_dwordx4 v52, s[8:11], s55 offen sc1 lds
    ds_read_b64_tr_b16 a[120:121], v58 offset:16392
    ds_read_b64_tr_b16 a[122:123], v58 offset:16904
    s_add_u32 m0, s54, 14336
    s_add_u32 s55, s56, 1638400
    buffer_load_dwordx4 v56, s[8:11], s55 offen sc1 lds
    ds_read_b64_tr_b16 a[124:125], v61 offset:16392
    ds_read_b64_tr_b16 a[126:127], v61 offset:16904
    s_add_u32 m0, s54, 15360
    s_add_u32 s55, s56, 1671168
    buffer_load_dwordx4 v52, s[8:11], s55 offen sc1 lds
    s_waitcnt lgkmcnt(0)
    s_waitcnt vmcnt(24)
    s_barrier
    ds_read_b64_tr_b16 a[136:137], v58 offset:20480
    ds_read_b64_tr_b16 a[138:139], v58 offset:20992
    s_add_u32 m0, s54, 16384
    s_add_u32 s55, s56, 2097152
    buffer_load_dwordx4 v56, s[8:11], s55 offen sc1 lds
    ds_read_b64_tr_b16 a[140:141], v61 offset:20480
    ds_read_b64_tr_b16 a[142:143], v61 offset:20992
    s_add_u32 m0, s54, 17408
    s_add_u32 s55, s56, 2129920
    buffer_load_dwordx4 v52, s[8:11], s55 offen sc1 lds
    ds_read_b64_tr_b16 a[152:153], v58 offset:20488
    ds_read_b64_tr_b16 a[154:155], v58 offset:21000
    s_add_u32 m0, s54, 18432
    s_add_u32 s55, s56, 2162688
    buffer_load_dwordx4 v56, s[8:11], s55 offen sc1 lds
    ds_read_b64_tr_b16 a[156:157], v61 offset:20488
    ds_read_b64_tr_b16 a[158:159], v61 offset:21000
    s_add_u32 m0, s54, 19456
    s_add_u32 s55, s56, 2195456
    buffer_load_dwordx4 v52, s[8:11], s55 offen sc1 lds
    s_waitcnt lgkmcnt(0)
    s_waitcnt vmcnt(24)
    s_barrier
    ds_read_b64_tr_b16 a[168:169], v58 offset:24576
    ds_read_b64_tr_b16 a[170:171], v58 offset:25088
    s_add_u32 m0, s54, 20480
    s_add_u32 s55, s56, 2621440
    buffer_load_dwordx4 v56, s[8:11], s55 offen sc1 lds
    ds_read_b64_tr_b16 a[172:173], v61 offset:24576
    ds_read_b64_tr_b16 a[174:175], v61 offset:25088
    s_add_u32 m0, s54, 21504
    s_add_u32 s55, s56, 2654208
    buffer_load_dwordx4 v52, s[8:11], s55 offen sc1 lds
    ds_read_b64_tr_b16 a[184:185], v58 offset:24584
    ds_read_b64_tr_b16 a[186:187], v58 offset:25096
    s_add_u32 m0, s54, 22528
    s_add_u32 s55, s56, 2686976
    buffer_load_dwordx4 v56, s[8:11], s55 offen sc1 lds
    ds_read_b64_tr_b16 a[188:189], v61 offset:24584
    ds_read_b64_tr_b16 a[190:191], v61 offset:25096
    s_add_u32 m0, s54, 23552
    s_add_u32 s55, s56, 2719744
    buffer_load_dwordx4 v52, s[8:11], s55 offen sc1 lds
    s_waitcnt lgkmcnt(0)
    s_waitcnt vmcnt(24)
    s_barrier
    ds_read_b64_tr_b16 v[72:73], v58 offset:28672
    ds_read_b64_tr_b16 v[74:75], v58 offset:29184
    s_add_u32 m0, s54, 24576
    s_add_u32 s55, s56, 3145728
    buffer_load_dwordx4 v56, s[8:11], s55 offen sc1 lds
    ds_read_b64_tr_b16 v[76:77], v61 offset:28672
    ds_read_b64_tr_b16 v[78:79], v61 offset:29184
    s_add_u32 m0, s54, 25600
    s_add_u32 s55, s56, 3178496
    buffer_load_dwordx4 v52, s[8:11], s55 offen sc1 lds
    ds_read_b64_tr_b16 v[88:89], v58 offset:28680
    ds_read_b64_tr_b16 v[90:91], v58 offset:29192
    s_add_u32 m0, s54, 26624
    s_add_u32 s55, s56, 3211264
    buffer_load_dwordx4 v56, s[8:11], s55 offen sc1 lds
    ds_read_b64_tr_b16 v[92:93], v61 offset:28680
    ds_read_b64_tr_b16 v[94:95], v61 offset:29192
    s_add_u32 m0, s54, 27648
    s_add_u32 s55, s56, 3244032
    buffer_load_dwordx4 v52, s[8:11], s55 offen sc1 lds
    s_waitcnt lgkmcnt(0)
    s_waitcnt vmcnt(24)
    s_barrier
    ds_read_b64_tr_b16 a[0:1], v58 offset:0
    ds_read_b64_tr_b16 a[2:3], v58 offset:512
    s_add_u32 m0, s54, 28672
    s_add_u32 s55, s56, 3670016
    buffer_load_dwordx4 v56, s[8:11], s55 offen sc1 lds
    ds_read_b64_tr_b16 a[4:5], v61 offset:0
    ds_read_b64_tr_b16 a[6:7], v61 offset:512
    s_add_u32 m0, s54, 29696
    s_add_u32 s55, s56, 3702784
    buffer_load_dwordx4 v52, s[8:11], s55 offen sc1 lds
    ds_read_b64_tr_b16 a[16:17], v58 offset:8
    ds_read_b64_tr_b16 a[18:19], v58 offset:520
    s_add_u32 m0, s54, 30720
    s_add_u32 s55, s56, 3735552
    buffer_load_dwordx4 v56, s[8:11], s55 offen sc1 lds
    ds_read_b64_tr_b16 a[20:21], v61 offset:8
    ds_read_b64_tr_b16 a[22:23], v61 offset:520
    s_add_u32 m0, s54, 31744
    s_add_u32 s55, s56, 3768320
    buffer_load_dwordx4 v52, s[8:11], s55 offen sc1 lds
    s_waitcnt lgkmcnt(0)
    s_waitcnt vmcnt(24)
    s_barrier
    ds_read_b64_tr_b16 a[32:33], v58 offset:4096
    ds_read_b64_tr_b16 a[34:35], v58 offset:4608
    s_add_u32 m0, s54, 0
    s_add_u32 s55, s57, 0
    buffer_load_dwordx4 v57, s[20:23], s55 offen sc1 lds
    ds_read_b64_tr_b16 a[36:37], v61 offset:4096
    ds_read_b64_tr_b16 a[38:39], v61 offset:4608
    s_add_u32 m0, s54, 1024
    s_add_u32 s55, s57, 4096
    buffer_load_dwordx4 v53, s[20:23], s55 offen sc1 lds
    ds_read_b64_tr_b16 a[48:49], v58 offset:4104
    ds_read_b64_tr_b16 a[50:51], v58 offset:4616
    s_add_u32 m0, s54, 2048
    s_add_u32 s55, s57, 8192
    buffer_load_dwordx4 v57, s[20:23], s55 offen sc1 lds
    ds_read_b64_tr_b16 a[52:53], v61 offset:4104
    ds_read_b64_tr_b16 a[54:55], v61 offset:4616
    s_add_u32 m0, s54, 3072
    s_add_u32 s55, s57, 12288
    buffer_load_dwordx4 v53, s[20:23], s55 offen sc1 lds
    s_waitcnt lgkmcnt(0)
    s_waitcnt vmcnt(24)
    s_barrier
    ds_read_b64_tr_b16 a[64:65], v58 offset:8192
    ds_read_b64_tr_b16 a[66:67], v58 offset:8704
    s_add_u32 m0, s54, 4096
    s_add_u32 s55, s57, 65536
    buffer_load_dwordx4 v57, s[20:23], s55 offen sc1 lds
    ds_read_b64_tr_b16 a[68:69], v61 offset:8192
    ds_read_b64_tr_b16 a[70:71], v61 offset:8704
    s_add_u32 m0, s54, 5120
    s_add_u32 s55, s57, 69632
    buffer_load_dwordx4 v53, s[20:23], s55 offen sc1 lds
    ds_read_b64_tr_b16 a[80:81], v58 offset:8200
    ds_read_b64_tr_b16 a[82:83], v58 offset:8712
    s_add_u32 m0, s54, 6144
    s_add_u32 s55, s57, 73728
    buffer_load_dwordx4 v57, s[20:23], s55 offen sc1 lds
    ds_read_b64_tr_b16 a[84:85], v61 offset:8200
    ds_read_b64_tr_b16 a[86:87], v61 offset:8712
    s_add_u32 m0, s54, 7168
    s_add_u32 s55, s57, 77824
    buffer_load_dwordx4 v53, s[20:23], s55 offen sc1 lds
    s_waitcnt lgkmcnt(0)
    s_waitcnt vmcnt(24)
    s_barrier
    ds_read_b64_tr_b16 v[96:97], v58 offset:12288
    ds_read_b64_tr_b16 v[98:99], v58 offset:12800
    s_add_u32 m0, s54, 8192
    s_add_u32 s55, s57, 256
    buffer_load_dwordx4 v57, s[20:23], s55 offen sc1 lds
    ds_read_b64_tr_b16 v[100:101], v61 offset:12288
    ds_read_b64_tr_b16 v[102:103], v61 offset:12800
    s_add_u32 m0, s54, 9216
    s_add_u32 s55, s57, 4352
    buffer_load_dwordx4 v53, s[20:23], s55 offen sc1 lds
    ds_read_b64_tr_b16 v[112:113], v58 offset:12296
    ds_read_b64_tr_b16 v[114:115], v58 offset:12808
    s_add_u32 m0, s54, 10240
    s_add_u32 s55, s57, 8448
    buffer_load_dwordx4 v57, s[20:23], s55 offen sc1 lds
    ds_read_b64_tr_b16 v[116:117], v61 offset:12296
    ds_read_b64_tr_b16 v[118:119], v61 offset:12808
    s_add_u32 m0, s54, 11264
    s_add_u32 s55, s57, 12544
    buffer_load_dwordx4 v53, s[20:23], s55 offen sc1 lds
    s_waitcnt lgkmcnt(0)
    s_waitcnt vmcnt(24)
    s_barrier
    ds_read_b64_tr_b16 a[96:97], v58 offset:16384
    ds_read_b64_tr_b16 a[98:99], v58 offset:16896
    s_add_u32 m0, s54, 12288
    s_add_u32 s55, s57, 65792
    buffer_load_dwordx4 v57, s[20:23], s55 offen sc1 lds
    ds_read_b64_tr_b16 a[100:101], v61 offset:16384
    ds_read_b64_tr_b16 a[102:103], v61 offset:16896
    s_add_u32 m0, s54, 13312
    s_add_u32 s55, s57, 69888
    buffer_load_dwordx4 v53, s[20:23], s55 offen sc1 lds
    ds_read_b64_tr_b16 a[112:113], v58 offset:16392
    ds_read_b64_tr_b16 a[114:115], v58 offset:16904
    s_add_u32 m0, s54, 14336
    s_add_u32 s55, s57, 73984
    buffer_load_dwordx4 v57, s[20:23], s55 offen sc1 lds
    ds_read_b64_tr_b16 a[116:117], v61 offset:16392
    ds_read_b64_tr_b16 a[118:119], v61 offset:16904
    s_add_u32 m0, s54, 15360
    s_add_u32 s55, s57, 78080
    buffer_load_dwordx4 v53, s[20:23], s55 offen sc1 lds
    s_waitcnt lgkmcnt(0)
    s_waitcnt vmcnt(24)
    s_barrier
    ds_read_b64_tr_b16 a[128:129], v58 offset:20480
    ds_read_b64_tr_b16 a[130:131], v58 offset:20992
    s_add_u32 m0, s54, 16384
    s_add_u32 s55, s57, 512
    buffer_load_dwordx4 v57, s[20:23], s55 offen sc1 lds
    ds_read_b64_tr_b16 a[132:133], v61 offset:20480
    ds_read_b64_tr_b16 a[134:135], v61 offset:20992
    s_add_u32 m0, s54, 17408
    s_add_u32 s55, s57, 4608
    buffer_load_dwordx4 v53, s[20:23], s55 offen sc1 lds
    ds_read_b64_tr_b16 a[144:145], v58 offset:20488
    ds_read_b64_tr_b16 a[146:147], v58 offset:21000
    s_add_u32 m0, s54, 18432
    s_add_u32 s55, s57, 8704
    buffer_load_dwordx4 v57, s[20:23], s55 offen sc1 lds
    ds_read_b64_tr_b16 a[148:149], v61 offset:20488
    ds_read_b64_tr_b16 a[150:151], v61 offset:21000
    s_add_u32 m0, s54, 19456
    s_add_u32 s55, s57, 12800
    buffer_load_dwordx4 v53, s[20:23], s55 offen sc1 lds
    s_waitcnt lgkmcnt(0)
    s_waitcnt vmcnt(24)
    s_barrier
    ds_read_b64_tr_b16 a[160:161], v58 offset:24576
    ds_read_b64_tr_b16 a[162:163], v58 offset:25088
    s_add_u32 m0, s54, 20480
    s_add_u32 s55, s57, 66048
    buffer_load_dwordx4 v57, s[20:23], s55 offen sc1 lds
    ds_read_b64_tr_b16 a[164:165], v61 offset:24576
    ds_read_b64_tr_b16 a[166:167], v61 offset:25088
    s_add_u32 m0, s54, 21504
    s_add_u32 s55, s57, 70144
    buffer_load_dwordx4 v53, s[20:23], s55 offen sc1 lds
    ds_read_b64_tr_b16 a[176:177], v58 offset:24584
    ds_read_b64_tr_b16 a[178:179], v58 offset:25096
    s_add_u32 m0, s54, 22528
    s_add_u32 s55, s57, 74240
    buffer_load_dwordx4 v57, s[20:23], s55 offen sc1 lds
    ds_read_b64_tr_b16 a[180:181], v61 offset:24584
    ds_read_b64_tr_b16 a[182:183], v61 offset:25096
    s_add_u32 m0, s54, 23552
    s_add_u32 s55, s57, 78336
    buffer_load_dwordx4 v53, s[20:23], s55 offen sc1 lds
    s_waitcnt lgkmcnt(0)
    s_waitcnt vmcnt(24)
    s_barrier
    ds_read_b64_tr_b16 v[64:65], v58 offset:28672
    ds_read_b64_tr_b16 v[66:67], v58 offset:29184
    s_add_u32 m0, s54, 24576
    s_add_u32 s55, s57, 768
    buffer_load_dwordx4 v57, s[20:23], s55 offen sc1 lds
    ds_read_b64_tr_b16 v[68:69], v61 offset:28672
    ds_read_b64_tr_b16 v[70:71], v61 offset:29184
    s_add_u32 m0, s54, 25600
    s_add_u32 s55, s57, 4864
    buffer_load_dwordx4 v53, s[20:23], s55 offen sc1 lds
    ds_read_b64_tr_b16 v[80:81], v58 offset:28680
    ds_read_b64_tr_b16 v[82:83], v58 offset:29192
    s_add_u32 m0, s54, 26624
    s_add_u32 s55, s57, 8960
    buffer_load_dwordx4 v57, s[20:23], s55 offen sc1 lds
    ds_read_b64_tr_b16 v[84:85], v61 offset:28680
    ds_read_b64_tr_b16 v[86:87], v61 offset:29192
    s_add_u32 m0, s54, 27648
    s_add_u32 s55, s57, 13056
    buffer_load_dwordx4 v53, s[20:23], s55 offen sc1 lds
    s_waitcnt lgkmcnt(0)
    s_waitcnt vmcnt(24)
    s_barrier
    s_lshl_b32 s52, s2, 12
    buffer_load_dword v39, off, s[24:27], s52 offset:12 sc1
    ds_read_b64_tr_b16 v[192:193], v59 offset:0
    ds_read_b64_tr_b16 v[194:195], v59 offset:512
    s_add_u32 m0, s54, 28672
    s_add_u32 s55, s57, 66304
    buffer_load_dwordx4 v57, s[20:23], s55 offen sc1 lds
    ds_read_b64_tr_b16 v[196:197], v59 offset:32768
    ds_read_b64_tr_b16 v[198:199], v59 offset:33280
    s_add_u32 m0, s54, 29696
    s_add_u32 s55, s57, 70400
    buffer_load_dwordx4 v53, s[20:23], s55 offen sc1 lds
    ds_read_b64_tr_b16 v[200:201], v62 offset:0
    ds_read_b64_tr_b16 v[202:203], v62 offset:512
    s_add_u32 m0, s54, 30720
    s_add_u32 s55, s57, 74496
    buffer_load_dwordx4 v57, s[20:23], s55 offen sc1 lds
    ds_read_b64_tr_b16 v[204:205], v62 offset:32768
    ds_read_b64_tr_b16 v[206:207], v62 offset:33280
    s_add_u32 m0, s54, 31744
    s_add_u32 s55, s57, 78592
    buffer_load_dwordx4 v53, s[20:23], s55 offen sc1 lds
    s_waitcnt lgkmcnt(0)
    s_waitcnt vmcnt(25)
    s_barrier
    s_getpc_b64 s[50:51]
L_cpc_1:
    v_lshlrev_b32 v63, 3, v1
    s_cmp_lg_u32 s2, 0
    s_cselect_b32 s52, s45, 50864128
    s_cselect_b32 s53, s45, s37
    buffer_load_dword v36, v63, s[4:7], s52 offen sc1
    v_and_b32 v37, 0x780, v63
    v_min_u32 v63, L_step_1-L_top_1, v63
    v_add_u32 v63, L_top_1-L_cpc_1, v63
    s_mul_i32 s52, s2, L_bstep_1-L_top_1
    v_add_u32 v63, s52, v63
    buffer_load_dword v36, v37, s[4:7], s53 offen sc1
    global_load_dword v36, v63, s[50:51]
    s_mov_b32 s52, 35713024
    buffer_load_dword v36, off, s[4:7], s52 sc1
    ds_read_b64_tr_b16 v[208:209], v59 offset:4096
    ds_read_b64_tr_b16 v[210:211], v59 offset:4608
    ds_read_b64_tr_b16 v[212:213], v59 offset:36864
    ds_read_b64_tr_b16 v[214:215], v59 offset:37376
    ds_read_b64_tr_b16 v[216:217], v62 offset:4096
    ds_read_b64_tr_b16 v[218:219], v62 offset:4608
    ds_read_b64_tr_b16 v[220:221], v62 offset:36864
    ds_read_b64_tr_b16 v[222:223], v62 offset:37376
    s_waitcnt lgkmcnt(0)
    s_waitcnt vmcnt(25)
    s_barrier
    ds_read_b64_tr_b16 v[224:225], v59 offset:8192
    ds_read_b64_tr_b16 v[226:227], v59 offset:8704
    ds_read_b64_tr_b16 v[228:229], v59 offset:40960
    ds_read_b64_tr_b16 v[230:231], v59 offset:41472
    ds_read_b64_tr_b16 v[232:233], v62 offset:8192
    ds_read_b64_tr_b16 v[234:235], v62 offset:8704
    ds_read_b64_tr_b16 v[236:237], v62 offset:40960
    ds_read_b64_tr_b16 v[238:239], v62 offset:41472
    s_waitcnt lgkmcnt(0)
    s_waitcnt vmcnt(21)
    s_barrier
    ds_read_b64_tr_b16 v[240:241], v59 offset:12288
    ds_read_b64_tr_b16 v[242:243], v59 offset:12800
    ds_read_b64_tr_b16 v[244:245], v59 offset:45056
    ds_read_b64_tr_b16 v[246:247], v59 offset:45568
    ds_read_b64_tr_b16 v[248:249], v62 offset:12288
    ds_read_b64_tr_b16 v[250:251], v62 offset:12800
    ds_read_b64_tr_b16 v[252:253], v62 offset:45056
    ds_read_b64_tr_b16 v[254:255], v62 offset:45568
    s_waitcnt lgkmcnt(0)
    s_waitcnt vmcnt(17)
    s_barrier
    ds_write_b128 v2, v[96:99] offset:0
    ds_write_b128 v2, v[100:103] offset:1024
    ds_write_b128 v2, v[104:107] offset:4096
    ds_write_b128 v2, v[108:111] offset:5120
    ds_write_b128 v2, v[112:115] offset:2048
    ds_write_b128 v2, v[116:119] offset:3072
    ds_write_b128 v2, v[120:123] offset:6144
    ds_write_b128 v2, v[124:127] offset:7168
    s_waitcnt lgkmcnt(0)
    ds_write_b128 v2, v[64:67] offset:8192
    ds_write_b128 v2, v[68:71] offset:9216
    ds_write_b128 v2, v[72:75] offset:12288
    ds_write_b128 v2, v[76:79] offset:13312
    ds_write_b128 v2, v[80:83] offset:10240
    ds_write_b128 v2, v[84:87] offset:11264
    ds_write_b128 v2, v[88:91] offset:14336
    ds_write_b128 v2, v[92:95] offset:15360
    s_waitcnt lgkmcnt(0)
    ds_read_b64_tr_b16 v[28:29], v59 offset:16384
    ds_read_b64_tr_b16 v[30:31], v59 offset:16896
    ds_read_b64_tr_b16 v[32:33], v59 offset:49152
    ds_read_b64_tr_b16 v[34:35], v59 offset:49664
    ds_read_b64_tr_b16 v[44:45], v62 offset:16384
    ds_read_b64_tr_b16 v[46:47], v62 offset:16896
    ds_read_b64_tr_b16 v[48:49], v62 offset:49152
    ds_read_b64_tr_b16 v[50:51], v62 offset:49664
    s_waitcnt lgkmcnt(0)
    s_waitcnt vmcnt(13)
    s_barrier
    ds_write_b128 v2, v[28:31] offset:16384
    ds_write_b128 v2, v[32:35] offset:17408
    ds_write_b128 v2, v[44:47] offset:18432
    ds_write_b128 v2, v[48:51] offset:19456
    ds_read_b64_tr_b16 v[28:29], v59 offset:20480
    ds_read_b64_tr_b16 v[30:31], v59 offset:20992
    ds_read_b64_tr_b16 v[32:33], v59 offset:53248
    ds_read_b64_tr_b16 v[34:35], v59 offset:53760
    ds_read_b64_tr_b16 v[44:45], v62 offset:20480
    ds_read_b64_tr_b16 v[46:47], v62 offset:20992
    ds_read_b64_tr_b16 v[48:49], v62 offset:53248
    ds_read_b64_tr_b16 v[50:51], v62 offset:53760
    s_waitcnt lgkmcnt(0)
    s_waitcnt vmcnt(9)
    s_barrier
    s_waitcnt vmcnt(8)
    v_readfirstlane_b32 s53, v39
    s_cmp_ge_u32 s53, 32
    s_cselect_b32 s52, s35, 0x70000000
    s_mov_b32 s39, 50990080
    s_mov_b32 s59, 50994176
    s_cselect_b32 s39, s39, s52
    s_cselect_b32 s59, s59, s52
    s_cmp_lg_u32 s2, 0
    s_cselect_b32 s52, s35, s52
    buffer_load_dwordx4 v[80:83], v1, s[4:7], s52 offen offset:0 sc1
    buffer_load_dwordx4 v[84:87], v1, s[4:7], s52 offen offset:1024 sc1
    buffer_load_dwordx4 v[88:91], v1, s[4:7], s52 offen offset:2048 sc1
    buffer_load_dwordx4 v[92:95], v1, s[4:7], s52 offen offset:3072 sc1
    buffer_load_dwordx4 v[64:67], v1, s[4:7], s39 offen sc1
    buffer_load_dwordx4 v[68:71], v1, s[4:7], s59 offen sc1
    ds_write_b128 v2, v[28:31] offset:20480
    ds_write_b128 v2, v[32:35] offset:21504
    ds_write_b128 v2, v[44:47] offset:22528
    ds_write_b128 v2, v[48:51] offset:23552
    ds_read_b64_tr_b16 v[28:29], v59 offset:24576
    ds_read_b64_tr_b16 v[30:31], v59 offset:25088
    ds_read_b64_tr_b16 v[32:33], v59 offset:57344
    ds_read_b64_tr_b16 v[34:35], v59 offset:57856
    ds_read_b64_tr_b16 v[44:45], v62 offset:24576
    ds_read_b64_tr_b16 v[46:47], v62 offset:25088
    ds_read_b64_tr_b16 v[48:49], v62 offset:57344
    ds_read_b64_tr_b16 v[50:51], v62 offset:57856
    s_waitcnt lgkmcnt(0)
    s_waitcnt vmcnt(10)
    s_barrier
    ds_write_b128 v2, v[28:31] offset:24576
    ds_write_b128 v2, v[32:35] offset:25600
    ds_write_b128 v2, v[44:47] offset:26624
    ds_write_b128 v2, v[48:51] offset:27648
    ds_read_b64_tr_b16 v[28:29], v59 offset:28672
    ds_read_b64_tr_b16 v[30:31], v59 offset:29184
    ds_read_b64_tr_b16 v[32:33], v59 offset:61440
    ds_read_b64_tr_b16 v[34:35], v59 offset:61952
    ds_read_b64_tr_b16 v[44:45], v62 offset:28672
    ds_read_b64_tr_b16 v[46:47], v62 offset:29184
    ds_read_b64_tr_b16 v[48:49], v62 offset:61440
    ds_read_b64_tr_b16 v[50:51], v62 offset:61952
    s_waitcnt lgkmcnt(0)
    s_barrier
    ds_write_b128 v2, v[28:31] offset:28672
    ds_write_b128 v2, v[32:35] offset:29696
    ds_write_b128 v2, v[44:47] offset:30720
    ds_write_b128 v2, v[48:51] offset:31744
    s_waitcnt lgkmcnt(0)
    s_mov_b32 s47, 0
    s_mov_b32 m0, 20480
    s_barrier
    s_cmp_ge_u32 s53, 32
    s_cbranch_scc1 L_c_kv_1
    s_cmp_lg_u32 s2, 0
    s_cbranch_scc1 L_c_m3_1
    buffer_load_dwordx4 v[80:83], v1, s[4:7], s35 offen offset:0 sc1
    buffer_load_dwordx4 v[84:87], v1, s[4:7], s35 offen offset:1024 sc1
    buffer_load_dwordx4 v[88:91], v1, s[4:7], s35 offen offset:2048 sc1
    buffer_load_dwordx4 v[92:95], v1, s[4:7], s35 offen offset:3072 sc1
L_c_m1_1:
    s_mov_b32 s39, 50990080
    s_mov_b32 s59, 50994176
    s_sleep 4
    buffer_load_dwordx4 v[64:67], v1, s[4:7], s39 offen sc1
    buffer_load_dwordx4 v[68:71], v1, s[4:7], s59 offen sc1
    s_add_u32 s47, s47, 1
    s_cmp_gt_u32 s47, 1000000
    s_cbranch_scc1 L_exit
L_c_kv_1:
    s_cmp_lg_u32 s2, 0
    s_cbranch_scc1 L_c_m3_1
    s_waitcnt vmcnt(0)
    v_max3_u32 v36, v64, v65, v66
    v_max3_u32 v37, v67, v68, v69
    v_max3_u32 v36, v36, v70, v71
    v_max_u32 v36, v36, v37
    v_cmp_eq_u32 vcc, -1, v36
    v_mov_b64 v[24:25], v[64:65]
    v_mov_b64 v[26:27], v[66:67]
    v_mov_b64 v[40:41], v[68:69]
    v_mov_b64 v[42:43], v[70:71]
    s_cbranch_vccnz L_c_m1_1
    s_branch L_c_m4_1
L_c_m2_1:
    s_add_u32 s47, s47, 1
    s_cmp_gt_u32 s47, 1000000
    s_cbranch_scc1 L_end
    s_sleep 4
    buffer_load_dword v9, off, s[4:7], s81 offset:4092 sc1
    s_waitcnt vmcnt(0)
    v_cmp_eq_u32 vcc, -1, v9
    s_cbranch_vccnz L_c_m2_1
    s_branch L_c_m5_1
L_c_m7_1:
    s_add_u32 s47, s47, 1
    s_cmp_gt_u32 s47, 1000000
    s_cbranch_scc1 L_end
    s_sleep 4
L_c_m5_1:
    buffer_load_dwordx4 v[80:83], v1, s[4:7], s81 offen offset:0 sc1
    buffer_load_dwordx4 v[84:87], v1, s[4:7], s81 offen offset:1024 sc1
    buffer_load_dwordx4 v[88:91], v1, s[4:7], s81 offen offset:2048 sc1
    buffer_load_dwordx4 v[92:95], v1, s[4:7], s81 offen offset:3072 sc1
L_c_m6_1:
    s_waitcnt vmcnt(0)
    v_max3_u32 v9, v80, v81, v82
    v_max3_u32 v9, v9, v83, v84
    v_max3_u32 v9, v9, v85, v86
    v_max3_u32 v9, v9, v87, v88
    v_max3_u32 v9, v9, v89, v90
    v_max3_u32 v9, v9, v91, v92
    v_max3_u32 v9, v9, v93, v94
    v_max_u32 v9, v9, v95
    v_cmp_eq_u32 vcc, -1, v9
    s_cbranch_vccnz L_c_m7_1
    s_branch L_bk_1
L_c_m3_1:
    s_waitcnt vmcnt(0)
    s_mov_b32 s81, s35
    s_mov_b32 s35, 0x70000000
L_c_m4_1:
    s_add_u32 s35, s35, 0x80000
    s_mov_b32 s46, 140
    s_mov_b64 s[54:55], 0
    v_mov_b32 v9, 32
    s_mov_b32 s47, 0
    v_mov_b64 v[56:57], 0
    v_mov_b64 v[58:59], 0
    v_mov_b64 v[60:61], 0
    v_mov_b64 v[62:63], 0
    v_mov_b64 v[64:65], 0
    v_mov_b64 v[66:67], 0
    v_mov_b64 v[68:69], 0
    v_mov_b64 v[70:71], 0
    v_mov_b64 v[72:73], 0
    v_mov_b64 v[74:75], 0
    v_mov_b64 v[76:77], 0
    v_mov_b64 v[78:79], 0
    s_waitcnt lgkmcnt(0)
L_cpe_1:
    s_cmp_lg_u32 s2, 0
    s_cbranch_scc1 L_bstep_1
    s_branch L_step_1
L_cp_2:
    s_waitcnt vmcnt(33)
    s_barrier
    ds_read_b64_tr_b16 a[192:193], v58 offset:0
    ds_read_b64_tr_b16 a[194:195], v58 offset:512
    ds_read_b64_tr_b16 a[196:197], v61 offset:0
    ds_read_b64_tr_b16 a[198:199], v61 offset:512
    ds_read_b64_tr_b16 a[200:201], v58 offset:8
    ds_read_b64_tr_b16 a[202:203], v58 offset:520
    ds_read_b64_tr_b16 a[204:205], v61 offset:8
    ds_read_b64_tr_b16 a[206:207], v61 offset:520
    s_waitcnt lgkmcnt(0)
    s_waitcnt vmcnt(29)
    s_barrier
    ds_read_b64_tr_b16 a[208:209], v58 offset:4096
    ds_read_b64_tr_b16 a[210:211], v58 offset:4608
    s_add_u32 m0, s54, 0
    s_add_u32 s55, s56, 0
    buffer_load_dwordx4 v56, s[12:15], s55 offen sc1 lds
    ds_read_b64_tr_b16 a[212:213], v61 offset:4096
    ds_read_b64_tr_b16 a[214:215], v61 offset:4608
    s_add_u32 m0, s54, 1024
    s_add_u32 s55, s56, 32768
    buffer_load_dwordx4 v52, s[12:15], s55 offen sc1 lds
    ds_read_b64_tr_b16 a[216:217], v58 offset:4104
    ds_read_b64_tr_b16 a[218:219], v58 offset:4616
    s_add_u32 m0, s54, 2048
    s_add_u32 s55, s56, 65536
    buffer_load_dwordx4 v56, s[12:15], s55 offen sc1 lds
    ds_read_b64_tr_b16 a[220:221], v61 offset:4104
    ds_read_b64_tr_b16 a[222:223], v61 offset:4616
    s_add_u32 m0, s54, 3072
    s_add_u32 s55, s56, 98304
    buffer_load_dwordx4 v52, s[12:15], s55 offen sc1 lds
    s_waitcnt lgkmcnt(0)
    s_waitcnt vmcnt(29)
    s_barrier
    ds_read_b64_tr_b16 a[224:225], v58 offset:8192
    ds_read_b64_tr_b16 a[226:227], v58 offset:8704
    s_add_u32 m0, s54, 4096
    s_add_u32 s55, s56, 524288
    buffer_load_dwordx4 v56, s[12:15], s55 offen sc1 lds
    ds_read_b64_tr_b16 a[228:229], v61 offset:8192
    ds_read_b64_tr_b16 a[230:231], v61 offset:8704
    s_add_u32 m0, s54, 5120
    s_add_u32 s55, s56, 557056
    buffer_load_dwordx4 v52, s[12:15], s55 offen sc1 lds
    ds_read_b64_tr_b16 a[232:233], v58 offset:8200
    ds_read_b64_tr_b16 a[234:235], v58 offset:8712
    s_add_u32 m0, s54, 6144
    s_add_u32 s55, s56, 589824
    buffer_load_dwordx4 v56, s[12:15], s55 offen sc1 lds
    ds_read_b64_tr_b16 a[236:237], v61 offset:8200
    ds_read_b64_tr_b16 a[238:239], v61 offset:8712
    s_add_u32 m0, s54, 7168
    s_add_u32 s55, s56, 622592
    buffer_load_dwordx4 v52, s[12:15], s55 offen sc1 lds
    s_waitcnt lgkmcnt(0)
    s_waitcnt vmcnt(29)
    s_barrier
    ds_read_b64_tr_b16 a[240:241], v58 offset:12288
    ds_read_b64_tr_b16 a[242:243], v58 offset:12800
    s_add_u32 m0, s54, 8192
    s_add_u32 s55, s56, 1048576
    buffer_load_dwordx4 v56, s[12:15], s55 offen sc1 lds
    ds_read_b64_tr_b16 a[244:245], v61 offset:12288
    ds_read_b64_tr_b16 a[246:247], v61 offset:12800
    s_add_u32 m0, s54, 9216
    s_add_u32 s55, s56, 1081344
    buffer_load_dwordx4 v52, s[12:15], s55 offen sc1 lds
    ds_read_b64_tr_b16 a[248:249], v58 offset:12296
    ds_read_b64_tr_b16 a[250:251], v58 offset:12808
    s_add_u32 m0, s54, 10240
    s_add_u32 s55, s56, 1114112
    buffer_load_dwordx4 v56, s[12:15], s55 offen sc1 lds
    ds_read_b64_tr_b16 a[252:253], v61 offset:12296
    ds_read_b64_tr_b16 a[254:255], v61 offset:12808
    s_add_u32 m0, s54, 11264
    s_add_u32 s55, s56, 1146880
    buffer_load_dwordx4 v52, s[12:15], s55 offen sc1 lds
    s_waitcnt lgkmcnt(0)
    s_waitcnt vmcnt(29)
    s_barrier
    ds_read_b64_tr_b16 v[128:129], v58 offset:16384
    ds_read_b64_tr_b16 v[130:131], v58 offset:16896
    s_add_u32 m0, s54, 12288
    s_add_u32 s55, s56, 1572864
    buffer_load_dwordx4 v56, s[12:15], s55 offen sc1 lds
    ds_read_b64_tr_b16 v[132:133], v61 offset:16384
    ds_read_b64_tr_b16 v[134:135], v61 offset:16896
    s_add_u32 m0, s54, 13312
    s_add_u32 s55, s56, 1605632
    buffer_load_dwordx4 v52, s[12:15], s55 offen sc1 lds
    ds_read_b64_tr_b16 v[136:137], v58 offset:16392
    ds_read_b64_tr_b16 v[138:139], v58 offset:16904
    s_add_u32 m0, s54, 14336
    s_add_u32 s55, s56, 1638400
    buffer_load_dwordx4 v56, s[12:15], s55 offen sc1 lds
    ds_read_b64_tr_b16 v[140:141], v61 offset:16392
    ds_read_b64_tr_b16 v[142:143], v61 offset:16904
    s_add_u32 m0, s54, 15360
    s_add_u32 s55, s56, 1671168
    buffer_load_dwordx4 v52, s[12:15], s55 offen sc1 lds
    s_waitcnt lgkmcnt(0)
    s_waitcnt vmcnt(29)
    s_barrier
    ds_read_b64_tr_b16 v[144:145], v58 offset:20480
    ds_read_b64_tr_b16 v[146:147], v58 offset:20992
    s_add_u32 m0, s54, 16384
    s_add_u32 s55, s56, 2097152
    buffer_load_dwordx4 v56, s[12:15], s55 offen sc1 lds
    ds_read_b64_tr_b16 v[148:149], v61 offset:20480
    ds_read_b64_tr_b16 v[150:151], v61 offset:20992
    s_add_u32 m0, s54, 17408
    s_add_u32 s55, s56, 2129920
    buffer_load_dwordx4 v52, s[12:15], s55 offen sc1 lds
    ds_read_b64_tr_b16 v[152:153], v58 offset:20488
    ds_read_b64_tr_b16 v[154:155], v58 offset:21000
    s_add_u32 m0, s54, 18432
    s_add_u32 s55, s56, 2162688
    buffer_load_dwordx4 v56, s[12:15], s55 offen sc1 lds
    ds_read_b64_tr_b16 v[156:157], v61 offset:20488
    ds_read_b64_tr_b16 v[158:159], v61 offset:21000
    s_add_u32 m0, s54, 19456
    s_add_u32 s55, s56, 2195456
    buffer_load_dwordx4 v52, s[12:15], s55 offen sc1 lds
    s_waitcnt lgkmcnt(0)
    s_waitcnt vmcnt(29)
    s_barrier
    ds_read_b64_tr_b16 v[160:161], v58 offset:24576
    ds_read_b64_tr_b16 v[162:163], v58 offset:25088
    s_add_u32 m0, s54, 20480
    s_add_u32 s55, s56, 2621440
    buffer_load_dwordx4 v56, s[12:15], s55 offen sc1 lds
    ds_read_b64_tr_b16 v[164:165], v61 offset:24576
    ds_read_b64_tr_b16 v[166:167], v61 offset:25088
    s_add_u32 m0, s54, 21504
    s_add_u32 s55, s56, 2654208
    buffer_load_dwordx4 v52, s[12:15], s55 offen sc1 lds
    ds_read_b64_tr_b16 v[168:169], v58 offset:24584
    ds_read_b64_tr_b16 v[170:171], v58 offset:25096
    s_add_u32 m0, s54, 22528
    s_add_u32 s55, s56, 2686976
    buffer_load_dwordx4 v56, s[12:15], s55 offen sc1 lds
    ds_read_b64_tr_b16 v[172:173], v61 offset:24584
    ds_read_b64_tr_b16 v[174:175], v61 offset:25096
    s_add_u32 m0, s54, 23552
    s_add_u32 s55, s56, 2719744
    buffer_load_dwordx4 v52, s[12:15], s55 offen sc1 lds
    s_waitcnt lgkmcnt(0)
    s_waitcnt vmcnt(29)
    s_barrier
    ds_read_b64_tr_b16 v[176:177], v58 offset:28672
    ds_read_b64_tr_b16 v[178:179], v58 offset:29184
    s_add_u32 m0, s54, 24576
    s_add_u32 s55, s56, 3145728
    buffer_load_dwordx4 v56, s[12:15], s55 offen sc1 lds
    ds_read_b64_tr_b16 v[180:181], v61 offset:28672
    ds_read_b64_tr_b16 v[182:183], v61 offset:29184
    s_add_u32 m0, s54, 25600
    s_add_u32 s55, s56, 3178496
    buffer_load_dwordx4 v52, s[12:15], s55 offen sc1 lds
    ds_read_b64_tr_b16 v[184:185], v58 offset:28680
    ds_read_b64_tr_b16 v[186:187], v58 offset:29192
    s_add_u32 m0, s54, 26624
    s_add_u32 s55, s56, 3211264
    buffer_load_dwordx4 v56, s[12:15], s55 offen sc1 lds
    ds_read_b64_tr_b16 v[188:189], v61 offset:28680
    ds_read_b64_tr_b16 v[190:191], v61 offset:29192
    s_add_u32 m0, s54, 27648
    s_add_u32 s55, s56, 3244032
    buffer_load_dwordx4 v52, s[12:15], s55 offen sc1 lds
    s_waitcnt lgkmcnt(0)
    s_waitcnt vmcnt(24)
    s_barrier
    ds_read_b64_tr_b16 v[104:105], v58 offset:0
    ds_read_b64_tr_b16 v[106:107], v58 offset:512
    s_add_u32 m0, s54, 28672
    s_add_u32 s55, s56, 3670016
    buffer_load_dwordx4 v56, s[12:15], s55 offen sc1 lds
    ds_read_b64_tr_b16 v[108:109], v61 offset:0
    ds_read_b64_tr_b16 v[110:111], v61 offset:512
    s_add_u32 m0, s54, 29696
    s_add_u32 s55, s56, 3702784
    buffer_load_dwordx4 v52, s[12:15], s55 offen sc1 lds
    ds_read_b64_tr_b16 v[120:121], v58 offset:8
    ds_read_b64_tr_b16 v[122:123], v58 offset:520
    s_add_u32 m0, s54, 30720
    s_add_u32 s55, s56, 3735552
    buffer_load_dwordx4 v56, s[12:15], s55 offen sc1 lds
    ds_read_b64_tr_b16 v[124:125], v61 offset:8
    ds_read_b64_tr_b16 v[126:127], v61 offset:520
    s_add_u32 m0, s54, 31744
    s_add_u32 s55, s56, 3768320
    buffer_load_dwordx4 v52, s[12:15], s55 offen sc1 lds
    s_waitcnt lgkmcnt(0)
    s_waitcnt vmcnt(24)
    s_barrier
    v_min_u32 v24, -2, v24
    v_min_u32 v25, -2, v25
    v_min_u32 v26, -2, v26
    v_min_u32 v27, -2, v27
    v_min_u32 v40, -2, v40
    v_min_u32 v41, -2, v41
    v_min_u32 v42, -2, v42
    v_min_u32 v43, -2, v43
    ds_read_b64_tr_b16 a[8:9], v58 offset:4096
    ds_read_b64_tr_b16 a[10:11], v58 offset:4608
    s_add_u32 m0, s54, 0
    s_add_u32 s55, s56, 0
    buffer_load_dwordx4 v56, s[8:11], s55 offen sc1 lds
    ds_read_b64_tr_b16 a[12:13], v61 offset:4096
    ds_read_b64_tr_b16 a[14:15], v61 offset:4608
    s_add_u32 m0, s54, 1024
    s_add_u32 s55, s56, 32768
    buffer_load_dwordx4 v52, s[8:11], s55 offen sc1 lds
    ds_read_b64_tr_b16 a[24:25], v58 offset:4104
    ds_read_b64_tr_b16 a[26:27], v58 offset:4616
    s_add_u32 m0, s54, 2048
    s_add_u32 s55, s56, 65536
    buffer_load_dwordx4 v56, s[8:11], s55 offen sc1 lds
    ds_read_b64_tr_b16 a[28:29], v61 offset:4104
    ds_read_b64_tr_b16 a[30:31], v61 offset:4616
    s_add_u32 m0, s54, 3072
    s_add_u32 s55, s56, 98304
    buffer_load_dwordx4 v52, s[8:11], s55 offen sc1 lds
    s_waitcnt lgkmcnt(0)
    s_waitcnt vmcnt(24)
    s_barrier
    ds_read_b64_tr_b16 a[40:41], v58 offset:8192
    ds_read_b64_tr_b16 a[42:43], v58 offset:8704
    s_add_u32 m0, s54, 4096
    s_add_u32 s55, s56, 524288
    buffer_load_dwordx4 v56, s[8:11], s55 offen sc1 lds
    ds_read_b64_tr_b16 a[44:45], v61 offset:8192
    ds_read_b64_tr_b16 a[46:47], v61 offset:8704
    s_add_u32 m0, s54, 5120
    s_add_u32 s55, s56, 557056
    buffer_load_dwordx4 v52, s[8:11], s55 offen sc1 lds
    ds_read_b64_tr_b16 a[56:57], v58 offset:8200
    ds_read_b64_tr_b16 a[58:59], v58 offset:8712
    s_add_u32 m0, s54, 6144
    s_add_u32 s55, s56, 589824
    buffer_load_dwordx4 v56, s[8:11], s55 offen sc1 lds
    ds_read_b64_tr_b16 a[60:61], v61 offset:8200
    ds_read_b64_tr_b16 a[62:63], v61 offset:8712
    s_add_u32 m0, s54, 7168
    s_add_u32 s55, s56, 622592
    buffer_load_dwordx4 v52, s[8:11], s55 offen sc1 lds
    s_waitcnt lgkmcnt(0)
    s_waitcnt vmcnt(24)
    s_barrier
    ds_read_b64_tr_b16 a[72:73], v58 offset:12288
    ds_read_b64_tr_b16 a[74:75], v58 offset:12800
    s_add_u32 m0, s54, 8192
    s_add_u32 s55, s56, 1048576
    buffer_load_dwordx4 v56, s[8:11], s55 offen sc1 lds
    ds_read_b64_tr_b16 a[76:77], v61 offset:12288
    ds_read_b64_tr_b16 a[78:79], v61 offset:12800
    s_add_u32 m0, s54, 9216
    s_add_u32 s55, s56, 1081344
    buffer_load_dwordx4 v52, s[8:11], s55 offen sc1 lds
    ds_read_b64_tr_b16 a[88:89], v58 offset:12296
    ds_read_b64_tr_b16 a[90:91], v58 offset:12808
    s_add_u32 m0, s54, 10240
    s_add_u32 s55, s56, 1114112
    buffer_load_dwordx4 v56, s[8:11], s55 offen sc1 lds
    ds_read_b64_tr_b16 a[92:93], v61 offset:12296
    ds_read_b64_tr_b16 a[94:95], v61 offset:12808
    s_add_u32 m0, s54, 11264
    s_add_u32 s55, s56, 1146880
    buffer_load_dwordx4 v52, s[8:11], s55 offen sc1 lds
    s_waitcnt lgkmcnt(0)
    s_waitcnt vmcnt(24)
    s_barrier
    ds_read_b64_tr_b16 v[72:73], v58 offset:16384
    ds_read_b64_tr_b16 v[74:75], v58 offset:16896
    s_add_u32 m0, s54, 12288
    s_add_u32 s55, s56, 1572864
    buffer_load_dwordx4 v56, s[8:11], s55 offen sc1 lds
    ds_read_b64_tr_b16 v[76:77], v61 offset:16384
    ds_read_b64_tr_b16 v[78:79], v61 offset:16896
    s_add_u32 m0, s54, 13312
    s_add_u32 s55, s56, 1605632
    buffer_load_dwordx4 v52, s[8:11], s55 offen sc1 lds
    ds_read_b64_tr_b16 v[88:89], v58 offset:16392
    ds_read_b64_tr_b16 v[90:91], v58 offset:16904
    s_add_u32 m0, s54, 14336
    s_add_u32 s55, s56, 1638400
    buffer_load_dwordx4 v56, s[8:11], s55 offen sc1 lds
    ds_read_b64_tr_b16 v[92:93], v61 offset:16392
    ds_read_b64_tr_b16 v[94:95], v61 offset:16904
    s_add_u32 m0, s54, 15360
    s_add_u32 s55, s56, 1671168
    buffer_load_dwordx4 v52, s[8:11], s55 offen sc1 lds
    s_waitcnt lgkmcnt(0)
    s_waitcnt vmcnt(24)
    s_barrier
    ds_read_b64_tr_b16 a[104:105], v58 offset:20480
    ds_read_b64_tr_b16 a[106:107], v58 offset:20992
    s_add_u32 m0, s54, 16384
    s_add_u32 s55, s56, 2097152
    buffer_load_dwordx4 v56, s[8:11], s55 offen sc1 lds
    ds_read_b64_tr_b16 a[108:109], v61 offset:20480
    ds_read_b64_tr_b16 a[110:111], v61 offset:20992
    s_add_u32 m0, s54, 17408
    s_add_u32 s55, s56, 2129920
    buffer_load_dwordx4 v52, s[8:11], s55 offen sc1 lds
    ds_read_b64_tr_b16 a[120:121], v58 offset:20488
    ds_read_b64_tr_b16 a[122:123], v58 offset:21000
    s_add_u32 m0, s54, 18432
    s_add_u32 s55, s56, 2162688
    buffer_load_dwordx4 v56, s[8:11], s55 offen sc1 lds
    ds_read_b64_tr_b16 a[124:125], v61 offset:20488
    ds_read_b64_tr_b16 a[126:127], v61 offset:21000
    s_add_u32 m0, s54, 19456
    s_add_u32 s55, s56, 2195456
    buffer_load_dwordx4 v52, s[8:11], s55 offen sc1 lds
    s_waitcnt lgkmcnt(0)
    s_waitcnt vmcnt(24)
    s_barrier
    ds_read_b64_tr_b16 a[136:137], v58 offset:24576
    ds_read_b64_tr_b16 a[138:139], v58 offset:25088
    s_add_u32 m0, s54, 20480
    s_add_u32 s55, s56, 2621440
    buffer_load_dwordx4 v56, s[8:11], s55 offen sc1 lds
    ds_read_b64_tr_b16 a[140:141], v61 offset:24576
    ds_read_b64_tr_b16 a[142:143], v61 offset:25088
    s_add_u32 m0, s54, 21504
    s_add_u32 s55, s56, 2654208
    buffer_load_dwordx4 v52, s[8:11], s55 offen sc1 lds
    ds_read_b64_tr_b16 a[152:153], v58 offset:24584
    ds_read_b64_tr_b16 a[154:155], v58 offset:25096
    s_add_u32 m0, s54, 22528
    s_add_u32 s55, s56, 2686976
    buffer_load_dwordx4 v56, s[8:11], s55 offen sc1 lds
    ds_read_b64_tr_b16 a[156:157], v61 offset:24584
    ds_read_b64_tr_b16 a[158:159], v61 offset:25096
    s_add_u32 m0, s54, 23552
    s_add_u32 s55, s56, 2719744
    buffer_load_dwordx4 v52, s[8:11], s55 offen sc1 lds
    s_waitcnt lgkmcnt(0)
    s_waitcnt vmcnt(24)
    s_barrier
    ds_read_b64_tr_b16 a[168:169], v58 offset:28672
    ds_read_b64_tr_b16 a[170:171], v58 offset:29184
    s_add_u32 m0, s54, 24576
    s_add_u32 s55, s56, 3145728
    buffer_load_dwordx4 v56, s[8:11], s55 offen sc1 lds
    ds_read_b64_tr_b16 a[172:173], v61 offset:28672
    ds_read_b64_tr_b16 a[174:175], v61 offset:29184
    s_add_u32 m0, s54, 25600
    s_add_u32 s55, s56, 3178496
    buffer_load_dwordx4 v52, s[8:11], s55 offen sc1 lds
    ds_read_b64_tr_b16 a[184:185], v58 offset:28680
    ds_read_b64_tr_b16 a[186:187], v58 offset:29192
    s_add_u32 m0, s54, 26624
    s_add_u32 s55, s56, 3211264
    buffer_load_dwordx4 v56, s[8:11], s55 offen sc1 lds
    ds_read_b64_tr_b16 a[188:189], v61 offset:28680
    ds_read_b64_tr_b16 a[190:191], v61 offset:29192
    s_add_u32 m0, s54, 27648
    s_add_u32 s55, s56, 3244032
    buffer_load_dwordx4 v52, s[8:11], s55 offen sc1 lds
    s_waitcnt lgkmcnt(0)
    s_waitcnt vmcnt(24)
    s_barrier
    ds_read_b64_tr_b16 v[96:97], v58 offset:0
    ds_read_b64_tr_b16 v[98:99], v58 offset:512
    s_add_u32 m0, s54, 28672
    s_add_u32 s55, s56, 3670016
    buffer_load_dwordx4 v56, s[8:11], s55 offen sc1 lds
    ds_read_b64_tr_b16 v[100:101], v61 offset:0
    ds_read_b64_tr_b16 v[102:103], v61 offset:512
    s_add_u32 m0, s54, 29696
    s_add_u32 s55, s56, 3702784
    buffer_load_dwordx4 v52, s[8:11], s55 offen sc1 lds
    ds_read_b64_tr_b16 v[112:113], v58 offset:8
    ds_read_b64_tr_b16 v[114:115], v58 offset:520
    s_add_u32 m0, s54, 30720
    s_add_u32 s55, s56, 3735552
    buffer_load_dwordx4 v56, s[8:11], s55 offen sc1 lds
    ds_read_b64_tr_b16 v[116:117], v61 offset:8
    ds_read_b64_tr_b16 v[118:119], v61 offset:520
    s_add_u32 m0, s54, 31744
    s_add_u32 s55, s56, 3768320
    buffer_load_dwordx4 v52, s[8:11], s55 offen sc1 lds
    s_waitcnt lgkmcnt(0)
    s_waitcnt vmcnt(24)
    s_barrier
    ds_read_b64_tr_b16 a[0:1], v58 offset:4096
    ds_read_b64_tr_b16 a[2:3], v58 offset:4608
    s_add_u32 m0, s54, 0
    s_add_u32 s55, s57, 0
    buffer_load_dwordx4 v57, s[20:23], s55 offen sc1 lds
    ds_read_b64_tr_b16 a[4:5], v61 offset:4096
    ds_read_b64_tr_b16 a[6:7], v61 offset:4608
    s_add_u32 m0, s54, 1024
    s_add_u32 s55, s57, 4096
    buffer_load_dwordx4 v53, s[20:23], s55 offen sc1 lds
    ds_read_b64_tr_b16 a[16:17], v58 offset:4104
    ds_read_b64_tr_b16 a[18:19], v58 offset:4616
    s_add_u32 m0, s54, 2048
    s_add_u32 s55, s57, 8192
    buffer_load_dwordx4 v57, s[20:23], s55 offen sc1 lds
    ds_read_b64_tr_b16 a[20:21], v61 offset:4104
    ds_read_b64_tr_b16 a[22:23], v61 offset:4616
    s_add_u32 m0, s54, 3072
    s_add_u32 s55, s57, 12288
    buffer_load_dwordx4 v53, s[20:23], s55 offen sc1 lds
    s_waitcnt lgkmcnt(0)
    s_waitcnt vmcnt(24)
    s_barrier
    ds_read_b64_tr_b16 a[32:33], v58 offset:8192
    ds_read_b64_tr_b16 a[34:35], v58 offset:8704
    s_add_u32 m0, s54, 4096
    s_add_u32 s55, s57, 65536
    buffer_load_dwordx4 v57, s[20:23], s55 offen sc1 lds
    ds_read_b64_tr_b16 a[36:37], v61 offset:8192
    ds_read_b64_tr_b16 a[38:39], v61 offset:8704
    s_add_u32 m0, s54, 5120
    s_add_u32 s55, s57, 69632
    buffer_load_dwordx4 v53, s[20:23], s55 offen sc1 lds
    ds_read_b64_tr_b16 a[48:49], v58 offset:8200
    ds_read_b64_tr_b16 a[50:51], v58 offset:8712
    s_add_u32 m0, s54, 6144
    s_add_u32 s55, s57, 73728
    buffer_load_dwordx4 v57, s[20:23], s55 offen sc1 lds
    ds_read_b64_tr_b16 a[52:53], v61 offset:8200
    ds_read_b64_tr_b16 a[54:55], v61 offset:8712
    s_add_u32 m0, s54, 7168
    s_add_u32 s55, s57, 77824
    buffer_load_dwordx4 v53, s[20:23], s55 offen sc1 lds
    s_waitcnt lgkmcnt(0)
    s_waitcnt vmcnt(24)
    s_barrier
    ds_read_b64_tr_b16 a[64:65], v58 offset:12288
    ds_read_b64_tr_b16 a[66:67], v58 offset:12800
    s_add_u32 m0, s54, 8192
    s_add_u32 s55, s57, 256
    buffer_load_dwordx4 v57, s[20:23], s55 offen sc1 lds
    ds_read_b64_tr_b16 a[68:69], v61 offset:12288
    ds_read_b64_tr_b16 a[70:71], v61 offset:12800
    s_add_u32 m0, s54, 9216
    s_add_u32 s55, s57, 4352
    buffer_load_dwordx4 v53, s[20:23], s55 offen sc1 lds
    ds_read_b64_tr_b16 a[80:81], v58 offset:12296
    ds_read_b64_tr_b16 a[82:83], v58 offset:12808
    s_add_u32 m0, s54, 10240
    s_add_u32 s55, s57, 8448
    buffer_load_dwordx4 v57, s[20:23], s55 offen sc1 lds
    ds_read_b64_tr_b16 a[84:85], v61 offset:12296
    ds_read_b64_tr_b16 a[86:87], v61 offset:12808
    s_add_u32 m0, s54, 11264
    s_add_u32 s55, s57, 12544
    buffer_load_dwordx4 v53, s[20:23], s55 offen sc1 lds
    s_waitcnt lgkmcnt(0)
    s_waitcnt vmcnt(24)
    s_barrier
    ds_read_b64_tr_b16 v[64:65], v58 offset:16384
    ds_read_b64_tr_b16 v[66:67], v58 offset:16896
    s_add_u32 m0, s54, 12288
    s_add_u32 s55, s57, 65792
    buffer_load_dwordx4 v57, s[20:23], s55 offen sc1 lds
    ds_read_b64_tr_b16 v[68:69], v61 offset:16384
    ds_read_b64_tr_b16 v[70:71], v61 offset:16896
    s_add_u32 m0, s54, 13312
    s_add_u32 s55, s57, 69888
    buffer_load_dwordx4 v53, s[20:23], s55 offen sc1 lds
    ds_read_b64_tr_b16 v[80:81], v58 offset:16392
    ds_read_b64_tr_b16 v[82:83], v58 offset:16904
    s_add_u32 m0, s54, 14336
    s_add_u32 s55, s57, 73984
    buffer_load_dwordx4 v57, s[20:23], s55 offen sc1 lds
    ds_read_b64_tr_b16 v[84:85], v61 offset:16392
    ds_read_b64_tr_b16 v[86:87], v61 offset:16904
    s_add_u32 m0, s54, 15360
    s_add_u32 s55, s57, 78080
    buffer_load_dwordx4 v53, s[20:23], s55 offen sc1 lds
    s_waitcnt lgkmcnt(0)
    s_waitcnt vmcnt(24)
    s_barrier
    ds_read_b64_tr_b16 a[96:97], v58 offset:20480
    ds_read_b64_tr_b16 a[98:99], v58 offset:20992
    s_add_u32 m0, s54, 16384
    s_add_u32 s55, s57, 512
    buffer_load_dwordx4 v57, s[20:23], s55 offen sc1 lds
    ds_read_b64_tr_b16 a[100:101], v61 offset:20480
    ds_read_b64_tr_b16 a[102:103], v61 offset:20992
    s_add_u32 m0, s54, 17408
    s_add_u32 s55, s57, 4608
    buffer_load_dwordx4 v53, s[20:23], s55 offen sc1 lds
    ds_read_b64_tr_b16 a[112:113], v58 offset:20488
    ds_read_b64_tr_b16 a[114:115], v58 offset:21000
    s_add_u32 m0, s54, 18432
    s_add_u32 s55, s57, 8704
    buffer_load_dwordx4 v57, s[20:23], s55 offen sc1 lds
    ds_read_b64_tr_b16 a[116:117], v61 offset:20488
    ds_read_b64_tr_b16 a[118:119], v61 offset:21000
    s_add_u32 m0, s54, 19456
    s_add_u32 s55, s57, 12800
    buffer_load_dwordx4 v53, s[20:23], s55 offen sc1 lds
    s_waitcnt lgkmcnt(0)
    s_waitcnt vmcnt(24)
    s_barrier
    ds_read_b64_tr_b16 a[128:129], v58 offset:24576
    ds_read_b64_tr_b16 a[130:131], v58 offset:25088
    s_add_u32 m0, s54, 20480
    s_add_u32 s55, s57, 66048
    buffer_load_dwordx4 v57, s[20:23], s55 offen sc1 lds
    ds_read_b64_tr_b16 a[132:133], v61 offset:24576
    ds_read_b64_tr_b16 a[134:135], v61 offset:25088
    s_add_u32 m0, s54, 21504
    s_add_u32 s55, s57, 70144
    buffer_load_dwordx4 v53, s[20:23], s55 offen sc1 lds
    ds_read_b64_tr_b16 a[144:145], v58 offset:24584
    ds_read_b64_tr_b16 a[146:147], v58 offset:25096
    s_add_u32 m0, s54, 22528
    s_add_u32 s55, s57, 74240
    buffer_load_dwordx4 v57, s[20:23], s55 offen sc1 lds
    ds_read_b64_tr_b16 a[148:149], v61 offset:24584
    ds_read_b64_tr_b16 a[150:151], v61 offset:25096
    s_add_u32 m0, s54, 23552
    s_add_u32 s55, s57, 78336
    buffer_load_dwordx4 v53, s[20:23], s55 offen sc1 lds
    s_waitcnt lgkmcnt(0)
    s_waitcnt vmcnt(24)
    s_barrier
    ds_read_b64_tr_b16 a[160:161], v58 offset:28672
    ds_read_b64_tr_b16 a[162:163], v58 offset:29184
    s_add_u32 m0, s54, 24576
    s_add_u32 s55, s57, 768
    buffer_load_dwordx4 v57, s[20:23], s55 offen sc1 lds
    ds_read_b64_tr_b16 a[164:165], v61 offset:28672
    ds_read_b64_tr_b16 a[166:167], v61 offset:29184
    s_add_u32 m0, s54, 25600
    s_add_u32 s55, s57, 4864
    buffer_load_dwordx4 v53, s[20:23], s55 offen sc1 lds
    ds_read_b64_tr_b16 a[176:177], v58 offset:28680
    ds_read_b64_tr_b16 a[178:179], v58 offset:29192
    s_add_u32 m0, s54, 26624
    s_add_u32 s55, s57, 8960
    buffer_load_dwordx4 v57, s[20:23], s55 offen sc1 lds
    ds_read_b64_tr_b16 a[180:181], v61 offset:28680
    ds_read_b64_tr_b16 a[182:183], v61 offset:29192
    s_add_u32 m0, s54, 27648
    s_add_u32 s55, s57, 13056
    buffer_load_dwordx4 v53, s[20:23], s55 offen sc1 lds
    s_waitcnt lgkmcnt(0)
    s_waitcnt vmcnt(24)
    s_barrier
    s_lshl_b32 s52, s2, 12
    buffer_load_dword v39, off, s[24:27], s52 offset:12 sc1
    ds_read_b64_tr_b16 v[192:193], v59 offset:0
    ds_read_b64_tr_b16 v[194:195], v59 offset:512
    s_add_u32 m0, s54, 28672
    s_add_u32 s55, s57, 66304
    buffer_load_dwordx4 v57, s[20:23], s55 offen sc1 lds
    ds_read_b64_tr_b16 v[196:197], v59 offset:32768
    ds_read_b64_tr_b16 v[198:199], v59 offset:33280
    s_add_u32 m0, s54, 29696
    s_add_u32 s55, s57, 70400
    buffer_load_dwordx4 v53, s[20:23], s55 offen sc1 lds
    ds_read_b64_tr_b16 v[200:201], v62 offset:0
    ds_read_b64_tr_b16 v[202:203], v62 offset:512
    s_add_u32 m0, s54, 30720
    s_add_u32 s55, s57, 74496
    buffer_load_dwordx4 v57, s[20:23], s55 offen sc1 lds
    ds_read_b64_tr_b16 v[204:205], v62 offset:32768
    ds_read_b64_tr_b16 v[206:207], v62 offset:33280
    s_add_u32 m0, s54, 31744
    s_add_u32 s55, s57, 78592
    buffer_load_dwordx4 v53, s[20:23], s55 offen sc1 lds
    s_waitcnt lgkmcnt(0)
    s_waitcnt vmcnt(25)
    s_barrier
    s_getpc_b64 s[50:51]
L_cpc_2:
    v_lshlrev_b32 v63, 3, v1
    s_cmp_lg_u32 s2, 0
    s_cselect_b32 s52, s45, 50872320
    s_cselect_b32 s53, s45, s37
    buffer_load_dword v36, v63, s[4:7], s52 offen sc1
    v_and_b32 v37, 0x780, v63
    v_min_u32 v63, L_step_2-L_top_2, v63
    v_add_u32 v63, L_top_2-L_cpc_2, v63
    s_mul_i32 s52, s2, L_bstep_2-L_top_2
    v_add_u32 v63, s52, v63
    buffer_load_dword v36, v37, s[4:7], s53 offen sc1
    global_load_dword v36, v63, s[50:51]
    ds_read_b64_tr_b16 v[208:209], v59 offset:4096
    ds_read_b64_tr_b16 v[210:211], v59 offset:4608
    ds_read_b64_tr_b16 v[212:213], v59 offset:36864
    ds_read_b64_tr_b16 v[214:215], v59 offset:37376
    ds_read_b64_tr_b16 v[216:217], v62 offset:4096
    ds_read_b64_tr_b16 v[218:219], v62 offset:4608
    ds_read_b64_tr_b16 v[220:221], v62 offset:36864
    ds_read_b64_tr_b16 v[222:223], v62 offset:37376
    s_waitcnt lgkmcnt(0)
    s_waitcnt vmcnt(24)
    s_barrier
    ds_read_b64_tr_b16 v[224:225], v59 offset:8192
    ds_read_b64_tr_b16 v[226:227], v59 offset:8704
    ds_read_b64_tr_b16 v[228:229], v59 offset:40960
    ds_read_b64_tr_b16 v[230:231], v59 offset:41472
    ds_read_b64_tr_b16 v[232:233], v62 offset:8192
    ds_read_b64_tr_b16 v[234:235], v62 offset:8704
    ds_read_b64_tr_b16 v[236:237], v62 offset:40960
    ds_read_b64_tr_b16 v[238:239], v62 offset:41472
    s_waitcnt lgkmcnt(0)
    s_waitcnt vmcnt(20)
    s_barrier
    ds_read_b64_tr_b16 v[240:241], v59 offset:12288
    ds_read_b64_tr_b16 v[242:243], v59 offset:12800
    ds_read_b64_tr_b16 v[244:245], v59 offset:45056
    ds_read_b64_tr_b16 v[246:247], v59 offset:45568
    ds_read_b64_tr_b16 v[248:249], v62 offset:12288
    ds_read_b64_tr_b16 v[250:251], v62 offset:12800
    ds_read_b64_tr_b16 v[252:253], v62 offset:45056
    ds_read_b64_tr_b16 v[254:255], v62 offset:45568
    s_waitcnt lgkmcnt(0)
    s_waitcnt vmcnt(16)
    s_barrier
    ds_write_b128 v2, v[96:99] offset:0
    ds_write_b128 v2, v[100:103] offset:1024
    ds_write_b128 v2, v[104:107] offset:4096
    ds_write_b128 v2, v[108:111] offset:5120
    ds_write_b128 v2, v[112:115] offset:2048
    ds_write_b128 v2, v[116:119] offset:3072
    ds_write_b128 v2, v[120:123] offset:6144
    ds_write_b128 v2, v[124:127] offset:7168
    s_waitcnt lgkmcnt(0)
    ds_write_b128 v2, v[64:67] offset:8192
    ds_write_b128 v2, v[68:71] offset:9216
    ds_write_b128 v2, v[72:75] offset:12288
    ds_write_b128 v2, v[76:79] offset:13312
    ds_write_b128 v2, v[80:83] offset:10240
    ds_write_b128 v2, v[84:87] offset:11264
    ds_write_b128 v2, v[88:91] offset:14336
    ds_write_b128 v2, v[92:95] offset:15360
    s_waitcnt lgkmcnt(0)
    ds_read_b64_tr_b16 v[28:29], v59 offset:16384
    ds_read_b64_tr_b16 v[30:31], v59 offset:16896
    ds_read_b64_tr_b16 v[32:33], v59 offset:49152
    ds_read_b64_tr_b16 v[34:35], v59 offset:49664
    ds_read_b64_tr_b16 v[44:45], v62 offset:16384
    ds_read_b64_tr_b16 v[46:47], v62 offset:16896
    ds_read_b64_tr_b16 v[48:49], v62 offset:49152
    ds_read_b64_tr_b16 v[50:51], v62 offset:49664
    s_waitcnt lgkmcnt(0)
    s_waitcnt vmcnt(12)
    s_barrier
    ds_write_b128 v2, v[28:31] offset:16384
    ds_write_b128 v2, v[32:35] offset:17408
    ds_write_b128 v2, v[44:47] offset:18432
    ds_write_b128 v2, v[48:51] offset:19456
    ds_read_b64_tr_b16 v[28:29], v59 offset:20480
    ds_read_b64_tr_b16 v[30:31], v59 offset:20992
    ds_read_b64_tr_b16 v[32:33], v59 offset:53248
    ds_read_b64_tr_b16 v[34:35], v59 offset:53760
    ds_read_b64_tr_b16 v[44:45], v62 offset:20480
    ds_read_b64_tr_b16 v[46:47], v62 offset:20992
    ds_read_b64_tr_b16 v[48:49], v62 offset:53248
    ds_read_b64_tr_b16 v[50:51], v62 offset:53760
    s_waitcnt lgkmcnt(0)
    s_waitcnt vmcnt(8)
    s_barrier
    s_waitcnt vmcnt(7)
    v_readfirstlane_b32 s53, v39
    s_cmp_ge_u32 s53, 32
    s_cselect_b32 s52, s35, 0x70000000
    s_mov_b32 s39, 50987008
    s_mov_b32 s59, 50991104
    s_cselect_b32 s39, s39, s52
    s_cselect_b32 s59, s59, s52
    s_cmp_lg_u32 s2, 0
    s_cselect_b32 s52, s35, s52
    buffer_load_dwordx4 v[80:83], v1, s[4:7], s52 offen offset:0 sc1
    buffer_load_dwordx4 v[84:87], v1, s[4:7], s52 offen offset:1024 sc1
    buffer_load_dwordx4 v[88:91], v1, s[4:7], s52 offen offset:2048 sc1
    buffer_load_dwordx4 v[92:95], v1, s[4:7], s52 offen offset:3072 sc1
    buffer_load_dwordx4 v[64:67], v1, s[4:7], s39 offen sc1
    buffer_load_dwordx4 v[68:71], v1, s[4:7], s59 offen sc1
    ds_write_b128 v2, v[28:31] offset:20480
    ds_write_b128 v2, v[32:35] offset:21504
    ds_write_b128 v2, v[44:47] offset:22528
    ds_write_b128 v2, v[48:51] offset:23552
    ds_read_b64_tr_b16 v[28:29], v59 offset:24576
    ds_read_b64_tr_b16 v[30:31], v59 offset:25088
    ds_read_b64_tr_b16 v[32:33], v59 offset:57344
    ds_read_b64_tr_b16 v[34:35], v59 offset:57856
    ds_read_b64_tr_b16 v[44:45], v62 offset:24576
    ds_read_b64_tr_b16 v[46:47], v62 offset:25088
    ds_read_b64_tr_b16 v[48:49], v62 offset:57344
    ds_read_b64_tr_b16 v[50:51], v62 offset:57856
    s_waitcnt lgkmcnt(0)
    s_waitcnt vmcnt(9)
    s_barrier
    ds_write_b128 v2, v[28:31] offset:24576
    ds_write_b128 v2, v[32:35] offset:25600
    ds_write_b128 v2, v[44:47] offset:26624
    ds_write_b128 v2, v[48:51] offset:27648
    ds_read_b64_tr_b16 v[28:29], v59 offset:28672
    ds_read_b64_tr_b16 v[30:31], v59 offset:29184
    ds_read_b64_tr_b16 v[32:33], v59 offset:61440
    ds_read_b64_tr_b16 v[34:35], v59 offset:61952
    ds_read_b64_tr_b16 v[44:45], v62 offset:28672
    ds_read_b64_tr_b16 v[46:47], v62 offset:29184
    ds_read_b64_tr_b16 v[48:49], v62 offset:61440
    ds_read_b64_tr_b16 v[50:51], v62 offset:61952
    s_waitcnt lgkmcnt(0)
    s_barrier
    ds_write_b128 v2, v[28:31] offset:28672
    ds_write_b128 v2, v[32:35] offset:29696
    ds_write_b128 v2, v[44:47] offset:30720
    ds_write_b128 v2, v[48:51] offset:31744
    s_waitcnt lgkmcnt(0)
    s_mov_b32 s47, 0
    s_mov_b32 m0, 24576
    s_barrier
    s_cmp_ge_u32 s53, 32
    s_cbranch_scc1 L_c_kv_2
    s_cmp_lg_u32 s2, 0
    s_cbranch_scc1 L_c_m3_2
    buffer_load_dwordx4 v[80:83], v1, s[4:7], s35 offen offset:0 sc1
    buffer_load_dwordx4 v[84:87], v1, s[4:7], s35 offen offset:1024 sc1
    buffer_load_dwordx4 v[88:91], v1, s[4:7], s35 offen offset:2048 sc1
    buffer_load_dwordx4 v[92:95], v1, s[4:7], s35 offen offset:3072 sc1
L_c_m1_2:
    s_mov_b32 s39, 50987008
    s_mov_b32 s59, 50991104
    s_sleep 4
    buffer_load_dwordx4 v[64:67], v1, s[4:7], s39 offen sc1
    buffer_load_dwordx4 v[68:71], v1, s[4:7], s59 offen sc1
    s_add_u32 s47, s47, 1
    s_cmp_gt_u32 s47, 1000000
    s_cbranch_scc1 L_exit
L_c_kv_2:
    s_cmp_lg_u32 s2, 0
    s_cbranch_scc1 L_c_m3_2
    s_waitcnt vmcnt(0)
    v_max3_u32 v36, v64, v65, v66
    v_max3_u32 v37, v67, v68, v69
    v_max3_u32 v36, v36, v70, v71
    v_max_u32 v36, v36, v37
    v_cmp_eq_u32 vcc, -1, v36
    v_mov_b64 v[24:25], v[64:65]
    v_mov_b64 v[26:27], v[66:67]
    v_mov_b64 v[40:41], v[68:69]
    v_mov_b64 v[42:43], v[70:71]
    s_cbranch_vccnz L_c_m1_2
    s_branch L_c_m4_2
L_c_m2_2:
    s_add_u32 s47, s47, 1
    s_cmp_gt_u32 s47, 1000000
    s_cbranch_scc1 L_end
    s_sleep 4
    buffer_load_dword v9, off, s[4:7], s81 offset:4092 sc1
    s_waitcnt vmcnt(0)
    v_cmp_eq_u32 vcc, -1, v9
    s_cbranch_vccnz L_c_m2_2
    s_branch L_c_m5_2
L_c_m7_2:
    s_add_u32 s47, s47, 1
    s_cmp_gt_u32 s47, 1000000
    s_cbranch_scc1 L_end
    s_sleep 4
L_c_m5_2:
    buffer_load_dwordx4 v[80:83], v1, s[4:7], s81 offen offset:0 sc1
    buffer_load_dwordx4 v[84:87], v1, s[4:7], s81 offen offset:1024 sc1
    buffer_load_dwordx4 v[88:91], v1, s[4:7], s81 offen offset:2048 sc1
    buffer_load_dwordx4 v[92:95], v1, s[4:7], s81 offen offset:3072 sc1
L_c_m6_2:
    s_waitcnt vmcnt(0)
    v_max3_u32 v9, v80, v81, v82
    v_max3_u32 v9, v9, v83, v84
    v_max3_u32 v9, v9, v85, v86
    v_max3_u32 v9, v9, v87, v88
    v_max3_u32 v9, v9, v89, v90
    v_max3_u32 v9, v9, v91, v92
    v_max3_u32 v9, v9, v93, v94
    v_max_u32 v9, v9, v95
    v_cmp_eq_u32 vcc, -1, v9
    s_cbranch_vccnz L_c_m7_2
    s_branch L_bk_2
L_c_m3_2:
    s_waitcnt vmcnt(0)
    s_mov_b32 s81, s35
    s_mov_b32 s35, 0x70000000
L_c_m4_2:
    s_add_u32 s35, s35, 0x80000
    s_mov_b32 s46, 140
    s_mov_b64 s[54:55], 0
    v_mov_b32 v9, 32
    s_mov_b32 s47, 0
    v_mov_b64 v[56:57], 0
    v_mov_b64 v[58:59], 0
    v_mov_b64 v[60:61], 0
    v_mov_b64 v[62:63], 0
    v_mov_b64 v[64:65], 0
    v_mov_b64 v[66:67], 0
    v_mov_b64 v[68:69], 0
    v_mov_b64 v[70:71], 0
    v_mov_b64 v[72:73], 0
    v_mov_b64 v[74:75], 0
    v_mov_b64 v[76:77], 0
    v_mov_b64 v[78:79], 0
    s_waitcnt lgkmcnt(0)
L_cpe_2:
    s_cmp_lg_u32 s2, 0
    s_cbranch_scc1 L_bstep_2
    s_branch L_step_2
L_cp_3:
    s_waitcnt vmcnt(33)
    s_barrier
    ds_read_b64_tr_b16 a[240:241], v58 offset:0
    ds_read_b64_tr_b16 a[242:243], v58 offset:512
    ds_read_b64_tr_b16 a[244:245], v61 offset:0
    ds_read_b64_tr_b16 a[246:247], v61 offset:512
    ds_read_b64_tr_b16 a[248:249], v58 offset:8
    ds_read_b64_tr_b16 a[250:251], v58 offset:520
    ds_read_b64_tr_b16 a[252:253], v61 offset:8
    ds_read_b64_tr_b16 a[254:255], v61 offset:520
    s_waitcnt lgkmcnt(0)
    s_waitcnt vmcnt(29)
    s_barrier
    ds_read_b64_tr_b16 a[192:193], v58 offset:4096
    ds_read_b64_tr_b16 a[194:195], v58 offset:4608
    s_add_u32 m0, s54, 0
    s_add_u32 s55, s56, 0
    buffer_load_dwordx4 v56, s[12:15], s55 offen sc1 lds
    ds_read_b64_tr_b16 a[196:197], v61 offset:4096
    ds_read_b64_tr_b16 a[198:199], v61 offset:4608
    s_add_u32 m0, s54, 1024
    s_add_u32 s55, s56, 32768
    buffer_load_dwordx4 v52, s[12:15], s55 offen sc1 lds
    ds_read_b64_tr_b16 a[200:201], v58 offset:4104
    ds_read_b64_tr_b16 a[202:203], v58 offset:4616
    s_add_u32 m0, s54, 2048
    s_add_u32 s55, s56, 65536
    buffer_load_dwordx4 v56, s[12:15], s55 offen sc1 lds
    ds_read_b64_tr_b16 a[204:205], v61 offset:4104
    ds_read_b64_tr_b16 a[206:207], v61 offset:4616
    s_add_u32 m0, s54, 3072
    s_add_u32 s55, s56, 98304
    buffer_load_dwordx4 v52, s[12:15], s55 offen sc1 lds
    s_waitcnt lgkmcnt(0)
    s_waitcnt vmcnt(29)
    s_barrier
    ds_read_b64_tr_b16 a[208:209], v58 offset:8192
    ds_read_b64_tr_b16 a[210:211], v58 offset:8704
    s_add_u32 m0, s54, 4096
    s_add_u32 s55, s56, 524288
    buffer_load_dwordx4 v56, s[12:15], s55 offen sc1 lds
    ds_read_b64_tr_b16 a[212:213], v61 offset:8192
    ds_read_b64_tr_b16 a[214:215], v61 offset:8704
    s_add_u32 m0, s54, 5120
    s_add_u32 s55, s56, 557056
    buffer_load_dwordx4 v52, s[12:15], s55 offen sc1 lds
    ds_read_b64_tr_b16 a[216:217], v58 offset:8200
    ds_read_b64_tr_b16 a[218:219], v58 offset:8712
    s_add_u32 m0, s54, 6144
    s_add_u32 s55, s56, 589824
    buffer_load_dwordx4 v56, s[12:15], s55 offen sc1 lds
    ds_read_b64_tr_b16 a[220:221], v61 offset:8200
    ds_read_b64_tr_b16 a[222:223], v61 offset:8712
    s_add_u32 m0, s54, 7168
    s_add_u32 s55, s56, 622592
    buffer_load_dwordx4 v52, s[12:15], s55 offen sc1 lds
    s_waitcnt lgkmcnt(0)
    s_waitcnt vmcnt(29)
    s_barrier
    ds_read_b64_tr_b16 a[224:225], v58 offset:12288
    ds_read_b64_tr_b16 a[226:227], v58 offset:12800
    s_add_u32 m0, s54, 8192
    s_add_u32 s55, s56, 1048576
    buffer_load_dwordx4 v56, s[12:15], s55 offen sc1 lds
    ds_read_b64_tr_b16 a[228:229], v61 offset:12288
    ds_read_b64_tr_b16 a[230:231], v61 offset:12800
    s_add_u32 m0, s54, 9216
    s_add_u32 s55, s56, 1081344
    buffer_load_dwordx4 v52, s[12:15], s55 offen sc1 lds
    ds_read_b64_tr_b16 a[232:233], v58 offset:12296
    ds_read_b64_tr_b16 a[234:235], v58 offset:12808
    s_add_u32 m0, s54, 10240
    s_add_u32 s55, s56, 1114112
    buffer_load_dwordx4 v56, s[12:15], s55 offen sc1 lds
    ds_read_b64_tr_b16 a[236:237], v61 offset:12296
    ds_read_b64_tr_b16 a[238:239], v61 offset:12808
    s_add_u32 m0, s54, 11264
    s_add_u32 s55, s56, 1146880
    buffer_load_dwordx4 v52, s[12:15], s55 offen sc1 lds
    s_waitcnt lgkmcnt(0)
    s_waitcnt vmcnt(29)
    s_barrier
    ds_read_b64_tr_b16 v[176:177], v58 offset:16384
    ds_read_b64_tr_b16 v[178:179], v58 offset:16896
    s_add_u32 m0, s54, 12288
    s_add_u32 s55, s56, 1572864
    buffer_load_dwordx4 v56, s[12:15], s55 offen sc1 lds
    ds_read_b64_tr_b16 v[180:181], v61 offset:16384
    ds_read_b64_tr_b16 v[182:183], v61 offset:16896
    s_add_u32 m0, s54, 13312
    s_add_u32 s55, s56, 1605632
    buffer_load_dwordx4 v52, s[12:15], s55 offen sc1 lds
    ds_read_b64_tr_b16 v[184:185], v58 offset:16392
    ds_read_b64_tr_b16 v[186:187], v58 offset:16904
    s_add_u32 m0, s54, 14336
    s_add_u32 s55, s56, 1638400
    buffer_load_dwordx4 v56, s[12:15], s55 offen sc1 lds
    ds_read_b64_tr_b16 v[188:189], v61 offset:16392
    ds_read_b64_tr_b16 v[190:191], v61 offset:16904
    s_add_u32 m0, s54, 15360
    s_add_u32 s55, s56, 1671168
    buffer_load_dwordx4 v52, s[12:15], s55 offen sc1 lds
    s_waitcnt lgkmcnt(0)
    s_waitcnt vmcnt(29)
    s_barrier
    ds_read_b64_tr_b16 v[128:129], v58 offset:20480
    ds_read_b64_tr_b16 v[130:131], v58 offset:20992
    s_add_u32 m0, s54, 16384
    s_add_u32 s55, s56, 2097152
    buffer_load_dwordx4 v56, s[12:15], s55 offen sc1 lds
    ds_read_b64_tr_b16 v[132:133], v61 offset:20480
    ds_read_b64_tr_b16 v[134:135], v61 offset:20992
    s_add_u32 m0, s54, 17408
    s_add_u32 s55, s56, 2129920
    buffer_load_dwordx4 v52, s[12:15], s55 offen sc1 lds
    ds_read_b64_tr_b16 v[136:137], v58 offset:20488
    ds_read_b64_tr_b16 v[138:139], v58 offset:21000
    s_add_u32 m0, s54, 18432
    s_add_u32 s55, s56, 2162688
    buffer_load_dwordx4 v56, s[12:15], s55 offen sc1 lds
    ds_read_b64_tr_b16 v[140:141], v61 offset:20488
    ds_read_b64_tr_b16 v[142:143], v61 offset:21000
    s_add_u32 m0, s54, 19456
    s_add_u32 s55, s56, 2195456
    buffer_load_dwordx4 v52, s[12:15], s55 offen sc1 lds
    s_waitcnt lgkmcnt(0)
    s_waitcnt vmcnt(29)
    s_barrier
    ds_read_b64_tr_b16 v[144:145], v58 offset:24576
    ds_read_b64_tr_b16 v[146:147], v58 offset:25088
    s_add_u32 m0, s54, 20480
    s_add_u32 s55, s56, 2621440
    buffer_load_dwordx4 v56, s[12:15], s55 offen sc1 lds
    ds_read_b64_tr_b16 v[148:149], v61 offset:24576
    ds_read_b64_tr_b16 v[150:151], v61 offset:25088
    s_add_u32 m0, s54, 21504
    s_add_u32 s55, s56, 2654208
    buffer_load_dwordx4 v52, s[12:15], s55 offen sc1 lds
    ds_read_b64_tr_b16 v[152:153], v58 offset:24584
    ds_read_b64_tr_b16 v[154:155], v58 offset:25096
    s_add_u32 m0, s54, 22528
    s_add_u32 s55, s56, 2686976
    buffer_load_dwordx4 v56, s[12:15], s55 offen sc1 lds
    ds_read_b64_tr_b16 v[156:157], v61 offset:24584
    ds_read_b64_tr_b16 v[158:159], v61 offset:25096
    s_add_u32 m0, s54, 23552
    s_add_u32 s55, s56, 2719744
    buffer_load_dwordx4 v52, s[12:15], s55 offen sc1 lds
    s_waitcnt lgkmcnt(0)
    s_waitcnt vmcnt(29)
    s_barrier
    ds_read_b64_tr_b16 v[160:161], v58 offset:28672
    ds_read_b64_tr_b16 v[162:163], v58 offset:29184
    s_add_u32 m0, s54, 24576
    s_add_u32 s55, s56, 3145728
    buffer_load_dwordx4 v56, s[12:15], s55 offen sc1 lds
    ds_read_b64_tr_b16 v[164:165], v61 offset:28672
    ds_read_b64_tr_b16 v[166:167], v61 offset:29184
    s_add_u32 m0, s54, 25600
    s_add_u32 s55, s56, 3178496
    buffer_load_dwordx4 v52, s[12:15], s55 offen sc1 lds
    ds_read_b64_tr_b16 v[168:169], v58 offset:28680
    ds_read_b64_tr_b16 v[170:171], v58 offset:29192
    s_add_u32 m0, s54, 26624
    s_add_u32 s55, s56, 3211264
    buffer_load_dwordx4 v56, s[12:15], s55 offen sc1 lds
    ds_read_b64_tr_b16 v[172:173], v61 offset:28680
    ds_read_b64_tr_b16 v[174:175], v61 offset:29192
    s_add_u32 m0, s54, 27648
    s_add_u32 s55, s56, 3244032
    buffer_load_dwordx4 v52, s[12:15], s55 offen sc1 lds
    s_waitcnt lgkmcnt(0)
    s_waitcnt vmcnt(24)
    s_barrier
    ds_read_b64_tr_b16 a[72:73], v58 offset:0
    ds_read_b64_tr_b16 a[74:75], v58 offset:512
    s_add_u32 m0, s54, 28672
    s_add_u32 s55, s56, 3670016
    buffer_load_dwordx4 v56, s[12:15], s55 offen sc1 lds
    ds_read_b64_tr_b16 a[76:77], v61 offset:0
    ds_read_b64_tr_b16 a[78:79], v61 offset:512
    s_add_u32 m0, s54, 29696
    s_add_u32 s55, s56, 3702784
    buffer_load_dwordx4 v52, s[12:15], s55 offen sc1 lds
    ds_read_b64_tr_b16 a[88:89], v58 offset:8
    ds_read_b64_tr_b16 a[90:91], v58 offset:520
    s_add_u32 m0, s54, 30720
    s_add_u32 s55, s56, 3735552
    buffer_load_dwordx4 v56, s[12:15], s55 offen sc1 lds
    ds_read_b64_tr_b16 a[92:93], v61 offset:8
    ds_read_b64_tr_b16 a[94:95], v61 offset:520
    s_add_u32 m0, s54, 31744
    s_add_u32 s55, s56, 3768320
    buffer_load_dwordx4 v52, s[12:15], s55 offen sc1 lds
    s_waitcnt lgkmcnt(0)
    s_waitcnt vmcnt(24)
    s_barrier
    v_min_u32 v24, -2, v24
    v_min_u32 v25, -2, v25
    v_min_u32 v26, -2, v26
    v_min_u32 v27, -2, v27
    v_min_u32 v40, -2, v40
    v_min_u32 v41, -2, v41
    v_min_u32 v42, -2, v42
    v_min_u32 v43, -2, v43
    ds_read_b64_tr_b16 v[104:105], v58 offset:4096
    ds_read_b64_tr_b16 v[106:107], v58 offset:4608
    s_add_u32 m0, s54, 0
    s_add_u32 s55, s56, 0
    buffer_load_dwordx4 v56, s[8:11], s55 offen sc1 lds
    ds_read_b64_tr_b16 v[108:109], v61 offset:4096
    ds_read_b64_tr_b16 v[110:111], v61 offset:4608
    s_add_u32 m0, s54, 1024
    s_add_u32 s55, s56, 32768
    buffer_load_dwordx4 v52, s[8:11], s55 offen sc1 lds
    ds_read_b64_tr_b16 v[120:121], v58 offset:4104
    ds_read_b64_tr_b16 v[122:123], v58 offset:4616
    s_add_u32 m0, s54, 2048
    s_add_u32 s55, s56, 65536
    buffer_load_dwordx4 v56, s[8:11], s55 offen sc1 lds
    ds_read_b64_tr_b16 v[124:125], v61 offset:4104
    ds_read_b64_tr_b16 v[126:127], v61 offset:4616
    s_add_u32 m0, s54, 3072
    s_add_u32 s55, s56, 98304
    buffer_load_dwordx4 v52, s[8:11], s55 offen sc1 lds
    s_waitcnt lgkmcnt(0)
    s_waitcnt vmcnt(24)
    s_barrier
    ds_read_b64_tr_b16 a[8:9], v58 offset:8192
    ds_read_b64_tr_b16 a[10:11], v58 offset:8704
    s_add_u32 m0, s54, 4096
    s_add_u32 s55, s56, 524288
    buffer_load_dwordx4 v56, s[8:11], s55 offen sc1 lds
    ds_read_b64_tr_b16 a[12:13], v61 offset:8192
    ds_read_b64_tr_b16 a[14:15], v61 offset:8704
    s_add_u32 m0, s54, 5120
    s_add_u32 s55, s56, 557056
    buffer_load_dwordx4 v52, s[8:11], s55 offen sc1 lds
    ds_read_b64_tr_b16 a[24:25], v58 offset:8200
    ds_read_b64_tr_b16 a[26:27], v58 offset:8712
    s_add_u32 m0, s54, 6144
    s_add_u32 s55, s56, 589824
    buffer_load_dwordx4 v56, s[8:11], s55 offen sc1 lds
    ds_read_b64_tr_b16 a[28:29], v61 offset:8200
    ds_read_b64_tr_b16 a[30:31], v61 offset:8712
    s_add_u32 m0, s54, 7168
    s_add_u32 s55, s56, 622592
    buffer_load_dwordx4 v52, s[8:11], s55 offen sc1 lds
    s_waitcnt lgkmcnt(0)
    s_waitcnt vmcnt(24)
    s_barrier
    ds_read_b64_tr_b16 a[40:41], v58 offset:12288
    ds_read_b64_tr_b16 a[42:43], v58 offset:12800
    s_add_u32 m0, s54, 8192
    s_add_u32 s55, s56, 1048576
    buffer_load_dwordx4 v56, s[8:11], s55 offen sc1 lds
    ds_read_b64_tr_b16 a[44:45], v61 offset:12288
    ds_read_b64_tr_b16 a[46:47], v61 offset:12800
    s_add_u32 m0, s54, 9216
    s_add_u32 s55, s56, 1081344
    buffer_load_dwordx4 v52, s[8:11], s55 offen sc1 lds
    ds_read_b64_tr_b16 a[56:57], v58 offset:12296
    ds_read_b64_tr_b16 a[58:59], v58 offset:12808
    s_add_u32 m0, s54, 10240
    s_add_u32 s55, s56, 1114112
    buffer_load_dwordx4 v56, s[8:11], s55 offen sc1 lds
    ds_read_b64_tr_b16 a[60:61], v61 offset:12296
    ds_read_b64_tr_b16 a[62:63], v61 offset:12808
    s_add_u32 m0, s54, 11264
    s_add_u32 s55, s56, 1146880
    buffer_load_dwordx4 v52, s[8:11], s55 offen sc1 lds
    s_waitcnt lgkmcnt(0)
    s_waitcnt vmcnt(24)
    s_barrier
    ds_read_b64_tr_b16 a[168:169], v58 offset:16384
    ds_read_b64_tr_b16 a[170:171], v58 offset:16896
    s_add_u32 m0, s54, 12288
    s_add_u32 s55, s56, 1572864
    buffer_load_dwordx4 v56, s[8:11], s55 offen sc1 lds
    ds_read_b64_tr_b16 a[172:173], v61 offset:16384
    ds_read_b64_tr_b16 a[174:175], v61 offset:16896
    s_add_u32 m0, s54, 13312
    s_add_u32 s55, s56, 1605632
    buffer_load_dwordx4 v52, s[8:11], s55 offen sc1 lds
    ds_read_b64_tr_b16 a[184:185], v58 offset:16392
    ds_read_b64_tr_b16 a[186:187], v58 offset:16904
    s_add_u32 m0, s54, 14336
    s_add_u32 s55, s56, 1638400
    buffer_load_dwordx4 v56, s[8:11], s55 offen sc1 lds
    ds_read_b64_tr_b16 a[188:189], v61 offset:16392
    ds_read_b64_tr_b16 a[190:191], v61 offset:16904
    s_add_u32 m0, s54, 15360
    s_add_u32 s55, s56, 1671168
    buffer_load_dwordx4 v52, s[8:11], s55 offen sc1 lds
    s_waitcnt lgkmcnt(0)
    s_waitcnt vmcnt(24)
    s_barrier
    ds_read_b64_tr_b16 v[72:73], v58 offset:20480
    ds_read_b64_tr_b16 v[74:75], v58 offset:20992
    s_add_u32 m0, s54, 16384
    s_add_u32 s55, s56, 2097152
    buffer_load_dwordx4 v56, s[8:11], s55 offen sc1 lds
    ds_read_b64_tr_b16 v[76:77], v61 offset:20480
    ds_read_b64_tr_b16 v[78:79], v61 offset:20992
    s_add_u32 m0, s54, 17408
    s_add_u32 s55, s56, 2129920
    buffer_load_dwordx4 v52, s[8:11], s55 offen sc1 lds
    ds_read_b64_tr_b16 v[88:89], v58 offset:20488
    ds_read_b64_tr_b16 v[90:91], v58 offset:21000
    s_add_u32 m0, s54, 18432
    s_add_u32 s55, s56, 2162688
    buffer_load_dwordx4 v56, s[8:11], s55 offen sc1 lds
    ds_read_b64_tr_b16 v[92:93], v61 offset:20488
    ds_read_b64_tr_b16 v[94:95], v61 offset:21000
    s_add_u32 m0, s54, 19456
    s_add_u32 s55, s56, 2195456
    buffer_load_dwordx4 v52, s[8:11], s55 offen sc1 lds
    s_waitcnt lgkmcnt(0)
    s_waitcnt vmcnt(24)
    s_barrier
    ds_read_b64_tr_b16 a[104:105], v58 offset:24576
    ds_read_b64_tr_b16 a[106:107], v58 offset:25088
    s_add_u32 m0, s54, 20480
    s_add_u32 s55, s56, 2621440
    buffer_load_dwordx4 v56, s[8:11], s55 offen sc1 lds
    ds_read_b64_tr_b16 a[108:109], v61 offset:24576
    ds_read_b64_tr_b16 a[110:111], v61 offset:25088
    s_add_u32 m0, s54, 21504
    s_add_u32 s55, s56, 2654208
    buffer_load_dwordx4 v52, s[8:11], s55 offen sc1 lds
    ds_read_b64_tr_b16 a[120:121], v58 offset:24584
    ds_read_b64_tr_b16 a[122:123], v58 offset:25096
    s_add_u32 m0, s54, 22528
    s_add_u32 s55, s56, 2686976
    buffer_load_dwordx4 v56, s[8:11], s55 offen sc1 lds
    ds_read_b64_tr_b16 a[124:125], v61 offset:24584
    ds_read_b64_tr_b16 a[126:127], v61 offset:25096
    s_add_u32 m0, s54, 23552
    s_add_u32 s55, s56, 2719744
    buffer_load_dwordx4 v52, s[8:11], s55 offen sc1 lds
    s_waitcnt lgkmcnt(0)
    s_waitcnt vmcnt(24)
    s_barrier
    ds_read_b64_tr_b16 a[136:137], v58 offset:28672
    ds_read_b64_tr_b16 a[138:139], v58 offset:29184
    s_add_u32 m0, s54, 24576
    s_add_u32 s55, s56, 3145728
    buffer_load_dwordx4 v56, s[8:11], s55 offen sc1 lds
    ds_read_b64_tr_b16 a[140:141], v61 offset:28672
    ds_read_b64_tr_b16 a[142:143], v61 offset:29184
    s_add_u32 m0, s54, 25600
    s_add_u32 s55, s56, 3178496
    buffer_load_dwordx4 v52, s[8:11], s55 offen sc1 lds
    ds_read_b64_tr_b16 a[152:153], v58 offset:28680
    ds_read_b64_tr_b16 a[154:155], v58 offset:29192
    s_add_u32 m0, s54, 26624
    s_add_u32 s55, s56, 3211264
    buffer_load_dwordx4 v56, s[8:11], s55 offen sc1 lds
    ds_read_b64_tr_b16 a[156:157], v61 offset:28680
    ds_read_b64_tr_b16 a[158:159], v61 offset:29192
    s_add_u32 m0, s54, 27648
    s_add_u32 s55, s56, 3244032
    buffer_load_dwordx4 v52, s[8:11], s55 offen sc1 lds
    s_waitcnt lgkmcnt(0)
    s_waitcnt vmcnt(24)
    s_barrier
    ds_read_b64_tr_b16 a[64:65], v58 offset:0
    ds_read_b64_tr_b16 a[66:67], v58 offset:512
    s_add_u32 m0, s54, 28672
    s_add_u32 s55, s56, 3670016
    buffer_load_dwordx4 v56, s[8:11], s55 offen sc1 lds
    ds_read_b64_tr_b16 a[68:69], v61 offset:0
    ds_read_b64_tr_b16 a[70:71], v61 offset:512
    s_add_u32 m0, s54, 29696
    s_add_u32 s55, s56, 3702784
    buffer_load_dwordx4 v52, s[8:11], s55 offen sc1 lds
    ds_read_b64_tr_b16 a[80:81], v58 offset:8
    ds_read_b64_tr_b16 a[82:83], v58 offset:520
    s_add_u32 m0, s54, 30720
    s_add_u32 s55, s56, 3735552
    buffer_load_dwordx4 v56, s[8:11], s55 offen sc1 lds
    ds_read_b64_tr_b16 a[84:85], v61 offset:8
    ds_read_b64_tr_b16 a[86:87], v61 offset:520
    s_add_u32 m0, s54, 31744
    s_add_u32 s55, s56, 3768320
    buffer_load_dwordx4 v52, s[8:11], s55 offen sc1 lds
    s_waitcnt lgkmcnt(0)
    s_waitcnt vmcnt(24)
    s_barrier
    ds_read_b64_tr_b16 v[96:97], v58 offset:4096
    ds_read_b64_tr_b16 v[98:99], v58 offset:4608
    s_add_u32 m0, s54, 0
    s_add_u32 s55, s57, 0
    buffer_load_dwordx4 v57, s[20:23], s55 offen sc1 lds
    ds_read_b64_tr_b16 v[100:101], v61 offset:4096
    ds_read_b64_tr_b16 v[102:103], v61 offset:4608
    s_add_u32 m0, s54, 1024
    s_add_u32 s55, s57, 4096
    buffer_load_dwordx4 v53, s[20:23], s55 offen sc1 lds
    ds_read_b64_tr_b16 v[112:113], v58 offset:4104
    ds_read_b64_tr_b16 v[114:115], v58 offset:4616
    s_add_u32 m0, s54, 2048
    s_add_u32 s55, s57, 8192
    buffer_load_dwordx4 v57, s[20:23], s55 offen sc1 lds
    ds_read_b64_tr_b16 v[116:117], v61 offset:4104
    ds_read_b64_tr_b16 v[118:119], v61 offset:4616
    s_add_u32 m0, s54, 3072
    s_add_u32 s55, s57, 12288
    buffer_load_dwordx4 v53, s[20:23], s55 offen sc1 lds
    s_waitcnt lgkmcnt(0)
    s_waitcnt vmcnt(24)
    s_barrier
    ds_read_b64_tr_b16 a[0:1], v58 offset:8192
    ds_read_b64_tr_b16 a[2:3], v58 offset:8704
    s_add_u32 m0, s54, 4096
    s_add_u32 s55, s57, 65536
    buffer_load_dwordx4 v57, s[20:23], s55 offen sc1 lds
    ds_read_b64_tr_b16 a[4:5], v61 offset:8192
    ds_read_b64_tr_b16 a[6:7], v61 offset:8704
    s_add_u32 m0, s54, 5120
    s_add_u32 s55, s57, 69632
    buffer_load_dwordx4 v53, s[20:23], s55 offen sc1 lds
    ds_read_b64_tr_b16 a[16:17], v58 offset:8200
    ds_read_b64_tr_b16 a[18:19], v58 offset:8712
    s_add_u32 m0, s54, 6144
    s_add_u32 s55, s57, 73728
    buffer_load_dwordx4 v57, s[20:23], s55 offen sc1 lds
    ds_read_b64_tr_b16 a[20:21], v61 offset:8200
    ds_read_b64_tr_b16 a[22:23], v61 offset:8712
    s_add_u32 m0, s54, 7168
    s_add_u32 s55, s57, 77824
    buffer_load_dwordx4 v53, s[20:23], s55 offen sc1 lds
    s_waitcnt lgkmcnt(0)
    s_waitcnt vmcnt(24)
    s_barrier
    ds_read_b64_tr_b16 a[32:33], v58 offset:12288
    ds_read_b64_tr_b16 a[34:35], v58 offset:12800
    s_add_u32 m0, s54, 8192
    s_add_u32 s55, s57, 256
    buffer_load_dwordx4 v57, s[20:23], s55 offen sc1 lds
    ds_read_b64_tr_b16 a[36:37], v61 offset:12288
    ds_read_b64_tr_b16 a[38:39], v61 offset:12800
    s_add_u32 m0, s54, 9216
    s_add_u32 s55, s57, 4352
    buffer_load_dwordx4 v53, s[20:23], s55 offen sc1 lds
    ds_read_b64_tr_b16 a[48:49], v58 offset:12296
    ds_read_b64_tr_b16 a[50:51], v58 offset:12808
    s_add_u32 m0, s54, 10240
    s_add_u32 s55, s57, 8448
    buffer_load_dwordx4 v57, s[20:23], s55 offen sc1 lds
    ds_read_b64_tr_b16 a[52:53], v61 offset:12296
    ds_read_b64_tr_b16 a[54:55], v61 offset:12808
    s_add_u32 m0, s54, 11264
    s_add_u32 s55, s57, 12544
    buffer_load_dwordx4 v53, s[20:23], s55 offen sc1 lds
    s_waitcnt lgkmcnt(0)
    s_waitcnt vmcnt(24)
    s_barrier
    ds_read_b64_tr_b16 a[160:161], v58 offset:16384
    ds_read_b64_tr_b16 a[162:163], v58 offset:16896
    s_add_u32 m0, s54, 12288
    s_add_u32 s55, s57, 65792
    buffer_load_dwordx4 v57, s[20:23], s55 offen sc1 lds
    ds_read_b64_tr_b16 a[164:165], v61 offset:16384
    ds_read_b64_tr_b16 a[166:167], v61 offset:16896
    s_add_u32 m0, s54, 13312
    s_add_u32 s55, s57, 69888
    buffer_load_dwordx4 v53, s[20:23], s55 offen sc1 lds
    ds_read_b64_tr_b16 a[176:177], v58 offset:16392
    ds_read_b64_tr_b16 a[178:179], v58 offset:16904
    s_add_u32 m0, s54, 14336
    s_add_u32 s55, s57, 73984
    buffer_load_dwordx4 v57, s[20:23], s55 offen sc1 lds
    ds_read_b64_tr_b16 a[180:181], v61 offset:16392
    ds_read_b64_tr_b16 a[182:183], v61 offset:16904
    s_add_u32 m0, s54, 15360
    s_add_u32 s55, s57, 78080
    buffer_load_dwordx4 v53, s[20:23], s55 offen sc1 lds
    s_waitcnt lgkmcnt(0)
    s_waitcnt vmcnt(24)
    s_barrier
    ds_read_b64_tr_b16 v[64:65], v58 offset:20480
    ds_read_b64_tr_b16 v[66:67], v58 offset:20992
    s_add_u32 m0, s54, 16384
    s_add_u32 s55, s57, 512
    buffer_load_dwordx4 v57, s[20:23], s55 offen sc1 lds
    ds_read_b64_tr_b16 v[68:69], v61 offset:20480
    ds_read_b64_tr_b16 v[70:71], v61 offset:20992
    s_add_u32 m0, s54, 17408
    s_add_u32 s55, s57, 4608
    buffer_load_dwordx4 v53, s[20:23], s55 offen sc1 lds
    ds_read_b64_tr_b16 v[80:81], v58 offset:20488
    ds_read_b64_tr_b16 v[82:83], v58 offset:21000
    s_add_u32 m0, s54, 18432
    s_add_u32 s55, s57, 8704
    buffer_load_dwordx4 v57, s[20:23], s55 offen sc1 lds
    ds_read_b64_tr_b16 v[84:85], v61 offset:20488
    ds_read_b64_tr_b16 v[86:87], v61 offset:21000
    s_add_u32 m0, s54, 19456
    s_add_u32 s55, s57, 12800
    buffer_load_dwordx4 v53, s[20:23], s55 offen sc1 lds
    s_waitcnt lgkmcnt(0)
    s_waitcnt vmcnt(24)
    s_barrier
    ds_read_b64_tr_b16 a[96:97], v58 offset:24576
    ds_read_b64_tr_b16 a[98:99], v58 offset:25088
    s_add_u32 m0, s54, 20480
    s_add_u32 s55, s57, 66048
    buffer_load_dwordx4 v57, s[20:23], s55 offen sc1 lds
    ds_read_b64_tr_b16 a[100:101], v61 offset:24576
    ds_read_b64_tr_b16 a[102:103], v61 offset:25088
    s_add_u32 m0, s54, 21504
    s_add_u32 s55, s57, 70144
    buffer_load_dwordx4 v53, s[20:23], s55 offen sc1 lds
    ds_read_b64_tr_b16 a[112:113], v58 offset:24584
    ds_read_b64_tr_b16 a[114:115], v58 offset:25096
    s_add_u32 m0, s54, 22528
    s_add_u32 s55, s57, 74240
    buffer_load_dwordx4 v57, s[20:23], s55 offen sc1 lds
    ds_read_b64_tr_b16 a[116:117], v61 offset:24584
    ds_read_b64_tr_b16 a[118:119], v61 offset:25096
    s_add_u32 m0, s54, 23552
    s_add_u32 s55, s57, 78336
    buffer_load_dwordx4 v53, s[20:23], s55 offen sc1 lds
    s_waitcnt lgkmcnt(0)
    s_waitcnt vmcnt(24)
    s_barrier
    ds_read_b64_tr_b16 a[128:129], v58 offset:28672
    ds_read_b64_tr_b16 a[130:131], v58 offset:29184
    s_add_u32 m0, s54, 24576
    s_add_u32 s55, s57, 768
    buffer_load_dwordx4 v57, s[20:23], s55 offen sc1 lds
    ds_read_b64_tr_b16 a[132:133], v61 offset:28672
    ds_read_b64_tr_b16 a[134:135], v61 offset:29184
    s_add_u32 m0, s54, 25600
    s_add_u32 s55, s57, 4864
    buffer_load_dwordx4 v53, s[20:23], s55 offen sc1 lds
    ds_read_b64_tr_b16 a[144:145], v58 offset:28680
    ds_read_b64_tr_b16 a[146:147], v58 offset:29192
    s_add_u32 m0, s54, 26624
    s_add_u32 s55, s57, 8960
    buffer_load_dwordx4 v57, s[20:23], s55 offen sc1 lds
    ds_read_b64_tr_b16 a[148:149], v61 offset:28680
    ds_read_b64_tr_b16 a[150:151], v61 offset:29192
    s_add_u32 m0, s54, 27648
    s_add_u32 s55, s57, 13056
    buffer_load_dwordx4 v53, s[20:23], s55 offen sc1 lds
    s_waitcnt lgkmcnt(0)
    s_waitcnt vmcnt(24)
    s_barrier
    s_lshl_b32 s52, s2, 12
    buffer_load_dword v39, off, s[24:27], s52 offset:12 sc1
    ds_read_b64_tr_b16 v[192:193], v59 offset:0
    ds_read_b64_tr_b16 v[194:195], v59 offset:512
    s_add_u32 m0, s54, 28672
    s_add_u32 s55, s57, 66304
    buffer_load_dwordx4 v57, s[20:23], s55 offen sc1 lds
    ds_read_b64_tr_b16 v[196:197], v59 offset:32768
    ds_read_b64_tr_b16 v[198:199], v59 offset:33280
    s_add_u32 m0, s54, 29696
    s_add_u32 s55, s57, 70400
    buffer_load_dwordx4 v53, s[20:23], s55 offen sc1 lds
    ds_read_b64_tr_b16 v[200:201], v62 offset:0
    ds_read_b64_tr_b16 v[202:203], v62 offset:512
    s_add_u32 m0, s54, 30720
    s_add_u32 s55, s57, 74496
    buffer_load_dwordx4 v57, s[20:23], s55 offen sc1 lds
    ds_read_b64_tr_b16 v[204:205], v62 offset:32768
    ds_read_b64_tr_b16 v[206:207], v62 offset:33280
    s_add_u32 m0, s54, 31744
    s_add_u32 s55, s57, 78592
    buffer_load_dwordx4 v53, s[20:23], s55 offen sc1 lds
    s_waitcnt lgkmcnt(0)
    s_waitcnt vmcnt(25)
    s_barrier
    s_getpc_b64 s[50:51]
L_cpc_3:
    v_lshlrev_b32 v63, 3, v1
    s_cmp_lg_u32 s2, 0
    s_cselect_b32 s52, s45, 50880512
    s_cselect_b32 s53, s45, s37
    buffer_load_dword v36, v63, s[4:7], s52 offen sc1
    v_and_b32 v37, 0x780, v63
    v_min_u32 v63, L_step_3-L_top_3, v63
    v_add_u32 v63, L_top_3-L_cpc_3, v63
    s_mul_i32 s52, s2, L_bstep_3-L_top_3
    v_add_u32 v63, s52, v63
    buffer_load_dword v36, v37, s[4:7], s53 offen sc1
    global_load_dword v36, v63, s[50:51]
    ds_read_b64_tr_b16 v[208:209], v59 offset:4096
    ds_read_b64_tr_b16 v[210:211], v59 offset:4608
    ds_read_b64_tr_b16 v[212:213], v59 offset:36864
    ds_read_b64_tr_b16 v[214:215], v59 offset:37376
    ds_read_b64_tr_b16 v[216:217], v62 offset:4096
    ds_read_b64_tr_b16 v[218:219], v62 offset:4608
    ds_read_b64_tr_b16 v[220:221], v62 offset:36864
    ds_read_b64_tr_b16 v[222:223], v62 offset:37376
    s_waitcnt lgkmcnt(0)
    s_waitcnt vmcnt(24)
    s_barrier
    ds_read_b64_tr_b16 v[224:225], v59 offset:8192
    ds_read_b64_tr_b16 v[226:227], v59 offset:8704
    ds_read_b64_tr_b16 v[228:229], v59 offset:40960
    ds_read_b64_tr_b16 v[230:231], v59 offset:41472
    ds_read_b64_tr_b16 v[232:233], v62 offset:8192
    ds_read_b64_tr_b16 v[234:235], v62 offset:8704
    ds_read_b64_tr_b16 v[236:237], v62 offset:40960
    ds_read_b64_tr_b16 v[238:239], v62 offset:41472
    s_waitcnt lgkmcnt(0)
    s_waitcnt vmcnt(20)
    s_barrier
    ds_read_b64_tr_b16 v[240:241], v59 offset:12288
    ds_read_b64_tr_b16 v[242:243], v59 offset:12800
    ds_read_b64_tr_b16 v[244:245], v59 offset:45056
    ds_read_b64_tr_b16 v[246:247], v59 offset:45568
    ds_read_b64_tr_b16 v[248:249], v62 offset:12288
    ds_read_b64_tr_b16 v[250:251], v62 offset:12800
    ds_read_b64_tr_b16 v[252:253], v62 offset:45056
    ds_read_b64_tr_b16 v[254:255], v62 offset:45568
    s_waitcnt lgkmcnt(0)
    s_waitcnt vmcnt(16)
    s_barrier
    ds_write_b128 v2, v[96:99] offset:0
    ds_write_b128 v2, v[100:103] offset:1024
    ds_write_b128 v2, v[104:107] offset:4096
    ds_write_b128 v2, v[108:111] offset:5120
    ds_write_b128 v2, v[112:115] offset:2048
    ds_write_b128 v2, v[116:119] offset:3072
    ds_write_b128 v2, v[120:123] offset:6144
    ds_write_b128 v2, v[124:127] offset:7168
    s_waitcnt lgkmcnt(0)
    ds_write_b128 v2, v[64:67] offset:8192
    ds_write_b128 v2, v[68:71] offset:9216
    ds_write_b128 v2, v[72:75] offset:12288
    ds_write_b128 v2, v[76:79] offset:13312
    ds_write_b128 v2, v[80:83] offset:10240
    ds_write_b128 v2, v[84:87] offset:11264
    ds_write_b128 v2, v[88:91] offset:14336
    ds_write_b128 v2, v[92:95] offset:15360
    s_waitcnt lgkmcnt(0)
    ds_read_b64_tr_b16 v[28:29], v59 offset:16384
    ds_read_b64_tr_b16 v[30:31], v59 offset:16896
    ds_read_b64_tr_b16 v[32:33], v59 offset:49152
    ds_read_b64_tr_b16 v[34:35], v59 offset:49664
    ds_read_b64_tr_b16 v[44:45], v62 offset:16384
    ds_read_b64_tr_b16 v[46:47], v62 offset:16896
    ds_read_b64_tr_b16 v[48:49], v62 offset:49152
    ds_read_b64_tr_b16 v[50:51], v62 offset:49664
    s_waitcnt lgkmcnt(0)
    s_waitcnt vmcnt(12)
    s_barrier
    ds_write_b128 v2, v[28:31] offset:16384
    ds_write_b128 v2, v[32:35] offset:17408
    ds_write_b128 v2, v[44:47] offset:18432
    ds_write_b128 v2, v[48:51] offset:19456
    ds_read_b64_tr_b16 v[28:29], v59 offset:20480
    ds_read_b64_tr_b16 v[30:31], v59 offset:20992
    ds_read_b64_tr_b16 v[32:33], v59 offset:53248
    ds_read_b64_tr_b16 v[34:35], v59 offset:53760
    ds_read_b64_tr_b16 v[44:45], v62 offset:20480
    ds_read_b64_tr_b16 v[46:47], v62 offset:20992
    ds_read_b64_tr_b16 v[48:49], v62 offset:53248
    ds_read_b64_tr_b16 v[50:51], v62 offset:53760
    s_waitcnt lgkmcnt(0)
    s_waitcnt vmcnt(8)
    s_barrier
    s_waitcnt vmcnt(7)
    v_readfirstlane_b32 s53, v39
    s_cmp_ge_u32 s53, 32
    s_cselect_b32 s52, s35, 0x70000000
    s_mov_b32 s39, 50988032
    s_mov_b32 s59, 50992128
    s_cselect_b32 s39, s39, s52
    s_cselect_b32 s59, s59, s52
    s_cmp_lg_u32 s2, 0
    s_cselect_b32 s52, s35, s52
    buffer_load_dwordx4 v[80:83], v1, s[4:7], s52 offen offset:0 sc1
    buffer_load_dwordx4 v[84:87], v1, s[4:7], s52 offen offset:1024 sc1
    buffer_load_dwordx4 v[88:91], v1, s[4:7], s52 offen offset:2048 sc1
    buffer_load_dwordx4 v[92:95], v1, s[4:7], s52 offen offset:3072 sc1
    buffer_load_dwordx4 v[64:67], v1, s[4:7], s39 offen sc1
    buffer_load_dwordx4 v[68:71], v1, s[4:7], s59 offen sc1
    ds_write_b128 v2, v[28:31] offset:20480
    ds_write_b128 v2, v[32:35] offset:21504
    ds_write_b128 v2, v[44:47] offset:22528
    ds_write_b128 v2, v[48:51] offset:23552
    ds_read_b64_tr_b16 v[28:29], v59 offset:24576
    ds_read_b64_tr_b16 v[30:31], v59 offset:25088
    ds_read_b64_tr_b16 v[32:33], v59 offset:57344
    ds_read_b64_tr_b16 v[34:35], v59 offset:57856
    ds_read_b64_tr_b16 v[44:45], v62 offset:24576
    ds_read_b64_tr_b16 v[46:47], v62 offset:25088
    ds_read_b64_tr_b16 v[48:49], v62 offset:57344
    ds_read_b64_tr_b16 v[50:51], v62 offset:57856
    s_waitcnt lgkmcnt(0)
    s_waitcnt vmcnt(9)
    s_barrier
    ds_write_b128 v2, v[28:31] offset:24576
    ds_write_b128 v2, v[32:35] offset:25600
    ds_write_b128 v2, v[44:47] offset:26624
    ds_write_b128 v2, v[48:51] offset:27648
    ds_read_b64_tr_b16 v[28:29], v59 offset:28672
    ds_read_b64_tr_b16 v[30:31], v59 offset:29184
    ds_read_b64_tr_b16 v[32:33], v59 offset:61440
    ds_read_b64_tr_b16 v[34:35], v59 offset:61952
    ds_read_b64_tr_b16 v[44:45], v62 offset:28672
    ds_read_b64_tr_b16 v[46:47], v62 offset:29184
    ds_read_b64_tr_b16 v[48:49], v62 offset:61440
    ds_read_b64_tr_b16 v[50:51], v62 offset:61952
    s_waitcnt lgkmcnt(0)
    s_barrier
    ds_write_b128 v2, v[28:31] offset:28672
    ds_write_b128 v2, v[32:35] offset:29696
    ds_write_b128 v2, v[44:47] offset:30720
    ds_write_b128 v2, v[48:51] offset:31744
    s_waitcnt lgkmcnt(0)
    s_mov_b32 s47, 0
    s_mov_b32 m0, 28672
    s_barrier
    s_cmp_ge_u32 s53, 32
    s_cbranch_scc1 L_c_kv_3
    s_cmp_lg_u32 s2, 0
    s_cbranch_scc1 L_c_m3_3
    buffer_load_dwordx4 v[80:83], v1, s[4:7], s35 offen offset:0 sc1
    buffer_load_dwordx4 v[84:87], v1, s[4:7], s35 offen offset:1024 sc1
    buffer_load_dwordx4 v[88:91], v1, s[4:7], s35 offen offset:2048 sc1
    buffer_load_dwordx4 v[92:95], v1, s[4:7], s35 offen offset:3072 sc1
L_c_m1_3:
    s_mov_b32 s39, 50988032
    s_mov_b32 s59, 50992128
    s_sleep 4
    buffer_load_dwordx4 v[64:67], v1, s[4:7], s39 offen sc1
    buffer_load_dwordx4 v[68:71], v1, s[4:7], s59 offen sc1
    s_add_u32 s47, s47, 1
    s_cmp_gt_u32 s47, 1000000
    s_cbranch_scc1 L_exit
L_c_kv_3:
    s_cmp_lg_u32 s2, 0
    s_cbranch_scc1 L_c_m3_3
    s_waitcnt vmcnt(0)
    v_max3_u32 v36, v64, v65, v66
    v_max3_u32 v37, v67, v68, v69
    v_max3_u32 v36, v36, v70, v71
    v_max_u32 v36, v36, v37
    v_cmp_eq_u32 vcc, -1, v36
    v_mov_b64 v[24:25], v[64:65]
    v_mov_b64 v[26:27], v[66:67]
    v_mov_b64 v[40:41], v[68:69]
    v_mov_b64 v[42:43], v[70:71]
    s_cbranch_vccnz L_c_m1_3
    s_branch L_c_m4_3
L_c_m2_3:
    s_add_u32 s47, s47, 1
    s_cmp_gt_u32 s47, 1000000
    s_cbranch_scc1 L_end
    s_sleep 4
    buffer_load_dword v9, off, s[4:7], s81 offset:4092 sc1
    s_waitcnt vmcnt(0)
    v_cmp_eq_u32 vcc, -1, v9
    s_cbranch_vccnz L_c_m2_3
    s_branch L_c_m5_3
L_c_m7_3:
    s_add_u32 s47, s47, 1
    s_cmp_gt_u32 s47, 1000000
    s_cbranch_scc1 L_end
    s_sleep 4
L_c_m5_3:
    buffer_load_dwordx4 v[80:83], v1, s[4:7], s81 offen offset:0 sc1
    buffer_load_dwordx4 v[84:87], v1, s[4:7], s81 offen offset:1024 sc1
    buffer_load_dwordx4 v[88:91], v1, s[4:7], s81 offen offset:2048 sc1
    buffer_load_dwordx4 v[92:95], v1, s[4:7], s81 offen offset:3072 sc1
L_c_m6_3:
    s_waitcnt vmcnt(0)
    v_max3_u32 v9, v80, v81, v82
    v_max3_u32 v9, v9, v83, v84
    v_max3_u32 v9, v9, v85, v86
    v_max3_u32 v9, v9, v87, v88
    v_max3_u32 v9, v9, v89, v90
    v_max3_u32 v9, v9, v91, v92
    v_max3_u32 v9, v9, v93, v94
    v_max_u32 v9, v9, v95
    v_cmp_eq_u32 vcc, -1, v9
    s_cbranch_vccnz L_c_m7_3
    s_branch L_bk_3
L_c_m3_3:
    s_waitcnt vmcnt(0)
    s_mov_b32 s81, s35
    s_mov_b32 s35, 0x70000000
L_c_m4_3:
    s_add_u32 s35, s35, 0x80000
    s_mov_b32 s46, 140
    s_mov_b64 s[54:55], 0
    v_mov_b32 v9, 32
    s_mov_b32 s47, 0
    v_mov_b64 v[56:57], 0
    v_mov_b64 v[58:59], 0
    v_mov_b64 v[60:61], 0
    v_mov_b64 v[62:63], 0
    v_mov_b64 v[64:65], 0
    v_mov_b64 v[66:67], 0
    v_mov_b64 v[68:69], 0
    v_mov_b64 v[70:71], 0
    v_mov_b64 v[72:73], 0
    v_mov_b64 v[74:75], 0
    v_mov_b64 v[76:77], 0
    v_mov_b64 v[78:79], 0
    s_waitcnt lgkmcnt(0)
L_cpe_3:
    s_cmp_lg_u32 s2, 0
    s_cbranch_scc1 L_bstep_3
    s_branch L_step_3
.p2align 6
L_top_0:
    s_waitcnt vmcnt(2) lgkmcnt(0)
    v_cmp_eq_u32 vcc, -1, v27
    ds_write_b128 v1, v[24:27] offset:0
    s_cbranch_vccnz L_f1_0
    buffer_load_dwordx4 v[40:43], v1, s[4:7], s59 offen sc1
L_go_0:
    v_smfmac_f32_16x16x64_bf16 v[56:59], v[24:27], v[96:103], v0
    v_smfmac_f32_16x16x64_bf16 v[60:63], v[24:27], v[104:111], v0
    v_smfmac_f32_16x16x64_bf16 v[64:67], v[24:27], v[112:119], v0
    s_waitcnt lgkmcnt(0)
    s_barrier
    ds_read_b128 v[28:31], v1 offset:2048
    ds_read_b128 v[32:35], v1 offset:4096
    v_smfmac_f32_16x16x64_bf16 v[68:71], v[24:27], v[120:127], v0
    ds_read_b128 v[36:39], v1 offset:6144
    v_smfmac_f32_16x16x64_bf16 v[72:75], v[24:27], a[192:199], v0
    v_smfmac_f32_16x16x64_bf16 v[76:79], v[24:27], a[200:207], v0
L_go2_0:
    s_waitcnt lgkmcnt(2)
    v_smfmac_f32_16x16x64_bf16 v[56:59], v[28:31], a[0:7], v0
    ds_read_b128 v[96:99], v2 offset:8192
    v_smfmac_f32_16x16x64_bf16 v[60:63], v[28:31], a[8:15], v0
    ds_read_b128 v[100:103], v2 offset:9216
    v_smfmac_f32_16x16x64_bf16 v[64:67], v[28:31], a[16:23], v0
    ds_read_b128 v[104:107], v2 offset:12288
    v_smfmac_f32_16x16x64_bf16 v[68:71], v[28:31], a[24:31], v0
    ds_read_b128 v[108:111], v2 offset:13312
    s_waitcnt lgkmcnt(4)
    v_smfmac_f32_16x16x64_bf16 v[56:59], v[32:35], a[32:39], v0
    buffer_store_dwordx4 v[20:23], v1, s[4:7], s58 offen sc1
    ds_read_b128 v[112:115], v2 offset:10240
    v_smfmac_f32_16x16x64_bf16 v[60:63], v[32:35], a[40:47], v0
    ds_read_b128 v[116:119], v2 offset:11264
    v_smfmac_f32_16x16x64_bf16 v[64:67], v[32:35], a[48:55], v0
    ds_read_b128 v[120:123], v2 offset:14336
    v_smfmac_f32_16x16x64_bf16 v[68:71], v[32:35], a[56:63], v0
    ds_read_b128 v[124:127], v2 offset:15360
    v_smfmac_f32_16x16x64_bf16 v[56:59], v[36:39], a[64:71], v0
    v_smfmac_f32_16x16x64_bf16 v[60:63], v[36:39], a[72:79], v0
    s_waitcnt vmcnt(1)
    ds_write_b128 v1, v[40:43] offset:1024
    v_smfmac_f32_16x16x64_bf16 v[64:67], v[36:39], a[80:87], v0
    s_nop 0
    v_smfmac_f32_16x16x64_bf16 v[68:71], v[36:39], a[88:95], v0
    v_cmp_eq_u32 vcc, -1, v43
    v_smfmac_f32_16x16x64_bf16 v[72:75], v[28:31], a[208:215], v0
    v_smfmac_f32_16x16x64_bf16 v[76:79], v[28:31], a[216:223], v0
    s_cbranch_vccnz L_rL_0
L_bL_0:
    s_waitcnt lgkmcnt(0)
    s_barrier
    ds_read_b128 v[44:47], v1 offset:3072
    v_smfmac_f32_16x16x64_bf16 v[56:59], v[40:43], v[96:103], v0
    ds_read_b128 v[48:51], v1 offset:5120
    ds_read_b128 v[52:55], v1 offset:7168
    v_smfmac_f32_16x16x64_bf16 v[60:63], v[40:43], v[104:111], v0
    buffer_load_dwordx4 v1, s[4:7], s35 offen offset:0 sc1 lds
    ds_read_b128 v[96:99], v2 offset:16384
    v_smfmac_f32_16x16x64_bf16 v[64:67], v[40:43], v[112:119], v0
    ds_read_b128 v[100:103], v2 offset:17408
    v_smfmac_f32_16x16x64_bf16 v[68:71], v[40:43], v[120:127], v0
    ds_read_b128 v[104:107], v2 offset:18432
    s_waitcnt lgkmcnt(5)
    v_smfmac_f32_16x16x64_bf16 v[56:59], v[44:47], a[96:103], v0
    ds_read_b128 v[108:111], v2 offset:19456
    v_mov_b64 v[20:21], s[84:85]
    v_smfmac_f32_16x16x64_bf16 v[60:63], v[44:47], a[104:111], v0
    buffer_load_dwordx4 v1, s[4:7], s35 offen offset:1024 sc1 lds
    ds_read_b128 v[112:115], v2 offset:20480
    v_smfmac_f32_16x16x64_bf16 v[64:67], v[44:47], a[112:119], v0
    ds_read_b128 v[116:119], v2 offset:21504
    v_mov_b64 v[22:23], s[84:85]
    v_smfmac_f32_16x16x64_bf16 v[68:71], v[44:47], a[120:127], v0
    ds_read_b128 v[120:123], v2 offset:22528
    s_waitcnt lgkmcnt(7)
    v_smfmac_f32_16x16x64_bf16 v[56:59], v[48:51], a[128:135], v0
    ds_read_b128 v[124:127], v2 offset:23552
    v_smfmac_f32_16x16x64_bf16 v[60:63], v[48:51], a[136:143], v0
    buffer_load_dwordx4 v1, s[4:7], s35 offen offset:2048 sc1 lds
    v_smfmac_f32_16x16x64_bf16 v[56:59], v[52:55], a[160:167], v0
    v_smfmac_f32_16x16x64_bf16 v[60:63], v[52:55], a[168:175], v0
    v_smfmac_f32_16x16x64_bf16 v[64:67], v[48:51], a[144:151], v0
    v_cvt_pk_bf16_f32 v56, v56, v57
    v_smfmac_f32_16x16x64_bf16 v[68:71], v[48:51], a[152:159], v0
    buffer_load_dwordx4 v1, s[4:7], s35 offen offset:3072 sc1 lds
    v_cvt_pk_bf16_f32 v57, v58, v59
    v_smfmac_f32_16x16x64_bf16 v[64:67], v[52:55], a[176:183], v0
    v_cvt_pk_bf16_f32 v58, v60, v61
    v_smfmac_f32_16x16x64_bf16 v[68:71], v[52:55], a[184:191], v0
    v_cvt_pk_bf16_f32 v59, v62, v63
    s_nop 0
    v_cvt_pk_bf16_f32 v64, v64, v65
    v_mfma_f32_16x16x32_bf16 v[60:63], v[56:59], v[12:15], 0
    v_cvt_pk_bf16_f32 v65, v66, v67
    v_cvt_pk_bf16_f32 v66, v68, v69
    v_cvt_pk_bf16_f32 v67, v70, v71
    s_nop 1
    v_mfma_f32_16x16x32_bf16 v[68:71], v[64:67], v[12:15], 0
    v_cvt_pk_bf16_f32 v56, v60, v61
    v_cvt_pk_bf16_f32 v57, v62, v63
    v_cndmask_b32 v24, 0, v56, s[86:87]
    v_cndmask_b32 v25, 0, v57, s[86:87]
    v_mov_b32_dpp v28, v56 row_shr:8 row_mask:0xf bank_mask:0xf bound_ctrl:1
    v_mov_b32_dpp v29, v57 row_shr:8 row_mask:0xf bank_mask:0xf bound_ctrl:1
    s_nop 0
    v_cvt_pk_bf16_f32 v58, v68, v69
    v_cvt_pk_bf16_f32 v59, v70, v71
    v_cndmask_b32 v26, 0, v58, s[86:87]
    v_cndmask_b32 v27, 0, v59, s[86:87]
    v_mfma_f32_16x16x32_bf16 v[68:71], v[56:59], v[56:59], 0
    v_mov_b32_dpp v30, v58 row_shr:8 row_mask:0xf bank_mask:0xf bound_ctrl:1
    v_mov_b32_dpp v31, v59 row_shr:8 row_mask:0xf bank_mask:0xf bound_ctrl:1
    v_mfma_f32_16x16x32_bf16 v[64:67], v[80:83], v[24:27], 0
    s_nop 0
    v_mfma_f32_16x16x32_bf16 v[64:67], v[84:87], v[28:31], v[64:67]
    v_mov_b32_dpp v68, v70 row_ror:8 row_mask:0xf bank_mask:0xc
    v_mov_b32_dpp v69, v71 row_ror:8 row_mask:0xf bank_mask:0xc
    v_smfmac_f32_16x16x64_bf16 v[72:75], v[32:35], a[224:231], v0
    s_nop 0
    ds_write2_b32 v3, v68, v69 offset0:0 offset1:32
    v_smfmac_f32_16x16x64_bf16 v[76:79], v[32:35], a[232:239], v0
    ds_write_b128 v1, v[64:67] offset:8192
    v_smfmac_f32_16x16x64_bf16 v[72:75], v[36:39], a[240:247], v0
    buffer_store_dword v4, v7, s[4:7], s45 offen
    v_smfmac_f32_16x16x64_bf16 v[76:79], v[36:39], a[248:255], v0
    s_mov_b64 exec, s[54:55]
    buffer_load_dword v9, off, s[24:27], s46 sc1
    s_mov_b64 exec, -1
    v_smfmac_f32_16x16x64_bf16 v[72:75], v[40:43], v[128:135], v0
    v_smfmac_f32_16x16x64_bf16 v[76:79], v[40:43], v[136:143], v0
    v_smfmac_f32_16x16x64_bf16 v[72:75], v[44:47], v[144:151], v0
    v_smfmac_f32_16x16x64_bf16 v[76:79], v[44:47], v[152:159], v0
    s_waitcnt lgkmcnt(0)
    s_barrier
    ds_read_b128 v[68:71], v1 offset:9216
    ds_read_b128 v[60:63], v1 offset:10240
    v_smfmac_f32_16x16x64_bf16 v[72:75], v[48:51], v[160:167], v0
    ds_read_b128 v[80:83], v1 offset:12288
    ds_read_b128 v[84:87], v1 offset:14336
    v_smfmac_f32_16x16x64_bf16 v[76:79], v[48:51], v[168:175], v0
    v_smfmac_f32_16x16x64_bf16 v[72:75], v[52:55], v[176:183], v0
    v_smfmac_f32_16x16x64_bf16 v[76:79], v[52:55], v[184:191], v0
    s_waitcnt lgkmcnt(2)
    v_add_f32 v68, v68, v69
    v_add_f32 v70, v70, v71
    v_add_f32 v64, v64, v60
    v_add_f32 v65, v65, v61
    v_pk_add_f32 v[66:67], v[66:67], v[62:63]
    v_add_f32 v68, v68, v70
    s_waitcnt lgkmcnt(0)
    v_pk_add_f32 v[80:81], v[80:81], v[84:85]
    v_pk_add_f32 v[82:83], v[82:83], v[86:87]
    v_pk_add_f32 v[64:65], v[64:65], v[80:81]
    v_pk_add_f32 v[66:67], v[66:67], v[82:83]
    v_max3_f32 v60, v68, v64, v65
    v_max3_f32 v60, v60, v66, v67
    v_cvt_pk_bf16_f32 v72, v72, v73
    v_cvt_pk_bf16_f32 v73, v74, v75
    v_max_f32_dpp v61, v60, v60 row_ror:8 row_mask:0xf bank_mask:0xf
    v_max_f32_dpp v60, v60, v60 row_ror:8 row_mask:0xf bank_mask:0xf
    v_cvt_pk_bf16_f32 v74, v76, v77
    v_cvt_pk_bf16_f32 v75, v78, v79
    v_permlane32_swap_b32 v60, v61
    v_max_f32 v62, v60, v61
    v_max_f32 v63, v60, v61
    v_permlane32_swap_b32 v72, v73
    v_permlane32_swap_b32 v74, v75
    v_permlane16_swap_b32 v62, v63
    v_max_f32 v60, v62, v63
    v_mul_f32 v60, s48, v60
    v_fma_f32 v68, v68, s48, -v60
    v_exp_f32 v68, v68
    v_pk_fma_f32 v[64:65], v[64:65], s[48:49], v[60:61] op_sel_hi:[1,1,0] neg_lo:[0,0,1] neg_hi:[0,0,1]
    v_pk_fma_f32 v[66:67], v[66:67], s[48:49], v[60:61] op_sel_hi:[1,1,0] neg_lo:[0,0,1] neg_hi:[0,0,1]
    v_mov_b32_dpp v69, v68 row_ror:8 row_mask:0xf bank_mask:0xf
    v_cvt_pk_bf16_f32 v52, v68, v69
    v_cvt_pk_bf16_f32 v53, v68, v69
    v_exp_f32 v64, v64
    v_exp_f32 v65, v65
    v_mfma_f32_16x16x16_bf16 v[80:83], v[72:73], v[52:53], 0
    v_exp_f32 v66, v66
    v_exp_f32 v67, v67
    v_cvt_pk_bf16_f32 v60, v64, v65
    v_cvt_pk_bf16_f32 v61, v66, v67
    v_mfma_f32_16x16x16_bf16 v[76:79], v[74:75], v[52:53], 0
    v_mov_b32_dpp v62, v60 row_ror:8 row_mask:0xf bank_mask:0xf
    v_mov_b32_dpp v63, v61 row_ror:8 row_mask:0xf bank_mask:0xf
    v_mov_b64 v[64:65], 0
    v_mov_b64 v[66:67], 0
    v_mfma_f32_16x16x32_bf16 v[80:83], v[88:91], v[60:63], v[80:83]
    ds_read_b128 v[24:27], v2 offset:24576
    ds_read_b128 v[28:31], v2 offset:25600
    v_mfma_f32_16x16x32_bf16 v[76:79], v[92:95], v[60:63], v[76:79]
    ds_read_b128 v[32:35], v2 offset:26624
    ds_read_b128 v[36:39], v2 offset:27648
    v_mfma_f32_16x16x16_bf16 v[68:71], v[52:53], v[10:11], 0
    v_cvt_pk_bf16_f32 v84, v80, v81
    v_cvt_pk_bf16_f32 v85, v82, v83
    v_mov_b64 v[80:81], 0
    v_mov_b64 v[82:83], 0
    v_cvt_pk_bf16_f32 v86, v76, v77
    v_cvt_pk_bf16_f32 v87, v78, v79
    v_mfma_f32_16x16x32_bf16 v[68:71], v[60:63], v[20:23], v[68:71]
    s_nop 0
    ds_write_b128 v8, v[84:87] offset:1024
    v_mov_b32_dpp v84, v84 row_ror:8 row_mask:0xf bank_mask:0xc
    v_mov_b32_dpp v85, v85 row_ror:8 row_mask:0xf bank_mask:0xc
    v_mov_b32_dpp v86, v86 row_ror:8 row_mask:0xf bank_mask:0xc
    v_mov_b32_dpp v87, v87 row_ror:8 row_mask:0xf bank_mask:0xc
    v_mov_b64 v[76:77], 0
    v_mov_b64 v[78:79], 0
    v_mov_b64 v[20:21], 0
    v_rcp_f32 v68, v68
    v_rcp_f32 v69, v69
    v_rcp_f32 v70, v70
    v_rcp_f32 v71, v71
    v_smfmac_f32_16x16x64_bf16 v[64:67], v[84:87], v[192:199], v0
    s_waitcnt lgkmcnt(0)
    s_barrier
    ds_read_b128 v[88:91], v5 offset:3072
    ds_read_b128 v[92:95], v5 offset:5120
    v_smfmac_f32_16x16x64_bf16 v[80:83], v[84:87], v[224:231], v0
    ds_read_b128 v[60:63], v5 offset:7168
    v_mov_b64 v[22:23], 0
    v_smfmac_f32_16x16x64_bf16 v[76:79], v[84:87], v[96:103], v0
    s_waitcnt lgkmcnt(2)
    v_smfmac_f32_16x16x64_bf16 v[64:67], v[88:91], v[200:207], v0
    ds_read_b128 v[40:43], v2 offset:28672
    s_waitcnt lgkmcnt(2)
    v_smfmac_f32_16x16x64_bf16 v[64:67], v[92:95], v[208:215], v0
    ds_read_b128 v[44:47], v2 offset:29696
    s_waitcnt lgkmcnt(2)
    v_smfmac_f32_16x16x64_bf16 v[64:67], v[60:63], v[216:223], v0
    ds_read_b128 v[48:51], v2 offset:30720
    v_smfmac_f32_16x16x64_bf16 v[80:83], v[88:91], v[232:239], v0
    ds_read_b128 v[52:55], v2 offset:31744
    v_smfmac_f32_16x16x64_bf16 v[80:83], v[92:95], v[240:247], v0
    v_mul_f32 v64, v64, v68
    v_smfmac_f32_16x16x64_bf16 v[80:83], v[60:63], v[248:255], v0
    v_mul_f32 v65, v65, v69
    v_mul_f32 v66, v66, v70
    v_mul_f32 v67, v67, v71
    v_cvt_pk_bf16_f32 v64, v64, v65
    v_cvt_pk_bf16_f32 v65, v66, v67
    v_bfi_b32 v64, 1, s38, v64
    v_smfmac_f32_16x16x64_bf16 v[76:79], v[88:91], v[104:111], v0
    s_nop 0
    buffer_store_dwordx2 v[64:65], v6, s[4:7], s40 offen
    v_mul_f32 v80, v80, v68
    v_mul_f32 v81, v81, v69
    v_mul_f32 v82, v82, v70
    v_mul_f32 v83, v83, v71
    v_cvt_pk_bf16_f32 v80, v80, v81
    v_cvt_pk_bf16_f32 v81, v82, v83
    v_bfi_b32 v80, 1, s38, v80
    v_smfmac_f32_16x16x64_bf16 v[76:79], v[92:95], v[112:119], v0
    s_nop 0
    buffer_store_dwordx2 v[80:81], v6, s[4:7], s41 offen
    v_smfmac_f32_16x16x64_bf16 v[76:79], v[60:63], v[120:127], v0
    s_waitcnt lgkmcnt(0)
    v_smfmac_f32_16x16x64_bf16 v[20:23], v[84:87], v[24:31], v0
    s_add_u32 s39, s44, 2048
    s_add_u32 s59, s44, 6144
    v_smfmac_f32_16x16x64_bf16 v[20:23], v[88:91], v[32:39], v0
    s_add_u32 s34, s34, 1
    s_mov_b32 s58, s36
    v_mul_f32 v76, v76, v68
    v_smfmac_f32_16x16x64_bf16 v[20:23], v[92:95], v[40:47], v0
    v_mul_f32 v77, v77, v69
    v_smfmac_f32_16x16x64_bf16 v[20:23], v[60:63], v[48:55], v0
    v_mul_f32 v78, v78, v70
    v_mul_f32 v79, v79, v71
    v_cvt_pk_bf16_f32 v76, v76, v77
    v_cvt_pk_bf16_f32 v77, v78, v79
    v_bfi_b32 v76, 1, s38, v76
    s_add_u32 s36, s36, 0x20000
    s_add_u32 s35, s35, 524288
    buffer_store_dwordx2 v[76:77], v6, s[4:7], s42 offen
    v_pk_mul_f32 v[20:21], v[20:21], v[68:69]
    v_pk_mul_f32 v[22:23], v[22:23], v[70:71]
    v_cvt_pk_bf16_f32 v20, v20, v21
    v_cvt_pk_bf16_f32 v21, v22, v23
    v_bfi_b32 v20, 1, s38, v20
    s_nop 1
    buffer_store_dwordx2 v[20:21], v6, s[4:7], s43 offen
    v_mov_b64 v[60:61], 0
    v_mov_b64 v[62:63], 0
    v_mov_b64 v[64:65], 0
    v_mov_b64 v[66:67], 0
    v_mov_b64 v[68:69], 0
    v_mov_b64 v[70:71], 0
    v_mov_b32_dpp v58, v56 row_ror:8 row_mask:0xf bank_mask:0x3
    v_mov_b32_dpp v59, v57 row_ror:8 row_mask:0xf bank_mask:0x3
    v_min_u32 v20, -2, v58
    v_min_u32 v21, -2, v59
    v_lshlrev_b32 v56, 16, v72
    v_lshlrev_b32 v57, 16, v73
    v_and_b32 v72, 0xffff0000, v72
    v_and_b32 v73, 0xffff0000, v73
    v_add_f32 v56, v56, v57
    v_add_f32 v57, v72, v73
    v_cvt_pk_bf16_f32 v56, v56, v57
    v_min_u32 v22, -2, v56
    v_lshlrev_b32 v56, 16, v74
    v_lshlrev_b32 v57, 16, v75
    v_and_b32 v74, 0xffff0000, v74
    v_and_b32 v75, 0xffff0000, v75
    v_add_f32 v56, v56, v57
    v_add_f32 v57, v74, v75
    v_cvt_pk_bf16_f32 v56, v56, v57
    s_nop 1
    buffer_load_dwordx4 v[80:83], v1, s[4:7], s37 offen offset:0 sc1
    buffer_load_dwordx4 v[84:87], v1, s[4:7], s37 offen offset:1024 sc1
    v_min_u32 v23, -2, v56
    v_mov_b64 v[56:57], 0
    v_mov_b64 v[58:59], 0
    v_mov_b64 v[72:73], 0
    v_mov_b64 v[74:75], 0
    v_mov_b64 v[76:77], 0
    v_mov_b64 v[78:79], 0
    s_nop 2
    ds_read_b128 v[96:99], v2 offset:0
    s_nop 2
    ds_read_b128 v[100:103], v2 offset:1024
    s_nop 2
    ds_read_b128 v[104:107], v2 offset:4096
    s_nop 2
    ds_read_b128 v[108:111], v2 offset:5120
    s_nop 4
    buffer_load_dwordx4 v[44:47], v1, s[4:7], s37 offen offset:0 sc1
    buffer_load_dwordx4 v[48:51], v1, s[4:7], s37 offen offset:1024 sc1
    ds_read_b128 v[112:115], v2 offset:2048
    ds_read_b128 v[116:119], v2 offset:3072
    ds_read_b128 v[120:123], v2 offset:6144
    ds_read_b128 v[124:127], v2 offset:7168
    s_waitcnt vmcnt(3)
L_a1_0:
    v_mfma_f32_16x16x32_bf16 v[32:35], v[16:19], v[80:83], 0
    v_bitop3_b32 v36, v80, v82, s38 bitop3:0x7e
    s_waitcnt vmcnt(2)
    v_mfma_f32_16x16x32_bf16 v[32:35], v[16:19], v[84:87], v[32:35]
    v_bitop3_b32 v37, v84, v86, s38 bitop3:0x7e
    v_bitop3_b32 v36, v36, v37, 1 bitop3:0xa8
    v_cmp_ne_u32 vcc, 0, v36
    s_nop 3
    v_add_f32_dpp v32, v32, v32 row_ror:4 row_mask:0xf bank_mask:0xf
    v_add_f32_dpp v33, v33, v33 row_ror:4 row_mask:0xf bank_mask:0xf
    s_nop 0
    v_add_f32_dpp v32, v32, v32 row_ror:8 row_mask:0xf bank_mask:0xf
    v_add_f32_dpp v33, v33, v33 row_ror:8 row_mask:0xf bank_mask:0xf
    v_cvt_pk_bf16_f32 v32, v32, v33
    s_cbranch_vccnz L_r2_0
    buffer_store_dword v32, v7, s[4:7], s44 offen
L_a2_0:
    v_cmp_gt_u32 vcc, 32, v9
    ds_read_b128 v[80:83], v1 offset:16384
    ds_read_b128 v[84:87], v1 offset:17408
    ds_read_b128 v[88:91], v1 offset:18432
    ds_read_b128 v[92:95], v1 offset:19456
    s_mov_b32 s44, s45
    s_add_u32 s45, s45, 0x2000
    s_and_b32 s45, s45, 0xffff7fff
    s_xor_b32 s38, s38, 1
    s_cbranch_vccnz L_rF_0
L_bF_0:
    s_add_u32 s3, s34, 2
    s_lshr_b32 s3, s3, 3
    s_min_u32 s3, s3, 7
    s_lshl2_add_u32 s3, s3, 144
    s_cmp_lt_u32 s34, 2
    s_cselect_b32 s3, 140, s3
    s_cmp_lg_u32 s46, s3
    s_cselect_b64 s[54:55], -1, 0
    s_mov_b32 s46, s3
    s_nop 15
    s_nop 0
    buffer_load_dwordx4 v[24:27], v1, s[4:7], s39 offen sc1
    s_nop 15
    s_nop 6
    buffer_load_dwordx4 v[24:27], v1, s[4:7], s39 offen sc1
    s_nop 15
    s_nop 6
    buffer_load_dwordx4 v[24:27], v1, s[4:7], s39 offen sc1
    s_cmp_lg_u32 s34, 63
    s_cbranch_scc1 L_top_0
    s_waitcnt vmcnt(2) lgkmcnt(0)
L_l0_0:
    v_cmp_eq_u32 vcc, -1, v27
    ds_write_b128 v1, v[24:27] offset:0
    s_cbranch_vccnz L_l1_0
    buffer_load_dwordx4 v[40:43], v1, s[4:7], s59 offen sc1
    v_smfmac_f32_16x16x64_bf16 v[60:63], v[24:27], v[104:111], v0
    v_smfmac_f32_16x16x64_bf16 v[68:71], v[24:27], v[120:127], v0
    s_waitcnt lgkmcnt(0)
    s_barrier
    ds_read_b128 v[28:31], v1 offset:2048
    ds_read_b128 v[32:35], v1 offset:4096
    ds_read_b128 v[36:39], v1 offset:6144
    v_smfmac_f32_16x16x64_bf16 v[72:75], v[24:27], a[192:199], v0
    v_smfmac_f32_16x16x64_bf16 v[76:79], v[24:27], a[200:207], v0
    buffer_store_dwordx4 v[20:23], v1, s[4:7], s58 offen sc1
    ds_read_b128 v[104:107], v2 offset:12288
    ds_read_b128 v[108:111], v2 offset:13312
    ds_read_b128 v[120:123], v2 offset:14336
    ds_read_b128 v[124:127], v2 offset:15360
    s_waitcnt lgkmcnt(6)
    v_smfmac_f32_16x16x64_bf16 v[60:63], v[28:31], a[8:15], v0
    v_smfmac_f32_16x16x64_bf16 v[68:71], v[28:31], a[24:31], v0
    v_smfmac_f32_16x16x64_bf16 v[72:75], v[28:31], a[208:215], v0
    v_smfmac_f32_16x16x64_bf16 v[76:79], v[28:31], a[216:223], v0
    s_waitcnt lgkmcnt(5)
    v_smfmac_f32_16x16x64_bf16 v[60:63], v[32:35], a[40:47], v0
    v_smfmac_f32_16x16x64_bf16 v[68:71], v[32:35], a[56:63], v0
    v_smfmac_f32_16x16x64_bf16 v[72:75], v[32:35], a[224:231], v0
    v_smfmac_f32_16x16x64_bf16 v[76:79], v[32:35], a[232:239], v0
    s_waitcnt vmcnt(1) lgkmcnt(0)
L_l2_0:
    s_nop 0
    s_nop 0
    v_cmp_eq_u32 vcc, -1, v43
    ds_write_b128 v1, v[40:43] offset:1024
    s_cbranch_vccnz L_l3_0
    v_smfmac_f32_16x16x64_bf16 v[60:63], v[36:39], a[72:79], v0
    v_smfmac_f32_16x16x64_bf16 v[68:71], v[36:39], a[88:95], v0
    v_smfmac_f32_16x16x64_bf16 v[72:75], v[36:39], a[240:247], v0
    v_smfmac_f32_16x16x64_bf16 v[76:79], v[36:39], a[248:255], v0
    s_waitcnt lgkmcnt(0)
    s_barrier
    ds_read_b128 v[44:47], v1 offset:3072
    ds_read_b128 v[48:51], v1 offset:5120
    ds_read_b128 v[52:55], v1 offset:7168
    v_smfmac_f32_16x16x64_bf16 v[60:63], v[40:43], v[104:111], v0
    v_smfmac_f32_16x16x64_bf16 v[68:71], v[40:43], v[120:127], v0
    v_smfmac_f32_16x16x64_bf16 v[72:75], v[40:43], v[128:135], v0
    v_smfmac_f32_16x16x64_bf16 v[76:79], v[40:43], v[136:143], v0
    s_waitcnt lgkmcnt(2)
    v_smfmac_f32_16x16x64_bf16 v[60:63], v[44:47], a[104:111], v0
    v_smfmac_f32_16x16x64_bf16 v[68:71], v[44:47], a[120:127], v0
    s_waitcnt lgkmcnt(1)
    v_smfmac_f32_16x16x64_bf16 v[60:63], v[48:51], a[136:143], v0
    v_smfmac_f32_16x16x64_bf16 v[68:71], v[48:51], a[152:159], v0
    s_waitcnt lgkmcnt(0)
    v_smfmac_f32_16x16x64_bf16 v[60:63], v[52:55], a[168:175], v0
    v_smfmac_f32_16x16x64_bf16 v[68:71], v[52:55], a[184:191], v0
    v_smfmac_f32_16x16x64_bf16 v[72:75], v[44:47], v[144:151], v0
    v_smfmac_f32_16x16x64_bf16 v[76:79], v[44:47], v[152:159], v0
    v_cvt_pk_bf16_f32 v58, v60, v61
    v_cvt_pk_bf16_f32 v59, v62, v63
    v_cvt_pk_bf16_f32 v66, v68, v69
    v_cvt_pk_bf16_f32 v67, v70, v71
    v_smfmac_f32_16x16x64_bf16 v[72:75], v[48:51], v[160:167], v0
    v_mfma_f32_16x16x32_bf16 v[60:63], v[56:59], v[12:15], 0
    v_mfma_f32_16x16x32_bf16 v[68:71], v[64:67], v[12:15], 0
    v_smfmac_f32_16x16x64_bf16 v[76:79], v[48:51], v[168:175], v0
    v_smfmac_f32_16x16x64_bf16 v[72:75], v[52:55], v[176:183], v0
    v_smfmac_f32_16x16x64_bf16 v[76:79], v[52:55], v[184:191], v0
    v_cvt_pk_bf16_f32 v56, v60, v61
    v_cvt_pk_bf16_f32 v57, v62, v63
    v_cvt_pk_bf16_f32 v58, v68, v69
    v_cvt_pk_bf16_f32 v59, v70, v71
    s_nop 1
    v_cvt_pk_bf16_f32 v72, v72, v73
    v_cvt_pk_bf16_f32 v73, v74, v75
    v_cvt_pk_bf16_f32 v74, v76, v77
    v_cvt_pk_bf16_f32 v75, v78, v79
    v_mov_b32_dpp v58, v56 row_ror:8 row_mask:0xf bank_mask:0x3
    v_mov_b32_dpp v59, v57 row_ror:8 row_mask:0xf bank_mask:0x3
    v_permlane32_swap_b32 v72, v73
    v_permlane32_swap_b32 v74, v75
    v_min_u32 v20, -2, v58
    v_min_u32 v21, -2, v59
    v_lshlrev_b32 v56, 16, v72
    v_lshlrev_b32 v57, 16, v73
    v_and_b32 v72, 0xffff0000, v72
    v_and_b32 v73, 0xffff0000, v73
    v_add_f32 v56, v56, v57
    v_add_f32 v57, v72, v73
    v_cvt_pk_bf16_f32 v56, v56, v57
    v_min_u32 v22, -2, v56
    v_lshlrev_b32 v56, 16, v74
    v_lshlrev_b32 v57, 16, v75
    v_and_b32 v74, 0xffff0000, v74
    v_and_b32 v75, 0xffff0000, v75
    v_add_f32 v56, v56, v57
    v_add_f32 v57, v74, v75
    v_cvt_pk_bf16_f32 v56, v56, v57
    v_min_u32 v23, -2, v56
    buffer_store_dwordx4 v[20:23], v1, s[4:7], s36 offen sc1
    s_endpgm
L_l1_0:
    buffer_load_dwordx4 v[24:27], v1, s[4:7], s39 offen sc1
    s_add_u32 s47, s47, 1
    s_cmp_gt_u32 s47, 1000000
    s_cbranch_scc1 L_exit
    s_waitcnt vmcnt(2)
    s_branch L_l0_0
L_l3_0:
    buffer_load_dwordx4 v[40:43], v1, s[4:7], s59 offen sc1
    s_add_u32 s47, s47, 1
    s_cmp_gt_u32 s47, 1000000
    s_cbranch_scc1 L_exit
    s_waitcnt vmcnt(0)
    s_branch L_l2_0
L_f1_0:
    buffer_load_dwordx4 v[24:27], v1, s[4:7], s39 offen sc1
    s_waitcnt vmcnt(2)
    v_cmp_eq_u32 vcc, -1, v27
    s_nop 0
    ds_write_b128 v1, v[24:27] offset:0
    s_cbranch_vccnz L_f2_0
    buffer_load_dwordx4 v[40:43], v1, s[4:7], s59 offen sc1
    v_smfmac_f32_16x16x64_bf16 v[56:59], v[24:27], v[96:103], v0
    v_smfmac_f32_16x16x64_bf16 v[60:63], v[24:27], v[104:111], v0
    v_smfmac_f32_16x16x64_bf16 v[64:67], v[24:27], v[112:119], v0
    s_waitcnt lgkmcnt(0)
    s_barrier
    ds_read_b128 v[28:31], v1 offset:2048
    ds_read_b128 v[32:35], v1 offset:4096
    v_smfmac_f32_16x16x64_bf16 v[68:71], v[24:27], v[120:127], v0
    ds_read_b128 v[36:39], v1 offset:6144
    v_smfmac_f32_16x16x64_bf16 v[72:75], v[24:27], a[192:199], v0
    v_smfmac_f32_16x16x64_bf16 v[76:79], v[24:27], a[200:207], v0
    s_branch L_go2_0
L_f2_0:
    buffer_load_dwordx4 v[24:27], v1, s[4:7], s39 offen sc1
    s_waitcnt vmcnt(2)
    v_cmp_eq_u32 vcc, -1, v27
    s_nop 0
    ds_write_b128 v1, v[24:27] offset:0
    s_cbranch_vccnz L_f3_0
    buffer_load_dwordx4 v[40:43], v1, s[4:7], s59 offen sc1
    s_branch L_go_0
L_f3_0:
    buffer_load_dwordx4 v[24:27], v1, s[4:7], s39 offen sc1
    s_waitcnt vmcnt(2)
    v_cmp_eq_u32 vcc, -1, v27
    s_nop 0
    ds_write_b128 v1, v[24:27] offset:0
    s_cbranch_vccnz L_f4_0
    buffer_load_dwordx4 v[40:43], v1, s[4:7], s59 offen sc1
    s_branch L_go_0
L_f4_0:
    s_add_u32 s47, s47, 1
    s_cmp_gt_u32 s47, 1000000
    s_cbranch_scc1 L_exit
    s_branch L_f3_0
L_rL_0:
    buffer_load_dwordx4 v[40:43], v1, s[4:7], s59 offen sc1
    s_add_u32 s47, s47, 1
    s_cmp_gt_u32 s47, 1000000
    s_cbranch_scc1 L_exit
    s_waitcnt vmcnt(0)
    ds_write_b128 v1, v[40:43] offset:1024
    s_nop 0
    s_nop 0
    v_cmp_eq_u32 vcc, -1, v43
    s_waitcnt lgkmcnt(0)
    s_cbranch_vccnz L_rL_0
    s_branch L_bL_0
L_rF_0:
    buffer_load_dword v9, off, s[24:27], s46 sc1
    s_add_u32 s47, s47, 1
    s_cmp_gt_u32 s47, 1000000
    s_cbranch_scc1 L_exit
    s_waitcnt vmcnt(0)
    v_cmp_gt_u32 vcc, 32, v9
    s_cbranch_vccnz L_rF_0
    s_branch L_bF_0
L_r2_0:
    s_waitcnt vmcnt(0)
    v_mfma_f32_16x16x32_bf16 v[32:35], v[16:19], v[44:47], 0
    v_bitop3_b32 v36, v44, v46, s38 bitop3:0x7e
    v_bitop3_b32 v37, v48, v50, s38 bitop3:0x7e
    v_mfma_f32_16x16x32_bf16 v[32:35], v[16:19], v[48:51], v[32:35]
    v_bitop3_b32 v36, v36, v37, 1 bitop3:0xa8
    v_cmp_ne_u32 vcc, 0, v36
    s_nop 0
    s_nop 3
    v_add_f32_dpp v32, v32, v32 row_ror:4 row_mask:0xf bank_mask:0xf
    v_add_f32_dpp v33, v33, v33 row_ror:4 row_mask:0xf bank_mask:0xf
    s_nop 0
    v_add_f32_dpp v32, v32, v32 row_ror:8 row_mask:0xf bank_mask:0xf
    v_add_f32_dpp v33, v33, v33 row_ror:8 row_mask:0xf bank_mask:0xf
    v_cvt_pk_bf16_f32 v32, v32, v33
    s_cbranch_vccnz L_r1_0
    buffer_store_dword v32, v7, s[4:7], s44 offen
    s_branch L_a2_0
L_r1_0:
    buffer_load_dwordx4 v[80:83], v1, s[4:7], s37 offen offset:0 sc1
    buffer_load_dwordx4 v[84:87], v1, s[4:7], s37 offen offset:1024 sc1
    s_add_u32 s47, s47, 1
    s_cmp_gt_u32 s47, 1000000
    s_cbranch_scc1 L_exit
    s_waitcnt vmcnt(0)
    s_branch L_a1_0
L_step_0:
    ds_write_b128 v1, v[24:27] offset:0
    s_branch L_go_0
.p2align 6
L_top_1:
    s_waitcnt vmcnt(2) lgkmcnt(0)
    v_cmp_eq_u32 vcc, -1, v27
    ds_write_b128 v1, v[24:27] offset:2048
    s_cbranch_vccnz L_f1_1
    buffer_load_dwordx4 v[40:43], v1, s[4:7], s59 offen sc1
L_go_1:
    v_smfmac_f32_16x16x64_bf16 v[56:59], v[24:27], v[96:103], v0
    v_smfmac_f32_16x16x64_bf16 v[60:63], v[24:27], v[104:111], v0
    v_smfmac_f32_16x16x64_bf16 v[64:67], v[24:27], v[112:119], v0
    s_waitcnt lgkmcnt(0)
    s_barrier
    ds_read_b128 v[28:31], v1 offset:4096
    ds_read_b128 v[32:35], v1 offset:6144
    v_smfmac_f32_16x16x64_bf16 v[68:71], v[24:27], v[120:127], v0
    ds_read_b128 v[36:39], v1 offset:0
    v_smfmac_f32_16x16x64_bf16 v[72:75], v[24:27], a[192:199], v0
    v_smfmac_f32_16x16x64_bf16 v[76:79], v[24:27], a[200:207], v0
L_go2_1:
    s_waitcnt lgkmcnt(2)
    v_smfmac_f32_16x16x64_bf16 v[56:59], v[28:31], a[0:7], v0
    ds_read_b128 v[96:99], v2 offset:8192
    v_smfmac_f32_16x16x64_bf16 v[60:63], v[28:31], a[8:15], v0
    ds_read_b128 v[100:103], v2 offset:9216
    v_smfmac_f32_16x16x64_bf16 v[64:67], v[28:31], a[16:23], v0
    buffer_store_dwordx4 v[20:23], v1, s[4:7], s58 offen sc1
    ds_read_b128 v[104:107], v2 offset:12288
    v_smfmac_f32_16x16x64_bf16 v[68:71], v[28:31], a[24:31], v0
    ds_read_b128 v[108:111], v2 offset:13312
    s_waitcnt lgkmcnt(4)
    v_smfmac_f32_16x16x64_bf16 v[56:59], v[32:35], a[32:39], v0
    ds_read_b128 v[112:115], v2 offset:10240
    v_smfmac_f32_16x16x64_bf16 v[60:63], v[32:35], a[40:47], v0
    ds_read_b128 v[116:119], v2 offset:11264
    v_smfmac_f32_16x16x64_bf16 v[64:67], v[32:35], a[48:55], v0
    ds_read_b128 v[120:123], v2 offset:14336
    v_smfmac_f32_16x16x64_bf16 v[68:71], v[32:35], a[56:63], v0
    ds_read_b128 v[124:127], v2 offset:15360
    v_smfmac_f32_16x16x64_bf16 v[56:59], v[36:39], a[64:71], v0
    v_smfmac_f32_16x16x64_bf16 v[60:63], v[36:39], a[72:79], v0
    s_waitcnt vmcnt(1)
    ds_write_b128 v1, v[40:43] offset:3072
    v_smfmac_f32_16x16x64_bf16 v[64:67], v[36:39], a[80:87], v0
    s_nop 0
    v_smfmac_f32_16x16x64_bf16 v[68:71], v[36:39], a[88:95], v0
    v_cmp_eq_u32 vcc, -1, v43
    v_smfmac_f32_16x16x64_bf16 v[72:75], v[28:31], a[208:215], v0
    v_smfmac_f32_16x16x64_bf16 v[76:79], v[28:31], a[216:223], v0
    s_cbranch_vccnz L_rL_1
L_bL_1:
    s_waitcnt lgkmcnt(0)
    s_barrier
    ds_read_b128 v[44:47], v1 offset:5120
    v_smfmac_f32_16x16x64_bf16 v[56:59], v[40:43], v[96:103], v0
    ds_read_b128 v[48:51], v1 offset:7168
    ds_read_b128 v[52:55], v1 offset:1024
    v_smfmac_f32_16x16x64_bf16 v[60:63], v[40:43], v[104:111], v0
    ds_read_b128 v[96:99], v2 offset:16384
    v_smfmac_f32_16x16x64_bf16 v[64:67], v[40:43], v[112:119], v0
    buffer_load_dwordx4 v1, s[4:7], s35 offen offset:0 sc1 lds
    ds_read_b128 v[100:103], v2 offset:17408
    v_smfmac_f32_16x16x64_bf16 v[68:71], v[40:43], v[120:127], v0
    ds_read_b128 v[104:107], v2 offset:18432
    s_waitcnt lgkmcnt(5)
    v_smfmac_f32_16x16x64_bf16 v[56:59], v[44:47], a[96:103], v0
    ds_read_b128 v[108:111], v2 offset:19456
    v_mov_b64 v[20:21], s[84:85]
    v_smfmac_f32_16x16x64_bf16 v[60:63], v[44:47], a[104:111], v0
    ds_read_b128 v[112:115], v2 offset:20480
    v_mov_b64 v[22:23], s[84:85]
    v_smfmac_f32_16x16x64_bf16 v[64:67], v[44:47], a[112:119], v0
    buffer_load_dwordx4 v1, s[4:7], s35 offen offset:1024 sc1 lds
    ds_read_b128 v[116:119], v2 offset:21504
    v_smfmac_f32_16x16x64_bf16 v[68:71], v[44:47], a[120:127], v0
    ds_read_b128 v[120:123], v2 offset:22528
    s_waitcnt lgkmcnt(7)
    v_smfmac_f32_16x16x64_bf16 v[56:59], v[48:51], a[128:135], v0
    ds_read_b128 v[124:127], v2 offset:23552
    v_smfmac_f32_16x16x64_bf16 v[60:63], v[48:51], a[136:143], v0
    v_smfmac_f32_16x16x64_bf16 v[56:59], v[52:55], a[160:167], v0
    buffer_load_dwordx4 v1, s[4:7], s35 offen offset:2048 sc1 lds
    v_smfmac_f32_16x16x64_bf16 v[60:63], v[52:55], a[168:175], v0
    v_smfmac_f32_16x16x64_bf16 v[64:67], v[48:51], a[144:151], v0
    v_cvt_pk_bf16_f32 v56, v56, v57
    v_smfmac_f32_16x16x64_bf16 v[68:71], v[48:51], a[152:159], v0
    v_cvt_pk_bf16_f32 v57, v58, v59
    v_smfmac_f32_16x16x64_bf16 v[64:67], v[52:55], a[176:183], v0
    buffer_load_dwordx4 v1, s[4:7], s35 offen offset:3072 sc1 lds
    v_cvt_pk_bf16_f32 v58, v60, v61
    v_smfmac_f32_16x16x64_bf16 v[68:71], v[52:55], a[184:191], v0
    v_cvt_pk_bf16_f32 v59, v62, v63
    s_nop 0
    v_cvt_pk_bf16_f32 v64, v64, v65
    v_mfma_f32_16x16x32_bf16 v[60:63], v[56:59], v[12:15], 0
    v_cvt_pk_bf16_f32 v65, v66, v67
    v_cvt_pk_bf16_f32 v66, v68, v69
    v_cvt_pk_bf16_f32 v67, v70, v71
    s_nop 1
    v_mfma_f32_16x16x32_bf16 v[68:71], v[64:67], v[12:15], 0
    v_cvt_pk_bf16_f32 v56, v60, v61
    v_cvt_pk_bf16_f32 v57, v62, v63
    v_cndmask_b32 v24, 0, v56, s[86:87]
    v_cndmask_b32 v25, 0, v57, s[86:87]
    v_mov_b32_dpp v28, v56 row_shr:8 row_mask:0xf bank_mask:0xf bound_ctrl:1
    v_mov_b32_dpp v29, v57 row_shr:8 row_mask:0xf bank_mask:0xf bound_ctrl:1
    s_nop 0
    v_cvt_pk_bf16_f32 v58, v68, v69
    v_cvt_pk_bf16_f32 v59, v70, v71
    v_cndmask_b32 v26, 0, v58, s[86:87]
    v_cndmask_b32 v27, 0, v59, s[86:87]
    v_mfma_f32_16x16x32_bf16 v[68:71], v[56:59], v[56:59], 0
    v_mov_b32_dpp v30, v58 row_shr:8 row_mask:0xf bank_mask:0xf bound_ctrl:1
    v_mov_b32_dpp v31, v59 row_shr:8 row_mask:0xf bank_mask:0xf bound_ctrl:1
    v_mfma_f32_16x16x32_bf16 v[64:67], v[80:83], v[24:27], 0
    s_nop 0
    v_mfma_f32_16x16x32_bf16 v[64:67], v[84:87], v[28:31], v[64:67]
    v_mov_b32_dpp v68, v70 row_ror:8 row_mask:0xf bank_mask:0xc
    v_mov_b32_dpp v69, v71 row_ror:8 row_mask:0xf bank_mask:0xc
    v_smfmac_f32_16x16x64_bf16 v[72:75], v[32:35], a[224:231], v0
    s_nop 0
    ds_write2_b32 v3, v68, v69 offset0:0 offset1:32
    v_smfmac_f32_16x16x64_bf16 v[76:79], v[32:35], a[232:239], v0
    ds_write_b128 v1, v[64:67] offset:10240
    v_smfmac_f32_16x16x64_bf16 v[72:75], v[36:39], a[240:247], v0
    v_smfmac_f32_16x16x64_bf16 v[76:79], v[36:39], a[248:255], v0
    buffer_store_dword v4, v7, s[4:7], s45 offen
    v_smfmac_f32_16x16x64_bf16 v[72:75], v[40:43], v[128:135], v0
    v_smfmac_f32_16x16x64_bf16 v[76:79], v[40:43], v[136:143], v0
    v_smfmac_f32_16x16x64_bf16 v[72:75], v[44:47], v[144:151], v0
    v_smfmac_f32_16x16x64_bf16 v[76:79], v[44:47], v[152:159], v0
    s_waitcnt lgkmcnt(0)
    s_barrier
    ds_read_b128 v[68:71], v1 offset:9216
    ds_read_b128 v[60:63], v1 offset:12288
    v_smfmac_f32_16x16x64_bf16 v[72:75], v[48:51], v[160:167], v0
    ds_read_b128 v[80:83], v1 offset:14336
    ds_read_b128 v[84:87], v1 offset:8192
    v_smfmac_f32_16x16x64_bf16 v[76:79], v[48:51], v[168:175], v0
    v_smfmac_f32_16x16x64_bf16 v[72:75], v[52:55], v[176:183], v0
    v_smfmac_f32_16x16x64_bf16 v[76:79], v[52:55], v[184:191], v0
    s_waitcnt lgkmcnt(2)
    v_add_f32 v68, v68, v69
    v_add_f32 v70, v70, v71
    v_add_f32 v64, v64, v60
    v_add_f32 v65, v65, v61
    v_pk_add_f32 v[66:67], v[66:67], v[62:63]
    v_add_f32 v68, v68, v70
    s_waitcnt lgkmcnt(0)
    v_pk_add_f32 v[80:81], v[80:81], v[84:85]
    v_pk_add_f32 v[82:83], v[82:83], v[86:87]
    v_pk_add_f32 v[64:65], v[64:65], v[80:81]
    v_pk_add_f32 v[66:67], v[66:67], v[82:83]
    v_max3_f32 v60, v68, v64, v65
    v_max3_f32 v60, v60, v66, v67
    v_cvt_pk_bf16_f32 v72, v72, v73
    v_cvt_pk_bf16_f32 v73, v74, v75
    v_max_f32_dpp v61, v60, v60 row_ror:8 row_mask:0xf bank_mask:0xf
    v_max_f32_dpp v60, v60, v60 row_ror:8 row_mask:0xf bank_mask:0xf
    v_cvt_pk_bf16_f32 v74, v76, v77
    v_cvt_pk_bf16_f32 v75, v78, v79
    v_permlane32_swap_b32 v60, v61
    v_max_f32 v62, v60, v61
    v_max_f32 v63, v60, v61
    v_permlane32_swap_b32 v72, v73
    v_permlane32_swap_b32 v74, v75
    v_permlane16_swap_b32 v62, v63
    v_max_f32 v60, v62, v63
    v_mul_f32 v60, s48, v60
    v_fma_f32 v68, v68, s48, -v60
    v_exp_f32 v68, v68
    v_pk_fma_f32 v[64:65], v[64:65], s[48:49], v[60:61] op_sel_hi:[1,1,0] neg_lo:[0,0,1] neg_hi:[0,0,1]
    v_pk_fma_f32 v[66:67], v[66:67], s[48:49], v[60:61] op_sel_hi:[1,1,0] neg_lo:[0,0,1] neg_hi:[0,0,1]
    v_mov_b32_dpp v69, v68 row_ror:8 row_mask:0xf bank_mask:0xf
    v_cvt_pk_bf16_f32 v28, v68, v69
    v_cvt_pk_bf16_f32 v29, v68, v69
    v_exp_f32 v64, v64
    v_exp_f32 v65, v65
    v_mfma_f32_16x16x16_bf16 v[80:83], v[72:73], v[28:29], 0
    v_exp_f32 v66, v66
    v_exp_f32 v67, v67
    v_cvt_pk_bf16_f32 v60, v64, v65
    v_cvt_pk_bf16_f32 v61, v66, v67
    v_mfma_f32_16x16x16_bf16 v[76:79], v[74:75], v[28:29], 0
    v_mov_b32_dpp v62, v60 row_ror:8 row_mask:0xf bank_mask:0xf
    v_mov_b32_dpp v63, v61 row_ror:8 row_mask:0xf bank_mask:0xf
    v_mov_b64 v[64:65], 0
    v_mov_b64 v[66:67], 0
    v_mfma_f32_16x16x32_bf16 v[80:83], v[88:91], v[60:63], v[80:83]
    ds_read_b128 v[32:35], v2 offset:26624
    ds_read_b128 v[36:39], v2 offset:27648
    v_mfma_f32_16x16x32_bf16 v[76:79], v[92:95], v[60:63], v[76:79]
    ds_read_b128 v[40:43], v2 offset:28672
    ds_read_b128 v[44:47], v2 offset:29696
    v_mfma_f32_16x16x16_bf16 v[68:71], v[28:29], v[10:11], 0
    v_cvt_pk_bf16_f32 v84, v80, v81
    v_cvt_pk_bf16_f32 v85, v82, v83
    v_mov_b64 v[80:81], 0
    v_mov_b64 v[82:83], 0
    v_cvt_pk_bf16_f32 v86, v76, v77
    v_cvt_pk_bf16_f32 v87, v78, v79
    v_mfma_f32_16x16x32_bf16 v[68:71], v[60:63], v[20:23], v[68:71]
    s_nop 0
    ds_write_b128 v8, v[84:87] offset:3072
    v_mov_b32_dpp v84, v84 row_ror:8 row_mask:0xf bank_mask:0xc
    v_mov_b32_dpp v85, v85 row_ror:8 row_mask:0xf bank_mask:0xc
    v_mov_b32_dpp v86, v86 row_ror:8 row_mask:0xf bank_mask:0xc
    v_mov_b32_dpp v87, v87 row_ror:8 row_mask:0xf bank_mask:0xc
    v_mov_b64 v[76:77], 0
    v_mov_b64 v[78:79], 0
    v_mov_b64 v[20:21], 0
    v_rcp_f32 v68, v68
    v_rcp_f32 v69, v69
    v_rcp_f32 v70, v70
    v_rcp_f32 v71, v71
    v_smfmac_f32_16x16x64_bf16 v[64:67], v[84:87], v[200:207], v0
    s_waitcnt lgkmcnt(0)
    s_barrier
    ds_read_b128 v[88:91], v5 offset:5120
    ds_read_b128 v[92:95], v5 offset:7168
    v_smfmac_f32_16x16x64_bf16 v[80:83], v[84:87], v[232:239], v0
    ds_read_b128 v[60:63], v5 offset:1024
    v_mov_b64 v[22:23], 0
    v_smfmac_f32_16x16x64_bf16 v[76:79], v[84:87], v[104:111], v0
    s_waitcnt lgkmcnt(2)
    v_smfmac_f32_16x16x64_bf16 v[64:67], v[88:91], v[208:215], v0
    ds_read_b128 v[48:51], v2 offset:30720
    s_waitcnt lgkmcnt(2)
    v_smfmac_f32_16x16x64_bf16 v[64:67], v[92:95], v[216:223], v0
    ds_read_b128 v[52:55], v2 offset:31744
    s_waitcnt lgkmcnt(2)
    v_smfmac_f32_16x16x64_bf16 v[64:67], v[60:63], v[192:199], v0
    ds_read_b128 v[24:27], v2 offset:24576
    v_smfmac_f32_16x16x64_bf16 v[80:83], v[88:91], v[240:247], v0
    ds_read_b128 v[28:31], v2 offset:25600
    v_smfmac_f32_16x16x64_bf16 v[80:83], v[92:95], v[248:255], v0
    v_mul_f32 v64, v64, v68
    v_smfmac_f32_16x16x64_bf16 v[80:83], v[60:63], v[224:231], v0
    v_mul_f32 v65, v65, v69
    v_mul_f32 v66, v66, v70
    v_mul_f32 v67, v67, v71
    v_cvt_pk_bf16_f32 v64, v64, v65
    v_cvt_pk_bf16_f32 v65, v66, v67
    v_bfi_b32 v64, 1, s38, v64
    v_smfmac_f32_16x16x64_bf16 v[76:79], v[88:91], v[112:119], v0
    s_nop 0
    buffer_store_dwordx2 v[64:65], v6, s[4:7], s40 offen
    v_mul_f32 v80, v80, v68
    v_mul_f32 v81, v81, v69
    v_mul_f32 v82, v82, v70
    v_mul_f32 v83, v83, v71
    v_cvt_pk_bf16_f32 v80, v80, v81
    v_cvt_pk_bf16_f32 v81, v82, v83
    v_bfi_b32 v80, 1, s38, v80
    v_smfmac_f32_16x16x64_bf16 v[76:79], v[92:95], v[120:127], v0
    s_nop 0
    buffer_store_dwordx2 v[80:81], v6, s[4:7], s41 offen
    v_smfmac_f32_16x16x64_bf16 v[76:79], v[60:63], v[96:103], v0
    s_waitcnt lgkmcnt(0)
    v_smfmac_f32_16x16x64_bf16 v[20:23], v[84:87], v[32:39], v0
    s_add_u32 s39, s44, 3072
    s_add_u32 s59, s44, 7168
    v_smfmac_f32_16x16x64_bf16 v[20:23], v[88:91], v[40:47], v0
    s_add_u32 s34, s34, 1
    s_mov_b32 s58, s36
    v_mul_f32 v76, v76, v68
    v_smfmac_f32_16x16x64_bf16 v[20:23], v[92:95], v[48:55], v0
    v_mul_f32 v77, v77, v69
    v_smfmac_f32_16x16x64_bf16 v[20:23], v[60:63], v[24:31], v0
    v_mul_f32 v78, v78, v70
    v_mul_f32 v79, v79, v71
    v_cvt_pk_bf16_f32 v76, v76, v77
    v_cvt_pk_bf16_f32 v77, v78, v79
    v_bfi_b32 v76, 1, s38, v76
    s_add_u32 s36, s36, 0x20000
    s_add_u32 s35, s35, 524288
    buffer_store_dwordx2 v[76:77], v6, s[4:7], s42 offen
    v_pk_mul_f32 v[20:21], v[20:21], v[68:69]
    v_pk_mul_f32 v[22:23], v[22:23], v[70:71]
    v_cvt_pk_bf16_f32 v20, v20, v21
    v_cvt_pk_bf16_f32 v21, v22, v23
    v_bfi_b32 v20, 1, s38, v20
    s_nop 1
    buffer_store_dwordx2 v[20:21], v6, s[4:7], s43 offen
    v_mov_b64 v[60:61], 0
    v_mov_b64 v[62:63], 0
    v_mov_b64 v[64:65], 0
    v_mov_b64 v[66:67], 0
    v_mov_b64 v[68:69], 0
    v_mov_b64 v[70:71], 0
    v_mov_b32_dpp v58, v56 row_ror:8 row_mask:0xf bank_mask:0x3
    v_mov_b32_dpp v59, v57 row_ror:8 row_mask:0xf bank_mask:0x3
    v_min_u32 v20, -2, v58
    v_min_u32 v21, -2, v59
    v_lshlrev_b32 v56, 16, v72
    v_lshlrev_b32 v57, 16, v73
    v_and_b32 v72, 0xffff0000, v72
    v_and_b32 v73, 0xffff0000, v73
    v_add_f32 v56, v56, v57
    v_add_f32 v57, v72, v73
    v_cvt_pk_bf16_f32 v56, v56, v57
    v_min_u32 v22, -2, v56
    v_lshlrev_b32 v56, 16, v74
    v_lshlrev_b32 v57, 16, v75
    v_and_b32 v74, 0xffff0000, v74
    v_and_b32 v75, 0xffff0000, v75
    v_add_f32 v56, v56, v57
    v_add_f32 v57, v74, v75
    v_cvt_pk_bf16_f32 v56, v56, v57
    v_min_u32 v23, -2, v56
    v_mov_b64 v[56:57], 0
    v_mov_b64 v[58:59], 0
    v_mov_b64 v[72:73], 0
    v_mov_b64 v[74:75], 0
    v_mov_b64 v[76:77], 0
    v_mov_b64 v[78:79], 0
    s_nop 2
    ds_read_b128 v[96:99], v2 offset:0
    s_nop 3
    buffer_load_dwordx4 v[80:83], v1, s[4:7], s37 offen offset:0 sc1
    buffer_load_dwordx4 v[84:87], v1, s[4:7], s37 offen offset:1024 sc1
    s_nop 2
    ds_read_b128 v[100:103], v2 offset:1024
    s_nop 2
    ds_read_b128 v[104:107], v2 offset:4096
    s_nop 2
    ds_read_b128 v[108:111], v2 offset:5120
    s_nop 2
    ds_read_b128 v[112:115], v2 offset:2048
    s_nop 2
    ds_read_b128 v[116:119], v2 offset:3072
    s_nop 2
    ds_read_b128 v[120:123], v2 offset:6144
    s_nop 2
    ds_read_b128 v[124:127], v2 offset:7168
    s_nop 1
    buffer_load_dwordx4 v[44:47], v1, s[4:7], s37 offen offset:0 sc1
    buffer_load_dwordx4 v[48:51], v1, s[4:7], s37 offen offset:1024 sc1
    s_waitcnt vmcnt(3)
L_a1_1:
    v_mfma_f32_16x16x32_bf16 v[32:35], v[16:19], v[80:83], 0
    v_bitop3_b32 v36, v80, v82, s38 bitop3:0x7e
    s_waitcnt vmcnt(2)
    v_mfma_f32_16x16x32_bf16 v[32:35], v[16:19], v[84:87], v[32:35]
    v_bitop3_b32 v37, v84, v86, s38 bitop3:0x7e
    v_bitop3_b32 v36, v36, v37, 1 bitop3:0xa8
    v_cmp_ne_u32 vcc, 0, v36
    s_nop 3
    v_add_f32_dpp v32, v32, v32 row_ror:4 row_mask:0xf bank_mask:0xf
    v_add_f32_dpp v33, v33, v33 row_ror:4 row_mask:0xf bank_mask:0xf
    s_nop 0
    v_add_f32_dpp v32, v32, v32 row_ror:8 row_mask:0xf bank_mask:0xf
    v_add_f32_dpp v33, v33, v33 row_ror:8 row_mask:0xf bank_mask:0xf
    v_cvt_pk_bf16_f32 v32, v32, v33
    s_cbranch_vccnz L_r2_1
    buffer_store_dword v32, v7, s[4:7], s44 offen
L_a2_1:
    ds_read_b128 v[80:83], v1 offset:20480
    ds_read_b128 v[84:87], v1 offset:21504
    ds_read_b128 v[88:91], v1 offset:22528
    ds_read_b128 v[92:95], v1 offset:23552
    s_mov_b32 s44, s45
    s_add_u32 s45, s45, 0x2000
    s_and_b32 s45, s45, 0xffff7fff
    s_xor_b32 s38, s38, 1
    s_nop 11
    buffer_load_dwordx4 v[24:27], v1, s[4:7], s39 offen sc1
    s_nop 15
    s_nop 6
    buffer_load_dwordx4 v[24:27], v1, s[4:7], s39 offen sc1
    s_nop 15
    s_nop 6
    buffer_load_dwordx4 v[24:27], v1, s[4:7], s39 offen sc1
    s_cmp_lg_u32 s34, 63
    s_cbranch_scc1 L_top_1
    s_waitcnt vmcnt(2) lgkmcnt(0)
L_l0_1:
    v_cmp_eq_u32 vcc, -1, v27
    ds_write_b128 v1, v[24:27] offset:2048
    s_cbranch_vccnz L_l1_1
    buffer_load_dwordx4 v[40:43], v1, s[4:7], s59 offen sc1
    v_smfmac_f32_16x16x64_bf16 v[60:63], v[24:27], v[104:111], v0
    v_smfmac_f32_16x16x64_bf16 v[68:71], v[24:27], v[120:127], v0
    s_waitcnt lgkmcnt(0)
    s_barrier
    ds_read_b128 v[28:31], v1 offset:4096
    ds_read_b128 v[32:35], v1 offset:6144
    ds_read_b128 v[36:39], v1 offset:0
    v_smfmac_f32_16x16x64_bf16 v[72:75], v[24:27], a[192:199], v0
    v_smfmac_f32_16x16x64_bf16 v[76:79], v[24:27], a[200:207], v0
    buffer_store_dwordx4 v[20:23], v1, s[4:7], s58 offen sc1
    ds_read_b128 v[104:107], v2 offset:12288
    ds_read_b128 v[108:111], v2 offset:13312
    ds_read_b128 v[120:123], v2 offset:14336
    ds_read_b128 v[124:127], v2 offset:15360
    s_waitcnt lgkmcnt(6)
    v_smfmac_f32_16x16x64_bf16 v[60:63], v[28:31], a[8:15], v0
    v_smfmac_f32_16x16x64_bf16 v[68:71], v[28:31], a[24:31], v0
    v_smfmac_f32_16x16x64_bf16 v[72:75], v[28:31], a[208:215], v0
    v_smfmac_f32_16x16x64_bf16 v[76:79], v[28:31], a[216:223], v0
    s_waitcnt lgkmcnt(5)
    v_smfmac_f32_16x16x64_bf16 v[60:63], v[32:35], a[40:47], v0
    v_smfmac_f32_16x16x64_bf16 v[68:71], v[32:35], a[56:63], v0
    v_smfmac_f32_16x16x64_bf16 v[72:75], v[32:35], a[224:231], v0
    v_smfmac_f32_16x16x64_bf16 v[76:79], v[32:35], a[232:239], v0
    s_waitcnt vmcnt(1) lgkmcnt(0)
L_l2_1:
    s_nop 0
    s_nop 0
    v_cmp_eq_u32 vcc, -1, v43
    ds_write_b128 v1, v[40:43] offset:3072
    s_cbranch_vccnz L_l3_1
    v_smfmac_f32_16x16x64_bf16 v[60:63], v[36:39], a[72:79], v0
    v_smfmac_f32_16x16x64_bf16 v[68:71], v[36:39], a[88:95], v0
    v_smfmac_f32_16x16x64_bf16 v[72:75], v[36:39], a[240:247], v0
    v_smfmac_f32_16x16x64_bf16 v[76:79], v[36:39], a[248:255], v0
    s_waitcnt lgkmcnt(0)
    s_barrier
    ds_read_b128 v[44:47], v1 offset:5120
    ds_read_b128 v[48:51], v1 offset:7168
    ds_read_b128 v[52:55], v1 offset:1024
    v_smfmac_f32_16x16x64_bf16 v[60:63], v[40:43], v[104:111], v0
    v_smfmac_f32_16x16x64_bf16 v[68:71], v[40:43], v[120:127], v0
    v_smfmac_f32_16x16x64_bf16 v[72:75], v[40:43], v[128:135], v0
    v_smfmac_f32_16x16x64_bf16 v[76:79], v[40:43], v[136:143], v0
    s_waitcnt lgkmcnt(2)
    v_smfmac_f32_16x16x64_bf16 v[60:63], v[44:47], a[104:111], v0
    v_smfmac_f32_16x16x64_bf16 v[68:71], v[44:47], a[120:127], v0
    s_waitcnt lgkmcnt(1)
    v_smfmac_f32_16x16x64_bf16 v[60:63], v[48:51], a[136:143], v0
    v_smfmac_f32_16x16x64_bf16 v[68:71], v[48:51], a[152:159], v0
    s_waitcnt lgkmcnt(0)
    v_smfmac_f32_16x16x64_bf16 v[60:63], v[52:55], a[168:175], v0
    v_smfmac_f32_16x16x64_bf16 v[68:71], v[52:55], a[184:191], v0
    v_smfmac_f32_16x16x64_bf16 v[72:75], v[44:47], v[144:151], v0
    v_smfmac_f32_16x16x64_bf16 v[76:79], v[44:47], v[152:159], v0
    v_cvt_pk_bf16_f32 v58, v60, v61
    v_cvt_pk_bf16_f32 v59, v62, v63
    v_cvt_pk_bf16_f32 v66, v68, v69
    v_cvt_pk_bf16_f32 v67, v70, v71
    v_smfmac_f32_16x16x64_bf16 v[72:75], v[48:51], v[160:167], v0
    v_mfma_f32_16x16x32_bf16 v[60:63], v[56:59], v[12:15], 0
    v_mfma_f32_16x16x32_bf16 v[68:71], v[64:67], v[12:15], 0
    v_smfmac_f32_16x16x64_bf16 v[76:79], v[48:51], v[168:175], v0
    v_smfmac_f32_16x16x64_bf16 v[72:75], v[52:55], v[176:183], v0
    v_smfmac_f32_16x16x64_bf16 v[76:79], v[52:55], v[184:191], v0
    v_cvt_pk_bf16_f32 v56, v60, v61
    v_cvt_pk_bf16_f32 v57, v62, v63
    v_cvt_pk_bf16_f32 v58, v68, v69
    v_cvt_pk_bf16_f32 v59, v70, v71
    s_nop 1
    v_cvt_pk_bf16_f32 v72, v72, v73
    v_cvt_pk_bf16_f32 v73, v74, v75
    v_cvt_pk_bf16_f32 v74, v76, v77
    v_cvt_pk_bf16_f32 v75, v78, v79
    v_mov_b32_dpp v58, v56 row_ror:8 row_mask:0xf bank_mask:0x3
    v_mov_b32_dpp v59, v57 row_ror:8 row_mask:0xf bank_mask:0x3
    v_permlane32_swap_b32 v72, v73
    v_permlane32_swap_b32 v74, v75
    v_min_u32 v20, -2, v58
    v_min_u32 v21, -2, v59
    v_lshlrev_b32 v56, 16, v72
    v_lshlrev_b32 v57, 16, v73
    v_and_b32 v72, 0xffff0000, v72
    v_and_b32 v73, 0xffff0000, v73
    v_add_f32 v56, v56, v57
    v_add_f32 v57, v72, v73
    v_cvt_pk_bf16_f32 v56, v56, v57
    v_min_u32 v22, -2, v56
    v_lshlrev_b32 v56, 16, v74
    v_lshlrev_b32 v57, 16, v75
    v_and_b32 v74, 0xffff0000, v74
    v_and_b32 v75, 0xffff0000, v75
    v_add_f32 v56, v56, v57
    v_add_f32 v57, v74, v75
    v_cvt_pk_bf16_f32 v56, v56, v57
    v_min_u32 v23, -2, v56
    buffer_store_dwordx4 v[20:23], v1, s[4:7], s36 offen sc1
    s_endpgm
L_l1_1:
    buffer_load_dwordx4 v[24:27], v1, s[4:7], s39 offen sc1
    s_add_u32 s47, s47, 1
    s_cmp_gt_u32 s47, 1000000
    s_cbranch_scc1 L_exit
    s_waitcnt vmcnt(2)
    s_branch L_l0_1
L_l3_1:
    buffer_load_dwordx4 v[40:43], v1, s[4:7], s59 offen sc1
    s_add_u32 s47, s47, 1
    s_cmp_gt_u32 s47, 1000000
    s_cbranch_scc1 L_exit
    s_waitcnt vmcnt(0)
    s_branch L_l2_1
L_f1_1:
    buffer_load_dwordx4 v[24:27], v1, s[4:7], s39 offen sc1
    s_waitcnt vmcnt(2)
    v_cmp_eq_u32 vcc, -1, v27
    s_nop 0
    ds_write_b128 v1, v[24:27] offset:2048
    s_cbranch_vccnz L_f2_1
    buffer_load_dwordx4 v[40:43], v1, s[4:7], s59 offen sc1
    v_smfmac_f32_16x16x64_bf16 v[56:59], v[24:27], v[96:103], v0
    v_smfmac_f32_16x16x64_bf16 v[60:63], v[24:27], v[104:111], v0
    v_smfmac_f32_16x16x64_bf16 v[64:67], v[24:27], v[112:119], v0
    s_waitcnt lgkmcnt(0)
    s_barrier
    ds_read_b128 v[28:31], v1 offset:4096
    ds_read_b128 v[32:35], v1 offset:6144
    v_smfmac_f32_16x16x64_bf16 v[68:71], v[24:27], v[120:127], v0
    ds_read_b128 v[36:39], v1 offset:0
    v_smfmac_f32_16x16x64_bf16 v[72:75], v[24:27], a[192:199], v0
    v_smfmac_f32_16x16x64_bf16 v[76:79], v[24:27], a[200:207], v0
    s_branch L_go2_1
L_f2_1:
    buffer_load_dwordx4 v[24:27], v1, s[4:7], s39 offen sc1
    s_waitcnt vmcnt(2)
    v_cmp_eq_u32 vcc, -1, v27
    s_nop 0
    ds_write_b128 v1, v[24:27] offset:2048
    s_cbranch_vccnz L_f3_1
    buffer_load_dwordx4 v[40:43], v1, s[4:7], s59 offen sc1
    s_branch L_go_1
L_f3_1:
    buffer_load_dwordx4 v[24:27], v1, s[4:7], s39 offen sc1
    s_waitcnt vmcnt(2)
    v_cmp_eq_u32 vcc, -1, v27
    s_nop 0
    ds_write_b128 v1, v[24:27] offset:2048
    s_cbranch_vccnz L_f4_1
    buffer_load_dwordx4 v[40:43], v1, s[4:7], s59 offen sc1
    s_branch L_go_1
L_f4_1:
    s_add_u32 s47, s47, 1
    s_cmp_gt_u32 s47, 1000000
    s_cbranch_scc1 L_exit
    s_branch L_f3_1
L_rL_1:
    buffer_load_dwordx4 v[40:43], v1, s[4:7], s59 offen sc1
    s_add_u32 s47, s47, 1
    s_cmp_gt_u32 s47, 1000000
    s_cbranch_scc1 L_exit
    s_waitcnt vmcnt(0)
    ds_write_b128 v1, v[40:43] offset:3072
    s_nop 0
    s_nop 0
    v_cmp_eq_u32 vcc, -1, v43
    s_waitcnt lgkmcnt(0)
    s_cbranch_vccnz L_rL_1
    s_branch L_bL_1
L_r2_1:
    s_waitcnt vmcnt(0)
    v_mfma_f32_16x16x32_bf16 v[32:35], v[16:19], v[44:47], 0
    v_bitop3_b32 v36, v44, v46, s38 bitop3:0x7e
    v_bitop3_b32 v37, v48, v50, s38 bitop3:0x7e
    v_mfma_f32_16x16x32_bf16 v[32:35], v[16:19], v[48:51], v[32:35]
    v_bitop3_b32 v36, v36, v37, 1 bitop3:0xa8
    v_cmp_ne_u32 vcc, 0, v36
    s_nop 0
    s_nop 3
    v_add_f32_dpp v32, v32, v32 row_ror:4 row_mask:0xf bank_mask:0xf
    v_add_f32_dpp v33, v33, v33 row_ror:4 row_mask:0xf bank_mask:0xf
    s_nop 0
    v_add_f32_dpp v32, v32, v32 row_ror:8 row_mask:0xf bank_mask:0xf
    v_add_f32_dpp v33, v33, v33 row_ror:8 row_mask:0xf bank_mask:0xf
    v_cvt_pk_bf16_f32 v32, v32, v33
    s_cbranch_vccnz L_r1_1
    buffer_store_dword v32, v7, s[4:7], s44 offen
    s_branch L_a2_1
L_r1_1:
    buffer_load_dwordx4 v[80:83], v1, s[4:7], s37 offen offset:0 sc1
    buffer_load_dwordx4 v[84:87], v1, s[4:7], s37 offen offset:1024 sc1
    s_add_u32 s47, s47, 1
    s_cmp_gt_u32 s47, 1000000
    s_cbranch_scc1 L_exit
    s_waitcnt vmcnt(0)
    s_branch L_a1_1
L_step_1:
    ds_write_b128 v1, v[24:27] offset:2048
    s_branch L_go_1
.p2align 6
L_top_2:
    s_waitcnt vmcnt(2) lgkmcnt(0)
    v_cmp_eq_u32 vcc, -1, v27
    ds_write_b128 v1, v[24:27] offset:4096
    s_cbranch_vccnz L_f1_2
    buffer_load_dwordx4 v[40:43], v1, s[4:7], s59 offen sc1
L_go_2:
    v_smfmac_f32_16x16x64_bf16 v[56:59], v[24:27], v[96:103], v0
    v_smfmac_f32_16x16x64_bf16 v[60:63], v[24:27], v[104:111], v0
    v_smfmac_f32_16x16x64_bf16 v[64:67], v[24:27], v[112:119], v0
    s_waitcnt lgkmcnt(0)
    s_barrier
    ds_read_b128 v[28:31], v1 offset:6144
    ds_read_b128 v[32:35], v1 offset:0
    v_smfmac_f32_16x16x64_bf16 v[68:71], v[24:27], v[120:127], v0
    ds_read_b128 v[36:39], v1 offset:2048
    v_smfmac_f32_16x16x64_bf16 v[72:75], v[24:27], a[192:199], v0
    v_smfmac_f32_16x16x64_bf16 v[76:79], v[24:27], a[200:207], v0
L_go2_2:
    s_waitcnt lgkmcnt(2)
    v_smfmac_f32_16x16x64_bf16 v[56:59], v[28:31], a[0:7], v0
    buffer_store_dwordx4 v[20:23], v1, s[4:7], s58 offen sc1
    ds_read_b128 v[96:99], v2 offset:8192
    v_smfmac_f32_16x16x64_bf16 v[60:63], v[28:31], a[8:15], v0
    ds_read_b128 v[100:103], v2 offset:9216
    v_smfmac_f32_16x16x64_bf16 v[64:67], v[28:31], a[16:23], v0
    ds_read_b128 v[104:107], v2 offset:12288
    v_smfmac_f32_16x16x64_bf16 v[68:71], v[28:31], a[24:31], v0
    ds_read_b128 v[108:111], v2 offset:13312
    s_waitcnt lgkmcnt(4)
    v_smfmac_f32_16x16x64_bf16 v[56:59], v[32:35], a[32:39], v0
    ds_read_b128 v[112:115], v2 offset:10240
    v_smfmac_f32_16x16x64_bf16 v[60:63], v[32:35], a[40:47], v0
    ds_read_b128 v[116:119], v2 offset:11264
    v_smfmac_f32_16x16x64_bf16 v[64:67], v[32:35], a[48:55], v0
    ds_read_b128 v[120:123], v2 offset:14336
    v_smfmac_f32_16x16x64_bf16 v[68:71], v[32:35], a[56:63], v0
    ds_read_b128 v[124:127], v2 offset:15360
    v_smfmac_f32_16x16x64_bf16 v[56:59], v[36:39], a[64:71], v0
    v_smfmac_f32_16x16x64_bf16 v[60:63], v[36:39], a[72:79], v0
    s_waitcnt vmcnt(1)
    ds_write_b128 v1, v[40:43] offset:5120
    v_smfmac_f32_16x16x64_bf16 v[64:67], v[36:39], a[80:87], v0
    s_nop 0
    v_smfmac_f32_16x16x64_bf16 v[68:71], v[36:39], a[88:95], v0
    v_cmp_eq_u32 vcc, -1, v43
    v_smfmac_f32_16x16x64_bf16 v[72:75], v[28:31], a[208:215], v0
    v_smfmac_f32_16x16x64_bf16 v[76:79], v[28:31], a[216:223], v0
    s_cbranch_vccnz L_rL_2
L_bL_2:
    s_waitcnt lgkmcnt(0)
    s_barrier
    ds_read_b128 v[44:47], v1 offset:7168
    v_smfmac_f32_16x16x64_bf16 v[56:59], v[40:43], v[96:103], v0
    ds_read_b128 v[48:51], v1 offset:1024
    ds_read_b128 v[52:55], v1 offset:3072
    v_smfmac_f32_16x16x64_bf16 v[60:63], v[40:43], v[104:111], v0
    ds_read_b128 v[96:99], v2 offset:16384
    v_smfmac_f32_16x16x64_bf16 v[64:67], v[40:43], v[112:119], v0
    ds_read_b128 v[100:103], v2 offset:17408
    v_smfmac_f32_16x16x64_bf16 v[68:71], v[40:43], v[120:127], v0
    buffer_load_dwordx4 v1, s[4:7], s35 offen offset:0 sc1 lds
    s_waitcnt lgkmcnt(4)
    v_smfmac_f32_16x16x64_bf16 v[56:59], v[44:47], a[96:103], v0
    ds_read_b128 v[104:107], v2 offset:18432
    v_mov_b64 v[20:21], s[84:85]
    v_smfmac_f32_16x16x64_bf16 v[60:63], v[44:47], a[104:111], v0
    ds_read_b128 v[108:111], v2 offset:19456
    v_mov_b64 v[22:23], s[84:85]
    v_smfmac_f32_16x16x64_bf16 v[64:67], v[44:47], a[112:119], v0
    ds_read_b128 v[112:115], v2 offset:20480
    v_smfmac_f32_16x16x64_bf16 v[68:71], v[44:47], a[120:127], v0
    buffer_load_dwordx4 v1, s[4:7], s35 offen offset:1024 sc1 lds
    s_waitcnt lgkmcnt(5)
    v_smfmac_f32_16x16x64_bf16 v[56:59], v[48:51], a[128:135], v0
    ds_read_b128 v[116:119], v2 offset:21504
    v_smfmac_f32_16x16x64_bf16 v[60:63], v[48:51], a[136:143], v0
    ds_read_b128 v[120:123], v2 offset:22528
    v_smfmac_f32_16x16x64_bf16 v[56:59], v[52:55], a[160:167], v0
    ds_read_b128 v[124:127], v2 offset:23552
    v_smfmac_f32_16x16x64_bf16 v[60:63], v[52:55], a[168:175], v0
    buffer_load_dwordx4 v1, s[4:7], s35 offen offset:2048 sc1 lds
    v_smfmac_f32_16x16x64_bf16 v[64:67], v[48:51], a[144:151], v0
    v_cvt_pk_bf16_f32 v56, v56, v57
    v_smfmac_f32_16x16x64_bf16 v[68:71], v[48:51], a[152:159], v0
    v_cvt_pk_bf16_f32 v57, v58, v59
    v_smfmac_f32_16x16x64_bf16 v[64:67], v[52:55], a[176:183], v0
    v_cvt_pk_bf16_f32 v58, v60, v61
    v_smfmac_f32_16x16x64_bf16 v[68:71], v[52:55], a[184:191], v0
    buffer_load_dwordx4 v1, s[4:7], s35 offen offset:3072 sc1 lds
    v_cvt_pk_bf16_f32 v59, v62, v63
    s_nop 0
    v_cvt_pk_bf16_f32 v64, v64, v65
    v_mfma_f32_16x16x32_bf16 v[60:63], v[56:59], v[12:15], 0
    v_cvt_pk_bf16_f32 v65, v66, v67
    v_cvt_pk_bf16_f32 v66, v68, v69
    v_cvt_pk_bf16_f32 v67, v70, v71
    s_nop 1
    v_mfma_f32_16x16x32_bf16 v[68:71], v[64:67], v[12:15], 0
    v_cvt_pk_bf16_f32 v56, v60, v61
    v_cvt_pk_bf16_f32 v57, v62, v63
    v_cndmask_b32 v24, 0, v56, s[86:87]
    v_cndmask_b32 v25, 0, v57, s[86:87]
    v_mov_b32_dpp v28, v56 row_shr:8 row_mask:0xf bank_mask:0xf bound_ctrl:1
    v_mov_b32_dpp v29, v57 row_shr:8 row_mask:0xf bank_mask:0xf bound_ctrl:1
    s_nop 0
    v_cvt_pk_bf16_f32 v58, v68, v69
    v_cvt_pk_bf16_f32 v59, v70, v71
    v_cndmask_b32 v26, 0, v58, s[86:87]
    v_cndmask_b32 v27, 0, v59, s[86:87]
    v_mfma_f32_16x16x32_bf16 v[68:71], v[56:59], v[56:59], 0
    v_mov_b32_dpp v30, v58 row_shr:8 row_mask:0xf bank_mask:0xf bound_ctrl:1
    v_mov_b32_dpp v31, v59 row_shr:8 row_mask:0xf bank_mask:0xf bound_ctrl:1
    v_mfma_f32_16x16x32_bf16 v[64:67], v[80:83], v[24:27], 0
    s_nop 0
    v_mfma_f32_16x16x32_bf16 v[64:67], v[84:87], v[28:31], v[64:67]
    v_mov_b32_dpp v68, v70 row_ror:8 row_mask:0xf bank_mask:0xc
    v_mov_b32_dpp v69, v71 row_ror:8 row_mask:0xf bank_mask:0xc
    v_smfmac_f32_16x16x64_bf16 v[72:75], v[32:35], a[224:231], v0
    s_nop 0
    ds_write2_b32 v3, v68, v69 offset0:0 offset1:32
    v_smfmac_f32_16x16x64_bf16 v[76:79], v[32:35], a[232:239], v0
    ds_write_b128 v1, v[64:67] offset:12288
    v_smfmac_f32_16x16x64_bf16 v[72:75], v[36:39], a[240:247], v0
    buffer_store_dword v4, v7, s[4:7], s45 offen
    v_smfmac_f32_16x16x64_bf16 v[76:79], v[36:39], a[248:255], v0
    v_smfmac_f32_16x16x64_bf16 v[72:75], v[40:43], v[128:135], v0
    v_smfmac_f32_16x16x64_bf16 v[76:79], v[40:43], v[136:143], v0
    v_smfmac_f32_16x16x64_bf16 v[72:75], v[44:47], v[144:151], v0
    v_smfmac_f32_16x16x64_bf16 v[76:79], v[44:47], v[152:159], v0
    s_waitcnt lgkmcnt(0)
    s_barrier
    ds_read_b128 v[68:71], v1 offset:9216
    ds_read_b128 v[60:63], v1 offset:14336
    v_smfmac_f32_16x16x64_bf16 v[72:75], v[48:51], v[160:167], v0
    ds_read_b128 v[80:83], v1 offset:8192
    ds_read_b128 v[84:87], v1 offset:10240
    v_smfmac_f32_16x16x64_bf16 v[76:79], v[48:51], v[168:175], v0
    v_smfmac_f32_16x16x64_bf16 v[72:75], v[52:55], v[176:183], v0
    v_smfmac_f32_16x16x64_bf16 v[76:79], v[52:55], v[184:191], v0
    s_waitcnt lgkmcnt(2)
    v_add_f32 v68, v68, v69
    v_add_f32 v70, v70, v71
    v_add_f32 v64, v64, v60
    v_add_f32 v65, v65, v61
    v_pk_add_f32 v[66:67], v[66:67], v[62:63]
    v_add_f32 v68, v68, v70
    s_waitcnt lgkmcnt(0)
    v_pk_add_f32 v[80:81], v[80:81], v[84:85]
    v_pk_add_f32 v[82:83], v[82:83], v[86:87]
    v_pk_add_f32 v[64:65], v[64:65], v[80:81]
    v_pk_add_f32 v[66:67], v[66:67], v[82:83]
    v_max3_f32 v60, v68, v64, v65
    v_max3_f32 v60, v60, v66, v67
    v_cvt_pk_bf16_f32 v72, v72, v73
    v_cvt_pk_bf16_f32 v73, v74, v75
    v_max_f32_dpp v61, v60, v60 row_ror:8 row_mask:0xf bank_mask:0xf
    v_max_f32_dpp v60, v60, v60 row_ror:8 row_mask:0xf bank_mask:0xf
    v_cvt_pk_bf16_f32 v74, v76, v77
    v_cvt_pk_bf16_f32 v75, v78, v79
    v_permlane32_swap_b32 v60, v61
    v_max_f32 v62, v60, v61
    v_max_f32 v63, v60, v61
    v_permlane32_swap_b32 v72, v73
    v_permlane32_swap_b32 v74, v75
    v_permlane16_swap_b32 v62, v63
    v_max_f32 v60, v62, v63
    v_mul_f32 v60, s48, v60
    v_fma_f32 v68, v68, s48, -v60
    v_exp_f32 v68, v68
    v_pk_fma_f32 v[64:65], v[64:65], s[48:49], v[60:61] op_sel_hi:[1,1,0] neg_lo:[0,0,1] neg_hi:[0,0,1]
    v_pk_fma_f32 v[66:67], v[66:67], s[48:49], v[60:61] op_sel_hi:[1,1,0] neg_lo:[0,0,1] neg_hi:[0,0,1]
    v_mov_b32_dpp v69, v68 row_ror:8 row_mask:0xf bank_mask:0xf
    v_cvt_pk_bf16_f32 v36, v68, v69
    v_cvt_pk_bf16_f32 v37, v68, v69
    v_exp_f32 v64, v64
    v_exp_f32 v65, v65
    v_mfma_f32_16x16x16_bf16 v[80:83], v[72:73], v[36:37], 0
    v_exp_f32 v66, v66
    v_exp_f32 v67, v67
    v_cvt_pk_bf16_f32 v60, v64, v65
    v_cvt_pk_bf16_f32 v61, v66, v67
    v_mfma_f32_16x16x16_bf16 v[76:79], v[74:75], v[36:37], 0
    v_mov_b32_dpp v62, v60 row_ror:8 row_mask:0xf bank_mask:0xf
    v_mov_b32_dpp v63, v61 row_ror:8 row_mask:0xf bank_mask:0xf
    v_mov_b64 v[64:65], 0
    v_mov_b64 v[66:67], 0
    v_mfma_f32_16x16x32_bf16 v[80:83], v[88:91], v[60:63], v[80:83]
    ds_read_b128 v[40:43], v2 offset:28672
    ds_read_b128 v[44:47], v2 offset:29696
    v_mfma_f32_16x16x32_bf16 v[76:79], v[92:95], v[60:63], v[76:79]
    ds_read_b128 v[48:51], v2 offset:30720
    ds_read_b128 v[52:55], v2 offset:31744
    v_mfma_f32_16x16x16_bf16 v[68:71], v[36:37], v[10:11], 0
    v_cvt_pk_bf16_f32 v84, v80, v81
    v_cvt_pk_bf16_f32 v85, v82, v83
    v_mov_b64 v[80:81], 0
    v_mov_b64 v[82:83], 0
    v_cvt_pk_bf16_f32 v86, v76, v77
    v_cvt_pk_bf16_f32 v87, v78, v79
    v_mfma_f32_16x16x32_bf16 v[68:71], v[60:63], v[20:23], v[68:71]
    s_nop 0
    ds_write_b128 v8, v[84:87] offset:5120
    v_mov_b32_dpp v84, v84 row_ror:8 row_mask:0xf bank_mask:0xc
    v_mov_b32_dpp v85, v85 row_ror:8 row_mask:0xf bank_mask:0xc
    v_mov_b32_dpp v86, v86 row_ror:8 row_mask:0xf bank_mask:0xc
    v_mov_b32_dpp v87, v87 row_ror:8 row_mask:0xf bank_mask:0xc
    v_mov_b64 v[76:77], 0
    v_mov_b64 v[78:79], 0
    v_mov_b64 v[20:21], 0
    v_rcp_f32 v68, v68
    v_rcp_f32 v69, v69
    v_rcp_f32 v70, v70
    v_rcp_f32 v71, v71
    v_smfmac_f32_16x16x64_bf16 v[64:67], v[84:87], v[208:215], v0
    s_waitcnt lgkmcnt(0)
    s_barrier
    ds_read_b128 v[88:91], v5 offset:7168
    ds_read_b128 v[92:95], v5 offset:1024
    v_smfmac_f32_16x16x64_bf16 v[80:83], v[84:87], v[240:247], v0
    ds_read_b128 v[60:63], v5 offset:3072
    v_mov_b64 v[22:23], 0
    v_smfmac_f32_16x16x64_bf16 v[76:79], v[84:87], v[112:119], v0
    s_waitcnt lgkmcnt(2)
    v_smfmac_f32_16x16x64_bf16 v[64:67], v[88:91], v[216:223], v0
    ds_read_b128 v[24:27], v2 offset:24576
    s_waitcnt lgkmcnt(2)
    v_smfmac_f32_16x16x64_bf16 v[64:67], v[92:95], v[192:199], v0
    ds_read_b128 v[28:31], v2 offset:25600
    s_waitcnt lgkmcnt(2)
    v_smfmac_f32_16x16x64_bf16 v[64:67], v[60:63], v[200:207], v0
    ds_read_b128 v[32:35], v2 offset:26624
    v_smfmac_f32_16x16x64_bf16 v[80:83], v[88:91], v[248:255], v0
    ds_read_b128 v[36:39], v2 offset:27648
    v_smfmac_f32_16x16x64_bf16 v[80:83], v[92:95], v[224:231], v0
    v_mul_f32 v64, v64, v68
    v_smfmac_f32_16x16x64_bf16 v[80:83], v[60:63], v[232:239], v0
    v_mul_f32 v65, v65, v69
    v_mul_f32 v66, v66, v70
    v_mul_f32 v67, v67, v71
    v_cvt_pk_bf16_f32 v64, v64, v65
    v_cvt_pk_bf16_f32 v65, v66, v67
    v_bfi_b32 v64, 1, s38, v64
    v_smfmac_f32_16x16x64_bf16 v[76:79], v[88:91], v[120:127], v0
    s_nop 0
    buffer_store_dwordx2 v[64:65], v6, s[4:7], s40 offen
    v_mul_f32 v80, v80, v68
    v_mul_f32 v81, v81, v69
    v_mul_f32 v82, v82, v70
    v_mul_f32 v83, v83, v71
    v_cvt_pk_bf16_f32 v80, v80, v81
    v_cvt_pk_bf16_f32 v81, v82, v83
    v_bfi_b32 v80, 1, s38, v80
    v_smfmac_f32_16x16x64_bf16 v[76:79], v[92:95], v[96:103], v0
    s_nop 0
    buffer_store_dwordx2 v[80:81], v6, s[4:7], s41 offen
    v_smfmac_f32_16x16x64_bf16 v[76:79], v[60:63], v[104:111], v0
    s_waitcnt lgkmcnt(0)
    v_smfmac_f32_16x16x64_bf16 v[20:23], v[84:87], v[40:47], v0
    s_add_u32 s39, s44, 0
    s_add_u32 s59, s44, 4096
    v_smfmac_f32_16x16x64_bf16 v[20:23], v[88:91], v[48:55], v0
    s_add_u32 s34, s34, 1
    s_mov_b32 s58, s36
    v_mul_f32 v76, v76, v68
    v_smfmac_f32_16x16x64_bf16 v[20:23], v[92:95], v[24:31], v0
    v_mul_f32 v77, v77, v69
    v_smfmac_f32_16x16x64_bf16 v[20:23], v[60:63], v[32:39], v0
    v_mul_f32 v78, v78, v70
    v_mul_f32 v79, v79, v71
    v_cvt_pk_bf16_f32 v76, v76, v77
    v_cvt_pk_bf16_f32 v77, v78, v79
    v_bfi_b32 v76, 1, s38, v76
    s_add_u32 s36, s36, 0x20000
    s_add_u32 s35, s35, 524288
    buffer_store_dwordx2 v[76:77], v6, s[4:7], s42 offen
    v_pk_mul_f32 v[20:21], v[20:21], v[68:69]
    v_pk_mul_f32 v[22:23], v[22:23], v[70:71]
    v_cvt_pk_bf16_f32 v20, v20, v21
    v_cvt_pk_bf16_f32 v21, v22, v23
    v_bfi_b32 v20, 1, s38, v20
    s_nop 1
    buffer_store_dwordx2 v[20:21], v6, s[4:7], s43 offen
    v_mov_b64 v[60:61], 0
    v_mov_b64 v[62:63], 0
    v_mov_b64 v[64:65], 0
    v_mov_b64 v[66:67], 0
    v_mov_b64 v[68:69], 0
    v_mov_b64 v[70:71], 0
    v_mov_b32_dpp v58, v56 row_ror:8 row_mask:0xf bank_mask:0x3
    v_mov_b32_dpp v59, v57 row_ror:8 row_mask:0xf bank_mask:0x3
    v_min_u32 v20, -2, v58
    v_min_u32 v21, -2, v59
    v_lshlrev_b32 v56, 16, v72
    v_lshlrev_b32 v57, 16, v73
    v_and_b32 v72, 0xffff0000, v72
    v_and_b32 v73, 0xffff0000, v73
    v_add_f32 v56, v56, v57
    v_add_f32 v57, v72, v73
    v_cvt_pk_bf16_f32 v56, v56, v57
    v_min_u32 v22, -2, v56
    v_lshlrev_b32 v56, 16, v74
    v_lshlrev_b32 v57, 16, v75
    v_and_b32 v74, 0xffff0000, v74
    v_and_b32 v75, 0xffff0000, v75
    v_add_f32 v56, v56, v57
    v_add_f32 v57, v74, v75
    v_cvt_pk_bf16_f32 v56, v56, v57
    v_min_u32 v23, -2, v56
    v_mov_b64 v[56:57], 0
    v_mov_b64 v[58:59], 0
    v_mov_b64 v[72:73], 0
    v_mov_b64 v[74:75], 0
    v_mov_b64 v[76:77], 0
    v_mov_b64 v[78:79], 0
    s_nop 2
    ds_read_b128 v[96:99], v2 offset:0
    s_nop 2
    ds_read_b128 v[100:103], v2 offset:1024
    s_nop 2
    ds_read_b128 v[104:107], v2 offset:4096
    s_nop 2
    ds_read_b128 v[108:111], v2 offset:5120
    s_nop 2
    ds_read_b128 v[112:115], v2 offset:2048
    s_nop 2
    ds_read_b128 v[116:119], v2 offset:3072
    s_nop 2
    ds_read_b128 v[120:123], v2 offset:6144
    s_nop 1
    buffer_load_dwordx4 v[80:83], v1, s[4:7], s37 offen offset:0 sc1
    buffer_load_dwordx4 v[84:87], v1, s[4:7], s37 offen offset:1024 sc1
    s_nop 2
    ds_read_b128 v[124:127], v2 offset:7168
    s_nop 15
    s_nop 7
    buffer_load_dwordx4 v[44:47], v1, s[4:7], s37 offen offset:0 sc1
    buffer_load_dwordx4 v[48:51], v1, s[4:7], s37 offen offset:1024 sc1
    s_waitcnt vmcnt(3)
L_a1_2:
    v_mfma_f32_16x16x32_bf16 v[32:35], v[16:19], v[80:83], 0
    v_bitop3_b32 v36, v80, v82, s38 bitop3:0x7e
    s_waitcnt vmcnt(2)
    v_mfma_f32_16x16x32_bf16 v[32:35], v[16:19], v[84:87], v[32:35]
    v_bitop3_b32 v37, v84, v86, s38 bitop3:0x7e
    v_bitop3_b32 v36, v36, v37, 1 bitop3:0xa8
    v_cmp_ne_u32 vcc, 0, v36
    s_nop 3
    v_add_f32_dpp v32, v32, v32 row_ror:4 row_mask:0xf bank_mask:0xf
    v_add_f32_dpp v33, v33, v33 row_ror:4 row_mask:0xf bank_mask:0xf
    s_nop 0
    v_add_f32_dpp v32, v32, v32 row_ror:8 row_mask:0xf bank_mask:0xf
    v_add_f32_dpp v33, v33, v33 row_ror:8 row_mask:0xf bank_mask:0xf
    v_cvt_pk_bf16_f32 v32, v32, v33
    s_cbranch_vccnz L_r2_2
    buffer_store_dword v32, v7, s[4:7], s44 offen
L_a2_2:
    ds_read_b128 v[80:83], v1 offset:24576
    ds_read_b128 v[84:87], v1 offset:25600
    ds_read_b128 v[88:91], v1 offset:26624
    ds_read_b128 v[92:95], v1 offset:27648
    s_mov_b32 s44, s45
    s_add_u32 s45, s45, 0x2000
    buffer_load_dwordx4 v[24:27], v1, s[4:7], s39 offen sc1
    s_and_b32 s45, s45, 0xffff7fff
    s_xor_b32 s38, s38, 1
    s_nop 15
    s_nop 4
    buffer_load_dwordx4 v[24:27], v1, s[4:7], s39 offen sc1
    s_nop 15
    s_nop 6
    buffer_load_dwordx4 v[24:27], v1, s[4:7], s39 offen sc1
    s_cmp_lg_u32 s34, 63
    s_cbranch_scc1 L_top_2
    s_waitcnt vmcnt(2) lgkmcnt(0)
L_l0_2:
    v_cmp_eq_u32 vcc, -1, v27
    ds_write_b128 v1, v[24:27] offset:4096
    s_cbranch_vccnz L_l1_2
    buffer_load_dwordx4 v[40:43], v1, s[4:7], s59 offen sc1
    v_smfmac_f32_16x16x64_bf16 v[60:63], v[24:27], v[104:111], v0
    v_smfmac_f32_16x16x64_bf16 v[68:71], v[24:27], v[120:127], v0
    s_waitcnt lgkmcnt(0)
    s_barrier
    ds_read_b128 v[28:31], v1 offset:6144
    ds_read_b128 v[32:35], v1 offset:0
    ds_read_b128 v[36:39], v1 offset:2048
    v_smfmac_f32_16x16x64_bf16 v[72:75], v[24:27], a[192:199], v0
    v_smfmac_f32_16x16x64_bf16 v[76:79], v[24:27], a[200:207], v0
    buffer_store_dwordx4 v[20:23], v1, s[4:7], s58 offen sc1
    ds_read_b128 v[104:107], v2 offset:12288
    ds_read_b128 v[108:111], v2 offset:13312
    ds_read_b128 v[120:123], v2 offset:14336
    ds_read_b128 v[124:127], v2 offset:15360
    s_waitcnt lgkmcnt(6)
    v_smfmac_f32_16x16x64_bf16 v[60:63], v[28:31], a[8:15], v0
    v_smfmac_f32_16x16x64_bf16 v[68:71], v[28:31], a[24:31], v0
    v_smfmac_f32_16x16x64_bf16 v[72:75], v[28:31], a[208:215], v0
    v_smfmac_f32_16x16x64_bf16 v[76:79], v[28:31], a[216:223], v0
    s_waitcnt lgkmcnt(5)
    v_smfmac_f32_16x16x64_bf16 v[60:63], v[32:35], a[40:47], v0
    v_smfmac_f32_16x16x64_bf16 v[68:71], v[32:35], a[56:63], v0
    v_smfmac_f32_16x16x64_bf16 v[72:75], v[32:35], a[224:231], v0
    v_smfmac_f32_16x16x64_bf16 v[76:79], v[32:35], a[232:239], v0
    s_waitcnt vmcnt(1) lgkmcnt(0)
L_l2_2:
    s_nop 0
    s_nop 0
    v_cmp_eq_u32 vcc, -1, v43
    ds_write_b128 v1, v[40:43] offset:5120
    s_cbranch_vccnz L_l3_2
    v_smfmac_f32_16x16x64_bf16 v[60:63], v[36:39], a[72:79], v0
    v_smfmac_f32_16x16x64_bf16 v[68:71], v[36:39], a[88:95], v0
    v_smfmac_f32_16x16x64_bf16 v[72:75], v[36:39], a[240:247], v0
    v_smfmac_f32_16x16x64_bf16 v[76:79], v[36:39], a[248:255], v0
    s_waitcnt lgkmcnt(0)
    s_barrier
    ds_read_b128 v[44:47], v1 offset:7168
    ds_read_b128 v[48:51], v1 offset:1024
    ds_read_b128 v[52:55], v1 offset:3072
    v_smfmac_f32_16x16x64_bf16 v[60:63], v[40:43], v[104:111], v0
    v_smfmac_f32_16x16x64_bf16 v[68:71], v[40:43], v[120:127], v0
    v_smfmac_f32_16x16x64_bf16 v[72:75], v[40:43], v[128:135], v0
    v_smfmac_f32_16x16x64_bf16 v[76:79], v[40:43], v[136:143], v0
    s_waitcnt lgkmcnt(2)
    v_smfmac_f32_16x16x64_bf16 v[60:63], v[44:47], a[104:111], v0
    v_smfmac_f32_16x16x64_bf16 v[68:71], v[44:47], a[120:127], v0
    s_waitcnt lgkmcnt(1)
    v_smfmac_f32_16x16x64_bf16 v[60:63], v[48:51], a[136:143], v0
    v_smfmac_f32_16x16x64_bf16 v[68:71], v[48:51], a[152:159], v0
    s_waitcnt lgkmcnt(0)
    v_smfmac_f32_16x16x64_bf16 v[60:63], v[52:55], a[168:175], v0
    v_smfmac_f32_16x16x64_bf16 v[68:71], v[52:55], a[184:191], v0
    v_smfmac_f32_16x16x64_bf16 v[72:75], v[44:47], v[144:151], v0
    v_smfmac_f32_16x16x64_bf16 v[76:79], v[44:47], v[152:159], v0
    v_cvt_pk_bf16_f32 v58, v60, v61
    v_cvt_pk_bf16_f32 v59, v62, v63
    v_cvt_pk_bf16_f32 v66, v68, v69
    v_cvt_pk_bf16_f32 v67, v70, v71
    v_smfmac_f32_16x16x64_bf16 v[72:75], v[48:51], v[160:167], v0
    v_mfma_f32_16x16x32_bf16 v[60:63], v[56:59], v[12:15], 0
    v_mfma_f32_16x16x32_bf16 v[68:71], v[64:67], v[12:15], 0
    v_smfmac_f32_16x16x64_bf16 v[76:79], v[48:51], v[168:175], v0
    v_smfmac_f32_16x16x64_bf16 v[72:75], v[52:55], v[176:183], v0
    v_smfmac_f32_16x16x64_bf16 v[76:79], v[52:55], v[184:191], v0
    v_cvt_pk_bf16_f32 v56, v60, v61
    v_cvt_pk_bf16_f32 v57, v62, v63
    v_cvt_pk_bf16_f32 v58, v68, v69
    v_cvt_pk_bf16_f32 v59, v70, v71
    s_nop 1
    v_cvt_pk_bf16_f32 v72, v72, v73
    v_cvt_pk_bf16_f32 v73, v74, v75
    v_cvt_pk_bf16_f32 v74, v76, v77
    v_cvt_pk_bf16_f32 v75, v78, v79
    v_mov_b32_dpp v58, v56 row_ror:8 row_mask:0xf bank_mask:0x3
    v_mov_b32_dpp v59, v57 row_ror:8 row_mask:0xf bank_mask:0x3
    v_permlane32_swap_b32 v72, v73
    v_permlane32_swap_b32 v74, v75
    v_min_u32 v20, -2, v58
    v_min_u32 v21, -2, v59
    v_lshlrev_b32 v56, 16, v72
    v_lshlrev_b32 v57, 16, v73
    v_and_b32 v72, 0xffff0000, v72
    v_and_b32 v73, 0xffff0000, v73
    v_add_f32 v56, v56, v57
    v_add_f32 v57, v72, v73
    v_cvt_pk_bf16_f32 v56, v56, v57
    v_min_u32 v22, -2, v56
    v_lshlrev_b32 v56, 16, v74
    v_lshlrev_b32 v57, 16, v75
    v_and_b32 v74, 0xffff0000, v74
    v_and_b32 v75, 0xffff0000, v75
    v_add_f32 v56, v56, v57
    v_add_f32 v57, v74, v75
    v_cvt_pk_bf16_f32 v56, v56, v57
    v_min_u32 v23, -2, v56
    buffer_store_dwordx4 v[20:23], v1, s[4:7], s36 offen sc1
    s_endpgm
L_l1_2:
    buffer_load_dwordx4 v[24:27], v1, s[4:7], s39 offen sc1
    s_add_u32 s47, s47, 1
    s_cmp_gt_u32 s47, 1000000
    s_cbranch_scc1 L_exit
    s_waitcnt vmcnt(2)
    s_branch L_l0_2
L_l3_2:
    buffer_load_dwordx4 v[40:43], v1, s[4:7], s59 offen sc1
    s_add_u32 s47, s47, 1
    s_cmp_gt_u32 s47, 1000000
    s_cbranch_scc1 L_exit
    s_waitcnt vmcnt(0)
    s_branch L_l2_2
L_f1_2:
    buffer_load_dwordx4 v[24:27], v1, s[4:7], s39 offen sc1
    s_waitcnt vmcnt(2)
    v_cmp_eq_u32 vcc, -1, v27
    s_nop 0
    ds_write_b128 v1, v[24:27] offset:4096
    s_cbranch_vccnz L_f2_2
    buffer_load_dwordx4 v[40:43], v1, s[4:7], s59 offen sc1
    v_smfmac_f32_16x16x64_bf16 v[56:59], v[24:27], v[96:103], v0
    v_smfmac_f32_16x16x64_bf16 v[60:63], v[24:27], v[104:111], v0
    v_smfmac_f32_16x16x64_bf16 v[64:67], v[24:27], v[112:119], v0
    s_waitcnt lgkmcnt(0)
    s_barrier
    ds_read_b128 v[28:31], v1 offset:6144
    ds_read_b128 v[32:35], v1 offset:0
    v_smfmac_f32_16x16x64_bf16 v[68:71], v[24:27], v[120:127], v0
    ds_read_b128 v[36:39], v1 offset:2048
    v_smfmac_f32_16x16x64_bf16 v[72:75], v[24:27], a[192:199], v0
    v_smfmac_f32_16x16x64_bf16 v[76:79], v[24:27], a[200:207], v0
    s_branch L_go2_2
L_f2_2:
    buffer_load_dwordx4 v[24:27], v1, s[4:7], s39 offen sc1
    s_waitcnt vmcnt(2)
    v_cmp_eq_u32 vcc, -1, v27
    s_nop 0
    ds_write_b128 v1, v[24:27] offset:4096
    s_cbranch_vccnz L_f3_2
    buffer_load_dwordx4 v[40:43], v1, s[4:7], s59 offen sc1
    s_branch L_go_2
L_f3_2:
    buffer_load_dwordx4 v[24:27], v1, s[4:7], s39 offen sc1
    s_waitcnt vmcnt(2)
    v_cmp_eq_u32 vcc, -1, v27
    s_nop 0
    ds_write_b128 v1, v[24:27] offset:4096
    s_cbranch_vccnz L_f4_2
    buffer_load_dwordx4 v[40:43], v1, s[4:7], s59 offen sc1
    s_branch L_go_2
L_f4_2:
    s_add_u32 s47, s47, 1
    s_cmp_gt_u32 s47, 1000000
    s_cbranch_scc1 L_exit
    s_branch L_f3_2
L_rL_2:
    buffer_load_dwordx4 v[40:43], v1, s[4:7], s59 offen sc1
    s_add_u32 s47, s47, 1
    s_cmp_gt_u32 s47, 1000000
    s_cbranch_scc1 L_exit
    s_waitcnt vmcnt(0)
    ds_write_b128 v1, v[40:43] offset:5120
    s_nop 0
    s_nop 0
    v_cmp_eq_u32 vcc, -1, v43
    s_waitcnt lgkmcnt(0)
    s_cbranch_vccnz L_rL_2
    s_branch L_bL_2
L_r2_2:
    s_waitcnt vmcnt(0)
    v_mfma_f32_16x16x32_bf16 v[32:35], v[16:19], v[44:47], 0
    v_bitop3_b32 v36, v44, v46, s38 bitop3:0x7e
    v_bitop3_b32 v37, v48, v50, s38 bitop3:0x7e
    v_mfma_f32_16x16x32_bf16 v[32:35], v[16:19], v[48:51], v[32:35]
    v_bitop3_b32 v36, v36, v37, 1 bitop3:0xa8
    v_cmp_ne_u32 vcc, 0, v36
    s_nop 0
    s_nop 3
    v_add_f32_dpp v32, v32, v32 row_ror:4 row_mask:0xf bank_mask:0xf
    v_add_f32_dpp v33, v33, v33 row_ror:4 row_mask:0xf bank_mask:0xf
    s_nop 0
    v_add_f32_dpp v32, v32, v32 row_ror:8 row_mask:0xf bank_mask:0xf
    v_add_f32_dpp v33, v33, v33 row_ror:8 row_mask:0xf bank_mask:0xf
    v_cvt_pk_bf16_f32 v32, v32, v33
    s_cbranch_vccnz L_r1_2
    buffer_store_dword v32, v7, s[4:7], s44 offen
    s_branch L_a2_2
L_r1_2:
    buffer_load_dwordx4 v[80:83], v1, s[4:7], s37 offen offset:0 sc1
    buffer_load_dwordx4 v[84:87], v1, s[4:7], s37 offen offset:1024 sc1
    s_add_u32 s47, s47, 1
    s_cmp_gt_u32 s47, 1000000
    s_cbranch_scc1 L_exit
    s_waitcnt vmcnt(0)
    s_branch L_a1_2
L_step_2:
    ds_write_b128 v1, v[24:27] offset:4096
    s_branch L_go_2
.p2align 6
L_top_3:
    s_waitcnt vmcnt(3) lgkmcnt(0)
    v_cmp_eq_u32 vcc, -1, v27
    ds_write_b128 v1, v[24:27] offset:6144
    s_cbranch_vccnz L_f1_3
    buffer_load_dwordx4 v[40:43], v1, s[4:7], s59 offen sc1
L_go_3:
    v_smfmac_f32_16x16x64_bf16 v[56:59], v[24:27], v[96:103], v0
    v_smfmac_f32_16x16x64_bf16 v[60:63], v[24:27], v[104:111], v0
    v_smfmac_f32_16x16x64_bf16 v[64:67], v[24:27], v[112:119], v0
    s_waitcnt lgkmcnt(0)
    s_barrier
    ds_read_b128 v[28:31], v1 offset:0
    ds_read_b128 v[32:35], v1 offset:2048
    v_smfmac_f32_16x16x64_bf16 v[68:71], v[24:27], v[120:127], v0
    ds_read_b128 v[36:39], v1 offset:4096
    buffer_store_dwordx4 v[20:23], v1, s[4:7], s58 offen sc1
    v_smfmac_f32_16x16x64_bf16 v[72:75], v[24:27], a[192:199], v0
    v_smfmac_f32_16x16x64_bf16 v[76:79], v[24:27], a[200:207], v0
L_go2_3:
    s_waitcnt lgkmcnt(2)
    v_smfmac_f32_16x16x64_bf16 v[56:59], v[28:31], a[0:7], v0
    ds_read_b128 v[96:99], v2 offset:8192
    v_smfmac_f32_16x16x64_bf16 v[60:63], v[28:31], a[8:15], v0
    ds_read_b128 v[100:103], v2 offset:9216
    v_smfmac_f32_16x16x64_bf16 v[64:67], v[28:31], a[16:23], v0
    ds_read_b128 v[104:107], v2 offset:12288
    v_smfmac_f32_16x16x64_bf16 v[68:71], v[28:31], a[24:31], v0
    ds_read_b128 v[108:111], v2 offset:13312
    s_waitcnt lgkmcnt(4)
    v_smfmac_f32_16x16x64_bf16 v[56:59], v[32:35], a[32:39], v0
    ds_read_b128 v[112:115], v2 offset:10240
    v_smfmac_f32_16x16x64_bf16 v[60:63], v[32:35], a[40:47], v0
    ds_read_b128 v[116:119], v2 offset:11264
    v_smfmac_f32_16x16x64_bf16 v[64:67], v[32:35], a[48:55], v0
    ds_read_b128 v[120:123], v2 offset:14336
    v_smfmac_f32_16x16x64_bf16 v[68:71], v[32:35], a[56:63], v0
    ds_read_b128 v[124:127], v2 offset:15360
    v_smfmac_f32_16x16x64_bf16 v[56:59], v[36:39], a[64:71], v0
    v_smfmac_f32_16x16x64_bf16 v[60:63], v[36:39], a[72:79], v0
    s_waitcnt vmcnt(1)
    ds_write_b128 v1, v[40:43] offset:7168
    v_smfmac_f32_16x16x64_bf16 v[64:67], v[36:39], a[80:87], v0
    s_nop 0
    v_smfmac_f32_16x16x64_bf16 v[68:71], v[36:39], a[88:95], v0
    v_cmp_eq_u32 vcc, -1, v43
    v_smfmac_f32_16x16x64_bf16 v[72:75], v[28:31], a[208:215], v0
    v_smfmac_f32_16x16x64_bf16 v[76:79], v[28:31], a[216:223], v0
    s_cbranch_vccnz L_rL_3
L_bL_3:
    s_waitcnt lgkmcnt(0)
    s_barrier
    ds_read_b128 v[44:47], v1 offset:1024
    v_smfmac_f32_16x16x64_bf16 v[56:59], v[40:43], v[96:103], v0
    ds_read_b128 v[48:51], v1 offset:3072
    ds_read_b128 v[52:55], v1 offset:5120
    v_smfmac_f32_16x16x64_bf16 v[60:63], v[40:43], v[104:111], v0
    ds_read_b128 v[96:99], v2 offset:16384
    v_smfmac_f32_16x16x64_bf16 v[64:67], v[40:43], v[112:119], v0
    ds_read_b128 v[100:103], v2 offset:17408
    v_smfmac_f32_16x16x64_bf16 v[68:71], v[40:43], v[120:127], v0
    ds_read_b128 v[104:107], v2 offset:18432
    s_waitcnt lgkmcnt(5)
    v_smfmac_f32_16x16x64_bf16 v[56:59], v[44:47], a[96:103], v0
    buffer_load_dwordx4 v1, s[4:7], s35 offen offset:0 sc1 lds
    ds_read_b128 v[108:111], v2 offset:19456
    v_smfmac_f32_16x16x64_bf16 v[60:63], v[44:47], a[104:111], v0
    ds_read_b128 v[112:115], v2 offset:20480
    v_mov_b64 v[20:21], s[84:85]
    v_smfmac_f32_16x16x64_bf16 v[64:67], v[44:47], a[112:119], v0
    ds_read_b128 v[116:119], v2 offset:21504
    v_mov_b64 v[22:23], s[84:85]
    v_smfmac_f32_16x16x64_bf16 v[68:71], v[44:47], a[120:127], v0
    ds_read_b128 v[120:123], v2 offset:22528
    s_waitcnt lgkmcnt(7)
    v_smfmac_f32_16x16x64_bf16 v[56:59], v[48:51], a[128:135], v0
    buffer_load_dwordx4 v1, s[4:7], s35 offen offset:1024 sc1 lds
    ds_read_b128 v[124:127], v2 offset:23552
    v_smfmac_f32_16x16x64_bf16 v[60:63], v[48:51], a[136:143], v0
    v_smfmac_f32_16x16x64_bf16 v[56:59], v[52:55], a[160:167], v0
    v_smfmac_f32_16x16x64_bf16 v[60:63], v[52:55], a[168:175], v0
    v_smfmac_f32_16x16x64_bf16 v[64:67], v[48:51], a[144:151], v0
    buffer_load_dwordx4 v1, s[4:7], s35 offen offset:2048 sc1 lds
    v_cvt_pk_bf16_f32 v56, v56, v57
    v_smfmac_f32_16x16x64_bf16 v[68:71], v[48:51], a[152:159], v0
    v_cvt_pk_bf16_f32 v57, v58, v59
    v_smfmac_f32_16x16x64_bf16 v[64:67], v[52:55], a[176:183], v0
    v_cvt_pk_bf16_f32 v58, v60, v61
    v_smfmac_f32_16x16x64_bf16 v[68:71], v[52:55], a[184:191], v0
    buffer_load_dwordx4 v1, s[4:7], s35 offen offset:3072 sc1 lds
    v_cvt_pk_bf16_f32 v59, v62, v63
    s_nop 0
    v_cvt_pk_bf16_f32 v64, v64, v65
    v_mfma_f32_16x16x32_bf16 v[60:63], v[56:59], v[12:15], 0
    v_cvt_pk_bf16_f32 v65, v66, v67
    v_cvt_pk_bf16_f32 v66, v68, v69
    v_cvt_pk_bf16_f32 v67, v70, v71
    s_nop 1
    v_mfma_f32_16x16x32_bf16 v[68:71], v[64:67], v[12:15], 0
    v_cvt_pk_bf16_f32 v56, v60, v61
    v_cvt_pk_bf16_f32 v57, v62, v63
    v_cndmask_b32 v24, 0, v56, s[86:87]
    v_cndmask_b32 v25, 0, v57, s[86:87]
    v_mov_b32_dpp v28, v56 row_shr:8 row_mask:0xf bank_mask:0xf bound_ctrl:1
    v_mov_b32_dpp v29, v57 row_shr:8 row_mask:0xf bank_mask:0xf bound_ctrl:1
    s_nop 0
    v_cvt_pk_bf16_f32 v58, v68, v69
    v_cvt_pk_bf16_f32 v59, v70, v71
    v_cndmask_b32 v26, 0, v58, s[86:87]
    v_cndmask_b32 v27, 0, v59, s[86:87]
    v_mfma_f32_16x16x32_bf16 v[68:71], v[56:59], v[56:59], 0
    v_mov_b32_dpp v30, v58 row_shr:8 row_mask:0xf bank_mask:0xf bound_ctrl:1
    v_mov_b32_dpp v31, v59 row_shr:8 row_mask:0xf bank_mask:0xf bound_ctrl:1
    v_mfma_f32_16x16x32_bf16 v[64:67], v[80:83], v[24:27], 0
    s_nop 0
    v_mfma_f32_16x16x32_bf16 v[64:67], v[84:87], v[28:31], v[64:67]
    v_mov_b32_dpp v68, v70 row_ror:8 row_mask:0xf bank_mask:0xc
    v_mov_b32_dpp v69, v71 row_ror:8 row_mask:0xf bank_mask:0xc
    v_smfmac_f32_16x16x64_bf16 v[72:75], v[32:35], a[224:231], v0
    s_nop 0
    ds_write2_b32 v3, v68, v69 offset0:0 offset1:32
    v_smfmac_f32_16x16x64_bf16 v[76:79], v[32:35], a[232:239], v0
    ds_write_b128 v1, v[64:67] offset:14336
    v_smfmac_f32_16x16x64_bf16 v[72:75], v[36:39], a[240:247], v0
    v_smfmac_f32_16x16x64_bf16 v[76:79], v[36:39], a[248:255], v0
    buffer_store_dword v4, v7, s[4:7], s45 offen
    v_smfmac_f32_16x16x64_bf16 v[72:75], v[40:43], v[128:135], v0
    v_smfmac_f32_16x16x64_bf16 v[76:79], v[40:43], v[136:143], v0
    v_smfmac_f32_16x16x64_bf16 v[72:75], v[44:47], v[144:151], v0
    v_smfmac_f32_16x16x64_bf16 v[76:79], v[44:47], v[152:159], v0
    s_waitcnt lgkmcnt(0)
    s_barrier
    ds_read_b128 v[68:71], v1 offset:9216
    ds_read_b128 v[60:63], v1 offset:8192
    v_smfmac_f32_16x16x64_bf16 v[72:75], v[48:51], v[160:167], v0
    ds_read_b128 v[80:83], v1 offset:10240
    ds_read_b128 v[84:87], v1 offset:12288
    v_smfmac_f32_16x16x64_bf16 v[76:79], v[48:51], v[168:175], v0
    v_smfmac_f32_16x16x64_bf16 v[72:75], v[52:55], v[176:183], v0
    v_smfmac_f32_16x16x64_bf16 v[76:79], v[52:55], v[184:191], v0
    s_waitcnt lgkmcnt(2)
    v_add_f32 v68, v68, v69
    v_add_f32 v70, v70, v71
    v_add_f32 v64, v64, v60
    v_add_f32 v65, v65, v61
    v_pk_add_f32 v[66:67], v[66:67], v[62:63]
    v_add_f32 v68, v68, v70
    s_waitcnt lgkmcnt(0)
    v_pk_add_f32 v[80:81], v[80:81], v[84:85]
    v_pk_add_f32 v[82:83], v[82:83], v[86:87]
    v_pk_add_f32 v[64:65], v[64:65], v[80:81]
    v_pk_add_f32 v[66:67], v[66:67], v[82:83]
    v_max3_f32 v60, v68, v64, v65
    v_max3_f32 v60, v60, v66, v67
    v_cvt_pk_bf16_f32 v72, v72, v73
    v_cvt_pk_bf16_f32 v73, v74, v75
    v_max_f32_dpp v61, v60, v60 row_ror:8 row_mask:0xf bank_mask:0xf
    v_max_f32_dpp v60, v60, v60 row_ror:8 row_mask:0xf bank_mask:0xf
    v_cvt_pk_bf16_f32 v74, v76, v77
    v_cvt_pk_bf16_f32 v75, v78, v79
    v_permlane32_swap_b32 v60, v61
    v_max_f32 v62, v60, v61
    v_max_f32 v63, v60, v61
    v_permlane32_swap_b32 v72, v73
    v_permlane32_swap_b32 v74, v75
    v_permlane16_swap_b32 v62, v63
    v_max_f32 v60, v62, v63
    v_mul_f32 v60, s48, v60
    v_fma_f32 v68, v68, s48, -v60
    v_exp_f32 v68, v68
    v_pk_fma_f32 v[64:65], v[64:65], s[48:49], v[60:61] op_sel_hi:[1,1,0] neg_lo:[0,0,1] neg_hi:[0,0,1]
    v_pk_fma_f32 v[66:67], v[66:67], s[48:49], v[60:61] op_sel_hi:[1,1,0] neg_lo:[0,0,1] neg_hi:[0,0,1]
    v_mov_b32_dpp v69, v68 row_ror:8 row_mask:0xf bank_mask:0xf
    v_cvt_pk_bf16_f32 v44, v68, v69
    v_cvt_pk_bf16_f32 v45, v68, v69
    v_exp_f32 v64, v64
    v_exp_f32 v65, v65
    v_mfma_f32_16x16x16_bf16 v[80:83], v[72:73], v[44:45], 0
    v_exp_f32 v66, v66
    v_exp_f32 v67, v67
    v_cvt_pk_bf16_f32 v60, v64, v65
    v_cvt_pk_bf16_f32 v61, v66, v67
    v_mfma_f32_16x16x16_bf16 v[76:79], v[74:75], v[44:45], 0
    v_mov_b32_dpp v62, v60 row_ror:8 row_mask:0xf bank_mask:0xf
    v_mov_b32_dpp v63, v61 row_ror:8 row_mask:0xf bank_mask:0xf
    v_mov_b64 v[64:65], 0
    v_mov_b64 v[66:67], 0
    v_mfma_f32_16x16x32_bf16 v[80:83], v[88:91], v[60:63], v[80:83]
    ds_read_b128 v[48:51], v2 offset:30720
    ds_read_b128 v[52:55], v2 offset:31744
    v_mfma_f32_16x16x32_bf16 v[76:79], v[92:95], v[60:63], v[76:79]
    ds_read_b128 v[24:27], v2 offset:24576
    ds_read_b128 v[28:31], v2 offset:25600
    v_mfma_f32_16x16x16_bf16 v[68:71], v[44:45], v[10:11], 0
    v_cvt_pk_bf16_f32 v84, v80, v81
    v_cvt_pk_bf16_f32 v85, v82, v83
    v_mov_b64 v[80:81], 0
    v_mov_b64 v[82:83], 0
    v_cvt_pk_bf16_f32 v86, v76, v77
    v_cvt_pk_bf16_f32 v87, v78, v79
    v_mfma_f32_16x16x32_bf16 v[68:71], v[60:63], v[20:23], v[68:71]
    s_nop 0
    ds_write_b128 v8, v[84:87] offset:7168
    v_mov_b32_dpp v84, v84 row_ror:8 row_mask:0xf bank_mask:0xc
    v_mov_b32_dpp v85, v85 row_ror:8 row_mask:0xf bank_mask:0xc
    v_mov_b32_dpp v86, v86 row_ror:8 row_mask:0xf bank_mask:0xc
    v_mov_b32_dpp v87, v87 row_ror:8 row_mask:0xf bank_mask:0xc
    v_mov_b64 v[76:77], 0
    v_mov_b64 v[78:79], 0
    v_mov_b64 v[20:21], 0
    v_rcp_f32 v68, v68
    v_rcp_f32 v69, v69
    v_rcp_f32 v70, v70
    v_rcp_f32 v71, v71
    v_smfmac_f32_16x16x64_bf16 v[64:67], v[84:87], v[216:223], v0
    s_waitcnt lgkmcnt(0)
    s_barrier
    ds_read_b128 v[88:91], v5 offset:1024
    ds_read_b128 v[92:95], v5 offset:3072
    v_smfmac_f32_16x16x64_bf16 v[80:83], v[84:87], v[248:255], v0
    ds_read_b128 v[60:63], v5 offset:5120
    v_mov_b64 v[22:23], 0
    v_smfmac_f32_16x16x64_bf16 v[76:79], v[84:87], v[120:127], v0
    s_waitcnt lgkmcnt(2)
    v_smfmac_f32_16x16x64_bf16 v[64:67], v[88:91], v[192:199], v0
    ds_read_b128 v[32:35], v2 offset:26624
    s_waitcnt lgkmcnt(2)
    v_smfmac_f32_16x16x64_bf16 v[64:67], v[92:95], v[200:207], v0
    ds_read_b128 v[36:39], v2 offset:27648
    s_waitcnt lgkmcnt(2)
    v_smfmac_f32_16x16x64_bf16 v[64:67], v[60:63], v[208:215], v0
    ds_read_b128 v[40:43], v2 offset:28672
    v_smfmac_f32_16x16x64_bf16 v[80:83], v[88:91], v[224:231], v0
    ds_read_b128 v[44:47], v2 offset:29696
    v_smfmac_f32_16x16x64_bf16 v[80:83], v[92:95], v[232:239], v0
    v_mul_f32 v64, v64, v68
    v_smfmac_f32_16x16x64_bf16 v[80:83], v[60:63], v[240:247], v0
    v_mul_f32 v65, v65, v69
    v_mul_f32 v66, v66, v70
    v_mul_f32 v67, v67, v71
    v_cvt_pk_bf16_f32 v64, v64, v65
    v_cvt_pk_bf16_f32 v65, v66, v67
    v_bfi_b32 v64, 1, s38, v64
    v_smfmac_f32_16x16x64_bf16 v[76:79], v[88:91], v[96:103], v0
    s_nop 0
    buffer_store_dwordx2 v[64:65], v6, s[4:7], s40 offen
    v_mul_f32 v80, v80, v68
    v_mul_f32 v81, v81, v69
    v_mul_f32 v82, v82, v70
    v_mul_f32 v83, v83, v71
    v_cvt_pk_bf16_f32 v80, v80, v81
    v_cvt_pk_bf16_f32 v81, v82, v83
    v_bfi_b32 v80, 1, s38, v80
    v_smfmac_f32_16x16x64_bf16 v[76:79], v[92:95], v[104:111], v0
    s_nop 0
    buffer_store_dwordx2 v[80:81], v6, s[4:7], s41 offen
    v_smfmac_f32_16x16x64_bf16 v[76:79], v[60:63], v[112:119], v0
    s_waitcnt lgkmcnt(0)
    v_smfmac_f32_16x16x64_bf16 v[20:23], v[84:87], v[48:55], v0
    s_add_u32 s39, s44, 1024
    s_add_u32 s59, s44, 5120
    v_smfmac_f32_16x16x64_bf16 v[20:23], v[88:91], v[24:31], v0
    s_add_u32 s34, s34, 1
    s_mov_b32 s58, s36
    v_mul_f32 v76, v76, v68
    v_smfmac_f32_16x16x64_bf16 v[20:23], v[92:95], v[32:39], v0
    v_mul_f32 v77, v77, v69
    v_smfmac_f32_16x16x64_bf16 v[20:23], v[60:63], v[40:47], v0
    v_mul_f32 v78, v78, v70
    v_mul_f32 v79, v79, v71
    v_cvt_pk_bf16_f32 v76, v76, v77
    v_cvt_pk_bf16_f32 v77, v78, v79
    v_bfi_b32 v76, 1, s38, v76
    s_add_u32 s36, s36, 0x20000
    s_add_u32 s35, s35, 524288
    buffer_store_dwordx2 v[76:77], v6, s[4:7], s42 offen
    v_pk_mul_f32 v[20:21], v[20:21], v[68:69]
    v_pk_mul_f32 v[22:23], v[22:23], v[70:71]
    v_cvt_pk_bf16_f32 v20, v20, v21
    v_cvt_pk_bf16_f32 v21, v22, v23
    v_bfi_b32 v20, 1, s38, v20
    s_nop 1
    buffer_store_dwordx2 v[20:21], v6, s[4:7], s43 offen
    v_mov_b64 v[60:61], 0
    v_mov_b64 v[62:63], 0
    v_mov_b64 v[64:65], 0
    v_mov_b64 v[66:67], 0
    v_mov_b64 v[68:69], 0
    v_mov_b64 v[70:71], 0
    v_mov_b32_dpp v58, v56 row_ror:8 row_mask:0xf bank_mask:0x3
    v_mov_b32_dpp v59, v57 row_ror:8 row_mask:0xf bank_mask:0x3
    v_min_u32 v20, -2, v58
    v_min_u32 v21, -2, v59
    v_lshlrev_b32 v56, 16, v72
    v_lshlrev_b32 v57, 16, v73
    v_and_b32 v72, 0xffff0000, v72
    v_and_b32 v73, 0xffff0000, v73
    v_add_f32 v56, v56, v57
    v_add_f32 v57, v72, v73
    v_cvt_pk_bf16_f32 v56, v56, v57
    v_min_u32 v22, -2, v56
    v_lshlrev_b32 v56, 16, v74
    v_lshlrev_b32 v57, 16, v75
    v_and_b32 v74, 0xffff0000, v74
    v_and_b32 v75, 0xffff0000, v75
    v_add_f32 v56, v56, v57
    v_add_f32 v57, v74, v75
    v_cvt_pk_bf16_f32 v56, v56, v57
    v_min_u32 v23, -2, v56
    v_mov_b64 v[56:57], 0
    v_mov_b64 v[58:59], 0
    v_mov_b64 v[72:73], 0
    v_mov_b64 v[74:75], 0
    v_mov_b64 v[76:77], 0
    v_mov_b64 v[78:79], 0
    s_nop 2
    ds_read_b128 v[96:99], v2 offset:0
    s_nop 2
    ds_read_b128 v[100:103], v2 offset:1024
    s_nop 2
    ds_read_b128 v[104:107], v2 offset:4096
    s_nop 2
    ds_read_b128 v[108:111], v2 offset:5120
    s_nop 2
    ds_read_b128 v[112:115], v2 offset:2048
    s_nop 2
    ds_read_b128 v[116:119], v2 offset:3072
    s_nop 2
    ds_read_b128 v[120:123], v2 offset:6144
    s_nop 2
    ds_read_b128 v[124:127], v2 offset:7168
    s_nop 8
    buffer_load_dwordx4 v[80:83], v1, s[4:7], s37 offen offset:0 sc1
    buffer_load_dwordx4 v[84:87], v1, s[4:7], s37 offen offset:1024 sc1
    s_nop 15
    s_nop 7
    buffer_load_dwordx4 v[44:47], v1, s[4:7], s37 offen offset:0 sc1
    buffer_load_dwordx4 v[48:51], v1, s[4:7], s37 offen offset:1024 sc1
    s_waitcnt vmcnt(3)
L_a1_3:
    v_mfma_f32_16x16x32_bf16 v[32:35], v[16:19], v[80:83], 0
    v_bitop3_b32 v36, v80, v82, s38 bitop3:0x7e
    s_waitcnt vmcnt(2)
    v_mfma_f32_16x16x32_bf16 v[32:35], v[16:19], v[84:87], v[32:35]
    v_bitop3_b32 v37, v84, v86, s38 bitop3:0x7e
    v_bitop3_b32 v36, v36, v37, 1 bitop3:0xa8
    v_cmp_ne_u32 vcc, 0, v36
    s_nop 1
    buffer_load_dwordx4 v[24:27], v1, s[4:7], s39 offen sc1
    s_nop 0
    v_add_f32_dpp v32, v32, v32 row_ror:4 row_mask:0xf bank_mask:0xf
    v_add_f32_dpp v33, v33, v33 row_ror:4 row_mask:0xf bank_mask:0xf
    s_nop 0
    v_add_f32_dpp v32, v32, v32 row_ror:8 row_mask:0xf bank_mask:0xf
    v_add_f32_dpp v33, v33, v33 row_ror:8 row_mask:0xf bank_mask:0xf
    v_cvt_pk_bf16_f32 v32, v32, v33
    s_cbranch_vccnz L_r2_3
    buffer_store_dword v32, v7, s[4:7], s44 offen
L_a2_3:
    buffer_load_dwordx4 v[24:27], v1, s[4:7], s39 offen sc1
    ds_read_b128 v[80:83], v1 offset:28672
    ds_read_b128 v[84:87], v1 offset:29696
    ds_read_b128 v[88:91], v1 offset:30720
    ds_read_b128 v[92:95], v1 offset:31744
    s_mov_b32 s44, s45
    s_add_u32 s45, s45, 0x2000
    s_and_b32 s45, s45, 0xffff7fff
    s_xor_b32 s38, s38, 1
    s_nop 14
    buffer_load_dwordx4 v[24:27], v1, s[4:7], s39 offen sc1
    s_cmp_lg_u32 s34, 63
    s_cbranch_scc1 L_top_3
    s_waitcnt vmcnt(3) lgkmcnt(0)
L_l0_3:
    v_cmp_eq_u32 vcc, -1, v27
    ds_write_b128 v1, v[24:27] offset:6144
    s_cbranch_vccnz L_l1_3
    buffer_load_dwordx4 v[40:43], v1, s[4:7], s59 offen sc1
    v_smfmac_f32_16x16x64_bf16 v[60:63], v[24:27], v[104:111], v0
    v_smfmac_f32_16x16x64_bf16 v[68:71], v[24:27], v[120:127], v0
    s_waitcnt lgkmcnt(0)
    s_barrier
    ds_read_b128 v[28:31], v1 offset:0
    ds_read_b128 v[32:35], v1 offset:2048
    ds_read_b128 v[36:39], v1 offset:4096
    v_smfmac_f32_16x16x64_bf16 v[72:75], v[24:27], a[192:199], v0
    v_smfmac_f32_16x16x64_bf16 v[76:79], v[24:27], a[200:207], v0
    buffer_store_dwordx4 v[20:23], v1, s[4:7], s58 offen sc1
    ds_read_b128 v[104:107], v2 offset:12288
    ds_read_b128 v[108:111], v2 offset:13312
    ds_read_b128 v[120:123], v2 offset:14336
    ds_read_b128 v[124:127], v2 offset:15360
    s_waitcnt lgkmcnt(6)
    v_smfmac_f32_16x16x64_bf16 v[60:63], v[28:31], a[8:15], v0
    v_smfmac_f32_16x16x64_bf16 v[68:71], v[28:31], a[24:31], v0
    v_smfmac_f32_16x16x64_bf16 v[72:75], v[28:31], a[208:215], v0
    v_smfmac_f32_16x16x64_bf16 v[76:79], v[28:31], a[216:223], v0
    s_waitcnt lgkmcnt(5)
    v_smfmac_f32_16x16x64_bf16 v[60:63], v[32:35], a[40:47], v0
    v_smfmac_f32_16x16x64_bf16 v[68:71], v[32:35], a[56:63], v0
    v_smfmac_f32_16x16x64_bf16 v[72:75], v[32:35], a[224:231], v0
    v_smfmac_f32_16x16x64_bf16 v[76:79], v[32:35], a[232:239], v0
    s_waitcnt vmcnt(1) lgkmcnt(0)
L_l2_3:
    s_nop 0
    s_nop 0
    v_cmp_eq_u32 vcc, -1, v43
    ds_write_b128 v1, v[40:43] offset:7168
    s_cbranch_vccnz L_l3_3
    v_smfmac_f32_16x16x64_bf16 v[60:63], v[36:39], a[72:79], v0
    v_smfmac_f32_16x16x64_bf16 v[68:71], v[36:39], a[88:95], v0
    v_smfmac_f32_16x16x64_bf16 v[72:75], v[36:39], a[240:247], v0
    v_smfmac_f32_16x16x64_bf16 v[76:79], v[36:39], a[248:255], v0
    s_waitcnt lgkmcnt(0)
    s_barrier
    ds_read_b128 v[44:47], v1 offset:1024
    ds_read_b128 v[48:51], v1 offset:3072
    ds_read_b128 v[52:55], v1 offset:5120
    v_smfmac_f32_16x16x64_bf16 v[60:63], v[40:43], v[104:111], v0
    v_smfmac_f32_16x16x64_bf16 v[68:71], v[40:43], v[120:127], v0
    v_smfmac_f32_16x16x64_bf16 v[72:75], v[40:43], v[128:135], v0
    v_smfmac_f32_16x16x64_bf16 v[76:79], v[40:43], v[136:143], v0
    s_waitcnt lgkmcnt(2)
    v_smfmac_f32_16x16x64_bf16 v[60:63], v[44:47], a[104:111], v0
    v_smfmac_f32_16x16x64_bf16 v[68:71], v[44:47], a[120:127], v0
    s_waitcnt lgkmcnt(1)
    v_smfmac_f32_16x16x64_bf16 v[60:63], v[48:51], a[136:143], v0
    v_smfmac_f32_16x16x64_bf16 v[68:71], v[48:51], a[152:159], v0
    s_waitcnt lgkmcnt(0)
    v_smfmac_f32_16x16x64_bf16 v[60:63], v[52:55], a[168:175], v0
    v_smfmac_f32_16x16x64_bf16 v[68:71], v[52:55], a[184:191], v0
    v_smfmac_f32_16x16x64_bf16 v[72:75], v[44:47], v[144:151], v0
    v_smfmac_f32_16x16x64_bf16 v[76:79], v[44:47], v[152:159], v0
    v_cvt_pk_bf16_f32 v58, v60, v61
    v_cvt_pk_bf16_f32 v59, v62, v63
    v_cvt_pk_bf16_f32 v66, v68, v69
    v_cvt_pk_bf16_f32 v67, v70, v71
    v_smfmac_f32_16x16x64_bf16 v[72:75], v[48:51], v[160:167], v0
    v_mfma_f32_16x16x32_bf16 v[60:63], v[56:59], v[12:15], 0
    v_mfma_f32_16x16x32_bf16 v[68:71], v[64:67], v[12:15], 0
    v_smfmac_f32_16x16x64_bf16 v[76:79], v[48:51], v[168:175], v0
    v_smfmac_f32_16x16x64_bf16 v[72:75], v[52:55], v[176:183], v0
    v_smfmac_f32_16x16x64_bf16 v[76:79], v[52:55], v[184:191], v0
    v_cvt_pk_bf16_f32 v56, v60, v61
    v_cvt_pk_bf16_f32 v57, v62, v63
    v_cvt_pk_bf16_f32 v58, v68, v69
    v_cvt_pk_bf16_f32 v59, v70, v71
    s_nop 1
    v_cvt_pk_bf16_f32 v72, v72, v73
    v_cvt_pk_bf16_f32 v73, v74, v75
    v_cvt_pk_bf16_f32 v74, v76, v77
    v_cvt_pk_bf16_f32 v75, v78, v79
    v_mov_b32_dpp v58, v56 row_ror:8 row_mask:0xf bank_mask:0x3
    v_mov_b32_dpp v59, v57 row_ror:8 row_mask:0xf bank_mask:0x3
    v_permlane32_swap_b32 v72, v73
    v_permlane32_swap_b32 v74, v75
    v_min_u32 v20, -2, v58
    v_min_u32 v21, -2, v59
    v_lshlrev_b32 v56, 16, v72
    v_lshlrev_b32 v57, 16, v73
    v_and_b32 v72, 0xffff0000, v72
    v_and_b32 v73, 0xffff0000, v73
    v_add_f32 v56, v56, v57
    v_add_f32 v57, v72, v73
    v_cvt_pk_bf16_f32 v56, v56, v57
    v_min_u32 v22, -2, v56
    v_lshlrev_b32 v56, 16, v74
    v_lshlrev_b32 v57, 16, v75
    v_and_b32 v74, 0xffff0000, v74
    v_and_b32 v75, 0xffff0000, v75
    v_add_f32 v56, v56, v57
    v_add_f32 v57, v74, v75
    v_cvt_pk_bf16_f32 v56, v56, v57
    v_min_u32 v23, -2, v56
    buffer_store_dwordx4 v[20:23], v1, s[4:7], s36 offen sc1
    s_endpgm
L_l1_3:
    buffer_load_dwordx4 v[24:27], v1, s[4:7], s39 offen sc1
    s_add_u32 s47, s47, 1
    s_cmp_gt_u32 s47, 1000000
    s_cbranch_scc1 L_exit
    s_waitcnt vmcnt(2)
    s_branch L_l0_3
L_l3_3:
    buffer_load_dwordx4 v[40:43], v1, s[4:7], s59 offen sc1
    s_add_u32 s47, s47, 1
    s_cmp_gt_u32 s47, 1000000
    s_cbranch_scc1 L_exit
    s_waitcnt vmcnt(0)
    s_branch L_l2_3
L_f1_3:
    buffer_load_dwordx4 v[24:27], v1, s[4:7], s39 offen sc1
    s_waitcnt vmcnt(2)
    v_cmp_eq_u32 vcc, -1, v27
    s_nop 0
    ds_write_b128 v1, v[24:27] offset:6144
    s_cbranch_vccnz L_f2_3
    buffer_load_dwordx4 v[40:43], v1, s[4:7], s59 offen sc1
    v_smfmac_f32_16x16x64_bf16 v[56:59], v[24:27], v[96:103], v0
    v_smfmac_f32_16x16x64_bf16 v[60:63], v[24:27], v[104:111], v0
    v_smfmac_f32_16x16x64_bf16 v[64:67], v[24:27], v[112:119], v0
    s_waitcnt lgkmcnt(0)
    s_barrier
    ds_read_b128 v[28:31], v1 offset:0
    ds_read_b128 v[32:35], v1 offset:2048
    v_smfmac_f32_16x16x64_bf16 v[68:71], v[24:27], v[120:127], v0
    ds_read_b128 v[36:39], v1 offset:4096
    buffer_store_dwordx4 v[20:23], v1, s[4:7], s58 offen sc1
    v_smfmac_f32_16x16x64_bf16 v[72:75], v[24:27], a[192:199], v0
    v_smfmac_f32_16x16x64_bf16 v[76:79], v[24:27], a[200:207], v0
    s_branch L_go2_3
L_f2_3:
    buffer_load_dwordx4 v[24:27], v1, s[4:7], s39 offen sc1
    s_waitcnt vmcnt(2)
    v_cmp_eq_u32 vcc, -1, v27
    s_nop 0
    ds_write_b128 v1, v[24:27] offset:6144
    s_cbranch_vccnz L_f3_3
    buffer_load_dwordx4 v[40:43], v1, s[4:7], s59 offen sc1
    s_branch L_go_3
L_f3_3:
    buffer_load_dwordx4 v[24:27], v1, s[4:7], s39 offen sc1
    s_waitcnt vmcnt(2)
    v_cmp_eq_u32 vcc, -1, v27
    s_nop 0
    ds_write_b128 v1, v[24:27] offset:6144
    s_cbranch_vccnz L_f4_3
    buffer_load_dwordx4 v[40:43], v1, s[4:7], s59 offen sc1
    s_branch L_go_3
L_f4_3:
    s_add_u32 s47, s47, 1
    s_cmp_gt_u32 s47, 1000000
    s_cbranch_scc1 L_exit
    s_branch L_f3_3
L_rL_3:
    buffer_load_dwordx4 v[40:43], v1, s[4:7], s59 offen sc1
    s_add_u32 s47, s47, 1
    s_cmp_gt_u32 s47, 1000000
    s_cbranch_scc1 L_exit
    s_waitcnt vmcnt(0)
    ds_write_b128 v1, v[40:43] offset:7168
    s_nop 0
    s_nop 0
    v_cmp_eq_u32 vcc, -1, v43
    s_waitcnt lgkmcnt(0)
    s_cbranch_vccnz L_rL_3
    s_branch L_bL_3
L_r2_3:
    s_waitcnt vmcnt(1)
    v_mfma_f32_16x16x32_bf16 v[32:35], v[16:19], v[44:47], 0
    v_bitop3_b32 v36, v44, v46, s38 bitop3:0x7e
    v_bitop3_b32 v37, v48, v50, s38 bitop3:0x7e
    v_mfma_f32_16x16x32_bf16 v[32:35], v[16:19], v[48:51], v[32:35]
    v_bitop3_b32 v36, v36, v37, 1 bitop3:0xa8
    v_cmp_ne_u32 vcc, 0, v36
    s_nop 0
    s_nop 3
    v_add_f32_dpp v32, v32, v32 row_ror:4 row_mask:0xf bank_mask:0xf
    v_add_f32_dpp v33, v33, v33 row_ror:4 row_mask:0xf bank_mask:0xf
    s_nop 0
    v_add_f32_dpp v32, v32, v32 row_ror:8 row_mask:0xf bank_mask:0xf
    v_add_f32_dpp v33, v33, v33 row_ror:8 row_mask:0xf bank_mask:0xf
    v_cvt_pk_bf16_f32 v32, v32, v33
    s_cbranch_vccnz L_r1_3
    buffer_store_dword v32, v7, s[4:7], s44 offen
    s_branch L_a2_3
L_r1_3:
    buffer_load_dwordx4 v[80:83], v1, s[4:7], s37 offen offset:0 sc1
    buffer_load_dwordx4 v[84:87], v1, s[4:7], s37 offen offset:1024 sc1
    s_add_u32 s47, s47, 1
    s_cmp_gt_u32 s47, 1000000
    s_cbranch_scc1 L_exit
    s_waitcnt vmcnt(0)
    s_branch L_a1_3
L_step_3:
    ds_write_b128 v1, v[24:27] offset:6144
    s_branch L_go_3
L_exit:
    s_endpgm
L_bstep_0:
    ds_write_b128 v1, v[24:27] offset:0
    s_nop 0
    v_smfmac_f32_16x16x64_bf16 v[56:59], v[24:27], v[96:103], v0
    v_smfmac_f32_16x16x64_bf16 v[60:63], v[24:27], v[104:111], v0
    v_smfmac_f32_16x16x64_bf16 v[64:67], v[24:27], v[112:119], v0
    s_waitcnt lgkmcnt(0)
    s_barrier
    ds_read_b128 v[28:31], v1 offset:2048
    ds_read_b128 v[32:35], v1 offset:4096
    v_smfmac_f32_16x16x64_bf16 v[68:71], v[24:27], v[120:127], v0
    ds_read_b128 v[36:39], v1 offset:6144
    v_smfmac_f32_16x16x64_bf16 v[72:75], v[24:27], a[192:199], v0
    v_smfmac_f32_16x16x64_bf16 v[76:79], v[24:27], a[200:207], v0
    s_waitcnt lgkmcnt(2)
    v_smfmac_f32_16x16x64_bf16 v[56:59], v[28:31], a[0:7], v0
    ds_read_b128 v[96:99], v2 offset:8192
    v_smfmac_f32_16x16x64_bf16 v[60:63], v[28:31], a[8:15], v0
    ds_read_b128 v[100:103], v2 offset:9216
    v_smfmac_f32_16x16x64_bf16 v[64:67], v[28:31], a[16:23], v0
    ds_read_b128 v[104:107], v2 offset:12288
    v_smfmac_f32_16x16x64_bf16 v[68:71], v[28:31], a[24:31], v0
    ds_read_b128 v[108:111], v2 offset:13312
    s_waitcnt lgkmcnt(4)
    v_smfmac_f32_16x16x64_bf16 v[56:59], v[32:35], a[32:39], v0
    s_nop 0
    ds_read_b128 v[112:115], v2 offset:10240
    v_smfmac_f32_16x16x64_bf16 v[60:63], v[32:35], a[40:47], v0
    ds_read_b128 v[116:119], v2 offset:11264
    v_smfmac_f32_16x16x64_bf16 v[64:67], v[32:35], a[48:55], v0
    ds_read_b128 v[120:123], v2 offset:14336
    v_smfmac_f32_16x16x64_bf16 v[68:71], v[32:35], a[56:63], v0
    ds_read_b128 v[124:127], v2 offset:15360
    v_smfmac_f32_16x16x64_bf16 v[56:59], v[36:39], a[64:71], v0
    v_smfmac_f32_16x16x64_bf16 v[60:63], v[36:39], a[72:79], v0
    s_waitcnt vmcnt(1)
    ds_write_b128 v1, v[40:43] offset:1024
    v_smfmac_f32_16x16x64_bf16 v[64:67], v[36:39], a[80:87], v0
    s_nop 0
    v_smfmac_f32_16x16x64_bf16 v[68:71], v[36:39], a[88:95], v0
    v_cmp_eq_u32 vcc, -1, v43
    v_smfmac_f32_16x16x64_bf16 v[72:75], v[28:31], a[208:215], v0
    v_smfmac_f32_16x16x64_bf16 v[76:79], v[28:31], a[216:223], v0
    s_nop 0
    s_waitcnt lgkmcnt(0)
    s_barrier
    ds_read_b128 v[44:47], v1 offset:3072
    v_smfmac_f32_16x16x64_bf16 v[56:59], v[40:43], v[96:103], v0
    ds_read_b128 v[48:51], v1 offset:5120
    ds_read_b128 v[52:55], v1 offset:7168
    v_smfmac_f32_16x16x64_bf16 v[60:63], v[40:43], v[104:111], v0
    s_nop 0
    ds_read_b128 v[96:99], v2 offset:16384
    v_smfmac_f32_16x16x64_bf16 v[64:67], v[40:43], v[112:119], v0
    ds_read_b128 v[100:103], v2 offset:17408
    v_smfmac_f32_16x16x64_bf16 v[68:71], v[40:43], v[120:127], v0
    ds_read_b128 v[104:107], v2 offset:18432
    s_waitcnt lgkmcnt(5)
    v_smfmac_f32_16x16x64_bf16 v[56:59], v[44:47], a[96:103], v0
    ds_read_b128 v[108:111], v2 offset:19456
    v_mov_b64 v[20:21], s[84:85]
    v_smfmac_f32_16x16x64_bf16 v[60:63], v[44:47], a[104:111], v0
    s_nop 0
    ds_read_b128 v[112:115], v2 offset:20480
    v_smfmac_f32_16x16x64_bf16 v[64:67], v[44:47], a[112:119], v0
    ds_read_b128 v[116:119], v2 offset:21504
    v_mov_b64 v[22:23], s[84:85]
    v_smfmac_f32_16x16x64_bf16 v[68:71], v[44:47], a[120:127], v0
    ds_read_b128 v[120:123], v2 offset:22528
    s_waitcnt lgkmcnt(7)
    v_smfmac_f32_16x16x64_bf16 v[56:59], v[48:51], a[128:135], v0
    ds_read_b128 v[124:127], v2 offset:23552
    v_smfmac_f32_16x16x64_bf16 v[60:63], v[48:51], a[136:143], v0
    s_nop 0
    v_smfmac_f32_16x16x64_bf16 v[56:59], v[52:55], a[160:167], v0
    v_smfmac_f32_16x16x64_bf16 v[60:63], v[52:55], a[168:175], v0
    v_smfmac_f32_16x16x64_bf16 v[64:67], v[48:51], a[144:151], v0
    v_cvt_pk_bf16_f32 v56, v56, v57
    v_smfmac_f32_16x16x64_bf16 v[68:71], v[48:51], a[152:159], v0
    s_nop 0
    v_cvt_pk_bf16_f32 v57, v58, v59
    v_smfmac_f32_16x16x64_bf16 v[64:67], v[52:55], a[176:183], v0
    v_cvt_pk_bf16_f32 v58, v60, v61
    v_smfmac_f32_16x16x64_bf16 v[68:71], v[52:55], a[184:191], v0
    s_branch L_c_m6_0
L_bk_0:
    v_cvt_pk_bf16_f32 v59, v62, v63
    s_nop 0
    v_cvt_pk_bf16_f32 v64, v64, v65
    v_mfma_f32_16x16x32_bf16 v[60:63], v[56:59], v[12:15], 0
    v_cvt_pk_bf16_f32 v65, v66, v67
    v_cvt_pk_bf16_f32 v66, v68, v69
    v_cvt_pk_bf16_f32 v67, v70, v71
    s_nop 1
    v_mfma_f32_16x16x32_bf16 v[68:71], v[64:67], v[12:15], 0
    v_cvt_pk_bf16_f32 v56, v60, v61
    v_cvt_pk_bf16_f32 v57, v62, v63
    v_cndmask_b32 v24, 0, v56, s[86:87]
    v_cndmask_b32 v25, 0, v57, s[86:87]
    v_mov_b32_dpp v28, v56 row_shr:8 row_mask:0xf bank_mask:0xf bound_ctrl:1
    v_mov_b32_dpp v29, v57 row_shr:8 row_mask:0xf bank_mask:0xf bound_ctrl:1
    s_nop 0
    v_cvt_pk_bf16_f32 v58, v68, v69
    v_cvt_pk_bf16_f32 v59, v70, v71
    v_cndmask_b32 v26, 0, v58, s[86:87]
    v_cndmask_b32 v27, 0, v59, s[86:87]
    v_mfma_f32_16x16x32_bf16 v[68:71], v[56:59], v[56:59], 0
    v_mov_b32_dpp v30, v58 row_shr:8 row_mask:0xf bank_mask:0xf bound_ctrl:1
    v_mov_b32_dpp v31, v59 row_shr:8 row_mask:0xf bank_mask:0xf bound_ctrl:1
    v_mfma_f32_16x16x32_bf16 v[64:67], v[80:83], v[24:27], 0
    s_nop 0
    v_mfma_f32_16x16x32_bf16 v[64:67], v[84:87], v[28:31], v[64:67]
    v_mov_b32_dpp v68, v70 row_ror:8 row_mask:0xf bank_mask:0xc
    v_mov_b32_dpp v69, v71 row_ror:8 row_mask:0xf bank_mask:0xc
    v_smfmac_f32_16x16x64_bf16 v[72:75], v[32:35], a[224:231], v0
    s_nop 0
    ds_write2_b32 v3, v68, v69 offset0:0 offset1:32
    v_smfmac_f32_16x16x64_bf16 v[76:79], v[32:35], a[232:239], v0
    ds_write_b128 v1, v[64:67] offset:8192
    v_smfmac_f32_16x16x64_bf16 v[72:75], v[36:39], a[240:247], v0
    s_nop 0
    v_smfmac_f32_16x16x64_bf16 v[76:79], v[36:39], a[248:255], v0
    s_nop 0
    s_nop 0
    s_nop 0
    v_smfmac_f32_16x16x64_bf16 v[72:75], v[40:43], v[128:135], v0
    v_smfmac_f32_16x16x64_bf16 v[76:79], v[40:43], v[136:143], v0
    v_smfmac_f32_16x16x64_bf16 v[72:75], v[44:47], v[144:151], v0
    v_smfmac_f32_16x16x64_bf16 v[76:79], v[44:47], v[152:159], v0
    s_waitcnt lgkmcnt(0)
    s_barrier
    ds_read_b128 v[68:71], v1 offset:9216
    ds_read_b128 v[60:63], v1 offset:10240
    v_smfmac_f32_16x16x64_bf16 v[72:75], v[48:51], v[160:167], v0
    ds_read_b128 v[80:83], v1 offset:12288
    ds_read_b128 v[84:87], v1 offset:14336
    v_smfmac_f32_16x16x64_bf16 v[76:79], v[48:51], v[168:175], v0
    v_smfmac_f32_16x16x64_bf16 v[72:75], v[52:55], v[176:183], v0
    v_smfmac_f32_16x16x64_bf16 v[76:79], v[52:55], v[184:191], v0
    s_waitcnt lgkmcnt(2)
    v_add_f32 v68, v68, v69
    v_add_f32 v70, v70, v71
    v_add_f32 v64, v64, v60
    v_add_f32 v65, v65, v61
    v_pk_add_f32 v[66:67], v[66:67], v[62:63]
    v_add_f32 v68, v68, v70
    s_waitcnt lgkmcnt(0)
    v_pk_add_f32 v[80:81], v[80:81], v[84:85]
    v_pk_add_f32 v[82:83], v[82:83], v[86:87]
    v_pk_add_f32 v[64:65], v[64:65], v[80:81]
    v_pk_add_f32 v[66:67], v[66:67], v[82:83]
    v_max3_f32 v60, v68, v64, v65
    v_max3_f32 v60, v60, v66, v67
    v_cvt_pk_bf16_f32 v72, v72, v73
    v_cvt_pk_bf16_f32 v73, v74, v75
    v_max_f32_dpp v61, v60, v60 row_ror:8 row_mask:0xf bank_mask:0xf
    v_max_f32_dpp v60, v60, v60 row_ror:8 row_mask:0xf bank_mask:0xf
    v_cvt_pk_bf16_f32 v74, v76, v77
    v_cvt_pk_bf16_f32 v75, v78, v79
    v_permlane32_swap_b32 v60, v61
    v_max_f32 v62, v60, v61
    v_max_f32 v63, v60, v61
    v_permlane32_swap_b32 v72, v73
    v_permlane32_swap_b32 v74, v75
    v_permlane16_swap_b32 v62, v63
    v_max_f32 v60, v62, v63
    v_mul_f32 v60, s48, v60
    v_fma_f32 v68, v68, s48, -v60
    v_exp_f32 v68, v68
    v_pk_fma_f32 v[64:65], v[64:65], s[48:49], v[60:61] op_sel_hi:[1,1,0] neg_lo:[0,0,1] neg_hi:[0,0,1]
    v_pk_fma_f32 v[66:67], v[66:67], s[48:49], v[60:61] op_sel_hi:[1,1,0] neg_lo:[0,0,1] neg_hi:[0,0,1]
    v_mov_b32_dpp v69, v68 row_ror:8 row_mask:0xf bank_mask:0xf
    v_cvt_pk_bf16_f32 v52, v68, v69
    v_cvt_pk_bf16_f32 v53, v68, v69
    v_exp_f32 v64, v64
    v_exp_f32 v65, v65
    v_mfma_f32_16x16x16_bf16 v[80:83], v[72:73], v[52:53], 0
    v_exp_f32 v66, v66
    v_exp_f32 v67, v67
    v_cvt_pk_bf16_f32 v60, v64, v65
    v_cvt_pk_bf16_f32 v61, v66, v67
    v_mfma_f32_16x16x16_bf16 v[76:79], v[74:75], v[52:53], 0
    v_mov_b32_dpp v62, v60 row_ror:8 row_mask:0xf bank_mask:0xf
    v_mov_b32_dpp v63, v61 row_ror:8 row_mask:0xf bank_mask:0xf
    v_mov_b64 v[64:65], 0
    v_mov_b64 v[66:67], 0
    v_mfma_f32_16x16x32_bf16 v[80:83], v[88:91], v[60:63], v[80:83]
    ds_read_b128 v[24:27], v2 offset:24576
    ds_read_b128 v[28:31], v2 offset:25600
    v_mfma_f32_16x16x32_bf16 v[76:79], v[92:95], v[60:63], v[76:79]
    ds_read_b128 v[32:35], v2 offset:26624
    ds_read_b128 v[36:39], v2 offset:27648
    v_mfma_f32_16x16x16_bf16 v[68:71], v[52:53], v[10:11], 0
    v_cvt_pk_bf16_f32 v84, v80, v81
    v_cvt_pk_bf16_f32 v85, v82, v83
    v_mov_b64 v[80:81], 0
    v_mov_b64 v[82:83], 0
    v_cvt_pk_bf16_f32 v86, v76, v77
    v_cvt_pk_bf16_f32 v87, v78, v79
    v_mfma_f32_16x16x32_bf16 v[68:71], v[60:63], v[20:23], v[68:71]
    s_nop 0
    ds_write_b128 v8, v[84:87] offset:1024
    v_mov_b32_dpp v84, v84 row_ror:8 row_mask:0xf bank_mask:0xc
    v_mov_b32_dpp v85, v85 row_ror:8 row_mask:0xf bank_mask:0xc
    v_mov_b32_dpp v86, v86 row_ror:8 row_mask:0xf bank_mask:0xc
    v_mov_b32_dpp v87, v87 row_ror:8 row_mask:0xf bank_mask:0xc
    v_mov_b64 v[76:77], 0
    v_mov_b64 v[78:79], 0
    v_mov_b64 v[20:21], 0
    v_rcp_f32 v68, v68
    v_rcp_f32 v69, v69
    v_rcp_f32 v70, v70
    v_rcp_f32 v71, v71
    v_smfmac_f32_16x16x64_bf16 v[64:67], v[84:87], v[192:199], v0
    s_waitcnt lgkmcnt(0)
    s_barrier
    ds_read_b128 v[88:91], v5 offset:3072
    ds_read_b128 v[92:95], v5 offset:5120
    v_smfmac_f32_16x16x64_bf16 v[80:83], v[84:87], v[224:231], v0
    ds_read_b128 v[60:63], v5 offset:7168
    v_mov_b64 v[22:23], 0
    v_smfmac_f32_16x16x64_bf16 v[76:79], v[84:87], v[96:103], v0
    s_waitcnt lgkmcnt(2)
    v_smfmac_f32_16x16x64_bf16 v[64:67], v[88:91], v[200:207], v0
    ds_read_b128 v[40:43], v2 offset:28672
    s_waitcnt lgkmcnt(2)
    v_smfmac_f32_16x16x64_bf16 v[64:67], v[92:95], v[208:215], v0
    ds_read_b128 v[44:47], v2 offset:29696
    s_waitcnt lgkmcnt(2)
    v_smfmac_f32_16x16x64_bf16 v[64:67], v[60:63], v[216:223], v0
    ds_read_b128 v[48:51], v2 offset:30720
    v_smfmac_f32_16x16x64_bf16 v[80:83], v[88:91], v[232:239], v0
    ds_read_b128 v[52:55], v2 offset:31744
    v_smfmac_f32_16x16x64_bf16 v[80:83], v[92:95], v[240:247], v0
    v_mul_f32 v64, v64, v68
    v_smfmac_f32_16x16x64_bf16 v[80:83], v[60:63], v[248:255], v0
    v_mul_f32 v65, v65, v69
    v_mul_f32 v66, v66, v70
    v_mul_f32 v67, v67, v71
    v_cvt_pk_bf16_f32 v64, v64, v65
    v_cvt_pk_bf16_f32 v65, v66, v67
    v_bfi_b32 v64, 1, s38, v64
    v_smfmac_f32_16x16x64_bf16 v[76:79], v[88:91], v[104:111], v0
    s_nop 0
    buffer_store_dwordx2 v[64:65], v6, s[4:7], s40 offen sc1
    v_mul_f32 v80, v80, v68
    v_mul_f32 v81, v81, v69
    v_mul_f32 v82, v82, v70
    v_mul_f32 v83, v83, v71
    v_cvt_pk_bf16_f32 v80, v80, v81
    v_cvt_pk_bf16_f32 v81, v82, v83
    v_bfi_b32 v80, 1, s38, v80
    v_smfmac_f32_16x16x64_bf16 v[76:79], v[92:95], v[112:119], v0
    s_nop 0
    buffer_store_dwordx2 v[80:81], v6, s[4:7], s41 offen sc1
    v_smfmac_f32_16x16x64_bf16 v[76:79], v[60:63], v[120:127], v0
    s_waitcnt lgkmcnt(0)
    v_smfmac_f32_16x16x64_bf16 v[20:23], v[84:87], v[24:31], v0
    s_add_u32 s39, s44, 2048
    s_add_u32 s59, s44, 6144
    v_smfmac_f32_16x16x64_bf16 v[20:23], v[88:91], v[32:39], v0
    s_add_u32 s34, s34, 1
    s_mov_b32 s58, s36
    v_mul_f32 v76, v76, v68
    v_smfmac_f32_16x16x64_bf16 v[20:23], v[92:95], v[40:47], v0
    v_mul_f32 v77, v77, v69
    v_smfmac_f32_16x16x64_bf16 v[20:23], v[60:63], v[48:55], v0
    v_mul_f32 v78, v78, v70
    v_mul_f32 v79, v79, v71
    v_cvt_pk_bf16_f32 v76, v76, v77
    v_cvt_pk_bf16_f32 v77, v78, v79
    v_bfi_b32 v76, 1, s38, v76
    s_add_u32 s36, s36, 0x20000
    s_add_u32 s35, s35, 524288
    buffer_store_dwordx2 v[76:77], v6, s[4:7], s42 offen sc1
    v_pk_mul_f32 v[20:21], v[20:21], v[68:69]
    v_pk_mul_f32 v[22:23], v[22:23], v[70:71]
    v_cvt_pk_bf16_f32 v20, v20, v21
    v_cvt_pk_bf16_f32 v21, v22, v23
    v_bfi_b32 v20, 1, s38, v20
    s_nop 1
    buffer_store_dwordx2 v[20:21], v6, s[4:7], s43 offen sc1
    s_branch L_btail
L_bstep_1:
    ds_write_b128 v1, v[24:27] offset:2048
    s_nop 0
    v_smfmac_f32_16x16x64_bf16 v[56:59], v[24:27], v[96:103], v0
    v_smfmac_f32_16x16x64_bf16 v[60:63], v[24:27], v[104:111], v0
    v_smfmac_f32_16x16x64_bf16 v[64:67], v[24:27], v[112:119], v0
    s_waitcnt lgkmcnt(0)
    s_barrier
    ds_read_b128 v[28:31], v1 offset:4096
    ds_read_b128 v[32:35], v1 offset:6144
    v_smfmac_f32_16x16x64_bf16 v[68:71], v[24:27], v[120:127], v0
    ds_read_b128 v[36:39], v1 offset:0
    v_smfmac_f32_16x16x64_bf16 v[72:75], v[24:27], a[192:199], v0
    v_smfmac_f32_16x16x64_bf16 v[76:79], v[24:27], a[200:207], v0
    s_waitcnt lgkmcnt(2)
    v_smfmac_f32_16x16x64_bf16 v[56:59], v[28:31], a[0:7], v0
    ds_read_b128 v[96:99], v2 offset:8192
    v_smfmac_f32_16x16x64_bf16 v[60:63], v[28:31], a[8:15], v0
    ds_read_b128 v[100:103], v2 offset:9216
    v_smfmac_f32_16x16x64_bf16 v[64:67], v[28:31], a[16:23], v0
    s_nop 0
    ds_read_b128 v[104:107], v2 offset:12288
    v_smfmac_f32_16x16x64_bf16 v[68:71], v[28:31], a[24:31], v0
    ds_read_b128 v[108:111], v2 offset:13312
    s_waitcnt lgkmcnt(4)
    v_smfmac_f32_16x16x64_bf16 v[56:59], v[32:35], a[32:39], v0
    ds_read_b128 v[112:115], v2 offset:10240
    v_smfmac_f32_16x16x64_bf16 v[60:63], v[32:35], a[40:47], v0
    ds_read_b128 v[116:119], v2 offset:11264
    v_smfmac_f32_16x16x64_bf16 v[64:67], v[32:35], a[48:55], v0
    ds_read_b128 v[120:123], v2 offset:14336
    v_smfmac_f32_16x16x64_bf16 v[68:71], v[32:35], a[56:63], v0
    ds_read_b128 v[124:127], v2 offset:15360
    v_smfmac_f32_16x16x64_bf16 v[56:59], v[36:39], a[64:71], v0
    v_smfmac_f32_16x16x64_bf16 v[60:63], v[36:39], a[72:79], v0
    s_waitcnt vmcnt(1)
    ds_write_b128 v1, v[40:43] offset:3072
    v_smfmac_f32_16x16x64_bf16 v[64:67], v[36:39], a[80:87], v0
    s_nop 0
    v_smfmac_f32_16x16x64_bf16 v[68:71], v[36:39], a[88:95], v0
    v_cmp_eq_u32 vcc, -1, v43
    v_smfmac_f32_16x16x64_bf16 v[72:75], v[28:31], a[208:215], v0
    v_smfmac_f32_16x16x64_bf16 v[76:79], v[28:31], a[216:223], v0
    s_nop 0
    s_waitcnt lgkmcnt(0)
    s_barrier
    ds_read_b128 v[44:47], v1 offset:5120
    v_smfmac_f32_16x16x64_bf16 v[56:59], v[40:43], v[96:103], v0
    ds_read_b128 v[48:51], v1 offset:7168
    ds_read_b128 v[52:55], v1 offset:1024
    v_smfmac_f32_16x16x64_bf16 v[60:63], v[40:43], v[104:111], v0
    ds_read_b128 v[96:99], v2 offset:16384
    v_smfmac_f32_16x16x64_bf16 v[64:67], v[40:43], v[112:119], v0
    s_nop 0
    ds_read_b128 v[100:103], v2 offset:17408
    v_smfmac_f32_16x16x64_bf16 v[68:71], v[40:43], v[120:127], v0
    ds_read_b128 v[104:107], v2 offset:18432
    s_waitcnt lgkmcnt(5)
    v_smfmac_f32_16x16x64_bf16 v[56:59], v[44:47], a[96:103], v0
    ds_read_b128 v[108:111], v2 offset:19456
    v_mov_b64 v[20:21], s[84:85]
    v_smfmac_f32_16x16x64_bf16 v[60:63], v[44:47], a[104:111], v0
    ds_read_b128 v[112:115], v2 offset:20480
    v_mov_b64 v[22:23], s[84:85]
    v_smfmac_f32_16x16x64_bf16 v[64:67], v[44:47], a[112:119], v0
    s_nop 0
    ds_read_b128 v[116:119], v2 offset:21504
    v_smfmac_f32_16x16x64_bf16 v[68:71], v[44:47], a[120:127], v0
    ds_read_b128 v[120:123], v2 offset:22528
    s_waitcnt lgkmcnt(7)
    v_smfmac_f32_16x16x64_bf16 v[56:59], v[48:51], a[128:135], v0
    ds_read_b128 v[124:127], v2 offset:23552
    v_smfmac_f32_16x16x64_bf16 v[60:63], v[48:51], a[136:143], v0
    v_smfmac_f32_16x16x64_bf16 v[56:59], v[52:55], a[160:167], v0
    s_nop 0
    v_smfmac_f32_16x16x64_bf16 v[60:63], v[52:55], a[168:175], v0
    v_smfmac_f32_16x16x64_bf16 v[64:67], v[48:51], a[144:151], v0
    v_cvt_pk_bf16_f32 v56, v56, v57
    v_smfmac_f32_16x16x64_bf16 v[68:71], v[48:51], a[152:159], v0
    v_cvt_pk_bf16_f32 v57, v58, v59
    v_smfmac_f32_16x16x64_bf16 v[64:67], v[52:55], a[176:183], v0
    s_nop 0
    v_cvt_pk_bf16_f32 v58, v60, v61
    v_smfmac_f32_16x16x64_bf16 v[68:71], v[52:55], a[184:191], v0
    s_branch L_c_m6_1
L_bk_1:
    v_cvt_pk_bf16_f32 v59, v62, v63
    s_nop 0
    v_cvt_pk_bf16_f32 v64, v64, v65
    v_mfma_f32_16x16x32_bf16 v[60:63], v[56:59], v[12:15], 0
    v_cvt_pk_bf16_f32 v65, v66, v67
    v_cvt_pk_bf16_f32 v66, v68, v69
    v_cvt_pk_bf16_f32 v67, v70, v71
    s_nop 1
    v_mfma_f32_16x16x32_bf16 v[68:71], v[64:67], v[12:15], 0
    v_cvt_pk_bf16_f32 v56, v60, v61
    v_cvt_pk_bf16_f32 v57, v62, v63
    v_cndmask_b32 v24, 0, v56, s[86:87]
    v_cndmask_b32 v25, 0, v57, s[86:87]
    v_mov_b32_dpp v28, v56 row_shr:8 row_mask:0xf bank_mask:0xf bound_ctrl:1
    v_mov_b32_dpp v29, v57 row_shr:8 row_mask:0xf bank_mask:0xf bound_ctrl:1
    s_nop 0
    v_cvt_pk_bf16_f32 v58, v68, v69
    v_cvt_pk_bf16_f32 v59, v70, v71
    v_cndmask_b32 v26, 0, v58, s[86:87]
    v_cndmask_b32 v27, 0, v59, s[86:87]
    v_mfma_f32_16x16x32_bf16 v[68:71], v[56:59], v[56:59], 0
    v_mov_b32_dpp v30, v58 row_shr:8 row_mask:0xf bank_mask:0xf bound_ctrl:1
    v_mov_b32_dpp v31, v59 row_shr:8 row_mask:0xf bank_mask:0xf bound_ctrl:1
    v_mfma_f32_16x16x32_bf16 v[64:67], v[80:83], v[24:27], 0
    s_nop 0
    v_mfma_f32_16x16x32_bf16 v[64:67], v[84:87], v[28:31], v[64:67]
    v_mov_b32_dpp v68, v70 row_ror:8 row_mask:0xf bank_mask:0xc
    v_mov_b32_dpp v69, v71 row_ror:8 row_mask:0xf bank_mask:0xc
    v_smfmac_f32_16x16x64_bf16 v[72:75], v[32:35], a[224:231], v0
    s_nop 0
    ds_write2_b32 v3, v68, v69 offset0:0 offset1:32
    v_smfmac_f32_16x16x64_bf16 v[76:79], v[32:35], a[232:239], v0
    ds_write_b128 v1, v[64:67] offset:10240
    v_smfmac_f32_16x16x64_bf16 v[72:75], v[36:39], a[240:247], v0
    v_smfmac_f32_16x16x64_bf16 v[76:79], v[36:39], a[248:255], v0
    s_nop 0
    v_smfmac_f32_16x16x64_bf16 v[72:75], v[40:43], v[128:135], v0
    v_smfmac_f32_16x16x64_bf16 v[76:79], v[40:43], v[136:143], v0
    v_smfmac_f32_16x16x64_bf16 v[72:75], v[44:47], v[144:151], v0
    v_smfmac_f32_16x16x64_bf16 v[76:79], v[44:47], v[152:159], v0
    s_waitcnt lgkmcnt(0)
    s_barrier
    ds_read_b128 v[68:71], v1 offset:9216
    ds_read_b128 v[60:63], v1 offset:12288
    v_smfmac_f32_16x16x64_bf16 v[72:75], v[48:51], v[160:167], v0
    ds_read_b128 v[80:83], v1 offset:14336
    ds_read_b128 v[84:87], v1 offset:8192
    v_smfmac_f32_16x16x64_bf16 v[76:79], v[48:51], v[168:175], v0
    v_smfmac_f32_16x16x64_bf16 v[72:75], v[52:55], v[176:183], v0
    v_smfmac_f32_16x16x64_bf16 v[76:79], v[52:55], v[184:191], v0
    s_waitcnt lgkmcnt(2)
    v_add_f32 v68, v68, v69
    v_add_f32 v70, v70, v71
    v_add_f32 v64, v64, v60
    v_add_f32 v65, v65, v61
    v_pk_add_f32 v[66:67], v[66:67], v[62:63]
    v_add_f32 v68, v68, v70
    s_waitcnt lgkmcnt(0)
    v_pk_add_f32 v[80:81], v[80:81], v[84:85]
    v_pk_add_f32 v[82:83], v[82:83], v[86:87]
    v_pk_add_f32 v[64:65], v[64:65], v[80:81]
    v_pk_add_f32 v[66:67], v[66:67], v[82:83]
    v_max3_f32 v60, v68, v64, v65
    v_max3_f32 v60, v60, v66, v67
    v_cvt_pk_bf16_f32 v72, v72, v73
    v_cvt_pk_bf16_f32 v73, v74, v75
    v_max_f32_dpp v61, v60, v60 row_ror:8 row_mask:0xf bank_mask:0xf
    v_max_f32_dpp v60, v60, v60 row_ror:8 row_mask:0xf bank_mask:0xf
    v_cvt_pk_bf16_f32 v74, v76, v77
    v_cvt_pk_bf16_f32 v75, v78, v79
    v_permlane32_swap_b32 v60, v61
    v_max_f32 v62, v60, v61
    v_max_f32 v63, v60, v61
    v_permlane32_swap_b32 v72, v73
    v_permlane32_swap_b32 v74, v75
    v_permlane16_swap_b32 v62, v63
    v_max_f32 v60, v62, v63
    v_mul_f32 v60, s48, v60
    v_fma_f32 v68, v68, s48, -v60
    v_exp_f32 v68, v68
    v_pk_fma_f32 v[64:65], v[64:65], s[48:49], v[60:61] op_sel_hi:[1,1,0] neg_lo:[0,0,1] neg_hi:[0,0,1]
    v_pk_fma_f32 v[66:67], v[66:67], s[48:49], v[60:61] op_sel_hi:[1,1,0] neg_lo:[0,0,1] neg_hi:[0,0,1]
    v_mov_b32_dpp v69, v68 row_ror:8 row_mask:0xf bank_mask:0xf
    v_cvt_pk_bf16_f32 v28, v68, v69
    v_cvt_pk_bf16_f32 v29, v68, v69
    v_exp_f32 v64, v64
    v_exp_f32 v65, v65
    v_mfma_f32_16x16x16_bf16 v[80:83], v[72:73], v[28:29], 0
    v_exp_f32 v66, v66
    v_exp_f32 v67, v67
    v_cvt_pk_bf16_f32 v60, v64, v65
    v_cvt_pk_bf16_f32 v61, v66, v67
    v_mfma_f32_16x16x16_bf16 v[76:79], v[74:75], v[28:29], 0
    v_mov_b32_dpp v62, v60 row_ror:8 row_mask:0xf bank_mask:0xf
    v_mov_b32_dpp v63, v61 row_ror:8 row_mask:0xf bank_mask:0xf
    v_mov_b64 v[64:65], 0
    v_mov_b64 v[66:67], 0
    v_mfma_f32_16x16x32_bf16 v[80:83], v[88:91], v[60:63], v[80:83]
    ds_read_b128 v[32:35], v2 offset:26624
    ds_read_b128 v[36:39], v2 offset:27648
    v_mfma_f32_16x16x32_bf16 v[76:79], v[92:95], v[60:63], v[76:79]
    ds_read_b128 v[40:43], v2 offset:28672
    ds_read_b128 v[44:47], v2 offset:29696
    v_mfma_f32_16x16x16_bf16 v[68:71], v[28:29], v[10:11], 0
    v_cvt_pk_bf16_f32 v84, v80, v81
    v_cvt_pk_bf16_f32 v85, v82, v83
    v_mov_b64 v[80:81], 0
    v_mov_b64 v[82:83], 0
    v_cvt_pk_bf16_f32 v86, v76, v77
    v_cvt_pk_bf16_f32 v87, v78, v79
    v_mfma_f32_16x16x32_bf16 v[68:71], v[60:63], v[20:23], v[68:71]
    s_nop 0
    ds_write_b128 v8, v[84:87] offset:3072
    v_mov_b32_dpp v84, v84 row_ror:8 row_mask:0xf bank_mask:0xc
    v_mov_b32_dpp v85, v85 row_ror:8 row_mask:0xf bank_mask:0xc
    v_mov_b32_dpp v86, v86 row_ror:8 row_mask:0xf bank_mask:0xc
    v_mov_b32_dpp v87, v87 row_ror:8 row_mask:0xf bank_mask:0xc
    v_mov_b64 v[76:77], 0
    v_mov_b64 v[78:79], 0
    v_mov_b64 v[20:21], 0
    v_rcp_f32 v68, v68
    v_rcp_f32 v69, v69
    v_rcp_f32 v70, v70
    v_rcp_f32 v71, v71
    v_smfmac_f32_16x16x64_bf16 v[64:67], v[84:87], v[200:207], v0
    s_waitcnt lgkmcnt(0)
    s_barrier
    ds_read_b128 v[88:91], v5 offset:5120
    ds_read_b128 v[92:95], v5 offset:7168
    v_smfmac_f32_16x16x64_bf16 v[80:83], v[84:87], v[232:239], v0
    ds_read_b128 v[60:63], v5 offset:1024
    v_mov_b64 v[22:23], 0
    v_smfmac_f32_16x16x64_bf16 v[76:79], v[84:87], v[104:111], v0
    s_waitcnt lgkmcnt(2)
    v_smfmac_f32_16x16x64_bf16 v[64:67], v[88:91], v[208:215], v0
    ds_read_b128 v[48:51], v2 offset:30720
    s_waitcnt lgkmcnt(2)
    v_smfmac_f32_16x16x64_bf16 v[64:67], v[92:95], v[216:223], v0
    ds_read_b128 v[52:55], v2 offset:31744
    s_waitcnt lgkmcnt(2)
    v_smfmac_f32_16x16x64_bf16 v[64:67], v[60:63], v[192:199], v0
    ds_read_b128 v[24:27], v2 offset:24576
    v_smfmac_f32_16x16x64_bf16 v[80:83], v[88:91], v[240:247], v0
    ds_read_b128 v[28:31], v2 offset:25600
    v_smfmac_f32_16x16x64_bf16 v[80:83], v[92:95], v[248:255], v0
    v_mul_f32 v64, v64, v68
    v_smfmac_f32_16x16x64_bf16 v[80:83], v[60:63], v[224:231], v0
    v_mul_f32 v65, v65, v69
    v_mul_f32 v66, v66, v70
    v_mul_f32 v67, v67, v71
    v_cvt_pk_bf16_f32 v64, v64, v65
    v_cvt_pk_bf16_f32 v65, v66, v67
    v_bfi_b32 v64, 1, s38, v64
    v_smfmac_f32_16x16x64_bf16 v[76:79], v[88:91], v[112:119], v0
    s_nop 0
    buffer_store_dwordx2 v[64:65], v6, s[4:7], s40 offen sc1
    v_mul_f32 v80, v80, v68
    v_mul_f32 v81, v81, v69
    v_mul_f32 v82, v82, v70
    v_mul_f32 v83, v83, v71
    v_cvt_pk_bf16_f32 v80, v80, v81
    v_cvt_pk_bf16_f32 v81, v82, v83
    v_bfi_b32 v80, 1, s38, v80
    v_smfmac_f32_16x16x64_bf16 v[76:79], v[92:95], v[120:127], v0
    s_nop 0
    buffer_store_dwordx2 v[80:81], v6, s[4:7], s41 offen sc1
    v_smfmac_f32_16x16x64_bf16 v[76:79], v[60:63], v[96:103], v0
    s_waitcnt lgkmcnt(0)
    v_smfmac_f32_16x16x64_bf16 v[20:23], v[84:87], v[32:39], v0
    s_add_u32 s39, s44, 3072
    s_add_u32 s59, s44, 7168
    v_smfmac_f32_16x16x64_bf16 v[20:23], v[88:91], v[40:47], v0
    s_add_u32 s34, s34, 1
    s_mov_b32 s58, s36
    v_mul_f32 v76, v76, v68
    v_smfmac_f32_16x16x64_bf16 v[20:23], v[92:95], v[48:55], v0
    v_mul_f32 v77, v77, v69
    v_smfmac_f32_16x16x64_bf16 v[20:23], v[60:63], v[24:31], v0
    v_mul_f32 v78, v78, v70
    v_mul_f32 v79, v79, v71
    v_cvt_pk_bf16_f32 v76, v76, v77
    v_cvt_pk_bf16_f32 v77, v78, v79
    v_bfi_b32 v76, 1, s38, v76
    s_add_u32 s36, s36, 0x20000
    s_add_u32 s35, s35, 524288
    buffer_store_dwordx2 v[76:77], v6, s[4:7], s42 offen sc1
    v_pk_mul_f32 v[20:21], v[20:21], v[68:69]
    v_pk_mul_f32 v[22:23], v[22:23], v[70:71]
    v_cvt_pk_bf16_f32 v20, v20, v21
    v_cvt_pk_bf16_f32 v21, v22, v23
    v_bfi_b32 v20, 1, s38, v20
    s_nop 1
    buffer_store_dwordx2 v[20:21], v6, s[4:7], s43 offen sc1
    s_branch L_btail
L_bstep_2:
    ds_write_b128 v1, v[24:27] offset:4096
    s_nop 0
    v_smfmac_f32_16x16x64_bf16 v[56:59], v[24:27], v[96:103], v0
    v_smfmac_f32_16x16x64_bf16 v[60:63], v[24:27], v[104:111], v0
    v_smfmac_f32_16x16x64_bf16 v[64:67], v[24:27], v[112:119], v0
    s_waitcnt lgkmcnt(0)
    s_barrier
    ds_read_b128 v[28:31], v1 offset:6144
    ds_read_b128 v[32:35], v1 offset:0
    v_smfmac_f32_16x16x64_bf16 v[68:71], v[24:27], v[120:127], v0
    ds_read_b128 v[36:39], v1 offset:2048
    v_smfmac_f32_16x16x64_bf16 v[72:75], v[24:27], a[192:199], v0
    v_smfmac_f32_16x16x64_bf16 v[76:79], v[24:27], a[200:207], v0
    s_waitcnt lgkmcnt(2)
    v_smfmac_f32_16x16x64_bf16 v[56:59], v[28:31], a[0:7], v0
    s_nop 0
    ds_read_b128 v[96:99], v2 offset:8192
    v_smfmac_f32_16x16x64_bf16 v[60:63], v[28:31], a[8:15], v0
    ds_read_b128 v[100:103], v2 offset:9216
    v_smfmac_f32_16x16x64_bf16 v[64:67], v[28:31], a[16:23], v0
    ds_read_b128 v[104:107], v2 offset:12288
    v_smfmac_f32_16x16x64_bf16 v[68:71], v[28:31], a[24:31], v0
    ds_read_b128 v[108:111], v2 offset:13312
    s_waitcnt lgkmcnt(4)
    v_smfmac_f32_16x16x64_bf16 v[56:59], v[32:35], a[32:39], v0
    ds_read_b128 v[112:115], v2 offset:10240
    v_smfmac_f32_16x16x64_bf16 v[60:63], v[32:35], a[40:47], v0
    ds_read_b128 v[116:119], v2 offset:11264
    v_smfmac_f32_16x16x64_bf16 v[64:67], v[32:35], a[48:55], v0
    ds_read_b128 v[120:123], v2 offset:14336
    v_smfmac_f32_16x16x64_bf16 v[68:71], v[32:35], a[56:63], v0
    ds_read_b128 v[124:127], v2 offset:15360
    v_smfmac_f32_16x16x64_bf16 v[56:59], v[36:39], a[64:71], v0
    v_smfmac_f32_16x16x64_bf16 v[60:63], v[36:39], a[72:79], v0
    s_waitcnt vmcnt(1)
    ds_write_b128 v1, v[40:43] offset:5120
    v_smfmac_f32_16x16x64_bf16 v[64:67], v[36:39], a[80:87], v0
    s_nop 0
    v_smfmac_f32_16x16x64_bf16 v[68:71], v[36:39], a[88:95], v0
    v_cmp_eq_u32 vcc, -1, v43
    v_smfmac_f32_16x16x64_bf16 v[72:75], v[28:31], a[208:215], v0
    v_smfmac_f32_16x16x64_bf16 v[76:79], v[28:31], a[216:223], v0
    s_nop 0
    s_waitcnt lgkmcnt(0)
    s_barrier
    ds_read_b128 v[44:47], v1 offset:7168
    v_smfmac_f32_16x16x64_bf16 v[56:59], v[40:43], v[96:103], v0
    ds_read_b128 v[48:51], v1 offset:1024
    ds_read_b128 v[52:55], v1 offset:3072
    v_smfmac_f32_16x16x64_bf16 v[60:63], v[40:43], v[104:111], v0
    ds_read_b128 v[96:99], v2 offset:16384
    v_smfmac_f32_16x16x64_bf16 v[64:67], v[40:43], v[112:119], v0
    ds_read_b128 v[100:103], v2 offset:17408
    v_smfmac_f32_16x16x64_bf16 v[68:71], v[40:43], v[120:127], v0
    s_nop 0
    s_waitcnt lgkmcnt(4)
    v_smfmac_f32_16x16x64_bf16 v[56:59], v[44:47], a[96:103], v0
    ds_read_b128 v[104:107], v2 offset:18432
    v_mov_b64 v[20:21], s[84:85]
    v_smfmac_f32_16x16x64_bf16 v[60:63], v[44:47], a[104:111], v0
    ds_read_b128 v[108:111], v2 offset:19456
    v_mov_b64 v[22:23], s[84:85]
    v_smfmac_f32_16x16x64_bf16 v[64:67], v[44:47], a[112:119], v0
    ds_read_b128 v[112:115], v2 offset:20480
    v_smfmac_f32_16x16x64_bf16 v[68:71], v[44:47], a[120:127], v0
    s_nop 0
    s_waitcnt lgkmcnt(5)
    v_smfmac_f32_16x16x64_bf16 v[56:59], v[48:51], a[128:135], v0
    ds_read_b128 v[116:119], v2 offset:21504
    v_smfmac_f32_16x16x64_bf16 v[60:63], v[48:51], a[136:143], v0
    ds_read_b128 v[120:123], v2 offset:22528
    v_smfmac_f32_16x16x64_bf16 v[56:59], v[52:55], a[160:167], v0
    ds_read_b128 v[124:127], v2 offset:23552
    v_smfmac_f32_16x16x64_bf16 v[60:63], v[52:55], a[168:175], v0
    s_nop 0
    v_smfmac_f32_16x16x64_bf16 v[64:67], v[48:51], a[144:151], v0
    v_cvt_pk_bf16_f32 v56, v56, v57
    v_smfmac_f32_16x16x64_bf16 v[68:71], v[48:51], a[152:159], v0
    v_cvt_pk_bf16_f32 v57, v58, v59
    v_smfmac_f32_16x16x64_bf16 v[64:67], v[52:55], a[176:183], v0
    v_cvt_pk_bf16_f32 v58, v60, v61
    v_smfmac_f32_16x16x64_bf16 v[68:71], v[52:55], a[184:191], v0
    s_nop 0
    s_branch L_c_m6_2
L_bk_2:
    v_cvt_pk_bf16_f32 v59, v62, v63
    s_nop 0
    v_cvt_pk_bf16_f32 v64, v64, v65
    v_mfma_f32_16x16x32_bf16 v[60:63], v[56:59], v[12:15], 0
    v_cvt_pk_bf16_f32 v65, v66, v67
    v_cvt_pk_bf16_f32 v66, v68, v69
    v_cvt_pk_bf16_f32 v67, v70, v71
    s_nop 1
    v_mfma_f32_16x16x32_bf16 v[68:71], v[64:67], v[12:15], 0
    v_cvt_pk_bf16_f32 v56, v60, v61
    v_cvt_pk_bf16_f32 v57, v62, v63
    v_cndmask_b32 v24, 0, v56, s[86:87]
    v_cndmask_b32 v25, 0, v57, s[86:87]
    v_mov_b32_dpp v28, v56 row_shr:8 row_mask:0xf bank_mask:0xf bound_ctrl:1
    v_mov_b32_dpp v29, v57 row_shr:8 row_mask:0xf bank_mask:0xf bound_ctrl:1
    s_nop 0
    v_cvt_pk_bf16_f32 v58, v68, v69
    v_cvt_pk_bf16_f32 v59, v70, v71
    v_cndmask_b32 v26, 0, v58, s[86:87]
    v_cndmask_b32 v27, 0, v59, s[86:87]
    v_mfma_f32_16x16x32_bf16 v[68:71], v[56:59], v[56:59], 0
    v_mov_b32_dpp v30, v58 row_shr:8 row_mask:0xf bank_mask:0xf bound_ctrl:1
    v_mov_b32_dpp v31, v59 row_shr:8 row_mask:0xf bank_mask:0xf bound_ctrl:1
    v_mfma_f32_16x16x32_bf16 v[64:67], v[80:83], v[24:27], 0
    s_nop 0
    v_mfma_f32_16x16x32_bf16 v[64:67], v[84:87], v[28:31], v[64:67]
    v_mov_b32_dpp v68, v70 row_ror:8 row_mask:0xf bank_mask:0xc
    v_mov_b32_dpp v69, v71 row_ror:8 row_mask:0xf bank_mask:0xc
    v_smfmac_f32_16x16x64_bf16 v[72:75], v[32:35], a[224:231], v0
    s_nop 0
    ds_write2_b32 v3, v68, v69 offset0:0 offset1:32
    v_smfmac_f32_16x16x64_bf16 v[76:79], v[32:35], a[232:239], v0
    ds_write_b128 v1, v[64:67] offset:12288
    v_smfmac_f32_16x16x64_bf16 v[72:75], v[36:39], a[240:247], v0
    s_nop 0
    v_smfmac_f32_16x16x64_bf16 v[76:79], v[36:39], a[248:255], v0
    v_smfmac_f32_16x16x64_bf16 v[72:75], v[40:43], v[128:135], v0
    v_smfmac_f32_16x16x64_bf16 v[76:79], v[40:43], v[136:143], v0
    v_smfmac_f32_16x16x64_bf16 v[72:75], v[44:47], v[144:151], v0
    v_smfmac_f32_16x16x64_bf16 v[76:79], v[44:47], v[152:159], v0
    s_waitcnt lgkmcnt(0)
    s_barrier
    ds_read_b128 v[68:71], v1 offset:9216
    ds_read_b128 v[60:63], v1 offset:14336
    v_smfmac_f32_16x16x64_bf16 v[72:75], v[48:51], v[160:167], v0
    ds_read_b128 v[80:83], v1 offset:8192
    ds_read_b128 v[84:87], v1 offset:10240
    v_smfmac_f32_16x16x64_bf16 v[76:79], v[48:51], v[168:175], v0
    v_smfmac_f32_16x16x64_bf16 v[72:75], v[52:55], v[176:183], v0
    v_smfmac_f32_16x16x64_bf16 v[76:79], v[52:55], v[184:191], v0
    s_waitcnt lgkmcnt(2)
    v_add_f32 v68, v68, v69
    v_add_f32 v70, v70, v71
    v_add_f32 v64, v64, v60
    v_add_f32 v65, v65, v61
    v_pk_add_f32 v[66:67], v[66:67], v[62:63]
    v_add_f32 v68, v68, v70
    s_waitcnt lgkmcnt(0)
    v_pk_add_f32 v[80:81], v[80:81], v[84:85]
    v_pk_add_f32 v[82:83], v[82:83], v[86:87]
    v_pk_add_f32 v[64:65], v[64:65], v[80:81]
    v_pk_add_f32 v[66:67], v[66:67], v[82:83]
    v_max3_f32 v60, v68, v64, v65
    v_max3_f32 v60, v60, v66, v67
    v_cvt_pk_bf16_f32 v72, v72, v73
    v_cvt_pk_bf16_f32 v73, v74, v75
    v_max_f32_dpp v61, v60, v60 row_ror:8 row_mask:0xf bank_mask:0xf
    v_max_f32_dpp v60, v60, v60 row_ror:8 row_mask:0xf bank_mask:0xf
    v_cvt_pk_bf16_f32 v74, v76, v77
    v_cvt_pk_bf16_f32 v75, v78, v79
    v_permlane32_swap_b32 v60, v61
    v_max_f32 v62, v60, v61
    v_max_f32 v63, v60, v61
    v_permlane32_swap_b32 v72, v73
    v_permlane32_swap_b32 v74, v75
    v_permlane16_swap_b32 v62, v63
    v_max_f32 v60, v62, v63
    v_mul_f32 v60, s48, v60
    v_fma_f32 v68, v68, s48, -v60
    v_exp_f32 v68, v68
    v_pk_fma_f32 v[64:65], v[64:65], s[48:49], v[60:61] op_sel_hi:[1,1,0] neg_lo:[0,0,1] neg_hi:[0,0,1]
    v_pk_fma_f32 v[66:67], v[66:67], s[48:49], v[60:61] op_sel_hi:[1,1,0] neg_lo:[0,0,1] neg_hi:[0,0,1]
    v_mov_b32_dpp v69, v68 row_ror:8 row_mask:0xf bank_mask:0xf
    v_cvt_pk_bf16_f32 v36, v68, v69
    v_cvt_pk_bf16_f32 v37, v68, v69
    v_exp_f32 v64, v64
    v_exp_f32 v65, v65
    v_mfma_f32_16x16x16_bf16 v[80:83], v[72:73], v[36:37], 0
    v_exp_f32 v66, v66
    v_exp_f32 v67, v67
    v_cvt_pk_bf16_f32 v60, v64, v65
    v_cvt_pk_bf16_f32 v61, v66, v67
    v_mfma_f32_16x16x16_bf16 v[76:79], v[74:75], v[36:37], 0
    v_mov_b32_dpp v62, v60 row_ror:8 row_mask:0xf bank_mask:0xf
    v_mov_b32_dpp v63, v61 row_ror:8 row_mask:0xf bank_mask:0xf
    v_mov_b64 v[64:65], 0
    v_mov_b64 v[66:67], 0
    v_mfma_f32_16x16x32_bf16 v[80:83], v[88:91], v[60:63], v[80:83]
    ds_read_b128 v[40:43], v2 offset:28672
    ds_read_b128 v[44:47], v2 offset:29696
    v_mfma_f32_16x16x32_bf16 v[76:79], v[92:95], v[60:63], v[76:79]
    ds_read_b128 v[48:51], v2 offset:30720
    ds_read_b128 v[52:55], v2 offset:31744
    v_mfma_f32_16x16x16_bf16 v[68:71], v[36:37], v[10:11], 0
    v_cvt_pk_bf16_f32 v84, v80, v81
    v_cvt_pk_bf16_f32 v85, v82, v83
    v_mov_b64 v[80:81], 0
    v_mov_b64 v[82:83], 0
    v_cvt_pk_bf16_f32 v86, v76, v77
    v_cvt_pk_bf16_f32 v87, v78, v79
    v_mfma_f32_16x16x32_bf16 v[68:71], v[60:63], v[20:23], v[68:71]
    s_nop 0
    ds_write_b128 v8, v[84:87] offset:5120
    v_mov_b32_dpp v84, v84 row_ror:8 row_mask:0xf bank_mask:0xc
    v_mov_b32_dpp v85, v85 row_ror:8 row_mask:0xf bank_mask:0xc
    v_mov_b32_dpp v86, v86 row_ror:8 row_mask:0xf bank_mask:0xc
    v_mov_b32_dpp v87, v87 row_ror:8 row_mask:0xf bank_mask:0xc
    v_mov_b64 v[76:77], 0
    v_mov_b64 v[78:79], 0
    v_mov_b64 v[20:21], 0
    v_rcp_f32 v68, v68
    v_rcp_f32 v69, v69
    v_rcp_f32 v70, v70
    v_rcp_f32 v71, v71
    v_smfmac_f32_16x16x64_bf16 v[64:67], v[84:87], v[208:215], v0
    s_waitcnt lgkmcnt(0)
    s_barrier
    ds_read_b128 v[88:91], v5 offset:7168
    ds_read_b128 v[92:95], v5 offset:1024
    v_smfmac_f32_16x16x64_bf16 v[80:83], v[84:87], v[240:247], v0
    ds_read_b128 v[60:63], v5 offset:3072
    v_mov_b64 v[22:23], 0
    v_smfmac_f32_16x16x64_bf16 v[76:79], v[84:87], v[112:119], v0
    s_waitcnt lgkmcnt(2)
    v_smfmac_f32_16x16x64_bf16 v[64:67], v[88:91], v[216:223], v0
    ds_read_b128 v[24:27], v2 offset:24576
    s_waitcnt lgkmcnt(2)
    v_smfmac_f32_16x16x64_bf16 v[64:67], v[92:95], v[192:199], v0
    ds_read_b128 v[28:31], v2 offset:25600
    s_waitcnt lgkmcnt(2)
    v_smfmac_f32_16x16x64_bf16 v[64:67], v[60:63], v[200:207], v0
    ds_read_b128 v[32:35], v2 offset:26624
    v_smfmac_f32_16x16x64_bf16 v[80:83], v[88:91], v[248:255], v0
    ds_read_b128 v[36:39], v2 offset:27648
    v_smfmac_f32_16x16x64_bf16 v[80:83], v[92:95], v[224:231], v0
    v_mul_f32 v64, v64, v68
    v_smfmac_f32_16x16x64_bf16 v[80:83], v[60:63], v[232:239], v0
    v_mul_f32 v65, v65, v69
    v_mul_f32 v66, v66, v70
    v_mul_f32 v67, v67, v71
    v_cvt_pk_bf16_f32 v64, v64, v65
    v_cvt_pk_bf16_f32 v65, v66, v67
    v_bfi_b32 v64, 1, s38, v64
    v_smfmac_f32_16x16x64_bf16 v[76:79], v[88:91], v[120:127], v0
    s_nop 0
    buffer_store_dwordx2 v[64:65], v6, s[4:7], s40 offen sc1
    v_mul_f32 v80, v80, v68
    v_mul_f32 v81, v81, v69
    v_mul_f32 v82, v82, v70
    v_mul_f32 v83, v83, v71
    v_cvt_pk_bf16_f32 v80, v80, v81
    v_cvt_pk_bf16_f32 v81, v82, v83
    v_bfi_b32 v80, 1, s38, v80
    v_smfmac_f32_16x16x64_bf16 v[76:79], v[92:95], v[96:103], v0
    s_nop 0
    buffer_store_dwordx2 v[80:81], v6, s[4:7], s41 offen sc1
    v_smfmac_f32_16x16x64_bf16 v[76:79], v[60:63], v[104:111], v0
    s_waitcnt lgkmcnt(0)
    v_smfmac_f32_16x16x64_bf16 v[20:23], v[84:87], v[40:47], v0
    s_add_u32 s39, s44, 0
    s_add_u32 s59, s44, 4096
    v_smfmac_f32_16x16x64_bf16 v[20:23], v[88:91], v[48:55], v0
    s_add_u32 s34, s34, 1
    s_mov_b32 s58, s36
    v_mul_f32 v76, v76, v68
    v_smfmac_f32_16x16x64_bf16 v[20:23], v[92:95], v[24:31], v0
    v_mul_f32 v77, v77, v69
    v_smfmac_f32_16x16x64_bf16 v[20:23], v[60:63], v[32:39], v0
    v_mul_f32 v78, v78, v70
    v_mul_f32 v79, v79, v71
    v_cvt_pk_bf16_f32 v76, v76, v77
    v_cvt_pk_bf16_f32 v77, v78, v79
    v_bfi_b32 v76, 1, s38, v76
    s_add_u32 s36, s36, 0x20000
    s_add_u32 s35, s35, 524288
    buffer_store_dwordx2 v[76:77], v6, s[4:7], s42 offen sc1
    v_pk_mul_f32 v[20:21], v[20:21], v[68:69]
    v_pk_mul_f32 v[22:23], v[22:23], v[70:71]
    v_cvt_pk_bf16_f32 v20, v20, v21
    v_cvt_pk_bf16_f32 v21, v22, v23
    v_bfi_b32 v20, 1, s38, v20
    s_nop 1
    buffer_store_dwordx2 v[20:21], v6, s[4:7], s43 offen sc1
    s_branch L_btail
L_bstep_3:
    ds_write_b128 v1, v[24:27] offset:6144
    s_nop 0
    v_smfmac_f32_16x16x64_bf16 v[56:59], v[24:27], v[96:103], v0
    v_smfmac_f32_16x16x64_bf16 v[60:63], v[24:27], v[104:111], v0
    v_smfmac_f32_16x16x64_bf16 v[64:67], v[24:27], v[112:119], v0
    s_waitcnt lgkmcnt(0)
    s_barrier
    ds_read_b128 v[28:31], v1 offset:0
    ds_read_b128 v[32:35], v1 offset:2048
    v_smfmac_f32_16x16x64_bf16 v[68:71], v[24:27], v[120:127], v0
    ds_read_b128 v[36:39], v1 offset:4096
    s_nop 0
    v_smfmac_f32_16x16x64_bf16 v[72:75], v[24:27], a[192:199], v0
    v_smfmac_f32_16x16x64_bf16 v[76:79], v[24:27], a[200:207], v0
    s_waitcnt lgkmcnt(2)
    v_smfmac_f32_16x16x64_bf16 v[56:59], v[28:31], a[0:7], v0
    ds_read_b128 v[96:99], v2 offset:8192
    v_smfmac_f32_16x16x64_bf16 v[60:63], v[28:31], a[8:15], v0
    ds_read_b128 v[100:103], v2 offset:9216
    v_smfmac_f32_16x16x64_bf16 v[64:67], v[28:31], a[16:23], v0
    ds_read_b128 v[104:107], v2 offset:12288
    v_smfmac_f32_16x16x64_bf16 v[68:71], v[28:31], a[24:31], v0
    ds_read_b128 v[108:111], v2 offset:13312
    s_waitcnt lgkmcnt(4)
    v_smfmac_f32_16x16x64_bf16 v[56:59], v[32:35], a[32:39], v0
    ds_read_b128 v[112:115], v2 offset:10240
    v_smfmac_f32_16x16x64_bf16 v[60:63], v[32:35], a[40:47], v0
    ds_read_b128 v[116:119], v2 offset:11264
    v_smfmac_f32_16x16x64_bf16 v[64:67], v[32:35], a[48:55], v0
    ds_read_b128 v[120:123], v2 offset:14336
    v_smfmac_f32_16x16x64_bf16 v[68:71], v[32:35], a[56:63], v0
    ds_read_b128 v[124:127], v2 offset:15360
    v_smfmac_f32_16x16x64_bf16 v[56:59], v[36:39], a[64:71], v0
    v_smfmac_f32_16x16x64_bf16 v[60:63], v[36:39], a[72:79], v0
    s_waitcnt vmcnt(1)
    ds_write_b128 v1, v[40:43] offset:7168
    v_smfmac_f32_16x16x64_bf16 v[64:67], v[36:39], a[80:87], v0
    s_nop 0
    v_smfmac_f32_16x16x64_bf16 v[68:71], v[36:39], a[88:95], v0
    v_cmp_eq_u32 vcc, -1, v43
    v_smfmac_f32_16x16x64_bf16 v[72:75], v[28:31], a[208:215], v0
    v_smfmac_f32_16x16x64_bf16 v[76:79], v[28:31], a[216:223], v0
    s_nop 0
    s_waitcnt lgkmcnt(0)
    s_barrier
    ds_read_b128 v[44:47], v1 offset:1024
    v_smfmac_f32_16x16x64_bf16 v[56:59], v[40:43], v[96:103], v0
    ds_read_b128 v[48:51], v1 offset:3072
    ds_read_b128 v[52:55], v1 offset:5120
    v_smfmac_f32_16x16x64_bf16 v[60:63], v[40:43], v[104:111], v0
    ds_read_b128 v[96:99], v2 offset:16384
    v_smfmac_f32_16x16x64_bf16 v[64:67], v[40:43], v[112:119], v0
    ds_read_b128 v[100:103], v2 offset:17408
    v_smfmac_f32_16x16x64_bf16 v[68:71], v[40:43], v[120:127], v0
    ds_read_b128 v[104:107], v2 offset:18432
    s_waitcnt lgkmcnt(5)
    v_smfmac_f32_16x16x64_bf16 v[56:59], v[44:47], a[96:103], v0
    s_nop 0
    ds_read_b128 v[108:111], v2 offset:19456
    v_smfmac_f32_16x16x64_bf16 v[60:63], v[44:47], a[104:111], v0
    ds_read_b128 v[112:115], v2 offset:20480
    v_mov_b64 v[20:21], s[84:85]
    v_smfmac_f32_16x16x64_bf16 v[64:67], v[44:47], a[112:119], v0
    ds_read_b128 v[116:119], v2 offset:21504
    v_mov_b64 v[22:23], s[84:85]
    v_smfmac_f32_16x16x64_bf16 v[68:71], v[44:47], a[120:127], v0
    ds_read_b128 v[120:123], v2 offset:22528
    s_waitcnt lgkmcnt(7)
    v_smfmac_f32_16x16x64_bf16 v[56:59], v[48:51], a[128:135], v0
    s_nop 0
    ds_read_b128 v[124:127], v2 offset:23552
    v_smfmac_f32_16x16x64_bf16 v[60:63], v[48:51], a[136:143], v0
    v_smfmac_f32_16x16x64_bf16 v[56:59], v[52:55], a[160:167], v0
    v_smfmac_f32_16x16x64_bf16 v[60:63], v[52:55], a[168:175], v0
    v_smfmac_f32_16x16x64_bf16 v[64:67], v[48:51], a[144:151], v0
    s_nop 0
    v_cvt_pk_bf16_f32 v56, v56, v57
    v_smfmac_f32_16x16x64_bf16 v[68:71], v[48:51], a[152:159], v0
    v_cvt_pk_bf16_f32 v57, v58, v59
    v_smfmac_f32_16x16x64_bf16 v[64:67], v[52:55], a[176:183], v0
    v_cvt_pk_bf16_f32 v58, v60, v61
    v_smfmac_f32_16x16x64_bf16 v[68:71], v[52:55], a[184:191], v0
    s_nop 0
    s_branch L_c_m6_3
L_bk_3:
    v_cvt_pk_bf16_f32 v59, v62, v63
    s_nop 0
    v_cvt_pk_bf16_f32 v64, v64, v65
    v_mfma_f32_16x16x32_bf16 v[60:63], v[56:59], v[12:15], 0
    v_cvt_pk_bf16_f32 v65, v66, v67
    v_cvt_pk_bf16_f32 v66, v68, v69
    v_cvt_pk_bf16_f32 v67, v70, v71
    s_nop 1
    v_mfma_f32_16x16x32_bf16 v[68:71], v[64:67], v[12:15], 0
    v_cvt_pk_bf16_f32 v56, v60, v61
    v_cvt_pk_bf16_f32 v57, v62, v63
    v_cndmask_b32 v24, 0, v56, s[86:87]
    v_cndmask_b32 v25, 0, v57, s[86:87]
    v_mov_b32_dpp v28, v56 row_shr:8 row_mask:0xf bank_mask:0xf bound_ctrl:1
    v_mov_b32_dpp v29, v57 row_shr:8 row_mask:0xf bank_mask:0xf bound_ctrl:1
    s_nop 0
    v_cvt_pk_bf16_f32 v58, v68, v69
    v_cvt_pk_bf16_f32 v59, v70, v71
    v_cndmask_b32 v26, 0, v58, s[86:87]
    v_cndmask_b32 v27, 0, v59, s[86:87]
    v_mfma_f32_16x16x32_bf16 v[68:71], v[56:59], v[56:59], 0
    v_mov_b32_dpp v30, v58 row_shr:8 row_mask:0xf bank_mask:0xf bound_ctrl:1
    v_mov_b32_dpp v31, v59 row_shr:8 row_mask:0xf bank_mask:0xf bound_ctrl:1
    v_mfma_f32_16x16x32_bf16 v[64:67], v[80:83], v[24:27], 0
    s_nop 0
    v_mfma_f32_16x16x32_bf16 v[64:67], v[84:87], v[28:31], v[64:67]
    v_mov_b32_dpp v68, v70 row_ror:8 row_mask:0xf bank_mask:0xc
    v_mov_b32_dpp v69, v71 row_ror:8 row_mask:0xf bank_mask:0xc
    v_smfmac_f32_16x16x64_bf16 v[72:75], v[32:35], a[224:231], v0
    s_nop 0
    ds_write2_b32 v3, v68, v69 offset0:0 offset1:32
    v_smfmac_f32_16x16x64_bf16 v[76:79], v[32:35], a[232:239], v0
    ds_write_b128 v1, v[64:67] offset:14336
    v_smfmac_f32_16x16x64_bf16 v[72:75], v[36:39], a[240:247], v0
    v_smfmac_f32_16x16x64_bf16 v[76:79], v[36:39], a[248:255], v0
    s_nop 0
    v_smfmac_f32_16x16x64_bf16 v[72:75], v[40:43], v[128:135], v0
    v_smfmac_f32_16x16x64_bf16 v[76:79], v[40:43], v[136:143], v0
    v_smfmac_f32_16x16x64_bf16 v[72:75], v[44:47], v[144:151], v0
    v_smfmac_f32_16x16x64_bf16 v[76:79], v[44:47], v[152:159], v0
    s_waitcnt lgkmcnt(0)
    s_barrier
    ds_read_b128 v[68:71], v1 offset:9216
    ds_read_b128 v[60:63], v1 offset:8192
    v_smfmac_f32_16x16x64_bf16 v[72:75], v[48:51], v[160:167], v0
    ds_read_b128 v[80:83], v1 offset:10240
    ds_read_b128 v[84:87], v1 offset:12288
    v_smfmac_f32_16x16x64_bf16 v[76:79], v[48:51], v[168:175], v0
    v_smfmac_f32_16x16x64_bf16 v[72:75], v[52:55], v[176:183], v0
    v_smfmac_f32_16x16x64_bf16 v[76:79], v[52:55], v[184:191], v0
    s_waitcnt lgkmcnt(2)
    v_add_f32 v68, v68, v69
    v_add_f32 v70, v70, v71
    v_add_f32 v64, v64, v60
    v_add_f32 v65, v65, v61
    v_pk_add_f32 v[66:67], v[66:67], v[62:63]
    v_add_f32 v68, v68, v70
    s_waitcnt lgkmcnt(0)
    v_pk_add_f32 v[80:81], v[80:81], v[84:85]
    v_pk_add_f32 v[82:83], v[82:83], v[86:87]
    v_pk_add_f32 v[64:65], v[64:65], v[80:81]
    v_pk_add_f32 v[66:67], v[66:67], v[82:83]
    v_max3_f32 v60, v68, v64, v65
    v_max3_f32 v60, v60, v66, v67
    v_cvt_pk_bf16_f32 v72, v72, v73
    v_cvt_pk_bf16_f32 v73, v74, v75
    v_max_f32_dpp v61, v60, v60 row_ror:8 row_mask:0xf bank_mask:0xf
    v_max_f32_dpp v60, v60, v60 row_ror:8 row_mask:0xf bank_mask:0xf
    v_cvt_pk_bf16_f32 v74, v76, v77
    v_cvt_pk_bf16_f32 v75, v78, v79
    v_permlane32_swap_b32 v60, v61
    v_max_f32 v62, v60, v61
    v_max_f32 v63, v60, v61
    v_permlane32_swap_b32 v72, v73
    v_permlane32_swap_b32 v74, v75
    v_permlane16_swap_b32 v62, v63
    v_max_f32 v60, v62, v63
    v_mul_f32 v60, s48, v60
    v_fma_f32 v68, v68, s48, -v60
    v_exp_f32 v68, v68
    v_pk_fma_f32 v[64:65], v[64:65], s[48:49], v[60:61] op_sel_hi:[1,1,0] neg_lo:[0,0,1] neg_hi:[0,0,1]
    v_pk_fma_f32 v[66:67], v[66:67], s[48:49], v[60:61] op_sel_hi:[1,1,0] neg_lo:[0,0,1] neg_hi:[0,0,1]
    v_mov_b32_dpp v69, v68 row_ror:8 row_mask:0xf bank_mask:0xf
    v_cvt_pk_bf16_f32 v44, v68, v69
    v_cvt_pk_bf16_f32 v45, v68, v69
    v_exp_f32 v64, v64
    v_exp_f32 v65, v65
    v_mfma_f32_16x16x16_bf16 v[80:83], v[72:73], v[44:45], 0
    v_exp_f32 v66, v66
    v_exp_f32 v67, v67
    v_cvt_pk_bf16_f32 v60, v64, v65
    v_cvt_pk_bf16_f32 v61, v66, v67
    v_mfma_f32_16x16x16_bf16 v[76:79], v[74:75], v[44:45], 0
    v_mov_b32_dpp v62, v60 row_ror:8 row_mask:0xf bank_mask:0xf
    v_mov_b32_dpp v63, v61 row_ror:8 row_mask:0xf bank_mask:0xf
    v_mov_b64 v[64:65], 0
    v_mov_b64 v[66:67], 0
    v_mfma_f32_16x16x32_bf16 v[80:83], v[88:91], v[60:63], v[80:83]
    ds_read_b128 v[48:51], v2 offset:30720
    ds_read_b128 v[52:55], v2 offset:31744
    v_mfma_f32_16x16x32_bf16 v[76:79], v[92:95], v[60:63], v[76:79]
    ds_read_b128 v[24:27], v2 offset:24576
    ds_read_b128 v[28:31], v2 offset:25600
    v_mfma_f32_16x16x16_bf16 v[68:71], v[44:45], v[10:11], 0
    v_cvt_pk_bf16_f32 v84, v80, v81
    v_cvt_pk_bf16_f32 v85, v82, v83
    v_mov_b64 v[80:81], 0
    v_mov_b64 v[82:83], 0
    v_cvt_pk_bf16_f32 v86, v76, v77
    v_cvt_pk_bf16_f32 v87, v78, v79
    v_mfma_f32_16x16x32_bf16 v[68:71], v[60:63], v[20:23], v[68:71]
    s_nop 0
    ds_write_b128 v8, v[84:87] offset:7168
    v_mov_b32_dpp v84, v84 row_ror:8 row_mask:0xf bank_mask:0xc
    v_mov_b32_dpp v85, v85 row_ror:8 row_mask:0xf bank_mask:0xc
    v_mov_b32_dpp v86, v86 row_ror:8 row_mask:0xf bank_mask:0xc
    v_mov_b32_dpp v87, v87 row_ror:8 row_mask:0xf bank_mask:0xc
    v_mov_b64 v[76:77], 0
    v_mov_b64 v[78:79], 0
    v_mov_b64 v[20:21], 0
    v_rcp_f32 v68, v68
    v_rcp_f32 v69, v69
    v_rcp_f32 v70, v70
    v_rcp_f32 v71, v71
    v_smfmac_f32_16x16x64_bf16 v[64:67], v[84:87], v[216:223], v0
    s_waitcnt lgkmcnt(0)
    s_barrier
    ds_read_b128 v[88:91], v5 offset:1024
    ds_read_b128 v[92:95], v5 offset:3072
    v_smfmac_f32_16x16x64_bf16 v[80:83], v[84:87], v[248:255], v0
    ds_read_b128 v[60:63], v5 offset:5120
    v_mov_b64 v[22:23], 0
    v_smfmac_f32_16x16x64_bf16 v[76:79], v[84:87], v[120:127], v0
    s_waitcnt lgkmcnt(2)
    v_smfmac_f32_16x16x64_bf16 v[64:67], v[88:91], v[192:199], v0
    ds_read_b128 v[32:35], v2 offset:26624
    s_waitcnt lgkmcnt(2)
    v_smfmac_f32_16x16x64_bf16 v[64:67], v[92:95], v[200:207], v0
    ds_read_b128 v[36:39], v2 offset:27648
    s_waitcnt lgkmcnt(2)
    v_smfmac_f32_16x16x64_bf16 v[64:67], v[60:63], v[208:215], v0
    ds_read_b128 v[40:43], v2 offset:28672
    v_smfmac_f32_16x16x64_bf16 v[80:83], v[88:91], v[224:231], v0
    ds_read_b128 v[44:47], v2 offset:29696
    v_smfmac_f32_16x16x64_bf16 v[80:83], v[92:95], v[232:239], v0
    v_mul_f32 v64, v64, v68
    v_smfmac_f32_16x16x64_bf16 v[80:83], v[60:63], v[240:247], v0
    v_mul_f32 v65, v65, v69
    v_mul_f32 v66, v66, v70
    v_mul_f32 v67, v67, v71
    v_cvt_pk_bf16_f32 v64, v64, v65
    v_cvt_pk_bf16_f32 v65, v66, v67
    v_bfi_b32 v64, 1, s38, v64
    v_smfmac_f32_16x16x64_bf16 v[76:79], v[88:91], v[96:103], v0
    s_nop 0
    buffer_store_dwordx2 v[64:65], v6, s[4:7], s40 offen sc1
    v_mul_f32 v80, v80, v68
    v_mul_f32 v81, v81, v69
    v_mul_f32 v82, v82, v70
    v_mul_f32 v83, v83, v71
    v_cvt_pk_bf16_f32 v80, v80, v81
    v_cvt_pk_bf16_f32 v81, v82, v83
    v_bfi_b32 v80, 1, s38, v80
    v_smfmac_f32_16x16x64_bf16 v[76:79], v[92:95], v[104:111], v0
    s_nop 0
    buffer_store_dwordx2 v[80:81], v6, s[4:7], s41 offen sc1
    v_smfmac_f32_16x16x64_bf16 v[76:79], v[60:63], v[112:119], v0
    s_waitcnt lgkmcnt(0)
    v_smfmac_f32_16x16x64_bf16 v[20:23], v[84:87], v[48:55], v0
    s_add_u32 s39, s44, 1024
    s_add_u32 s59, s44, 5120
    v_smfmac_f32_16x16x64_bf16 v[20:23], v[88:91], v[24:31], v0
    s_add_u32 s34, s34, 1
    s_mov_b32 s58, s36
    v_mul_f32 v76, v76, v68
    v_smfmac_f32_16x16x64_bf16 v[20:23], v[92:95], v[32:39], v0
    v_mul_f32 v77, v77, v69
    v_smfmac_f32_16x16x64_bf16 v[20:23], v[60:63], v[40:47], v0
    v_mul_f32 v78, v78, v70
    v_mul_f32 v79, v79, v71
    v_cvt_pk_bf16_f32 v76, v76, v77
    v_cvt_pk_bf16_f32 v77, v78, v79
    v_bfi_b32 v76, 1, s38, v76
    s_add_u32 s36, s36, 0x20000
    s_add_u32 s35, s35, 524288
    buffer_store_dwordx2 v[76:77], v6, s[4:7], s42 offen sc1
    v_pk_mul_f32 v[20:21], v[20:21], v[68:69]
    v_pk_mul_f32 v[22:23], v[22:23], v[70:71]
    v_cvt_pk_bf16_f32 v20, v20, v21
    v_cvt_pk_bf16_f32 v21, v22, v23
    v_bfi_b32 v20, 1, s38, v20
    s_nop 1
    buffer_store_dwordx2 v[20:21], v6, s[4:7], s43 offen sc1
    s_branch L_btail
L_btail:
    v_mov_b32_dpp v58, v56 row_ror:8 row_mask:0xf bank_mask:0x3
    v_mov_b32_dpp v59, v57 row_ror:8 row_mask:0xf bank_mask:0x3
    v_min_u32 v20, -2, v58
    v_min_u32 v21, -2, v59
    v_lshlrev_b32 v56, 16, v72
    v_lshlrev_b32 v57, 16, v73
    v_and_b32 v72, 0xffff0000, v72
    v_and_b32 v73, 0xffff0000, v73
    v_add_f32 v56, v56, v57
    v_add_f32 v57, v72, v73
    v_cvt_pk_bf16_f32 v56, v56, v57
    v_min_u32 v22, -2, v56
    v_lshlrev_b32 v56, 16, v74
    v_lshlrev_b32 v57, 16, v75
    v_and_b32 v74, 0xffff0000, v74
    v_and_b32 v75, 0xffff0000, v75
    v_add_f32 v56, v56, v57
    v_add_f32 v57, v74, v75
    v_cvt_pk_bf16_f32 v56, v56, v57
    v_min_u32 v23, -2, v56
    buffer_store_dwordx4 v[20:23], v1, s[4:7], s58 offen sc1
    s_waitcnt vmcnt(0)
L_bt1:
    s_sleep 1
    buffer_load_dwordx4 v[44:47], v1, s[4:7], s37 offen sc1
    buffer_load_dwordx4 v[48:51], v1, s[4:7], s37 offen offset:1024 sc1
    s_add_u32 s47, s47, 1
    s_cmp_gt_u32 s47, 1000000
    s_cbranch_scc1 L_end
    s_waitcnt vmcnt(0)
    v_mfma_f32_16x16x32_bf16 v[32:35], v[16:19], v[44:47], 0
    v_or_b32 v36, v44, v46
    v_or3_b32 v36, v36, v48, v50
    v_mfma_f32_16x16x32_bf16 v[32:35], v[16:19], v[48:51], v[32:35]
    v_and_b32 v36, 1, v36
    v_cmp_ne_u32 vcc, 0, v36
    s_nop 4
    v_add_f32_dpp v32, v32, v32 row_ror:4 row_mask:0xf bank_mask:0xf
    v_add_f32_dpp v33, v33, v33 row_ror:4 row_mask:0xf bank_mask:0xf
    s_nop 0
    v_add_f32_dpp v32, v32, v32 row_ror:8 row_mask:0xf bank_mask:0xf
    v_add_f32_dpp v33, v33, v33 row_ror:8 row_mask:0xf bank_mask:0xf
    s_nop 0
    v_cvt_pk_bf16_f32 v32, v32, v33
    s_cbranch_vccnz L_bt1
    buffer_store_dword v32, v7, s[4:7], s44 offen sc1
    v_lshrrev_b32 v0, 4, v1
    s_mov_b32 s80, 4
    s_mov_b32 s50, 1
    s_waitcnt vmcnt(0) lgkmcnt(0)
    s_branch L_helper2
L_bent:
    s_load_dwordx2 s[16:17], s[0:1], 104
    s_mov_b32 s18, 4194304
    s_mov_b32 s19, 0x20000
    s_load_dwordx2 s[12:13], s[0:1], 96
    s_mov_b32 s14, 4194304
    s_mov_b32 s15, 0x20000
    s_load_dwordx2 s[8:9], s[0:1], 88
    s_mov_b32 s10, 4194304
    s_mov_b32 s11, 0x20000
    s_load_dwordx2 s[28:29], s[0:1], 80
    s_mov_b32 s30, 8192
    s_mov_b32 s31, 0x20000
    s_mov_b32 s2, 1
    s_waitcnt lgkmcnt(0)
    s_barrier
    s_branch L_chain2
.p2align 6
L_helper:
    s_mov_b32 s80, 0
L_helper2:
    s_load_dwordx2 s[8:9], s[0:1], 0
    s_load_dwordx2 s[76:77], s[0:1], 96
    s_load_dwordx2 s[78:79], s[0:1], 104
    s_load_dwordx2 s[20:21], s[0:1], 112
    s_load_dwordx2 s[52:53], s[0:1], 88
    s_mov_b32 s10, 2097152
    s_mov_b32 s11, 0x20000
    s_mov_b32 s22, 4194304
    s_mov_b32 s23, 0x20000
    s_mov_b32 s30, 4194304
    s_mov_b32 s31, 0x20000
    s_mov_b32 s14, 4194304
    s_mov_b32 s15, 0x20000
    s_mov_b32 s18, 4194304
    s_mov_b32 s19, 0x20000
    s_mov_b32 s54, 4194304
    s_mov_b32 s55, 0x20000
    s_sub_u32 s50, s50, 2
    s_min_u32 s50, s50, 6
    s_mul_i32 s56, s50, 43
    s_lshr_b32 s56, s56, 7
    s_mul_i32 s57, s56, -188
    s_lshl_b32 s56, s50, 6
    s_add_u32 s57, s57, s56
    s_add_u32 s57, s57, 112
    s_waitcnt lgkmcnt(0)
    s_cmp_lg_u32 s80, 0
    s_cbranch_scc1 L_tk_h
    s_cmp_lg_u32 s33, 0
    s_cbranch_scc1 L_tk_h
    s_mov_b64 exec, 1
    v_mov_b32 v126, 1
    buffer_atomic_add v126, off, s[24:27], s57 sc0
    s_mov_b64 exec, -1
L_tk_h:
    s_mov_b64 s[12:13], s[76:77]
    s_mov_b64 s[16:17], s[78:79]
    s_mul_i32 s56, s50, 349536
    s_lshr_b32 s56, s56, 16
    s_cmp_eq_u32 s50, 6
    s_cselect_b32 s3, 0x200, s3
    s_lshl_b32 s45, s56, 8
    s_lshl_b32 s46, s3, 17
    s_add_u32 s45, s45, s46
    v_lshrrev_b32 v1, 4, v0
    v_and_b32 v2, 15, v0
    v_cmp_gt_u32 vcc, 12, v2
    v_lshlrev_b32 v2, 7, v2
    v_lshl_add_u32 v1, v1, 13, v2
    v_add_u32 v1, s45, v1
    v_bfrev_b32 v2, 1
    v_cndmask_b32 v253, v2, v1, vcc
    s_lshl_b32 s45, s3, 14
    v_lshlrev_b32 v1, 7, v0
    v_cmp_gt_u32 vcc, 128, v0
    buffer_load_dword v255, v253, s[16:19], 0 offen
    v_add_u32 v3, s45, v1
    buffer_load_dword v255, v253, s[12:15], 0 offen
    v_cndmask_b32 v3, v2, v3, vcc
    buffer_load_dword v255, v3, s[8:11], 0 offen
    s_load_dwordx2 s[28:29], s[0:1], 136
    s_load_dwordx2 s[58:59], s[0:1], 8
    s_load_dwordx2 s[62:63], s[0:1], 16
    s_load_dwordx2 s[64:65], s[0:1], 56
    s_load_dwordx2 s[66:67], s[0:1], 64
    s_load_dwordx2 s[68:69], s[0:1], 128
    s_waitcnt lgkmcnt(0)
    s_load_dwordx2 s[70:71], s[0:1], 40
    s_load_dwordx2 s[72:73], s[0:1], 48
    s_cmp_ge_u32 s33, 2
    s_cbranch_scc1 L_h_hi
    s_mov_b64 s[16:17], s[52:53]
    s_mov_b32 s38, 32768
    s_mov_b32 s39, 262144
    s_branch L_h_sel
L_h_hi:
    s_mov_b64 s[12:13], s[78:79]
    s_mov_b32 s18, 524288
    s_mov_b32 s38, 0x10000000
    s_mov_b32 s39, 64
    s_cmp_eq_u32 s33, 3
    s_cbranch_scc1 L_h_w3
    s_load_dwordx2 s[16:17], s[0:1], 24
    s_branch L_h_sel
L_h_w3:
    s_load_dwordx2 s[16:17], s[0:1], 32
L_h_sel:
    s_waitcnt lgkmcnt(0)
    s_getpc_b64 s[60:61]
L_pc_h:
    s_bfe_u32 s56, s2, 0x50003
    s_lshl_b32 s56, s56, 7
    v_lshlrev_b32 v1, 12, v0
    v_add_u32 v1, s56, v1
    v_min_u32 v2, L_end-L_chain2-4, v1
    s_sub_u32 s60, s60, L_pc_h-L_chain2
    s_subb_u32 s61, s61, 0
    global_load_dword v255, v2, s[60:61]
    v_and_b32 v0, 63, v0
    v_lshlrev_b32 v1, 4, v0
    v_and_b32 v16, 31, v0
    v_lshrrev_b32 v17, 5, v0
    v_lshrrev_b32 v32, 2, v0
    v_lshrrev_b32 v33, 4, v0
    v_and_b32 v34, 3, v0
    v_xor_b32 v35, v34, v33
    v_lshlrev_b32 v35, 4, v35
    v_lshl_add_u32 v2, v32, 10, v35
    v_and_b32 v35, 15, v0
    v_lshlrev_b32 v36, 2, v33
    v_xor_b32 v35, v35, v36
    v_lshlrev_b32 v35, 4, v35
    v_lshl_add_u32 v3, v33, 13, v35
    s_cmp_ge_u32 s33, 2
    s_cselect_b64 vcc, -1, 0
    v_cndmask_b32 v4, v3, v2, vcc
    v_bfe_u32 v37, v0, 2, 1
    v_bfe_u32 v38, v0, 3, 1
    v_bfe_u32 v39, v0, 4, 1
    v_lshl_add_u32 v40, v39, 2, v34
    v_lshl_add_u32 v40, v37, 3, v40
    v_lshl_add_u32 v41, v17, 5, v40
    v_lshlrev_b32 v41, 4, v41
    v_lshl_add_u32 v14, v38, 10, v41
    v_lshl_add_u32 v41, v17, 4, v40
    v_lshlrev_b32 v41, 4, v41
    v_lshl_add_u32 v41, v38, 2, v41
    s_lshl_b32 s45, s33, 12
    s_add_u32 s45, s45, 137216
    v_add3_u32 v19, v41, s45, 8
    v_and_b32 v41, 7, v0
    v_lshl_add_u32 v41, v17, 5, v41
    v_lshl_add_u32 v18, v41, 4, s45
    s_waitcnt lgkmcnt(0)
    s_mov_b32 s34, s80
    s_mov_b32 s2, 0
L_h_again:
    v_bfe_u32 v32, v0, 2, 1
    v_bfe_u32 v33, v0, 3, 2
    v_and_b32 v34, 3, v0
    v_lshl_add_u32 v35, v33, 2, v34
    v_lshl_add_u32 v35, v32, 4, v35
    s_lshl_b32 s45, s33, 12
    v_bfe_u32 v29, v35, 2, 2
    v_xor_b32 v29, v29, v17
    v_lshlrev_b32 v29, 4, v29
    v_lshl_add_u32 v29, v35, 6, v29
    v_add_u32 v5, s45, v29
    v_xor_b32 v6, 32, v5
    v_bfe_u32 v36, v0, 2, 2
    v_bfe_u32 v37, v0, 4, 1
    v_and_b32 v38, 1, v0
    v_bfe_u32 v39, v0, 1, 1
    v_lshl_add_u32 v40, v37, 1, v39
    v_lshl_add_u32 v40, v38, 2, v40
    v_lshlrev_b32 v40, 3, v40
    v_lshl_add_u32 v41, v17, 3, v36
    v_lshl_add_u32 v40, v41, 8, v40
    v_lshl_add_u32 v40, v36, 6, v40
    v_add_u32 v7, 16384, v40
    v_xor_b32 v8, 64, v7
    v_xor_b32 v9, 128, v7
    v_xor_b32 v10, 192, v7
    v_xor_b32 v20, 0, v1
    v_xor_b32 v21, 64, v1
    v_xor_b32 v22, 128, v1
    v_xor_b32 v23, 192, v1
    v_mov_b32 v44, -1
    v_mov_b32 v45, -1
    v_mov_b32 v46, -1
    v_mov_b32 v47, -1
    v_accvgpr_write_b32 a0, 0
    v_accvgpr_write_b32 a1, 0
    v_accvgpr_write_b32 a2, 0
    v_accvgpr_write_b32 a3, 0
    v_accvgpr_write_b32 a4, 0
    v_accvgpr_write_b32 a5, 0
    v_accvgpr_write_b32 a6, 0
    v_accvgpr_write_b32 a7, 0
    v_accvgpr_write_b32 a8, 0
    v_accvgpr_write_b32 a9, 0
    v_accvgpr_write_b32 a10, 0
    v_accvgpr_write_b32 a11, 0
    v_accvgpr_write_b32 a12, 0
    v_accvgpr_write_b32 a13, 0
    v_accvgpr_write_b32 a14, 0
    v_accvgpr_write_b32 a15, 0
    v_accvgpr_write_b32 a16, 0
    v_accvgpr_write_b32 a17, 0
    v_accvgpr_write_b32 a18, 0
    v_accvgpr_write_b32 a19, 0
    v_accvgpr_write_b32 a20, 0
    v_accvgpr_write_b32 a21, 0
    v_accvgpr_write_b32 a22, 0
    v_accvgpr_write_b32 a23, 0
    v_accvgpr_write_b32 a24, 0
    v_accvgpr_write_b32 a25, 0
    v_accvgpr_write_b32 a26, 0
    v_accvgpr_write_b32 a27, 0
    v_accvgpr_write_b32 a28, 0
    v_accvgpr_write_b32 a29, 0
    v_accvgpr_write_b32 a30, 0
    v_accvgpr_write_b32 a31, 0
    v_accvgpr_write_b32 a32, 0
    v_accvgpr_write_b32 a33, 0
    v_accvgpr_write_b32 a34, 0
    v_accvgpr_write_b32 a35, 0
    v_accvgpr_write_b32 a36, 0
    v_accvgpr_write_b32 a37, 0
    v_accvgpr_write_b32 a38, 0
    v_accvgpr_write_b32 a39, 0
    v_accvgpr_write_b32 a40, 0
    v_accvgpr_write_b32 a41, 0
    v_accvgpr_write_b32 a42, 0
    v_accvgpr_write_b32 a43, 0
    v_accvgpr_write_b32 a44, 0
    v_accvgpr_write_b32 a45, 0
    v_accvgpr_write_b32 a46, 0
    v_accvgpr_write_b32 a47, 0
    v_accvgpr_write_b32 a48, 0
    v_accvgpr_write_b32 a49, 0
    v_accvgpr_write_b32 a50, 0
    v_accvgpr_write_b32 a51, 0
    v_accvgpr_write_b32 a52, 0
    v_accvgpr_write_b32 a53, 0
    v_accvgpr_write_b32 a54, 0
    v_accvgpr_write_b32 a55, 0
    v_accvgpr_write_b32 a56, 0
    v_accvgpr_write_b32 a57, 0
    v_accvgpr_write_b32 a58, 0
    v_accvgpr_write_b32 a59, 0
    v_accvgpr_write_b32 a60, 0
    v_accvgpr_write_b32 a61, 0
    v_accvgpr_write_b32 a62, 0
    v_accvgpr_write_b32 a63, 0
    v_accvgpr_write_b32 a64, 0
    v_accvgpr_write_b32 a65, 0
    v_accvgpr_write_b32 a66, 0
    v_accvgpr_write_b32 a67, 0
    v_accvgpr_write_b32 a68, 0
    v_accvgpr_write_b32 a69, 0
    v_accvgpr_write_b32 a70, 0
    v_accvgpr_write_b32 a71, 0
    v_accvgpr_write_b32 a72, 0
    v_accvgpr_write_b32 a73, 0
    v_accvgpr_write_b32 a74, 0
    v_accvgpr_write_b32 a75, 0
    v_accvgpr_write_b32 a76, 0
    v_accvgpr_write_b32 a77, 0
    v_accvgpr_write_b32 a78, 0
    v_accvgpr_write_b32 a79, 0
    v_accvgpr_write_b32 a80, 0
    v_accvgpr_write_b32 a81, 0
    v_accvgpr_write_b32 a82, 0
    v_accvgpr_write_b32 a83, 0
    v_accvgpr_write_b32 a84, 0
    v_accvgpr_write_b32 a85, 0
    v_accvgpr_write_b32 a86, 0
    v_accvgpr_write_b32 a87, 0
    v_accvgpr_write_b32 a88, 0
    v_accvgpr_write_b32 a89, 0
    v_accvgpr_write_b32 a90, 0
    v_accvgpr_write_b32 a91, 0
    v_accvgpr_write_b32 a92, 0
    v_accvgpr_write_b32 a93, 0
    v_accvgpr_write_b32 a94, 0
    v_accvgpr_write_b32 a95, 0
    v_accvgpr_write_b32 a96, 0
    v_accvgpr_write_b32 a97, 0
    v_accvgpr_write_b32 a98, 0
    v_accvgpr_write_b32 a99, 0
    v_accvgpr_write_b32 a100, 0
    v_accvgpr_write_b32 a101, 0
    v_accvgpr_write_b32 a102, 0
    v_accvgpr_write_b32 a103, 0
    v_accvgpr_write_b32 a104, 0
    v_accvgpr_write_b32 a105, 0
    v_accvgpr_write_b32 a106, 0
    v_accvgpr_write_b32 a107, 0
    v_accvgpr_write_b32 a108, 0
    v_accvgpr_write_b32 a109, 0
    v_accvgpr_write_b32 a110, 0
    v_accvgpr_write_b32 a111, 0
    v_accvgpr_write_b32 a112, 0
    v_accvgpr_write_b32 a113, 0
    v_accvgpr_write_b32 a114, 0
    v_accvgpr_write_b32 a115, 0
    v_accvgpr_write_b32 a116, 0
    v_accvgpr_write_b32 a117, 0
    v_accvgpr_write_b32 a118, 0
    v_accvgpr_write_b32 a119, 0
    v_accvgpr_write_b32 a120, 0
    v_accvgpr_write_b32 a121, 0
    v_accvgpr_write_b32 a122, 0
    v_accvgpr_write_b32 a123, 0
    v_accvgpr_write_b32 a124, 0
    v_accvgpr_write_b32 a125, 0
    v_accvgpr_write_b32 a126, 0
    v_accvgpr_write_b32 a127, 0
    v_accvgpr_write_b32 a128, 0
    v_accvgpr_write_b32 a129, 0
    v_accvgpr_write_b32 a130, 0
    v_accvgpr_write_b32 a131, 0
    v_accvgpr_write_b32 a132, 0
    v_accvgpr_write_b32 a133, 0
    v_accvgpr_write_b32 a134, 0
    v_accvgpr_write_b32 a135, 0
    v_accvgpr_write_b32 a136, 0
    v_accvgpr_write_b32 a137, 0
    v_accvgpr_write_b32 a138, 0
    v_accvgpr_write_b32 a139, 0
    v_accvgpr_write_b32 a140, 0
    v_accvgpr_write_b32 a141, 0
    v_accvgpr_write_b32 a142, 0
    v_accvgpr_write_b32 a143, 0
    v_accvgpr_write_b32 a144, 0
    v_accvgpr_write_b32 a145, 0
    v_accvgpr_write_b32 a146, 0
    v_accvgpr_write_b32 a147, 0
    v_accvgpr_write_b32 a148, 0
    v_accvgpr_write_b32 a149, 0
    v_accvgpr_write_b32 a150, 0
    v_accvgpr_write_b32 a151, 0
    v_accvgpr_write_b32 a152, 0
    v_accvgpr_write_b32 a153, 0
    v_accvgpr_write_b32 a154, 0
    v_accvgpr_write_b32 a155, 0
    v_accvgpr_write_b32 a156, 0
    v_accvgpr_write_b32 a157, 0
    v_accvgpr_write_b32 a158, 0
    v_accvgpr_write_b32 a159, 0
    v_accvgpr_write_b32 a160, 0
    v_accvgpr_write_b32 a161, 0
    v_accvgpr_write_b32 a162, 0
    v_accvgpr_write_b32 a163, 0
    v_accvgpr_write_b32 a164, 0
    v_accvgpr_write_b32 a165, 0
    v_accvgpr_write_b32 a166, 0
    v_accvgpr_write_b32 a167, 0
    v_accvgpr_write_b32 a168, 0
    v_accvgpr_write_b32 a169, 0
    v_accvgpr_write_b32 a170, 0
    v_accvgpr_write_b32 a171, 0
    v_accvgpr_write_b32 a172, 0
    v_accvgpr_write_b32 a173, 0
    v_accvgpr_write_b32 a174, 0
    v_accvgpr_write_b32 a175, 0
    v_accvgpr_write_b32 a176, 0
    v_accvgpr_write_b32 a177, 0
    v_accvgpr_write_b32 a178, 0
    v_accvgpr_write_b32 a179, 0
    v_accvgpr_write_b32 a180, 0
    v_accvgpr_write_b32 a181, 0
    v_accvgpr_write_b32 a182, 0
    v_accvgpr_write_b32 a183, 0
    v_accvgpr_write_b32 a184, 0
    v_accvgpr_write_b32 a185, 0
    v_accvgpr_write_b32 a186, 0
    v_accvgpr_write_b32 a187, 0
    v_accvgpr_write_b32 a188, 0
    v_accvgpr_write_b32 a189, 0
    v_accvgpr_write_b32 a190, 0
    v_accvgpr_write_b32 a191, 0
    v_accvgpr_write_b32 a192, 0
    v_accvgpr_write_b32 a193, 0
    v_accvgpr_write_b32 a194, 0
    v_accvgpr_write_b32 a195, 0
    v_accvgpr_write_b32 a196, 0
    v_accvgpr_write_b32 a197, 0
    v_accvgpr_write_b32 a198, 0
    v_accvgpr_write_b32 a199, 0
    v_accvgpr_write_b32 a200, 0
    v_accvgpr_write_b32 a201, 0
    v_accvgpr_write_b32 a202, 0
    v_accvgpr_write_b32 a203, 0
    v_accvgpr_write_b32 a204, 0
    v_accvgpr_write_b32 a205, 0
    v_accvgpr_write_b32 a206, 0
    v_accvgpr_write_b32 a207, 0
    v_accvgpr_write_b32 a208, 0
    v_accvgpr_write_b32 a209, 0
    v_accvgpr_write_b32 a210, 0
    v_accvgpr_write_b32 a211, 0
    v_accvgpr_write_b32 a212, 0
    v_accvgpr_write_b32 a213, 0
    v_accvgpr_write_b32 a214, 0
    v_accvgpr_write_b32 a215, 0
    v_accvgpr_write_b32 a216, 0
    v_accvgpr_write_b32 a217, 0
    v_accvgpr_write_b32 a218, 0
    v_accvgpr_write_b32 a219, 0
    v_accvgpr_write_b32 a220, 0
    v_accvgpr_write_b32 a221, 0
    v_accvgpr_write_b32 a222, 0
    v_accvgpr_write_b32 a223, 0
    v_accvgpr_write_b32 a224, 0
    v_accvgpr_write_b32 a225, 0
    v_accvgpr_write_b32 a226, 0
    v_accvgpr_write_b32 a227, 0
    v_accvgpr_write_b32 a228, 0
    v_accvgpr_write_b32 a229, 0
    v_accvgpr_write_b32 a230, 0
    v_accvgpr_write_b32 a231, 0
    v_accvgpr_write_b32 a232, 0
    v_accvgpr_write_b32 a233, 0
    v_accvgpr_write_b32 a234, 0
    v_accvgpr_write_b32 a235, 0
    v_accvgpr_write_b32 a236, 0
    v_accvgpr_write_b32 a237, 0
    v_accvgpr_write_b32 a238, 0
    v_accvgpr_write_b32 a239, 0
    v_accvgpr_write_b32 a240, 0
    v_accvgpr_write_b32 a241, 0
    v_accvgpr_write_b32 a242, 0
    v_accvgpr_write_b32 a243, 0
    v_accvgpr_write_b32 a244, 0
    v_accvgpr_write_b32 a245, 0
    v_accvgpr_write_b32 a246, 0
    v_accvgpr_write_b32 a247, 0
    v_accvgpr_write_b32 a248, 0
    v_accvgpr_write_b32 a249, 0
    v_accvgpr_write_b32 a250, 0
    v_accvgpr_write_b32 a251, 0
    v_accvgpr_write_b32 a252, 0
    v_accvgpr_write_b32 a253, 0
    v_accvgpr_write_b32 a254, 0
    v_accvgpr_write_b32 a255, 0
    s_cmp_lg_u32 s34, 0
    s_cbranch_scc0 L_h_first
    s_barrier
    s_branch L_h_task
L_h_first:
    v_mov_b32 v125, 163824
    s_cmp_lg_u32 s33, 0
    s_cbranch_scc1 L_tg_h
    s_waitcnt vmcnt(4)
    s_mov_b64 exec, 1
    ds_write_b32 v125, v126
    s_mov_b64 exec, -1
    s_waitcnt lgkmcnt(0)
L_tg_h:
    s_barrier
    ds_read_b32 v126, v125
    s_waitcnt lgkmcnt(0)
    v_readfirstlane_b32 s51, v126
    s_cmp_ge_u32 s51, 32
    s_cbranch_scc1 L_end
    s_lshl_b32 s57, s50, 5
    s_add_u32 s57, s57, s51
    s_mul_i32 s32, s57, 10923
    s_lshr_b32 s32, s32, 16
    s_mul_i32 s56, s32, 6
    s_sub_u32 s34, s57, s56
    s_cmp_eq_u32 s50, 6
    s_cselect_b32 s32, s51, s32
    s_cselect_b32 s34, 8, s34
    s_cmp_eq_u32 s34, 0
    s_cselect_b32 s2, 1, 0
    s_cmp_eq_u32 s34, 5
    s_cselect_b32 s2, 2, s2
    s_cmp_eq_u32 s34, 4
    s_cbranch_scc1 L_bent
L_h_task:
    s_lshl_b32 s42, s34, 3
    s_cmp_eq_u32 s2, 2
    s_cselect_b32 s42, 4, s42
    s_add_u32 s42, s42, s33
    s_lshl_b32 s57, s42, 15
    s_lshl_b32 s36, s32, 8
    s_and_b32 s45, s33, 1
    s_lshl_b32 s45, s45, 17
    s_add_u32 s36, s36, s45
    s_lshl_b32 s45, s32, 14
    s_cmp_ge_u32 s33, 2
    s_cselect_b32 s37, s45, s36
    s_lshl_b32 s40, s33, 12
    s_lshl_b32 s49, s32, 17
    s_add_u32 s49, s49, s40
    s_mov_b32 s43, 0
    s_cmp_lg_u32 s34, 8
    s_cbranch_scc1 L_h_nse
    v_lshlrev_b32 v31, 7, v0
    s_lshl_b32 s45, s32, 14
    buffer_load_dword v255, v31, s[16:19], s45 offen
    s_add_u32 s46, s45, 8192
    buffer_load_dword v255, v31, s[16:19], s46 offen
    s_and_b32 s46, s33, 1
    s_lshl_b32 s46, s46, 13
    s_add_u32 s45, s45, s46
    v_add_u32 v31, s45, v31
    global_load_dword v255, v31, s[70:71]
    global_load_dword v255, v31, s[72:73]
    s_lshl_b32 s45, s33, 17
    s_lshl_b32 s46, s32, 12
    s_add_u32 s45, s45, s46
    s_add_u32 s45, s45, 35717120
    s_add_u32 s46, s45, 524288
    buffer_store_dwordx4 v[44:47], v1, s[4:7], s45 offen offset:0 sc1
    buffer_store_dwordx4 v[44:47], v1, s[4:7], s45 offen offset:1024 sc1
    buffer_store_dwordx4 v[44:47], v1, s[4:7], s45 offen offset:2048 sc1
    buffer_store_dwordx4 v[44:47], v1, s[4:7], s45 offen offset:3072 sc1
    buffer_store_dwordx4 v[44:47], v1, s[4:7], s46 offen offset:0 sc1
    buffer_store_dwordx4 v[44:47], v1, s[4:7], s46 offen offset:1024 sc1
    buffer_store_dwordx4 v[44:47], v1, s[4:7], s46 offen offset:2048 sc1
    buffer_store_dwordx4 v[44:47], v1, s[4:7], s46 offen offset:3072 sc1
    s_waitcnt vmcnt(0)
    s_barrier
    s_cmp_lg_u32 s33, 0
    s_cbranch_scc1 L_h_nse
    s_lshl_b32 s45, s34, 2
    v_mov_b32 v29, 1
    s_mov_b64 exec, 1
    buffer_atomic_add v29, off, s[24:27], 0 offset:132 sc0
    v_mov_b32 v30, 32
    s_waitcnt vmcnt(0)
    v_cmp_eq_u32 vcc, -1, v29
    s_cbranch_vccz L_h_nge
    buffer_store_dword v30, off, s[24:27], 0 offset:260 sc1
L_h_nge:
    s_mov_b64 exec, -1
L_h_nse:
    s_lshl_b32 s45, s33, 6
    v_add_u32 v29, s45, v0
    v_lshlrev_b32 v30, 7, v29
    s_sub_u32 s47, s34, 2
    s_cmp_ge_u32 s47, 2
    s_cbranch_scc1 L_h_nq
    s_waitcnt vmcnt(0)
    v_lshrrev_b32 v31, 1, v29
    v_and_b32 v29, 128, v30
    v_lshl_add_u32 v29, v31, 13, v29
    s_lshl_b32 s45, s47, 20
    s_lshl_b32 s46, s32, 8
    s_add_u32 s45, s45, s46
    buffer_load_dword v255, v29, s[52:55], s45 offen
    s_add_u32 s45, s45, 2097152
    buffer_load_dword v255, v29, s[52:55], s45 offen
    s_waitcnt vmcnt(0)
    s_lshl_b32 s45, s47, 15
    s_lshl_b32 s46, s32, 17
    s_add_u32 s45, s45, s46
    buffer_load_dword v255, v30, s[20:23], s45 offen
    s_add_u32 s45, s45, 65536
    buffer_load_dword v255, v30, s[20:23], s45 offen
    s_waitcnt vmcnt(0)
L_h_nq:
    s_cmp_lg_u32 s34, 8
    s_cbranch_scc1 L_h_nt
    s_lshl_b32 s45, s32, 16
    buffer_load_dword v255, v30, s[8:11], s45 offen
    s_add_u32 s45, s45, 32768
    buffer_load_dword v255, v30, s[8:11], s45 offen
    s_branch L_end
L_h_nt:
    s_cmp_eq_u32 s2, 0
    s_cbranch_scc1 L_h_d2
    s_add_u32 m0, s40, 0
    s_add_u32 s45, s57, 0
    buffer_load_dwordx4 v2, s[8:11], s45 offen lds
    s_add_u32 m0, s40, 1024
    s_add_u32 s45, s57, 16384
    buffer_load_dwordx4 v2, s[8:11], s45 offen lds
    s_add_u32 s57, s57, 64
    s_and_b32 s57, s57, 0xfffffbff
    s_add_u32 m0, s40, 16384
    s_add_u32 s45, s36, 0
    buffer_load_dwordx4 v3, s[12:15], s45 offen lds
    s_add_u32 m0, s40, 17408
    s_add_u32 s45, s36, 32768
    buffer_load_dwordx4 v3, s[12:15], s45 offen lds
    s_add_u32 m0, s40, 18432
    s_add_u32 s45, s36, 65536
    buffer_load_dwordx4 v3, s[12:15], s45 offen lds
    s_add_u32 m0, s40, 19456
    s_add_u32 s45, s36, 98304
    buffer_load_dwordx4 v3, s[12:15], s45 offen lds
    s_add_u32 s36, s36, 262144
    s_add_u32 s40, s40, 32768
    s_and_b32 s40, s40, 0x1ffff
    s_add_u32 m0, s40, 0
    s_add_u32 s45, s57, 0
    buffer_load_dwordx4 v2, s[8:11], s45 offen lds
    s_add_u32 m0, s40, 1024
    s_add_u32 s45, s57, 16384
    buffer_load_dwordx4 v2, s[8:11], s45 offen lds
    s_add_u32 s57, s57, 64
    s_and_b32 s57, s57, 0xfffffbff
    s_add_u32 m0, s40, 16384
    s_add_u32 s45, s36, 0
    buffer_load_dwordx4 v3, s[12:15], s45 offen lds
    s_add_u32 m0, s40, 17408
    s_add_u32 s45, s36, 32768
    buffer_load_dwordx4 v3, s[12:15], s45 offen lds
    s_add_u32 m0, s40, 18432
    s_add_u32 s45, s36, 65536
    buffer_load_dwordx4 v3, s[12:15], s45 offen lds
    s_add_u32 m0, s40, 19456
    s_add_u32 s45, s36, 98304
    buffer_load_dwordx4 v3, s[12:15], s45 offen lds
    s_add_u32 s36, s36, 262144
    s_add_u32 s40, s40, 32768
    s_and_b32 s40, s40, 0x1ffff
    s_add_u32 m0, s40, 0
    s_add_u32 s45, s57, 0
    buffer_load_dwordx4 v2, s[8:11], s45 offen lds
    s_add_u32 m0, s40, 1024
    s_add_u32 s45, s57, 16384
    buffer_load_dwordx4 v2, s[8:11], s45 offen lds
    s_add_u32 s57, s57, 64
    s_and_b32 s57, s57, 0xfffffbff
    s_add_u32 m0, s40, 16384
    s_add_u32 s45, s36, 0
    buffer_load_dwordx4 v3, s[12:15], s45 offen lds
    s_add_u32 m0, s40, 17408
    s_add_u32 s45, s36, 32768
    buffer_load_dwordx4 v3, s[12:15], s45 offen lds
    s_add_u32 m0, s40, 18432
    s_add_u32 s45, s36, 65536
    buffer_load_dwordx4 v3, s[12:15], s45 offen lds
    s_add_u32 m0, s40, 19456
    s_add_u32 s45, s36, 98304
    buffer_load_dwordx4 v3, s[12:15], s45 offen lds
    s_add_u32 s36, s36, 262144
    s_add_u32 s40, s40, 32768
    s_and_b32 s40, s40, 0x1ffff
    s_add_u32 m0, s40, 0
    s_add_u32 s45, s57, 0
    buffer_load_dwordx4 v2, s[8:11], s45 offen lds
    s_add_u32 m0, s40, 1024
    s_add_u32 s45, s57, 16384
    buffer_load_dwordx4 v2, s[8:11], s45 offen lds
    s_add_u32 s57, s57, 64
    s_and_b32 s57, s57, 0xfffffbff
    s_branch L_h_d3
L_h_d2:
    s_add_u32 m0, s40, 0
    s_add_u32 s45, s57, 0
    buffer_load_dwordx4 v2, s[8:11], s45 offen lds
    s_add_u32 m0, s40, 1024
    s_add_u32 s45, s57, 16384
    buffer_load_dwordx4 v2, s[8:11], s45 offen lds
    s_add_u32 m0, s40, 2048
    s_add_u32 s45, s57, 131072
    buffer_load_dwordx4 v2, s[8:11], s45 offen lds
    s_add_u32 m0, s40, 3072
    s_add_u32 s45, s57, 147456
    buffer_load_dwordx4 v2, s[8:11], s45 offen lds
    s_add_u32 s57, s57, 64
    s_and_b32 s57, s57, 0xfffffbff
    s_add_u32 m0, s40, 16384
    s_add_u32 s45, s36, 0
    buffer_load_dwordx4 v3, s[12:15], s45 offen lds
    s_add_u32 m0, s40, 17408
    s_add_u32 s45, s36, 32768
    buffer_load_dwordx4 v3, s[12:15], s45 offen lds
    s_add_u32 m0, s40, 18432
    s_add_u32 s45, s36, 65536
    buffer_load_dwordx4 v3, s[12:15], s45 offen lds
    s_add_u32 m0, s40, 19456
    s_add_u32 s45, s36, 98304
    buffer_load_dwordx4 v3, s[12:15], s45 offen lds
    s_add_u32 s36, s36, 262144
    s_add_u32 s40, s40, 32768
    s_and_b32 s40, s40, 0x1ffff
    s_add_u32 m0, s40, 0
    s_add_u32 s45, s57, 0
    buffer_load_dwordx4 v2, s[8:11], s45 offen lds
    s_add_u32 m0, s40, 1024
    s_add_u32 s45, s57, 16384
    buffer_load_dwordx4 v2, s[8:11], s45 offen lds
    s_add_u32 m0, s40, 2048
    s_add_u32 s45, s57, 131072
    buffer_load_dwordx4 v2, s[8:11], s45 offen lds
    s_add_u32 m0, s40, 3072
    s_add_u32 s45, s57, 147456
    buffer_load_dwordx4 v2, s[8:11], s45 offen lds
    s_add_u32 s57, s57, 64
    s_and_b32 s57, s57, 0xfffffbff
    s_add_u32 m0, s40, 16384
    s_add_u32 s45, s36, 0
    buffer_load_dwordx4 v3, s[12:15], s45 offen lds
    s_add_u32 m0, s40, 17408
    s_add_u32 s45, s36, 32768
    buffer_load_dwordx4 v3, s[12:15], s45 offen lds
    s_add_u32 m0, s40, 18432
    s_add_u32 s45, s36, 65536
    buffer_load_dwordx4 v3, s[12:15], s45 offen lds
    s_add_u32 m0, s40, 19456
    s_add_u32 s45, s36, 98304
    buffer_load_dwordx4 v3, s[12:15], s45 offen lds
    s_add_u32 s36, s36, 262144
    s_add_u32 s40, s40, 32768
    s_and_b32 s40, s40, 0x1ffff
    s_add_u32 m0, s40, 0
    s_add_u32 s45, s57, 0
    buffer_load_dwordx4 v2, s[8:11], s45 offen lds
    s_add_u32 m0, s40, 1024
    s_add_u32 s45, s57, 16384
    buffer_load_dwordx4 v2, s[8:11], s45 offen lds
    s_add_u32 m0, s40, 2048
    s_add_u32 s45, s57, 131072
    buffer_load_dwordx4 v2, s[8:11], s45 offen lds
    s_add_u32 m0, s40, 3072
    s_add_u32 s45, s57, 147456
    buffer_load_dwordx4 v2, s[8:11], s45 offen lds
    s_add_u32 s57, s57, 64
    s_and_b32 s57, s57, 0xfffffbff
    s_add_u32 m0, s40, 16384
    s_add_u32 s45, s36, 0
    buffer_load_dwordx4 v3, s[12:15], s45 offen lds
    s_add_u32 m0, s40, 17408
    s_add_u32 s45, s36, 32768
    buffer_load_dwordx4 v3, s[12:15], s45 offen lds
    s_add_u32 m0, s40, 18432
    s_add_u32 s45, s36, 65536
    buffer_load_dwordx4 v3, s[12:15], s45 offen lds
    s_add_u32 m0, s40, 19456
    s_add_u32 s45, s36, 98304
    buffer_load_dwordx4 v3, s[12:15], s45 offen lds
    s_add_u32 s36, s36, 262144
    s_add_u32 s40, s40, 32768
    s_and_b32 s40, s40, 0x1ffff
    s_add_u32 m0, s40, 0
    s_add_u32 s45, s57, 0
    buffer_load_dwordx4 v2, s[8:11], s45 offen lds
    s_add_u32 m0, s40, 1024
    s_add_u32 s45, s57, 16384
    buffer_load_dwordx4 v2, s[8:11], s45 offen lds
    s_add_u32 m0, s40, 2048
    s_add_u32 s45, s57, 131072
    buffer_load_dwordx4 v2, s[8:11], s45 offen lds
    s_add_u32 m0, s40, 3072
    s_add_u32 s45, s57, 147456
    buffer_load_dwordx4 v2, s[8:11], s45 offen lds
    s_add_u32 s57, s57, 64
    s_and_b32 s57, s57, 0xfffffbff
L_h_d3:
    s_lshl_b32 s45, s42, 17
    s_lshl_b32 s46, s32, 12
    s_add_u32 s45, s45, s46
    s_add_u32 s3, s45, 35717120
    s_cmp_ge_u32 s2, 1
    s_cselect_b32 s3, 0x70000000, s3
    s_mov_b32 s35, 520192
    s_lshl_b32 s45, s34, 5
    s_add_u32 s45, s45, s32
    s_lshl_b32 s45, s45, 7
    s_add_u32 s45, s45, 52428800
    s_mov_b64 exec, 0xff
    buffer_store_dwordx4 v[44:47], v1, s[4:7], s45 offen sc1
    s_mov_b64 exec, -1
    s_lshl_b32 s45, s32, 2
    s_add_u32 s45, s45, s42
    s_lshl_b32 s45, s45, 7
    s_add_u32 s45, s45, 52494336
    s_add_u32 s46, s32, s2
    s_cmp_eq_u32 s2, 1
    s_cselect_b32 s46, s32, s46
    s_cmp_lt_u32 s46, 2
    s_cselect_b32 s45, s45, 0x70000000
    v_mov_b32 v48, 0
    s_mov_b64 exec, 1
    buffer_store_dword v48, v48, s[4:7], s45 offen sc1
    s_mov_b64 exec, -1
    global_load_dwordx4 v[52:55], v1, s[68:69]
    s_cmp_lt_u32 s34, 2
    s_cbranch_scc1 L_h_go
    s_cmp_eq_u32 s2, 2
    s_cbranch_scc1 L_h_go
    v_lshlrev_b32 v29, 7, v0
    s_and_b32 s46, s57, 0xfffffc00
    s_cmp_ge_u32 s34, 6
    s_cbranch_scc1 L_h_x2
    s_waitcnt vmcnt(0)
L_h_x2:
    s_add_u32 s45, s46, 0
    buffer_load_dword v255, v29, s[8:11], s45 offen
    s_add_u32 s45, s46, 8192
    buffer_load_dword v255, v29, s[8:11], s45 offen
    s_add_u32 s45, s46, 16384
    buffer_load_dword v255, v29, s[8:11], s45 offen
    s_add_u32 s45, s46, 24576
    buffer_load_dword v255, v29, s[8:11], s45 offen
    s_add_u32 s45, s46, 131072
    buffer_load_dword v255, v29, s[8:11], s45 offen
    s_add_u32 s45, s46, 139264
    buffer_load_dword v255, v29, s[8:11], s45 offen
    s_add_u32 s45, s46, 147456
    buffer_load_dword v255, v29, s[8:11], s45 offen
    s_add_u32 s45, s46, 155648
    buffer_load_dword v255, v29, s[8:11], s45 offen
    s_cmp_lg_u32 s34, 4
    s_cbranch_scc1 L_h_n7
    s_add_u32 s45, s33, 56
    s_lshl_b32 s45, s45, 20
    s_lshl_b32 s46, s32, 15
    s_add_u32 s45, s45, s46
    s_add_u32 s45, s45, 67108864
    s_mov_b32 s41, 8
L_h_c7:
    s_add_u32 s46, s45, 4194304
    buffer_store_dwordx4 v[44:47], v1, s[4:7], s45 offen offset:0 sc1
    buffer_store_dwordx4 v[44:47], v1, s[4:7], s45 offen offset:1024 sc1
    buffer_store_dwordx4 v[44:47], v1, s[4:7], s45 offen offset:2048 sc1
    buffer_store_dwordx4 v[44:47], v1, s[4:7], s45 offen offset:3072 sc1
    buffer_store_dwordx4 v[44:47], v1, s[4:7], s46 offen offset:0 sc1
    buffer_store_dwordx4 v[44:47], v1, s[4:7], s46 offen offset:1024 sc1
    buffer_store_dwordx4 v[44:47], v1, s[4:7], s46 offen offset:2048 sc1
    buffer_store_dwordx4 v[44:47], v1, s[4:7], s46 offen offset:3072 sc1
    s_add_u32 s45, s45, 4096
    s_sub_u32 s41, s41, 1
    s_cmp_lg_u32 s41, 0
    s_cbranch_scc1 L_h_c7
L_h_n7:
    s_sub_i32 s47, s34, 2
    s_max_i32 s47, s47, 0
    s_lshl_b32 s47, s47, 2
    s_cmp_ge_u32 s34, 6
    s_cbranch_scc1 L_h_go
    s_cmp_lg_u32 s33, 0
    s_cbranch_scc1 L_h_go
L_h_w0:
    buffer_load_dword v29, off, s[24:27], s47 offset:144 sc1
    s_waitcnt vmcnt(0)
    v_cmp_eq_u32 vcc, 0, v29
    s_cbranch_vccz L_h_go
    s_add_u32 s43, s43, 1
    s_cmp_gt_u32 s43, 1000000
    s_cbranch_scc1 L_end
    s_sleep 8
    s_branch L_h_w0
L_h_go:
    s_waitcnt vmcnt(17)
    s_barrier
    ds_read_b128 v[160:163], v5 offset:0
    ds_read_b128 v[164:167], v5 offset:2048
    ds_read_b64_tr_b16 v[168:169], v7 offset:0
    ds_read_b64_tr_b16 v[170:171], v7 offset:1024
    ds_read_b64_tr_b16 v[172:173], v8 offset:0
    ds_read_b64_tr_b16 v[174:175], v8 offset:1024
    ds_read_b64_tr_b16 v[176:177], v9 offset:0
    ds_read_b64_tr_b16 v[178:179], v9 offset:1024
    ds_read_b64_tr_b16 v[180:181], v10 offset:0
    ds_read_b64_tr_b16 v[182:183], v10 offset:1024
    ds_read_b64_tr_b16 v[184:185], v7 offset:8192
    ds_read_b64_tr_b16 v[186:187], v7 offset:9216
    ds_read_b64_tr_b16 v[188:189], v8 offset:8192
    ds_read_b64_tr_b16 v[190:191], v8 offset:9216
    ds_read_b64_tr_b16 v[192:193], v9 offset:8192
    ds_read_b64_tr_b16 v[194:195], v9 offset:9216
    ds_read_b64_tr_b16 v[196:197], v10 offset:8192
    ds_read_b64_tr_b16 v[198:199], v10 offset:9216
    s_cmp_eq_u32 s2, 0
    s_cbranch_scc1 L_h_full
    s_mov_b32 s41, 12
L_h_q1a:
    s_waitcnt lgkmcnt(0)
    v_mfma_f32_32x32x16_bf16 a[0:15], v[168:171], v[160:163], a[0:15]
    ds_read_b128 v[200:203], v6 offset:0
    ds_read_b64_tr_b16 v[208:209], v7 offset:4096
    ds_read_b64_tr_b16 v[210:211], v7 offset:5120
    ds_read_b64_tr_b16 v[212:213], v8 offset:4096
    ds_read_b64_tr_b16 v[214:215], v8 offset:5120
    v_mfma_f32_32x32x16_bf16 a[16:31], v[172:175], v[160:163], a[16:31]
    ds_read_b64_tr_b16 v[216:217], v9 offset:4096
    ds_read_b64_tr_b16 v[218:219], v9 offset:5120
    s_add_u32 m0, s40, 16384
    s_add_u32 s45, s36, 0
    buffer_load_dwordx4 v3, s[12:15], s45 offen lds
    v_mfma_f32_32x32x16_bf16 a[32:47], v[176:179], v[160:163], a[32:47]
    ds_read_b64_tr_b16 v[220:221], v10 offset:4096
    ds_read_b64_tr_b16 v[222:223], v10 offset:5120
    ds_read_b64_tr_b16 v[224:225], v7 offset:12288
    ds_read_b64_tr_b16 v[226:227], v7 offset:13312
    ds_read_b64_tr_b16 v[228:229], v8 offset:12288
    v_mfma_f32_32x32x16_bf16 a[48:63], v[180:183], v[160:163], a[48:63]
    ds_read_b64_tr_b16 v[230:231], v8 offset:13312
    ds_read_b64_tr_b16 v[232:233], v9 offset:12288
    s_add_u32 m0, s40, 17408
    s_add_u32 s45, s36, 32768
    buffer_load_dwordx4 v3, s[12:15], s45 offen lds
    v_mfma_f32_32x32x16_bf16 a[128:143], v[160:163], v[184:187], a[128:143]
    ds_read_b64_tr_b16 v[234:235], v9 offset:13312
    ds_read_b64_tr_b16 v[236:237], v10 offset:12288
    ds_read_b64_tr_b16 v[238:239], v10 offset:13312
    v_add_u32 v5, 0x8000, v5
    v_and_b32 v5, 0x1ffff, v5
    v_add_u32 v6, 0x8000, v6
    v_and_b32 v6, 0x1ffff, v6
    v_add_u32 v7, 0x8000, v7
    v_and_b32 v7, 0x1ffff, v7
    v_mfma_f32_32x32x16_bf16 a[144:159], v[160:163], v[188:191], a[144:159]
    s_add_u32 m0, s40, 18432
    s_add_u32 s45, s36, 65536
    buffer_load_dwordx4 v3, s[12:15], s45 offen lds
    v_mfma_f32_32x32x16_bf16 a[160:175], v[160:163], v[192:195], a[160:175]
    v_add_u32 v8, 0x8000, v8
    v_and_b32 v8, 0x1ffff, v8
    v_add_u32 v9, 0x8000, v9
    v_and_b32 v9, 0x1ffff, v9
    v_add_u32 v10, 0x8000, v10
    v_and_b32 v10, 0x1ffff, v10
    v_mfma_f32_32x32x16_bf16 a[176:191], v[160:163], v[196:199], a[176:191]
    s_add_u32 m0, s40, 19456
    s_add_u32 s45, s36, 98304
    buffer_load_dwordx4 v3, s[12:15], s45 offen lds
    s_add_u32 s36, s36, 262144
    s_add_u32 s40, s40, 32768
    s_and_b32 s40, s40, 0x1ffff
    s_waitcnt vmcnt(12) lgkmcnt(0)
    s_barrier
    v_mfma_f32_32x32x16_bf16 a[0:15], v[208:211], v[200:203], a[0:15]
    ds_read_b128 v[160:163], v5 offset:0
    ds_read_b64_tr_b16 v[168:169], v7 offset:0
    ds_read_b64_tr_b16 v[170:171], v7 offset:1024
    ds_read_b64_tr_b16 v[172:173], v8 offset:0
    ds_read_b64_tr_b16 v[174:175], v8 offset:1024
    v_mfma_f32_32x32x16_bf16 a[16:31], v[212:215], v[200:203], a[16:31]
    ds_read_b64_tr_b16 v[176:177], v9 offset:0
    ds_read_b64_tr_b16 v[178:179], v9 offset:1024
    s_add_u32 m0, s40, 0
    s_add_u32 s45, s57, 0
    buffer_load_dwordx4 v2, s[8:11], s45 offen lds
    v_mfma_f32_32x32x16_bf16 a[32:47], v[216:219], v[200:203], a[32:47]
    ds_read_b64_tr_b16 v[180:181], v10 offset:0
    ds_read_b64_tr_b16 v[182:183], v10 offset:1024
    ds_read_b64_tr_b16 v[184:185], v7 offset:8192
    ds_read_b64_tr_b16 v[186:187], v7 offset:9216
    ds_read_b64_tr_b16 v[188:189], v8 offset:8192
    v_mfma_f32_32x32x16_bf16 a[48:63], v[220:223], v[200:203], a[48:63]
    ds_read_b64_tr_b16 v[190:191], v8 offset:9216
    ds_read_b64_tr_b16 v[192:193], v9 offset:8192
    s_add_u32 m0, s40, 1024
    s_add_u32 s45, s57, 16384
    buffer_load_dwordx4 v2, s[8:11], s45 offen lds
    s_add_u32 s57, s57, 64
    s_and_b32 s57, s57, 0xfffffbff
    v_mfma_f32_32x32x16_bf16 a[128:143], v[200:203], v[224:227], a[128:143]
    ds_read_b64_tr_b16 v[194:195], v9 offset:9216
    ds_read_b64_tr_b16 v[196:197], v10 offset:8192
    ds_read_b64_tr_b16 v[198:199], v10 offset:9216
    v_mfma_f32_32x32x16_bf16 a[144:159], v[200:203], v[228:231], a[144:159]
    v_mfma_f32_32x32x16_bf16 a[160:175], v[200:203], v[232:235], a[160:175]
    v_mfma_f32_32x32x16_bf16 a[176:191], v[200:203], v[236:239], a[176:191]
    s_sub_u32 s41, s41, 1
    s_cmp_lg_u32 s41, 0
    s_cbranch_scc1 L_h_q1a
    s_waitcnt lgkmcnt(0)
    v_mfma_f32_32x32x16_bf16 a[0:15], v[168:171], v[160:163], a[0:15]
    ds_read_b128 v[200:203], v6 offset:0
    ds_read_b64_tr_b16 v[208:209], v7 offset:4096
    ds_read_b64_tr_b16 v[210:211], v7 offset:5120
    ds_read_b64_tr_b16 v[212:213], v8 offset:4096
    ds_read_b64_tr_b16 v[214:215], v8 offset:5120
    v_mfma_f32_32x32x16_bf16 a[16:31], v[172:175], v[160:163], a[16:31]
    ds_read_b64_tr_b16 v[216:217], v9 offset:4096
    ds_read_b64_tr_b16 v[218:219], v9 offset:5120
    s_add_u32 m0, s40, 16384
    s_add_u32 s45, s36, 0
    buffer_load_dwordx4 v3, s[12:15], s45 offen lds
    v_mfma_f32_32x32x16_bf16 a[32:47], v[176:179], v[160:163], a[32:47]
    ds_read_b64_tr_b16 v[220:221], v10 offset:4096
    ds_read_b64_tr_b16 v[222:223], v10 offset:5120
    ds_read_b64_tr_b16 v[224:225], v7 offset:12288
    ds_read_b64_tr_b16 v[226:227], v7 offset:13312
    ds_read_b64_tr_b16 v[228:229], v8 offset:12288
    v_mfma_f32_32x32x16_bf16 a[48:63], v[180:183], v[160:163], a[48:63]
    ds_read_b64_tr_b16 v[230:231], v8 offset:13312
    ds_read_b64_tr_b16 v[232:233], v9 offset:12288
    s_add_u32 m0, s40, 17408
    s_add_u32 s45, s36, 32768
    buffer_load_dwordx4 v3, s[12:15], s45 offen lds
    v_mfma_f32_32x32x16_bf16 a[128:143], v[160:163], v[184:187], a[128:143]
    ds_read_b64_tr_b16 v[234:235], v9 offset:13312
    ds_read_b64_tr_b16 v[236:237], v10 offset:12288
    ds_read_b64_tr_b16 v[238:239], v10 offset:13312
    v_add_u32 v5, 0x8000, v5
    v_and_b32 v5, 0x1ffff, v5
    v_add_u32 v6, 0x8000, v6
    v_and_b32 v6, 0x1ffff, v6
    v_add_u32 v7, 0x8000, v7
    v_and_b32 v7, 0x1ffff, v7
    v_mfma_f32_32x32x16_bf16 a[144:159], v[160:163], v[188:191], a[144:159]
    s_add_u32 m0, s40, 18432
    s_add_u32 s45, s36, 65536
    buffer_load_dwordx4 v3, s[12:15], s45 offen lds
    v_mfma_f32_32x32x16_bf16 a[160:175], v[160:163], v[192:195], a[160:175]
    v_add_u32 v8, 0x8000, v8
    v_and_b32 v8, 0x1ffff, v8
    v_add_u32 v9, 0x8000, v9
    v_and_b32 v9, 0x1ffff, v9
    v_add_u32 v10, 0x8000, v10
    v_and_b32 v10, 0x1ffff, v10
    v_mfma_f32_32x32x16_bf16 a[176:191], v[160:163], v[196:199], a[176:191]
    s_add_u32 m0, s40, 19456
    s_add_u32 s45, s36, 98304
    buffer_load_dwordx4 v3, s[12:15], s45 offen lds
    s_add_u32 s36, s36, 262144
    s_add_u32 s40, s40, 32768
    s_and_b32 s40, s40, 0x1ffff
    s_waitcnt vmcnt(12) lgkmcnt(0)
    s_barrier
    v_mfma_f32_32x32x16_bf16 a[0:15], v[208:211], v[200:203], a[0:15]
    ds_read_b128 v[160:163], v5 offset:0
    ds_read_b64_tr_b16 v[168:169], v7 offset:0
    ds_read_b64_tr_b16 v[170:171], v7 offset:1024
    ds_read_b64_tr_b16 v[172:173], v8 offset:0
    ds_read_b64_tr_b16 v[174:175], v8 offset:1024
    v_mfma_f32_32x32x16_bf16 a[16:31], v[212:215], v[200:203], a[16:31]
    ds_read_b64_tr_b16 v[176:177], v9 offset:0
    ds_read_b64_tr_b16 v[178:179], v9 offset:1024
    s_add_u32 m0, s40, 0
    s_add_u32 s45, s57, 0
    buffer_load_dwordx4 v2, s[8:11], s45 offen lds
    v_mfma_f32_32x32x16_bf16 a[32:47], v[216:219], v[200:203], a[32:47]
    ds_read_b64_tr_b16 v[180:181], v10 offset:0
    ds_read_b64_tr_b16 v[182:183], v10 offset:1024
    ds_read_b64_tr_b16 v[184:185], v7 offset:8192
    ds_read_b64_tr_b16 v[186:187], v7 offset:9216
    ds_read_b64_tr_b16 v[188:189], v8 offset:8192
    v_mfma_f32_32x32x16_bf16 a[48:63], v[220:223], v[200:203], a[48:63]
    ds_read_b64_tr_b16 v[190:191], v8 offset:9216
    ds_read_b64_tr_b16 v[192:193], v9 offset:8192
    s_add_u32 m0, s40, 1024
    s_add_u32 s45, s57, 16384
    buffer_load_dwordx4 v2, s[8:11], s45 offen lds
    v_mfma_f32_32x32x16_bf16 a[128:143], v[200:203], v[224:227], a[128:143]
    ds_read_b64_tr_b16 v[194:195], v9 offset:9216
    ds_read_b64_tr_b16 v[196:197], v10 offset:8192
    ds_read_b64_tr_b16 v[198:199], v10 offset:9216
    v_mfma_f32_32x32x16_bf16 a[144:159], v[200:203], v[228:231], a[144:159]
    s_add_u32 m0, s40, 2048
    s_add_u32 s45, s57, 131072
    buffer_load_dwordx4 v2, s[8:11], s45 offen lds
    v_mfma_f32_32x32x16_bf16 a[160:175], v[200:203], v[232:235], a[160:175]
    v_mfma_f32_32x32x16_bf16 a[176:191], v[200:203], v[236:239], a[176:191]
    s_add_u32 m0, s40, 3072
    s_add_u32 s45, s57, 147456
    buffer_load_dwordx4 v2, s[8:11], s45 offen lds
    s_add_u32 s57, s57, 64
    s_and_b32 s57, s57, 0xfffffbff
    v_add_u32 v29, 131072, v1
    ds_write_b128 v29, v[52:55]
    v_mov_b32 v15, 64
    s_add_u32 s45, s33, s2
    s_cmp_lg_u32 s45, 1
    s_cbranch_scc1 L_h_a1
    buffer_load_dword v15, off, s[24:27], 0 offset:132 sc1
L_h_a1:
    s_mov_b32 s41, 3
L_h_q1b:
    s_waitcnt lgkmcnt(0)
    v_mfma_f32_32x32x16_bf16 a[0:15], v[168:171], v[160:163], a[0:15]
    ds_read_b128 v[200:203], v6 offset:0
    ds_read_b64_tr_b16 v[208:209], v7 offset:4096
    ds_read_b64_tr_b16 v[210:211], v7 offset:5120
    ds_read_b64_tr_b16 v[212:213], v8 offset:4096
    ds_read_b64_tr_b16 v[214:215], v8 offset:5120
    v_mfma_f32_32x32x16_bf16 a[16:31], v[172:175], v[160:163], a[16:31]
    ds_read_b64_tr_b16 v[216:217], v9 offset:4096
    ds_read_b64_tr_b16 v[218:219], v9 offset:5120
    s_add_u32 m0, s40, 16384
    s_mov_b32 s46, s37
    buffer_load_dwordx4 v4, s[16:19], s46 offen lds
    v_mfma_f32_32x32x16_bf16 a[32:47], v[176:179], v[160:163], a[32:47]
    ds_read_b64_tr_b16 v[220:221], v10 offset:4096
    ds_read_b64_tr_b16 v[222:223], v10 offset:5120
    ds_read_b64_tr_b16 v[224:225], v7 offset:12288
    ds_read_b64_tr_b16 v[226:227], v7 offset:13312
    ds_read_b64_tr_b16 v[228:229], v8 offset:12288
    v_mfma_f32_32x32x16_bf16 a[48:63], v[180:183], v[160:163], a[48:63]
    ds_read_b64_tr_b16 v[230:231], v8 offset:13312
    ds_read_b64_tr_b16 v[232:233], v9 offset:12288
    s_add_u32 m0, s40, 17408
    s_add_u32 s46, s46, s38
    buffer_load_dwordx4 v4, s[16:19], s46 offen lds
    v_mfma_f32_32x32x16_bf16 a[128:143], v[160:163], v[184:187], a[128:143]
    ds_read_b64_tr_b16 v[234:235], v9 offset:13312
    ds_read_b64_tr_b16 v[236:237], v10 offset:12288
    ds_read_b64_tr_b16 v[238:239], v10 offset:13312
    v_add_u32 v5, 0x8000, v5
    v_and_b32 v5, 0x1ffff, v5
    v_add_u32 v6, 0x8000, v6
    v_and_b32 v6, 0x1ffff, v6
    v_add_u32 v7, 0x8000, v7
    v_and_b32 v7, 0x1ffff, v7
    v_mfma_f32_32x32x16_bf16 a[144:159], v[160:163], v[188:191], a[144:159]
    s_add_u32 m0, s40, 18432
    s_add_u32 s46, s46, s38
    buffer_load_dwordx4 v4, s[16:19], s46 offen lds
    v_mfma_f32_32x32x16_bf16 a[160:175], v[160:163], v[192:195], a[160:175]
    v_add_u32 v8, 0x8000, v8
    v_and_b32 v8, 0x1ffff, v8
    v_add_u32 v9, 0x8000, v9
    v_and_b32 v9, 0x1ffff, v9
    v_add_u32 v10, 0x8000, v10
    v_and_b32 v10, 0x1ffff, v10
    v_mfma_f32_32x32x16_bf16 a[176:191], v[160:163], v[196:199], a[176:191]
    s_add_u32 m0, s40, 19456
    s_add_u32 s46, s46, s38
    buffer_load_dwordx4 v4, s[16:19], s46 offen lds
    s_add_u32 s37, s37, s39
    s_add_u32 s40, s40, 32768
    s_and_b32 s40, s40, 0x1ffff
    s_waitcnt vmcnt(14) lgkmcnt(0)
    s_barrier
    v_mfma_f32_32x32x16_bf16 a[0:15], v[208:211], v[200:203], a[0:15]
    ds_read_b128 v[160:163], v5 offset:0
    ds_read_b64_tr_b16 v[168:169], v7 offset:0
    ds_read_b64_tr_b16 v[170:171], v7 offset:1024
    ds_read_b64_tr_b16 v[172:173], v8 offset:0
    ds_read_b64_tr_b16 v[174:175], v8 offset:1024
    v_mfma_f32_32x32x16_bf16 a[16:31], v[212:215], v[200:203], a[16:31]
    ds_read_b64_tr_b16 v[176:177], v9 offset:0
    ds_read_b64_tr_b16 v[178:179], v9 offset:1024
    s_add_u32 m0, s40, 0
    s_add_u32 s45, s57, 0
    buffer_load_dwordx4 v2, s[8:11], s45 offen lds
    v_mfma_f32_32x32x16_bf16 a[32:47], v[216:219], v[200:203], a[32:47]
    ds_read_b64_tr_b16 v[180:181], v10 offset:0
    ds_read_b64_tr_b16 v[182:183], v10 offset:1024
    ds_read_b64_tr_b16 v[184:185], v7 offset:8192
    ds_read_b64_tr_b16 v[186:187], v7 offset:9216
    ds_read_b64_tr_b16 v[188:189], v8 offset:8192
    v_mfma_f32_32x32x16_bf16 a[48:63], v[220:223], v[200:203], a[48:63]
    ds_read_b64_tr_b16 v[190:191], v8 offset:9216
    ds_read_b64_tr_b16 v[192:193], v9 offset:8192
    s_add_u32 m0, s40, 1024
    s_add_u32 s45, s57, 16384
    buffer_load_dwordx4 v2, s[8:11], s45 offen lds
    v_mfma_f32_32x32x16_bf16 a[128:143], v[200:203], v[224:227], a[128:143]
    ds_read_b64_tr_b16 v[194:195], v9 offset:9216
    ds_read_b64_tr_b16 v[196:197], v10 offset:8192
    ds_read_b64_tr_b16 v[198:199], v10 offset:9216
    v_mfma_f32_32x32x16_bf16 a[144:159], v[200:203], v[228:231], a[144:159]
    s_add_u32 m0, s40, 2048
    s_add_u32 s45, s57, 131072
    buffer_load_dwordx4 v2, s[8:11], s45 offen lds
    v_mfma_f32_32x32x16_bf16 a[160:175], v[200:203], v[232:235], a[160:175]
    v_mfma_f32_32x32x16_bf16 a[176:191], v[200:203], v[236:239], a[176:191]
    s_add_u32 m0, s40, 3072
    s_add_u32 s45, s57, 147456
    buffer_load_dwordx4 v2, s[8:11], s45 offen lds
    s_add_u32 s57, s57, 64
    s_and_b32 s57, s57, 0xfffffbff
    s_sub_u32 s41, s41, 1
    s_cmp_lg_u32 s41, 0
    s_cbranch_scc1 L_h_q1b
L_h_a0:
    v_cmp_gt_u32 vcc, 64, v15
    s_cbranch_vccz L_h_e1
    buffer_load_dword v15, off, s[24:27], 0 offset:132 sc1
    s_waitcnt vmcnt(0)
    s_add_u32 s43, s43, 1
    s_cmp_gt_u32 s43, 1000000
    s_cbranch_scc1 L_end
    s_sleep 4
    s_branch L_h_a0
L_h_full:
    s_mov_b32 s41, 13
L_h_p1a:
    s_waitcnt lgkmcnt(0)
    v_mfma_f32_32x32x16_bf16 a[0:15], v[168:171], v[160:163], a[0:15]
    ds_read_b128 v[200:203], v6 offset:0
    ds_read_b128 v[204:207], v6 offset:2048
    v_mfma_f32_32x32x16_bf16 a[64:79], v[168:171], v[164:167], a[64:79]
    ds_read_b64_tr_b16 v[208:209], v7 offset:4096
    ds_read_b64_tr_b16 v[210:211], v7 offset:5120
    s_add_u32 m0, s40, 16384
    s_add_u32 s45, s36, 0
    buffer_load_dwordx4 v3, s[12:15], s45 offen lds
    v_mfma_f32_32x32x16_bf16 a[16:31], v[172:175], v[160:163], a[16:31]
    ds_read_b64_tr_b16 v[212:213], v8 offset:4096
    ds_read_b64_tr_b16 v[214:215], v8 offset:5120
    v_mfma_f32_32x32x16_bf16 a[80:95], v[172:175], v[164:167], a[80:95]
    ds_read_b64_tr_b16 v[216:217], v9 offset:4096
    ds_read_b64_tr_b16 v[218:219], v9 offset:5120
    v_mfma_f32_32x32x16_bf16 a[32:47], v[176:179], v[160:163], a[32:47]
    ds_read_b64_tr_b16 v[220:221], v10 offset:4096
    ds_read_b64_tr_b16 v[222:223], v10 offset:5120
    v_mfma_f32_32x32x16_bf16 a[96:111], v[176:179], v[164:167], a[96:111]
    ds_read_b64_tr_b16 v[224:225], v7 offset:12288
    ds_read_b64_tr_b16 v[226:227], v7 offset:13312
    s_add_u32 m0, s40, 17408
    s_add_u32 s45, s36, 32768
    buffer_load_dwordx4 v3, s[12:15], s45 offen lds
    v_mfma_f32_32x32x16_bf16 a[48:63], v[180:183], v[160:163], a[48:63]
    ds_read_b64_tr_b16 v[228:229], v8 offset:12288
    ds_read_b64_tr_b16 v[230:231], v8 offset:13312
    v_mfma_f32_32x32x16_bf16 a[112:127], v[180:183], v[164:167], a[112:127]
    ds_read_b64_tr_b16 v[232:233], v9 offset:12288
    ds_read_b64_tr_b16 v[234:235], v9 offset:13312
    v_mfma_f32_32x32x16_bf16 a[128:143], v[160:163], v[184:187], a[128:143]
    ds_read_b64_tr_b16 v[236:237], v10 offset:12288
    ds_read_b64_tr_b16 v[238:239], v10 offset:13312
    v_add_u32 v5, 0x8000, v5
    v_and_b32 v5, 0x1ffff, v5
    v_add_u32 v6, 0x8000, v6
    v_and_b32 v6, 0x1ffff, v6
    v_add_u32 v7, 0x8000, v7
    v_mfma_f32_32x32x16_bf16 a[192:207], v[164:167], v[184:187], a[192:207]
    s_add_u32 m0, s40, 18432
    s_add_u32 s45, s36, 65536
    buffer_load_dwordx4 v3, s[12:15], s45 offen lds
    v_mfma_f32_32x32x16_bf16 a[144:159], v[160:163], v[188:191], a[144:159]
    v_and_b32 v7, 0x1ffff, v7
    v_add_u32 v8, 0x8000, v8
    v_and_b32 v8, 0x1ffff, v8
    v_add_u32 v9, 0x8000, v9
    v_and_b32 v9, 0x1ffff, v9
    v_mfma_f32_32x32x16_bf16 a[208:223], v[164:167], v[188:191], a[208:223]
    v_add_u32 v10, 0x8000, v10
    v_and_b32 v10, 0x1ffff, v10
    v_mfma_f32_32x32x16_bf16 a[160:175], v[160:163], v[192:195], a[160:175]
    v_mfma_f32_32x32x16_bf16 a[224:239], v[164:167], v[192:195], a[224:239]
    s_add_u32 m0, s40, 19456
    s_add_u32 s45, s36, 98304
    buffer_load_dwordx4 v3, s[12:15], s45 offen lds
    s_add_u32 s36, s36, 262144
    s_add_u32 s40, s40, 32768
    s_and_b32 s40, s40, 0x1ffff
    v_mfma_f32_32x32x16_bf16 a[176:191], v[160:163], v[196:199], a[176:191]
    v_mfma_f32_32x32x16_bf16 a[240:255], v[164:167], v[196:199], a[240:255]
    s_waitcnt vmcnt(18) lgkmcnt(0)
    s_barrier
    v_mfma_f32_32x32x16_bf16 a[0:15], v[208:211], v[200:203], a[0:15]
    ds_read_b128 v[160:163], v5 offset:0
    ds_read_b128 v[164:167], v5 offset:2048
    v_mfma_f32_32x32x16_bf16 a[64:79], v[208:211], v[204:207], a[64:79]
    ds_read_b64_tr_b16 v[168:169], v7 offset:0
    ds_read_b64_tr_b16 v[170:171], v7 offset:1024
    s_add_u32 m0, s40, 0
    s_add_u32 s45, s57, 0
    buffer_load_dwordx4 v2, s[8:11], s45 offen lds
    v_mfma_f32_32x32x16_bf16 a[16:31], v[212:215], v[200:203], a[16:31]
    ds_read_b64_tr_b16 v[172:173], v8 offset:0
    ds_read_b64_tr_b16 v[174:175], v8 offset:1024
    v_mfma_f32_32x32x16_bf16 a[80:95], v[212:215], v[204:207], a[80:95]
    ds_read_b64_tr_b16 v[176:177], v9 offset:0
    ds_read_b64_tr_b16 v[178:179], v9 offset:1024
    v_mfma_f32_32x32x16_bf16 a[32:47], v[216:219], v[200:203], a[32:47]
    ds_read_b64_tr_b16 v[180:181], v10 offset:0
    ds_read_b64_tr_b16 v[182:183], v10 offset:1024
    v_mfma_f32_32x32x16_bf16 a[96:111], v[216:219], v[204:207], a[96:111]
    ds_read_b64_tr_b16 v[184:185], v7 offset:8192
    ds_read_b64_tr_b16 v[186:187], v7 offset:9216
    s_add_u32 m0, s40, 1024
    s_add_u32 s45, s57, 16384
    buffer_load_dwordx4 v2, s[8:11], s45 offen lds
    v_mfma_f32_32x32x16_bf16 a[48:63], v[220:223], v[200:203], a[48:63]
    ds_read_b64_tr_b16 v[188:189], v8 offset:8192
    ds_read_b64_tr_b16 v[190:191], v8 offset:9216
    v_mfma_f32_32x32x16_bf16 a[112:127], v[220:223], v[204:207], a[112:127]
    ds_read_b64_tr_b16 v[192:193], v9 offset:8192
    ds_read_b64_tr_b16 v[194:195], v9 offset:9216
    v_mfma_f32_32x32x16_bf16 a[128:143], v[200:203], v[224:227], a[128:143]
    ds_read_b64_tr_b16 v[196:197], v10 offset:8192
    ds_read_b64_tr_b16 v[198:199], v10 offset:9216
    v_mfma_f32_32x32x16_bf16 a[192:207], v[204:207], v[224:227], a[192:207]
    s_add_u32 m0, s40, 2048
    s_add_u32 s45, s57, 131072
    buffer_load_dwordx4 v2, s[8:11], s45 offen lds
    v_mfma_f32_32x32x16_bf16 a[144:159], v[200:203], v[228:231], a[144:159]
    v_mfma_f32_32x32x16_bf16 a[208:223], v[204:207], v[228:231], a[208:223]
    buffer_store_dwordx4 v[44:47], v1, s[4:7], s3 offen sc1
    s_add_u32 s3, s3, 1024
    v_mfma_f32_32x32x16_bf16 a[160:175], v[200:203], v[232:235], a[160:175]
    s_and_b32 s45, s3, 0xfff
    s_cselect_b32 s45, 0, s35
    s_cselect_b32 s35, s35, 0x20000000
    s_add_u32 s3, s3, s45
    v_mfma_f32_32x32x16_bf16 a[224:239], v[204:207], v[232:235], a[224:239]
    s_add_u32 m0, s40, 3072
    s_add_u32 s45, s57, 147456
    buffer_load_dwordx4 v2, s[8:11], s45 offen lds
    s_add_u32 s57, s57, 64
    s_and_b32 s57, s57, 0xfffffbff
    v_mfma_f32_32x32x16_bf16 a[176:191], v[200:203], v[236:239], a[176:191]
    v_mfma_f32_32x32x16_bf16 a[240:255], v[204:207], v[236:239], a[240:255]
    s_sub_u32 s41, s41, 1
    s_cmp_lg_u32 s41, 0
    s_cbranch_scc1 L_h_p1a
    v_add_u32 v29, 131072, v1
    ds_write_b128 v29, v[52:55]
    s_mov_b32 s41, 3
L_h_p1b:
    s_waitcnt lgkmcnt(0)
    v_mfma_f32_32x32x16_bf16 a[0:15], v[168:171], v[160:163], a[0:15]
    ds_read_b128 v[200:203], v6 offset:0
    ds_read_b128 v[204:207], v6 offset:2048
    v_mfma_f32_32x32x16_bf16 a[64:79], v[168:171], v[164:167], a[64:79]
    ds_read_b64_tr_b16 v[208:209], v7 offset:4096
    ds_read_b64_tr_b16 v[210:211], v7 offset:5120
    s_add_u32 m0, s40, 16384
    s_mov_b32 s46, s37
    buffer_load_dwordx4 v4, s[16:19], s46 offen lds
    v_mfma_f32_32x32x16_bf16 a[16:31], v[172:175], v[160:163], a[16:31]
    ds_read_b64_tr_b16 v[212:213], v8 offset:4096
    ds_read_b64_tr_b16 v[214:215], v8 offset:5120
    v_mfma_f32_32x32x16_bf16 a[80:95], v[172:175], v[164:167], a[80:95]
    ds_read_b64_tr_b16 v[216:217], v9 offset:4096
    ds_read_b64_tr_b16 v[218:219], v9 offset:5120
    v_mfma_f32_32x32x16_bf16 a[32:47], v[176:179], v[160:163], a[32:47]
    ds_read_b64_tr_b16 v[220:221], v10 offset:4096
    ds_read_b64_tr_b16 v[222:223], v10 offset:5120
    v_mfma_f32_32x32x16_bf16 a[96:111], v[176:179], v[164:167], a[96:111]
    ds_read_b64_tr_b16 v[224:225], v7 offset:12288
    ds_read_b64_tr_b16 v[226:227], v7 offset:13312
    s_add_u32 m0, s40, 17408
    s_add_u32 s46, s46, s38
    buffer_load_dwordx4 v4, s[16:19], s46 offen lds
    v_mfma_f32_32x32x16_bf16 a[48:63], v[180:183], v[160:163], a[48:63]
    ds_read_b64_tr_b16 v[228:229], v8 offset:12288
    ds_read_b64_tr_b16 v[230:231], v8 offset:13312
    v_mfma_f32_32x32x16_bf16 a[112:127], v[180:183], v[164:167], a[112:127]
    ds_read_b64_tr_b16 v[232:233], v9 offset:12288
    ds_read_b64_tr_b16 v[234:235], v9 offset:13312
    v_mfma_f32_32x32x16_bf16 a[128:143], v[160:163], v[184:187], a[128:143]
    ds_read_b64_tr_b16 v[236:237], v10 offset:12288
    ds_read_b64_tr_b16 v[238:239], v10 offset:13312
    v_add_u32 v5, 0x8000, v5
    v_and_b32 v5, 0x1ffff, v5
    v_add_u32 v6, 0x8000, v6
    v_and_b32 v6, 0x1ffff, v6
    v_add_u32 v7, 0x8000, v7
    v_mfma_f32_32x32x16_bf16 a[192:207], v[164:167], v[184:187], a[192:207]
    s_add_u32 m0, s40, 18432
    s_add_u32 s46, s46, s38
    buffer_load_dwordx4 v4, s[16:19], s46 offen lds
    v_mfma_f32_32x32x16_bf16 a[144:159], v[160:163], v[188:191], a[144:159]
    v_and_b32 v7, 0x1ffff, v7
    v_add_u32 v8, 0x8000, v8
    v_and_b32 v8, 0x1ffff, v8
    v_add_u32 v9, 0x8000, v9
    v_and_b32 v9, 0x1ffff, v9
    v_mfma_f32_32x32x16_bf16 a[208:223], v[164:167], v[188:191], a[208:223]
    v_add_u32 v10, 0x8000, v10
    v_and_b32 v10, 0x1ffff, v10
    v_mfma_f32_32x32x16_bf16 a[160:175], v[160:163], v[192:195], a[160:175]
    v_mfma_f32_32x32x16_bf16 a[224:239], v[164:167], v[192:195], a[224:239]
    s_add_u32 m0, s40, 19456
    s_add_u32 s46, s46, s38
    buffer_load_dwordx4 v4, s[16:19], s46 offen lds
    s_add_u32 s37, s37, s39
    s_add_u32 s40, s40, 32768
    s_and_b32 s40, s40, 0x1ffff
    v_mfma_f32_32x32x16_bf16 a[176:191], v[160:163], v[196:199], a[176:191]
    v_mfma_f32_32x32x16_bf16 a[240:255], v[164:167], v[196:199], a[240:255]
    s_waitcnt vmcnt(18) lgkmcnt(0)
    s_barrier
    v_mfma_f32_32x32x16_bf16 a[0:15], v[208:211], v[200:203], a[0:15]
    ds_read_b128 v[160:163], v5 offset:0
    ds_read_b128 v[164:167], v5 offset:2048
    v_mfma_f32_32x32x16_bf16 a[64:79], v[208:211], v[204:207], a[64:79]
    ds_read_b64_tr_b16 v[168:169], v7 offset:0
    ds_read_b64_tr_b16 v[170:171], v7 offset:1024
    s_add_u32 m0, s40, 0
    s_add_u32 s45, s57, 0
    buffer_load_dwordx4 v2, s[8:11], s45 offen lds
    v_mfma_f32_32x32x16_bf16 a[16:31], v[212:215], v[200:203], a[16:31]
    ds_read_b64_tr_b16 v[172:173], v8 offset:0
    ds_read_b64_tr_b16 v[174:175], v8 offset:1024
    v_mfma_f32_32x32x16_bf16 a[80:95], v[212:215], v[204:207], a[80:95]
    ds_read_b64_tr_b16 v[176:177], v9 offset:0
    ds_read_b64_tr_b16 v[178:179], v9 offset:1024
    v_mfma_f32_32x32x16_bf16 a[32:47], v[216:219], v[200:203], a[32:47]
    ds_read_b64_tr_b16 v[180:181], v10 offset:0
    ds_read_b64_tr_b16 v[182:183], v10 offset:1024
    v_mfma_f32_32x32x16_bf16 a[96:111], v[216:219], v[204:207], a[96:111]
    ds_read_b64_tr_b16 v[184:185], v7 offset:8192
    ds_read_b64_tr_b16 v[186:187], v7 offset:9216
    s_add_u32 m0, s40, 1024
    s_add_u32 s45, s57, 16384
    buffer_load_dwordx4 v2, s[8:11], s45 offen lds
    v_mfma_f32_32x32x16_bf16 a[48:63], v[220:223], v[200:203], a[48:63]
    ds_read_b64_tr_b16 v[188:189], v8 offset:8192
    ds_read_b64_tr_b16 v[190:191], v8 offset:9216
    v_mfma_f32_32x32x16_bf16 a[112:127], v[220:223], v[204:207], a[112:127]
    ds_read_b64_tr_b16 v[192:193], v9 offset:8192
    ds_read_b64_tr_b16 v[194:195], v9 offset:9216
    v_mfma_f32_32x32x16_bf16 a[128:143], v[200:203], v[224:227], a[128:143]
    ds_read_b64_tr_b16 v[196:197], v10 offset:8192
    ds_read_b64_tr_b16 v[198:199], v10 offset:9216
    v_mfma_f32_32x32x16_bf16 a[192:207], v[204:207], v[224:227], a[192:207]
    s_add_u32 m0, s40, 2048
    s_add_u32 s45, s57, 131072
    buffer_load_dwordx4 v2, s[8:11], s45 offen lds
    v_mfma_f32_32x32x16_bf16 a[144:159], v[200:203], v[228:231], a[144:159]
    v_mfma_f32_32x32x16_bf16 a[208:223], v[204:207], v[228:231], a[208:223]
    buffer_store_dwordx4 v[44:47], v1, s[4:7], s3 offen sc1
    s_add_u32 s3, s3, 1024
    v_mfma_f32_32x32x16_bf16 a[160:175], v[200:203], v[232:235], a[160:175]
    s_and_b32 s45, s3, 0xfff
    s_cselect_b32 s45, 0, s35
    s_cselect_b32 s35, s35, 0x20000000
    s_add_u32 s3, s3, s45
    v_mfma_f32_32x32x16_bf16 a[224:239], v[204:207], v[232:235], a[224:239]
    s_add_u32 m0, s40, 3072
    s_add_u32 s45, s57, 147456
    buffer_load_dwordx4 v2, s[8:11], s45 offen lds
    s_add_u32 s57, s57, 64
    s_and_b32 s57, s57, 0xfffffbff
    v_mfma_f32_32x32x16_bf16 a[176:191], v[200:203], v[236:239], a[176:191]
    v_mfma_f32_32x32x16_bf16 a[240:255], v[204:207], v[236:239], a[240:255]
    s_sub_u32 s41, s41, 1
    s_cmp_lg_u32 s41, 0
    s_cbranch_scc1 L_h_p1b
L_h_e1:
    s_lshl_b32 s47, s42, 19
    s_lshl_b32 s46, s32, 14
    s_add_u32 s47, s47, s46
    s_add_u32 s47, s47, 65536
    s_waitcnt lgkmcnt(0)
    s_nop 7
    s_lshl_b32 s48, s33, 2
    s_add_u32 s48, s48, s2
    v_accvgpr_read_b32 v240, a0
    v_accvgpr_read_b32 v241, a1
    v_accvgpr_read_b32 v242, a2
    v_accvgpr_read_b32 v243, a3
    v_accvgpr_read_b32 v244, a4
    v_accvgpr_read_b32 v245, a5
    v_accvgpr_read_b32 v246, a6
    v_accvgpr_read_b32 v247, a7
    v_accvgpr_read_b32 v248, a8
    v_accvgpr_read_b32 v249, a9
    v_accvgpr_read_b32 v250, a10
    v_accvgpr_read_b32 v251, a11
    v_accvgpr_read_b32 v252, a12
    v_accvgpr_read_b32 v253, a13
    v_accvgpr_read_b32 v254, a14
    v_accvgpr_read_b32 v255, a15
    v_cvt_pk_bf16_f32 v32, v240, v241
    v_cvt_pk_bf16_f32 v33, v242, v243
    v_cvt_pk_bf16_f32 v34, v244, v245
    v_cvt_pk_bf16_f32 v35, v246, v247
    v_cvt_pk_bf16_f32 v36, v248, v249
    v_cvt_pk_bf16_f32 v37, v250, v251
    v_cvt_pk_bf16_f32 v38, v252, v253
    v_cvt_pk_bf16_f32 v39, v254, v255
    s_cmp_lg_u32 s48, 1
    s_cbranch_scc1 L_h_sk000
    s_add_u32 s45, s47, 0
    buffer_store_dwordx4 v[32:35], v14, s[4:7], s45 offen offset:0 sc1
    buffer_store_dwordx4 v[36:39], v14, s[4:7], s45 offen offset:256 sc1
L_h_sk000:
    v_accvgpr_read_b32 v240, a16
    v_accvgpr_read_b32 v241, a17
    v_accvgpr_read_b32 v242, a18
    v_accvgpr_read_b32 v243, a19
    v_accvgpr_read_b32 v244, a20
    v_accvgpr_read_b32 v245, a21
    v_accvgpr_read_b32 v246, a22
    v_accvgpr_read_b32 v247, a23
    v_accvgpr_read_b32 v248, a24
    v_accvgpr_read_b32 v249, a25
    v_accvgpr_read_b32 v250, a26
    v_accvgpr_read_b32 v251, a27
    v_accvgpr_read_b32 v252, a28
    v_accvgpr_read_b32 v253, a29
    v_accvgpr_read_b32 v254, a30
    v_accvgpr_read_b32 v255, a31
    v_cvt_pk_bf16_f32 v40, v240, v241
    v_cvt_pk_bf16_f32 v41, v242, v243
    v_cvt_pk_bf16_f32 v42, v244, v245
    v_cvt_pk_bf16_f32 v43, v246, v247
    v_cvt_pk_bf16_f32 v44, v248, v249
    v_cvt_pk_bf16_f32 v45, v250, v251
    v_cvt_pk_bf16_f32 v46, v252, v253
    v_cvt_pk_bf16_f32 v47, v254, v255
    s_cmp_lg_u32 s48, 1
    s_cbranch_scc1 L_h_sk001
    s_add_u32 s45, s47, 4096
    buffer_store_dwordx4 v[40:43], v14, s[4:7], s45 offen offset:0 sc1
    buffer_store_dwordx4 v[44:47], v14, s[4:7], s45 offen offset:256 sc1
L_h_sk001:
    v_accvgpr_read_b32 v240, a32
    v_accvgpr_read_b32 v241, a33
    v_accvgpr_read_b32 v242, a34
    v_accvgpr_read_b32 v243, a35
    v_accvgpr_read_b32 v244, a36
    v_accvgpr_read_b32 v245, a37
    v_accvgpr_read_b32 v246, a38
    v_accvgpr_read_b32 v247, a39
    v_accvgpr_read_b32 v248, a40
    v_accvgpr_read_b32 v249, a41
    v_accvgpr_read_b32 v250, a42
    v_accvgpr_read_b32 v251, a43
    v_accvgpr_read_b32 v252, a44
    v_accvgpr_read_b32 v253, a45
    v_accvgpr_read_b32 v254, a46
    v_accvgpr_read_b32 v255, a47
    v_cvt_pk_bf16_f32 v48, v240, v241
    v_cvt_pk_bf16_f32 v49, v242, v243
    v_cvt_pk_bf16_f32 v50, v244, v245
    v_cvt_pk_bf16_f32 v51, v246, v247
    v_cvt_pk_bf16_f32 v52, v248, v249
    v_cvt_pk_bf16_f32 v53, v250, v251
    v_cvt_pk_bf16_f32 v54, v252, v253
    v_cvt_pk_bf16_f32 v55, v254, v255
    s_cmp_lg_u32 s48, 1
    s_cbranch_scc1 L_h_sk002
    s_add_u32 s45, s47, 8192
    buffer_store_dwordx4 v[48:51], v14, s[4:7], s45 offen offset:0 sc1
    buffer_store_dwordx4 v[52:55], v14, s[4:7], s45 offen offset:256 sc1
L_h_sk002:
    v_accvgpr_read_b32 v240, a48
    v_accvgpr_read_b32 v241, a49
    v_accvgpr_read_b32 v242, a50
    v_accvgpr_read_b32 v243, a51
    v_accvgpr_read_b32 v244, a52
    v_accvgpr_read_b32 v245, a53
    v_accvgpr_read_b32 v246, a54
    v_accvgpr_read_b32 v247, a55
    v_accvgpr_read_b32 v248, a56
    v_accvgpr_read_b32 v249, a57
    v_accvgpr_read_b32 v250, a58
    v_accvgpr_read_b32 v251, a59
    v_accvgpr_read_b32 v252, a60
    v_accvgpr_read_b32 v253, a61
    v_accvgpr_read_b32 v254, a62
    v_accvgpr_read_b32 v255, a63
    v_cvt_pk_bf16_f32 v56, v240, v241
    v_cvt_pk_bf16_f32 v57, v242, v243
    v_cvt_pk_bf16_f32 v58, v244, v245
    v_cvt_pk_bf16_f32 v59, v246, v247
    v_cvt_pk_bf16_f32 v60, v248, v249
    v_cvt_pk_bf16_f32 v61, v250, v251
    v_cvt_pk_bf16_f32 v62, v252, v253
    v_cvt_pk_bf16_f32 v63, v254, v255
    s_cmp_lg_u32 s48, 1
    s_cbranch_scc1 L_h_sk003
    s_add_u32 s45, s47, 12288
    buffer_store_dwordx4 v[56:59], v14, s[4:7], s45 offen offset:0 sc1
    buffer_store_dwordx4 v[60:63], v14, s[4:7], s45 offen offset:256 sc1
L_h_sk003:
    v_accvgpr_read_b32 v240, a128
    v_accvgpr_read_b32 v241, a129
    v_accvgpr_read_b32 v242, a130
    v_accvgpr_read_b32 v243, a131
    v_accvgpr_read_b32 v244, a132
    v_accvgpr_read_b32 v245, a133
    v_accvgpr_read_b32 v246, a134
    v_accvgpr_read_b32 v247, a135
    v_accvgpr_read_b32 v248, a136
    v_accvgpr_read_b32 v249, a137
    v_accvgpr_read_b32 v250, a138
    v_accvgpr_read_b32 v251, a139
    v_accvgpr_read_b32 v252, a140
    v_accvgpr_read_b32 v253, a141
    v_accvgpr_read_b32 v254, a142
    v_accvgpr_read_b32 v255, a143
    v_cvt_pk_bf16_f32 v96, v240, v241
    v_cvt_pk_bf16_f32 v97, v242, v243
    v_cvt_pk_bf16_f32 v98, v244, v245
    v_cvt_pk_bf16_f32 v99, v246, v247
    v_cvt_pk_bf16_f32 v100, v248, v249
    v_cvt_pk_bf16_f32 v101, v250, v251
    v_cvt_pk_bf16_f32 v102, v252, v253
    v_cvt_pk_bf16_f32 v103, v254, v255
    s_cmp_lg_u32 s48, 1
    s_cbranch_scc1 L_h_sk010
    s_add_u32 s45, s47, 0
    buffer_store_dwordx4 v[96:99], v14, s[4:7], s45 offen offset:2048 sc1
    buffer_store_dwordx4 v[100:103], v14, s[4:7], s45 offen offset:2304 sc1
L_h_sk010:
    v_accvgpr_read_b32 v240, a144
    v_accvgpr_read_b32 v241, a145
    v_accvgpr_read_b32 v242, a146
    v_accvgpr_read_b32 v243, a147
    v_accvgpr_read_b32 v244, a148
    v_accvgpr_read_b32 v245, a149
    v_accvgpr_read_b32 v246, a150
    v_accvgpr_read_b32 v247, a151
    v_accvgpr_read_b32 v248, a152
    v_accvgpr_read_b32 v249, a153
    v_accvgpr_read_b32 v250, a154
    v_accvgpr_read_b32 v251, a155
    v_accvgpr_read_b32 v252, a156
    v_accvgpr_read_b32 v253, a157
    v_accvgpr_read_b32 v254, a158
    v_accvgpr_read_b32 v255, a159
    v_cvt_pk_bf16_f32 v104, v240, v241
    v_cvt_pk_bf16_f32 v105, v242, v243
    v_cvt_pk_bf16_f32 v106, v244, v245
    v_cvt_pk_bf16_f32 v107, v246, v247
    v_cvt_pk_bf16_f32 v108, v248, v249
    v_cvt_pk_bf16_f32 v109, v250, v251
    v_cvt_pk_bf16_f32 v110, v252, v253
    v_cvt_pk_bf16_f32 v111, v254, v255
    s_cmp_lg_u32 s48, 1
    s_cbranch_scc1 L_h_sk011
    s_add_u32 s45, s47, 4096
    buffer_store_dwordx4 v[104:107], v14, s[4:7], s45 offen offset:2048 sc1
    buffer_store_dwordx4 v[108:111], v14, s[4:7], s45 offen offset:2304 sc1
L_h_sk011:
    v_accvgpr_read_b32 v240, a160
    v_accvgpr_read_b32 v241, a161
    v_accvgpr_read_b32 v242, a162
    v_accvgpr_read_b32 v243, a163
    v_accvgpr_read_b32 v244, a164
    v_accvgpr_read_b32 v245, a165
    v_accvgpr_read_b32 v246, a166
    v_accvgpr_read_b32 v247, a167
    v_accvgpr_read_b32 v248, a168
    v_accvgpr_read_b32 v249, a169
    v_accvgpr_read_b32 v250, a170
    v_accvgpr_read_b32 v251, a171
    v_accvgpr_read_b32 v252, a172
    v_accvgpr_read_b32 v253, a173
    v_accvgpr_read_b32 v254, a174
    v_accvgpr_read_b32 v255, a175
    v_cvt_pk_bf16_f32 v112, v240, v241
    v_cvt_pk_bf16_f32 v113, v242, v243
    v_cvt_pk_bf16_f32 v114, v244, v245
    v_cvt_pk_bf16_f32 v115, v246, v247
    v_cvt_pk_bf16_f32 v116, v248, v249
    v_cvt_pk_bf16_f32 v117, v250, v251
    v_cvt_pk_bf16_f32 v118, v252, v253
    v_cvt_pk_bf16_f32 v119, v254, v255
    s_cmp_lg_u32 s48, 1
    s_cbranch_scc1 L_h_sk012
    s_add_u32 s45, s47, 8192
    buffer_store_dwordx4 v[112:115], v14, s[4:7], s45 offen offset:2048 sc1
    buffer_store_dwordx4 v[116:119], v14, s[4:7], s45 offen offset:2304 sc1
L_h_sk012:
    v_accvgpr_read_b32 v240, a176
    v_accvgpr_read_b32 v241, a177
    v_accvgpr_read_b32 v242, a178
    v_accvgpr_read_b32 v243, a179
    v_accvgpr_read_b32 v244, a180
    v_accvgpr_read_b32 v245, a181
    v_accvgpr_read_b32 v246, a182
    v_accvgpr_read_b32 v247, a183
    v_accvgpr_read_b32 v248, a184
    v_accvgpr_read_b32 v249, a185
    v_accvgpr_read_b32 v250, a186
    v_accvgpr_read_b32 v251, a187
    v_accvgpr_read_b32 v252, a188
    v_accvgpr_read_b32 v253, a189
    v_accvgpr_read_b32 v254, a190
    v_accvgpr_read_b32 v255, a191
    v_cvt_pk_bf16_f32 v120, v240, v241
    v_cvt_pk_bf16_f32 v121, v242, v243
    v_cvt_pk_bf16_f32 v122, v244, v245
    v_cvt_pk_bf16_f32 v123, v246, v247
    v_cvt_pk_bf16_f32 v124, v248, v249
    v_cvt_pk_bf16_f32 v125, v250, v251
    v_cvt_pk_bf16_f32 v126, v252, v253
    v_cvt_pk_bf16_f32 v127, v254, v255
    s_cmp_lg_u32 s48, 1
    s_cbranch_scc1 L_h_sk013
    s_add_u32 s45, s47, 12288
    buffer_store_dwordx4 v[120:123], v14, s[4:7], s45 offen offset:2048 sc1
    buffer_store_dwordx4 v[124:127], v14, s[4:7], s45 offen offset:2304 sc1
L_h_sk013:
    s_cmp_eq_u32 s2, 0
    s_cbranch_scc1 L_h_j1
    s_lshl_b32 s46, s2, 2
    s_cmp_eq_u32 s48, 1
    s_cbranch_scc1 L_h_s0
    s_add_u32 s45, s47, 0
    buffer_store_dwordx4 v[32:35], v14, s[4:7], s45 offen offset:0 sc1
    buffer_store_dwordx4 v[36:39], v14, s[4:7], s45 offen offset:256 sc1
    s_add_u32 s45, s47, 4096
    buffer_store_dwordx4 v[40:43], v14, s[4:7], s45 offen offset:0 sc1
    buffer_store_dwordx4 v[44:47], v14, s[4:7], s45 offen offset:256 sc1
    s_add_u32 s45, s47, 8192
    buffer_store_dwordx4 v[48:51], v14, s[4:7], s45 offen offset:0 sc1
    buffer_store_dwordx4 v[52:55], v14, s[4:7], s45 offen offset:256 sc1
    s_add_u32 s45, s47, 12288
    buffer_store_dwordx4 v[56:59], v14, s[4:7], s45 offen offset:0 sc1
    buffer_store_dwordx4 v[60:63], v14, s[4:7], s45 offen offset:256 sc1
    s_add_u32 s45, s47, 0
    buffer_store_dwordx4 v[96:99], v14, s[4:7], s45 offen offset:2048 sc1
    buffer_store_dwordx4 v[100:103], v14, s[4:7], s45 offen offset:2304 sc1
    s_add_u32 s45, s47, 4096
    buffer_store_dwordx4 v[104:107], v14, s[4:7], s45 offen offset:2048 sc1
    buffer_store_dwordx4 v[108:111], v14, s[4:7], s45 offen offset:2304 sc1
    s_add_u32 s45, s47, 8192
    buffer_store_dwordx4 v[112:115], v14, s[4:7], s45 offen offset:2048 sc1
    buffer_store_dwordx4 v[116:119], v14, s[4:7], s45 offen offset:2304 sc1
    s_add_u32 s45, s47, 12288
    buffer_store_dwordx4 v[120:123], v14, s[4:7], s45 offen offset:2048 sc1
    buffer_store_dwordx4 v[124:127], v14, s[4:7], s45 offen offset:2304 sc1
L_h_s0:
    s_waitcnt vmcnt(0)
    s_barrier
    s_cmp_lg_u32 s33, 0
    s_cbranch_scc1 L_h_nsa
    s_lshl_b32 s45, s34, 2
    v_mov_b32 v29, 1
    s_mov_b64 exec, 1
    buffer_atomic_add v29, off, s[24:27], s46 offset:8 sc0
    v_mov_b32 v30, 32
    s_waitcnt vmcnt(0)
    v_cmp_eq_u32 vcc, 31, v29
    s_cbranch_vccz L_h_nga
    buffer_store_dword v30, off, s[24:27], s46 offset:136 sc1
L_h_nga:
    s_mov_b64 exec, -1
L_h_nsa:
    s_cmp_eq_u32 s2, 1
    s_cbranch_scc1 L_h_nj1
    s_mov_b32 s2, 0
    s_waitcnt vmcnt(0) lgkmcnt(0)
    s_branch L_h_again
L_h_j1:
    v_accvgpr_read_b32 v240, a64
    v_accvgpr_read_b32 v241, a65
    v_accvgpr_read_b32 v242, a66
    v_accvgpr_read_b32 v243, a67
    v_accvgpr_read_b32 v244, a68
    v_accvgpr_read_b32 v245, a69
    v_accvgpr_read_b32 v246, a70
    v_accvgpr_read_b32 v247, a71
    v_accvgpr_read_b32 v248, a72
    v_accvgpr_read_b32 v249, a73
    v_accvgpr_read_b32 v250, a74
    v_accvgpr_read_b32 v251, a75
    v_accvgpr_read_b32 v252, a76
    v_accvgpr_read_b32 v253, a77
    v_accvgpr_read_b32 v254, a78
    v_accvgpr_read_b32 v255, a79
    v_cvt_pk_bf16_f32 v64, v240, v241
    v_cvt_pk_bf16_f32 v65, v242, v243
    v_cvt_pk_bf16_f32 v66, v244, v245
    v_cvt_pk_bf16_f32 v67, v246, v247
    v_cvt_pk_bf16_f32 v68, v248, v249
    v_cvt_pk_bf16_f32 v69, v250, v251
    v_cvt_pk_bf16_f32 v70, v252, v253
    v_cvt_pk_bf16_f32 v71, v254, v255
    v_accvgpr_read_b32 v240, a80
    v_accvgpr_read_b32 v241, a81
    v_accvgpr_read_b32 v242, a82
    v_accvgpr_read_b32 v243, a83
    v_accvgpr_read_b32 v244, a84
    v_accvgpr_read_b32 v245, a85
    v_accvgpr_read_b32 v246, a86
    v_accvgpr_read_b32 v247, a87
    v_accvgpr_read_b32 v248, a88
    v_accvgpr_read_b32 v249, a89
    v_accvgpr_read_b32 v250, a90
    v_accvgpr_read_b32 v251, a91
    v_accvgpr_read_b32 v252, a92
    v_accvgpr_read_b32 v253, a93
    v_accvgpr_read_b32 v254, a94
    v_accvgpr_read_b32 v255, a95
    v_cvt_pk_bf16_f32 v72, v240, v241
    v_cvt_pk_bf16_f32 v73, v242, v243
    v_cvt_pk_bf16_f32 v74, v244, v245
    v_cvt_pk_bf16_f32 v75, v246, v247
    v_cvt_pk_bf16_f32 v76, v248, v249
    v_cvt_pk_bf16_f32 v77, v250, v251
    v_cvt_pk_bf16_f32 v78, v252, v253
    v_cvt_pk_bf16_f32 v79, v254, v255
    v_accvgpr_read_b32 v240, a96
    v_accvgpr_read_b32 v241, a97
    v_accvgpr_read_b32 v242, a98
    v_accvgpr_read_b32 v243, a99
    v_accvgpr_read_b32 v244, a100
    v_accvgpr_read_b32 v245, a101
    v_accvgpr_read_b32 v246, a102
    v_accvgpr_read_b32 v247, a103
    v_accvgpr_read_b32 v248, a104
    v_accvgpr_read_b32 v249, a105
    v_accvgpr_read_b32 v250, a106
    v_accvgpr_read_b32 v251, a107
    v_accvgpr_read_b32 v252, a108
    v_accvgpr_read_b32 v253, a109
    v_accvgpr_read_b32 v254, a110
    v_accvgpr_read_b32 v255, a111
    v_cvt_pk_bf16_f32 v80, v240, v241
    v_cvt_pk_bf16_f32 v81, v242, v243
    v_cvt_pk_bf16_f32 v82, v244, v245
    v_cvt_pk_bf16_f32 v83, v246, v247
    v_cvt_pk_bf16_f32 v84, v248, v249
    v_cvt_pk_bf16_f32 v85, v250, v251
    v_cvt_pk_bf16_f32 v86, v252, v253
    v_cvt_pk_bf16_f32 v87, v254, v255
    v_accvgpr_read_b32 v240, a112
    v_accvgpr_read_b32 v241, a113
    v_accvgpr_read_b32 v242, a114
    v_accvgpr_read_b32 v243, a115
    v_accvgpr_read_b32 v244, a116
    v_accvgpr_read_b32 v245, a117
    v_accvgpr_read_b32 v246, a118
    v_accvgpr_read_b32 v247, a119
    v_accvgpr_read_b32 v248, a120
    v_accvgpr_read_b32 v249, a121
    v_accvgpr_read_b32 v250, a122
    v_accvgpr_read_b32 v251, a123
    v_accvgpr_read_b32 v252, a124
    v_accvgpr_read_b32 v253, a125
    v_accvgpr_read_b32 v254, a126
    v_accvgpr_read_b32 v255, a127
    v_cvt_pk_bf16_f32 v88, v240, v241
    v_cvt_pk_bf16_f32 v89, v242, v243
    v_cvt_pk_bf16_f32 v90, v244, v245
    v_cvt_pk_bf16_f32 v91, v246, v247
    v_cvt_pk_bf16_f32 v92, v248, v249
    v_cvt_pk_bf16_f32 v93, v250, v251
    v_cvt_pk_bf16_f32 v94, v252, v253
    v_cvt_pk_bf16_f32 v95, v254, v255
    v_accvgpr_read_b32 v240, a192
    v_accvgpr_read_b32 v241, a193
    v_accvgpr_read_b32 v242, a194
    v_accvgpr_read_b32 v243, a195
    v_accvgpr_read_b32 v244, a196
    v_accvgpr_read_b32 v245, a197
    v_accvgpr_read_b32 v246, a198
    v_accvgpr_read_b32 v247, a199
    v_accvgpr_read_b32 v248, a200
    v_accvgpr_read_b32 v249, a201
    v_accvgpr_read_b32 v250, a202
    v_accvgpr_read_b32 v251, a203
    v_accvgpr_read_b32 v252, a204
    v_accvgpr_read_b32 v253, a205
    v_accvgpr_read_b32 v254, a206
    v_accvgpr_read_b32 v255, a207
    v_cvt_pk_bf16_f32 v128, v240, v241
    v_cvt_pk_bf16_f32 v129, v242, v243
    v_cvt_pk_bf16_f32 v130, v244, v245
    v_cvt_pk_bf16_f32 v131, v246, v247
    v_cvt_pk_bf16_f32 v132, v248, v249
    v_cvt_pk_bf16_f32 v133, v250, v251
    v_cvt_pk_bf16_f32 v134, v252, v253
    v_cvt_pk_bf16_f32 v135, v254, v255
    v_accvgpr_read_b32 v240, a208
    v_accvgpr_read_b32 v241, a209
    v_accvgpr_read_b32 v242, a210
    v_accvgpr_read_b32 v243, a211
    v_accvgpr_read_b32 v244, a212
    v_accvgpr_read_b32 v245, a213
    v_accvgpr_read_b32 v246, a214
    v_accvgpr_read_b32 v247, a215
    v_accvgpr_read_b32 v248, a216
    v_accvgpr_read_b32 v249, a217
    v_accvgpr_read_b32 v250, a218
    v_accvgpr_read_b32 v251, a219
    v_accvgpr_read_b32 v252, a220
    v_accvgpr_read_b32 v253, a221
    v_accvgpr_read_b32 v254, a222
    v_accvgpr_read_b32 v255, a223
    v_cvt_pk_bf16_f32 v136, v240, v241
    v_cvt_pk_bf16_f32 v137, v242, v243
    v_cvt_pk_bf16_f32 v138, v244, v245
    v_cvt_pk_bf16_f32 v139, v246, v247
    v_cvt_pk_bf16_f32 v140, v248, v249
    v_cvt_pk_bf16_f32 v141, v250, v251
    v_cvt_pk_bf16_f32 v142, v252, v253
    v_cvt_pk_bf16_f32 v143, v254, v255
    v_accvgpr_read_b32 v240, a224
    v_accvgpr_read_b32 v241, a225
    v_accvgpr_read_b32 v242, a226
    v_accvgpr_read_b32 v243, a227
    v_accvgpr_read_b32 v244, a228
    v_accvgpr_read_b32 v245, a229
    v_accvgpr_read_b32 v246, a230
    v_accvgpr_read_b32 v247, a231
    v_accvgpr_read_b32 v248, a232
    v_accvgpr_read_b32 v249, a233
    v_accvgpr_read_b32 v250, a234
    v_accvgpr_read_b32 v251, a235
    v_accvgpr_read_b32 v252, a236
    v_accvgpr_read_b32 v253, a237
    v_accvgpr_read_b32 v254, a238
    v_accvgpr_read_b32 v255, a239
    v_cvt_pk_bf16_f32 v144, v240, v241
    v_cvt_pk_bf16_f32 v145, v242, v243
    v_cvt_pk_bf16_f32 v146, v244, v245
    v_cvt_pk_bf16_f32 v147, v246, v247
    v_cvt_pk_bf16_f32 v148, v248, v249
    v_cvt_pk_bf16_f32 v149, v250, v251
    v_cvt_pk_bf16_f32 v150, v252, v253
    v_cvt_pk_bf16_f32 v151, v254, v255
    v_accvgpr_read_b32 v240, a240
    v_accvgpr_read_b32 v241, a241
    v_accvgpr_read_b32 v242, a242
    v_accvgpr_read_b32 v243, a243
    v_accvgpr_read_b32 v244, a244
    v_accvgpr_read_b32 v245, a245
    v_accvgpr_read_b32 v246, a246
    v_accvgpr_read_b32 v247, a247
    v_accvgpr_read_b32 v248, a248
    v_accvgpr_read_b32 v249, a249
    v_accvgpr_read_b32 v250, a250
    v_accvgpr_read_b32 v251, a251
    v_accvgpr_read_b32 v252, a252
    v_accvgpr_read_b32 v253, a253
    v_accvgpr_read_b32 v254, a254
    v_accvgpr_read_b32 v255, a255
    v_cvt_pk_bf16_f32 v152, v240, v241
    v_cvt_pk_bf16_f32 v153, v242, v243
    v_cvt_pk_bf16_f32 v154, v244, v245
    v_cvt_pk_bf16_f32 v155, v246, v247
    v_cvt_pk_bf16_f32 v156, v248, v249
    v_cvt_pk_bf16_f32 v157, v250, v251
    v_cvt_pk_bf16_f32 v158, v252, v253
    v_cvt_pk_bf16_f32 v159, v254, v255
L_h_nj1:
    v_accvgpr_write_b32 a0, 0
    v_accvgpr_write_b32 a1, 0
    v_accvgpr_write_b32 a2, 0
    v_accvgpr_write_b32 a3, 0
    v_accvgpr_write_b32 a4, 0
    v_accvgpr_write_b32 a5, 0
    v_accvgpr_write_b32 a6, 0
    v_accvgpr_write_b32 a7, 0
    v_accvgpr_write_b32 a8, 0
    v_accvgpr_write_b32 a9, 0
    v_accvgpr_write_b32 a10, 0
    v_accvgpr_write_b32 a11, 0
    v_accvgpr_write_b32 a12, 0
    v_accvgpr_write_b32 a13, 0
    v_accvgpr_write_b32 a14, 0
    v_accvgpr_write_b32 a15, 0
    v_accvgpr_write_b32 a16, 0
    v_accvgpr_write_b32 a17, 0
    v_accvgpr_write_b32 a18, 0
    v_accvgpr_write_b32 a19, 0
    v_accvgpr_write_b32 a20, 0
    v_accvgpr_write_b32 a21, 0
    v_accvgpr_write_b32 a22, 0
    v_accvgpr_write_b32 a23, 0
    v_accvgpr_write_b32 a24, 0
    v_accvgpr_write_b32 a25, 0
    v_accvgpr_write_b32 a26, 0
    v_accvgpr_write_b32 a27, 0
    v_accvgpr_write_b32 a28, 0
    v_accvgpr_write_b32 a29, 0
    v_accvgpr_write_b32 a30, 0
    v_accvgpr_write_b32 a31, 0
    v_accvgpr_write_b32 a32, 0
    v_accvgpr_write_b32 a33, 0
    v_accvgpr_write_b32 a34, 0
    v_accvgpr_write_b32 a35, 0
    v_accvgpr_write_b32 a36, 0
    v_accvgpr_write_b32 a37, 0
    v_accvgpr_write_b32 a38, 0
    v_accvgpr_write_b32 a39, 0
    v_accvgpr_write_b32 a40, 0
    v_accvgpr_write_b32 a41, 0
    v_accvgpr_write_b32 a42, 0
    v_accvgpr_write_b32 a43, 0
    v_accvgpr_write_b32 a44, 0
    v_accvgpr_write_b32 a45, 0
    v_accvgpr_write_b32 a46, 0
    v_accvgpr_write_b32 a47, 0
    v_accvgpr_write_b32 a48, 0
    v_accvgpr_write_b32 a49, 0
    v_accvgpr_write_b32 a50, 0
    v_accvgpr_write_b32 a51, 0
    v_accvgpr_write_b32 a52, 0
    v_accvgpr_write_b32 a53, 0
    v_accvgpr_write_b32 a54, 0
    v_accvgpr_write_b32 a55, 0
    v_accvgpr_write_b32 a56, 0
    v_accvgpr_write_b32 a57, 0
    v_accvgpr_write_b32 a58, 0
    v_accvgpr_write_b32 a59, 0
    v_accvgpr_write_b32 a60, 0
    v_accvgpr_write_b32 a61, 0
    v_accvgpr_write_b32 a62, 0
    v_accvgpr_write_b32 a63, 0
    v_accvgpr_write_b32 a64, 0
    v_accvgpr_write_b32 a65, 0
    v_accvgpr_write_b32 a66, 0
    v_accvgpr_write_b32 a67, 0
    v_accvgpr_write_b32 a68, 0
    v_accvgpr_write_b32 a69, 0
    v_accvgpr_write_b32 a70, 0
    v_accvgpr_write_b32 a71, 0
    v_accvgpr_write_b32 a72, 0
    v_accvgpr_write_b32 a73, 0
    v_accvgpr_write_b32 a74, 0
    v_accvgpr_write_b32 a75, 0
    v_accvgpr_write_b32 a76, 0
    v_accvgpr_write_b32 a77, 0
    v_accvgpr_write_b32 a78, 0
    v_accvgpr_write_b32 a79, 0
    v_accvgpr_write_b32 a80, 0
    v_accvgpr_write_b32 a81, 0
    v_accvgpr_write_b32 a82, 0
    v_accvgpr_write_b32 a83, 0
    v_accvgpr_write_b32 a84, 0
    v_accvgpr_write_b32 a85, 0
    v_accvgpr_write_b32 a86, 0
    v_accvgpr_write_b32 a87, 0
    v_accvgpr_write_b32 a88, 0
    v_accvgpr_write_b32 a89, 0
    v_accvgpr_write_b32 a90, 0
    v_accvgpr_write_b32 a91, 0
    v_accvgpr_write_b32 a92, 0
    v_accvgpr_write_b32 a93, 0
    v_accvgpr_write_b32 a94, 0
    v_accvgpr_write_b32 a95, 0
    v_accvgpr_write_b32 a96, 0
    v_accvgpr_write_b32 a97, 0
    v_accvgpr_write_b32 a98, 0
    v_accvgpr_write_b32 a99, 0
    v_accvgpr_write_b32 a100, 0
    v_accvgpr_write_b32 a101, 0
    v_accvgpr_write_b32 a102, 0
    v_accvgpr_write_b32 a103, 0
    v_accvgpr_write_b32 a104, 0
    v_accvgpr_write_b32 a105, 0
    v_accvgpr_write_b32 a106, 0
    v_accvgpr_write_b32 a107, 0
    v_accvgpr_write_b32 a108, 0
    v_accvgpr_write_b32 a109, 0
    v_accvgpr_write_b32 a110, 0
    v_accvgpr_write_b32 a111, 0
    v_accvgpr_write_b32 a112, 0
    v_accvgpr_write_b32 a113, 0
    v_accvgpr_write_b32 a114, 0
    v_accvgpr_write_b32 a115, 0
    v_accvgpr_write_b32 a116, 0
    v_accvgpr_write_b32 a117, 0
    v_accvgpr_write_b32 a118, 0
    v_accvgpr_write_b32 a119, 0
    v_accvgpr_write_b32 a120, 0
    v_accvgpr_write_b32 a121, 0
    v_accvgpr_write_b32 a122, 0
    v_accvgpr_write_b32 a123, 0
    v_accvgpr_write_b32 a124, 0
    v_accvgpr_write_b32 a125, 0
    v_accvgpr_write_b32 a126, 0
    v_accvgpr_write_b32 a127, 0
    v_accvgpr_write_b32 a128, 0
    v_accvgpr_write_b32 a129, 0
    v_accvgpr_write_b32 a130, 0
    v_accvgpr_write_b32 a131, 0
    v_accvgpr_write_b32 a132, 0
    v_accvgpr_write_b32 a133, 0
    v_accvgpr_write_b32 a134, 0
    v_accvgpr_write_b32 a135, 0
    v_accvgpr_write_b32 a136, 0
    v_accvgpr_write_b32 a137, 0
    v_accvgpr_write_b32 a138, 0
    v_accvgpr_write_b32 a139, 0
    v_accvgpr_write_b32 a140, 0
    v_accvgpr_write_b32 a141, 0
    v_accvgpr_write_b32 a142, 0
    v_accvgpr_write_b32 a143, 0
    v_accvgpr_write_b32 a144, 0
    v_accvgpr_write_b32 a145, 0
    v_accvgpr_write_b32 a146, 0
    v_accvgpr_write_b32 a147, 0
    v_accvgpr_write_b32 a148, 0
    v_accvgpr_write_b32 a149, 0
    v_accvgpr_write_b32 a150, 0
    v_accvgpr_write_b32 a151, 0
    v_accvgpr_write_b32 a152, 0
    v_accvgpr_write_b32 a153, 0
    v_accvgpr_write_b32 a154, 0
    v_accvgpr_write_b32 a155, 0
    v_accvgpr_write_b32 a156, 0
    v_accvgpr_write_b32 a157, 0
    v_accvgpr_write_b32 a158, 0
    v_accvgpr_write_b32 a159, 0
    v_accvgpr_write_b32 a160, 0
    v_accvgpr_write_b32 a161, 0
    v_accvgpr_write_b32 a162, 0
    v_accvgpr_write_b32 a163, 0
    v_accvgpr_write_b32 a164, 0
    v_accvgpr_write_b32 a165, 0
    v_accvgpr_write_b32 a166, 0
    v_accvgpr_write_b32 a167, 0
    v_accvgpr_write_b32 a168, 0
    v_accvgpr_write_b32 a169, 0
    v_accvgpr_write_b32 a170, 0
    v_accvgpr_write_b32 a171, 0
    v_accvgpr_write_b32 a172, 0
    v_accvgpr_write_b32 a173, 0
    v_accvgpr_write_b32 a174, 0
    v_accvgpr_write_b32 a175, 0
    v_accvgpr_write_b32 a176, 0
    v_accvgpr_write_b32 a177, 0
    v_accvgpr_write_b32 a178, 0
    v_accvgpr_write_b32 a179, 0
    v_accvgpr_write_b32 a180, 0
    v_accvgpr_write_b32 a181, 0
    v_accvgpr_write_b32 a182, 0
    v_accvgpr_write_b32 a183, 0
    v_accvgpr_write_b32 a184, 0
    v_accvgpr_write_b32 a185, 0
    v_accvgpr_write_b32 a186, 0
    v_accvgpr_write_b32 a187, 0
    v_accvgpr_write_b32 a188, 0
    v_accvgpr_write_b32 a189, 0
    v_accvgpr_write_b32 a190, 0
    v_accvgpr_write_b32 a191, 0
    s_lshl_b32 s45, s33, 12
    v_bfe_u32 v29, v16, 2, 2
    v_xor_b32 v29, v29, v17
    v_lshlrev_b32 v29, 4, v29
    v_lshl_add_u32 v29, v16, 6, v29
    v_add_u32 v5, s45, v29
    v_xor_b32 v6, 32, v5
    v_bfe_u32 v240, v0, 2, 1
    v_bfe_u32 v241, v0, 3, 1
    v_and_b32 v242, 3, v0
    v_lshl_add_u32 v242, v241, 2, v242
    v_lshl_add_u32 v242, v240, 3, v242
    v_bfe_u32 v243, v0, 4, 1
    v_lshlrev_b32 v243, 12, v243
    v_add_u32 v243, 24576, v243
    v_lshlrev_b32 v13, 4, v17
    v_add_u32 v13, 131072, v13
    v_bfe_u32 v29, v242, 2, 2
    v_xor_b32 v29, v29, v17
    v_lshlrev_b32 v29, 4, v29
    v_lshl_add_u32 v29, v242, 6, v29
    v_add_u32 v11, v243, v29
    v_xor_b32 v12, 32, v11
    ds_read_b128 v[160:163], v5 offset:0
    ds_read_b128 v[164:167], v5 offset:2048
    ds_read_b64_tr_b16 v[168:169], v7 offset:0
    ds_read_b64_tr_b16 v[170:171], v7 offset:1024
    ds_read_b64_tr_b16 v[172:173], v8 offset:0
    ds_read_b64_tr_b16 v[174:175], v8 offset:1024
    ds_read_b64_tr_b16 v[176:177], v9 offset:0
    ds_read_b64_tr_b16 v[178:179], v9 offset:1024
    ds_read_b64_tr_b16 v[180:181], v10 offset:0
    ds_read_b64_tr_b16 v[182:183], v10 offset:1024
    ds_read_b128 v[184:187], v11
    ds_read_b128 v[188:191], v13 offset:0
    s_lshl_b32 s48, s34, 1
    s_and_b32 s48, s48, 2
    s_sub_i32 s48, s48, -1
    s_max_i32 s48, s48, 1
    s_cmp_ge_u32 s34, 6
    s_cselect_b32 s48, 1, s48
    s_sub_u32 s44, 12, s48
    s_mov_b32 s41, s48
L_h_p20:
    s_waitcnt lgkmcnt(0)
    v_mfma_f32_32x32x16_bf16 a[0:15], v[168:171], v[160:163], a[0:15]
    ds_read_b128 v[200:203], v6 offset:0
    ds_read_b128 v[204:207], v6 offset:2048
    v_mfma_f32_32x32x16_bf16 a[64:79], v[168:171], v[164:167], a[64:79]
    ds_read_b64_tr_b16 v[208:209], v7 offset:4096
    ds_read_b64_tr_b16 v[210:211], v7 offset:5120
    s_add_u32 m0, s40, 16384
    s_mov_b32 s46, s37
    buffer_load_dwordx4 v4, s[16:19], s46 offen lds
    v_mfma_f32_32x32x16_bf16 a[16:31], v[172:175], v[160:163], a[16:31]
    ds_read_b64_tr_b16 v[212:213], v8 offset:4096
    ds_read_b64_tr_b16 v[214:215], v8 offset:5120
    v_mfma_f32_32x32x16_bf16 a[80:95], v[172:175], v[164:167], a[80:95]
    ds_read_b64_tr_b16 v[216:217], v9 offset:4096
    ds_read_b64_tr_b16 v[218:219], v9 offset:5120
    v_mfma_f32_32x32x16_bf16 a[32:47], v[176:179], v[160:163], a[32:47]
    ds_read_b64_tr_b16 v[220:221], v10 offset:4096
    ds_read_b64_tr_b16 v[222:223], v10 offset:5120
    s_add_u32 m0, s40, 17408
    s_add_u32 s46, s46, s38
    buffer_load_dwordx4 v4, s[16:19], s46 offen lds
    v_mfma_f32_32x32x16_bf16 a[96:111], v[176:179], v[164:167], a[96:111]
    ds_read_b128 v[224:227], v12
    ds_read_b128 v[228:231], v13 offset:32
    v_add_u32 v5, 0x8000, v5
    v_and_b32 v5, 0x1ffff, v5
    v_add_u32 v6, 0x8000, v6
    v_and_b32 v6, 0x1ffff, v6
    v_add_u32 v7, 0x8000, v7
    v_mfma_f32_32x32x16_bf16 a[48:63], v[180:183], v[160:163], a[48:63]
    v_and_b32 v7, 0x1ffff, v7
    v_add_u32 v8, 0x8000, v8
    v_and_b32 v8, 0x1ffff, v8
    v_add_u32 v9, 0x8000, v9
    v_and_b32 v9, 0x1ffff, v9
    v_mfma_f32_32x32x16_bf16 a[112:127], v[180:183], v[164:167], a[112:127]
    s_add_u32 m0, s40, 18432
    s_add_u32 s46, s46, s38
    buffer_load_dwordx4 v4, s[16:19], s46 offen lds
    v_mfma_f32_32x32x16_bf16 a[128:143], v[184:187], v[160:163], a[128:143]
    v_add_u32 v10, 0x8000, v10
    v_and_b32 v10, 0x1ffff, v10
    v_add_u32 v11, 0x8000, v11
    v_and_b32 v11, 0x1ffff, v11
    v_add_u32 v12, 0x8000, v12
    v_mfma_f32_32x32x16_bf16 a[144:159], v[184:187], v[164:167], a[144:159]
    v_and_b32 v12, 0x1ffff, v12
    v_add_u32 v13, 64, v13
    v_mfma_f32_32x32x16_bf16 a[160:175], v[188:191], v[160:163], a[160:175]
    s_add_u32 m0, s40, 19456
    s_add_u32 s46, s46, s38
    buffer_load_dwordx4 v4, s[16:19], s46 offen lds
    s_add_u32 s37, s37, s39
    s_add_u32 s40, s40, 32768
    s_and_b32 s40, s40, 0x1ffff
    v_mfma_f32_32x32x16_bf16 a[176:191], v[188:191], v[164:167], a[176:191]
    s_waitcnt vmcnt(16) lgkmcnt(0)
    s_barrier
    v_mfma_f32_32x32x16_bf16 a[0:15], v[208:211], v[200:203], a[0:15]
    ds_read_b128 v[160:163], v5 offset:0
    ds_read_b128 v[164:167], v5 offset:2048
    v_mfma_f32_32x32x16_bf16 a[64:79], v[208:211], v[204:207], a[64:79]
    ds_read_b64_tr_b16 v[168:169], v7 offset:0
    ds_read_b64_tr_b16 v[170:171], v7 offset:1024
    s_add_u32 m0, s40, 0
    s_add_u32 s45, s57, 0
    buffer_load_dwordx4 v2, s[8:11], s45 offen lds
    v_mfma_f32_32x32x16_bf16 a[16:31], v[212:215], v[200:203], a[16:31]
    ds_read_b64_tr_b16 v[172:173], v8 offset:0
    ds_read_b64_tr_b16 v[174:175], v8 offset:1024
    v_mfma_f32_32x32x16_bf16 a[80:95], v[212:215], v[204:207], a[80:95]
    ds_read_b64_tr_b16 v[176:177], v9 offset:0
    ds_read_b64_tr_b16 v[178:179], v9 offset:1024
    v_mfma_f32_32x32x16_bf16 a[32:47], v[216:219], v[200:203], a[32:47]
    ds_read_b64_tr_b16 v[180:181], v10 offset:0
    ds_read_b64_tr_b16 v[182:183], v10 offset:1024
    s_add_u32 m0, s40, 1024
    s_add_u32 s45, s57, 16384
    buffer_load_dwordx4 v2, s[8:11], s45 offen lds
    v_mfma_f32_32x32x16_bf16 a[96:111], v[216:219], v[204:207], a[96:111]
    ds_read_b128 v[184:187], v11
    ds_read_b128 v[188:191], v13 offset:0
    v_mfma_f32_32x32x16_bf16 a[48:63], v[220:223], v[200:203], a[48:63]
    v_mfma_f32_32x32x16_bf16 a[112:127], v[220:223], v[204:207], a[112:127]
    s_add_u32 m0, s40, 2048
    s_add_u32 s45, s57, 131072
    buffer_load_dwordx4 v2, s[8:11], s45 offen lds
    v_mfma_f32_32x32x16_bf16 a[128:143], v[224:227], v[200:203], a[128:143]
    v_mfma_f32_32x32x16_bf16 a[144:159], v[224:227], v[204:207], a[144:159]
    v_mfma_f32_32x32x16_bf16 a[160:175], v[228:231], v[200:203], a[160:175]
    s_add_u32 m0, s40, 3072
    s_add_u32 s45, s57, 147456
    buffer_load_dwordx4 v2, s[8:11], s45 offen lds
    s_add_u32 s57, s57, 64
    s_and_b32 s57, s57, 0xfffffbff
    v_mfma_f32_32x32x16_bf16 a[176:191], v[228:231], v[204:207], a[176:191]
    s_sub_u32 s41, s41, 1
    s_cmp_lg_u32 s41, 0
    s_cbranch_scc1 L_h_p20
    s_cmp_eq_u32 s2, 0
    s_cbranch_scc1 L_h_st
    s_cmp_lg_u32 s33, 0
    s_cbranch_scc1 L_h_l1
L_h_l0:
    buffer_load_dword v29, off, s[24:27], 0 offset:144 sc1
    s_waitcnt vmcnt(0)
    v_cmp_eq_u32 vcc, 0, v29
    s_cbranch_vccz L_h_l1
    s_add_u32 s43, s43, 1
    s_cmp_gt_u32 s43, 1000000
    s_cbranch_scc1 L_end
    s_sleep 8
    s_branch L_h_l0
L_h_l1:
    s_barrier
    s_add_u32 s45, s47, 2097152
    buffer_load_dwordx4 v[64:67], v14, s[4:7], s45 offen offset:0 sc1
    buffer_load_dwordx4 v[68:71], v14, s[4:7], s45 offen offset:256 sc1
    s_add_u32 s45, s47, 2101248
    buffer_load_dwordx4 v[72:75], v14, s[4:7], s45 offen offset:0 sc1
    buffer_load_dwordx4 v[76:79], v14, s[4:7], s45 offen offset:256 sc1
    s_add_u32 s45, s47, 2105344
    buffer_load_dwordx4 v[80:83], v14, s[4:7], s45 offen offset:0 sc1
    buffer_load_dwordx4 v[84:87], v14, s[4:7], s45 offen offset:256 sc1
    s_add_u32 s45, s47, 2109440
    buffer_load_dwordx4 v[88:91], v14, s[4:7], s45 offen offset:0 sc1
    buffer_load_dwordx4 v[92:95], v14, s[4:7], s45 offen offset:256 sc1
    s_add_u32 s45, s47, 2097152
    buffer_load_dwordx4 v[128:131], v14, s[4:7], s45 offen offset:2048 sc1
    buffer_load_dwordx4 v[132:135], v14, s[4:7], s45 offen offset:2304 sc1
    s_add_u32 s45, s47, 2101248
    buffer_load_dwordx4 v[136:139], v14, s[4:7], s45 offen offset:2048 sc1
    buffer_load_dwordx4 v[140:143], v14, s[4:7], s45 offen offset:2304 sc1
    s_add_u32 s45, s47, 2105344
    buffer_load_dwordx4 v[144:147], v14, s[4:7], s45 offen offset:2048 sc1
    buffer_load_dwordx4 v[148:151], v14, s[4:7], s45 offen offset:2304 sc1
    s_add_u32 s45, s47, 2109440
    buffer_load_dwordx4 v[152:155], v14, s[4:7], s45 offen offset:2048 sc1
    buffer_load_dwordx4 v[156:159], v14, s[4:7], s45 offen offset:2304 sc1
    s_mov_b32 s2, 0
    s_branch L_h_nsc
L_h_st:
    s_add_u32 s45, s47, 0
    buffer_store_dwordx4 v[32:35], v14, s[4:7], s45 offen offset:0 sc1
    buffer_store_dwordx4 v[36:39], v14, s[4:7], s45 offen offset:256 sc1
    s_add_u32 s45, s47, 4096
    buffer_store_dwordx4 v[40:43], v14, s[4:7], s45 offen offset:0 sc1
    buffer_store_dwordx4 v[44:47], v14, s[4:7], s45 offen offset:256 sc1
    s_add_u32 s45, s47, 8192
    buffer_store_dwordx4 v[48:51], v14, s[4:7], s45 offen offset:0 sc1
    buffer_store_dwordx4 v[52:55], v14, s[4:7], s45 offen offset:256 sc1
    s_add_u32 s45, s47, 12288
    buffer_store_dwordx4 v[56:59], v14, s[4:7], s45 offen offset:0 sc1
    buffer_store_dwordx4 v[60:63], v14, s[4:7], s45 offen offset:256 sc1
    s_add_u32 s45, s47, 0
    buffer_store_dwordx4 v[96:99], v14, s[4:7], s45 offen offset:2048 sc1
    buffer_store_dwordx4 v[100:103], v14, s[4:7], s45 offen offset:2304 sc1
    s_add_u32 s45, s47, 4096
    buffer_store_dwordx4 v[104:107], v14, s[4:7], s45 offen offset:2048 sc1
    buffer_store_dwordx4 v[108:111], v14, s[4:7], s45 offen offset:2304 sc1
    s_add_u32 s45, s47, 8192
    buffer_store_dwordx4 v[112:115], v14, s[4:7], s45 offen offset:2048 sc1
    buffer_store_dwordx4 v[116:119], v14, s[4:7], s45 offen offset:2304 sc1
    s_add_u32 s45, s47, 12288
    buffer_store_dwordx4 v[120:123], v14, s[4:7], s45 offen offset:2048 sc1
    buffer_store_dwordx4 v[124:127], v14, s[4:7], s45 offen offset:2304 sc1
    s_add_u32 s45, s47, 2097152
    buffer_store_dwordx4 v[64:67], v14, s[4:7], s45 offen offset:0 sc1
    buffer_store_dwordx4 v[68:71], v14, s[4:7], s45 offen offset:256 sc1
    s_add_u32 s45, s47, 2101248
    buffer_store_dwordx4 v[72:75], v14, s[4:7], s45 offen offset:0 sc1
    buffer_store_dwordx4 v[76:79], v14, s[4:7], s45 offen offset:256 sc1
    s_add_u32 s45, s47, 2105344
    buffer_store_dwordx4 v[80:83], v14, s[4:7], s45 offen offset:0 sc1
    buffer_store_dwordx4 v[84:87], v14, s[4:7], s45 offen offset:256 sc1
    s_add_u32 s45, s47, 2109440
    buffer_store_dwordx4 v[88:91], v14, s[4:7], s45 offen offset:0 sc1
    buffer_store_dwordx4 v[92:95], v14, s[4:7], s45 offen offset:256 sc1
    s_add_u32 s45, s47, 2097152
    buffer_store_dwordx4 v[128:131], v14, s[4:7], s45 offen offset:2048 sc1
    buffer_store_dwordx4 v[132:135], v14, s[4:7], s45 offen offset:2304 sc1
    s_add_u32 s45, s47, 2101248
    buffer_store_dwordx4 v[136:139], v14, s[4:7], s45 offen offset:2048 sc1
    buffer_store_dwordx4 v[140:143], v14, s[4:7], s45 offen offset:2304 sc1
    s_add_u32 s45, s47, 2105344
    buffer_store_dwordx4 v[144:147], v14, s[4:7], s45 offen offset:2048 sc1
    buffer_store_dwordx4 v[148:151], v14, s[4:7], s45 offen offset:2304 sc1
    s_add_u32 s45, s47, 2109440
    buffer_store_dwordx4 v[152:155], v14, s[4:7], s45 offen offset:2048 sc1
    buffer_store_dwordx4 v[156:159], v14, s[4:7], s45 offen offset:2304 sc1
    s_waitcnt vmcnt(0)
    s_barrier
    s_cmp_lg_u32 s33, 0
    s_cbranch_scc1 L_h_nsc
    s_lshl_b32 s45, s34, 2
    v_mov_b32 v29, 1
    s_mov_b64 exec, 1
    buffer_atomic_add v29, off, s[24:27], s45 offset:16 sc0
    v_mov_b32 v30, 32
    s_waitcnt vmcnt(0)
    v_cmp_eq_u32 vcc, 31, v29
    s_cbranch_vccz L_h_ngc
    buffer_store_dword v30, off, s[24:27], s45 offset:144 sc1
L_h_ngc:
    s_mov_b64 exec, -1
L_h_nsc:
    s_mov_b32 s41, s44
L_h_p2a:
    s_waitcnt lgkmcnt(0)
    v_mfma_f32_32x32x16_bf16 a[0:15], v[168:171], v[160:163], a[0:15]
    ds_read_b128 v[200:203], v6 offset:0
    ds_read_b128 v[204:207], v6 offset:2048
    v_mfma_f32_32x32x16_bf16 a[64:79], v[168:171], v[164:167], a[64:79]
    ds_read_b64_tr_b16 v[208:209], v7 offset:4096
    ds_read_b64_tr_b16 v[210:211], v7 offset:5120
    s_add_u32 m0, s40, 16384
    s_mov_b32 s46, s37
    buffer_load_dwordx4 v4, s[16:19], s46 offen lds
    v_mfma_f32_32x32x16_bf16 a[16:31], v[172:175], v[160:163], a[16:31]
    ds_read_b64_tr_b16 v[212:213], v8 offset:4096
    ds_read_b64_tr_b16 v[214:215], v8 offset:5120
    v_mfma_f32_32x32x16_bf16 a[80:95], v[172:175], v[164:167], a[80:95]
    ds_read_b64_tr_b16 v[216:217], v9 offset:4096
    ds_read_b64_tr_b16 v[218:219], v9 offset:5120
    v_mfma_f32_32x32x16_bf16 a[32:47], v[176:179], v[160:163], a[32:47]
    ds_read_b64_tr_b16 v[220:221], v10 offset:4096
    ds_read_b64_tr_b16 v[222:223], v10 offset:5120
    s_add_u32 m0, s40, 17408
    s_add_u32 s46, s46, s38
    buffer_load_dwordx4 v4, s[16:19], s46 offen lds
    v_mfma_f32_32x32x16_bf16 a[96:111], v[176:179], v[164:167], a[96:111]
    ds_read_b128 v[224:227], v12
    ds_read_b128 v[228:231], v13 offset:32
    v_add_u32 v5, 0x8000, v5
    v_and_b32 v5, 0x1ffff, v5
    v_add_u32 v6, 0x8000, v6
    v_and_b32 v6, 0x1ffff, v6
    v_add_u32 v7, 0x8000, v7
    v_mfma_f32_32x32x16_bf16 a[48:63], v[180:183], v[160:163], a[48:63]
    v_and_b32 v7, 0x1ffff, v7
    v_add_u32 v8, 0x8000, v8
    v_and_b32 v8, 0x1ffff, v8
    v_add_u32 v9, 0x8000, v9
    v_and_b32 v9, 0x1ffff, v9
    v_mfma_f32_32x32x16_bf16 a[112:127], v[180:183], v[164:167], a[112:127]
    s_add_u32 m0, s40, 18432
    s_add_u32 s46, s46, s38
    buffer_load_dwordx4 v4, s[16:19], s46 offen lds
    v_mfma_f32_32x32x16_bf16 a[128:143], v[184:187], v[160:163], a[128:143]
    v_add_u32 v10, 0x8000, v10
    v_and_b32 v10, 0x1ffff, v10
    v_add_u32 v11, 0x8000, v11
    v_and_b32 v11, 0x1ffff, v11
    v_add_u32 v12, 0x8000, v12
    v_mfma_f32_32x32x16_bf16 a[144:159], v[184:187], v[164:167], a[144:159]
    v_and_b32 v12, 0x1ffff, v12
    v_add_u32 v13, 64, v13
    v_mfma_f32_32x32x16_bf16 a[160:175], v[188:191], v[160:163], a[160:175]
    s_add_u32 m0, s40, 19456
    s_add_u32 s46, s46, s38
    buffer_load_dwordx4 v4, s[16:19], s46 offen lds
    s_add_u32 s37, s37, s39
    s_add_u32 s40, s40, 32768
    s_and_b32 s40, s40, 0x1ffff
    v_mfma_f32_32x32x16_bf16 a[176:191], v[188:191], v[164:167], a[176:191]
    s_waitcnt vmcnt(16) lgkmcnt(0)
    s_barrier
    v_mfma_f32_32x32x16_bf16 a[0:15], v[208:211], v[200:203], a[0:15]
    ds_read_b128 v[160:163], v5 offset:0
    ds_read_b128 v[164:167], v5 offset:2048
    v_mfma_f32_32x32x16_bf16 a[64:79], v[208:211], v[204:207], a[64:79]
    ds_read_b64_tr_b16 v[168:169], v7 offset:0
    ds_read_b64_tr_b16 v[170:171], v7 offset:1024
    s_add_u32 m0, s40, 0
    s_add_u32 s45, s57, 0
    buffer_load_dwordx4 v2, s[8:11], s45 offen lds
    v_mfma_f32_32x32x16_bf16 a[16:31], v[212:215], v[200:203], a[16:31]
    ds_read_b64_tr_b16 v[172:173], v8 offset:0
    ds_read_b64_tr_b16 v[174:175], v8 offset:1024
    v_mfma_f32_32x32x16_bf16 a[80:95], v[212:215], v[204:207], a[80:95]
    ds_read_b64_tr_b16 v[176:177], v9 offset:0
    ds_read_b64_tr_b16 v[178:179], v9 offset:1024
    v_mfma_f32_32x32x16_bf16 a[32:47], v[216:219], v[200:203], a[32:47]
    ds_read_b64_tr_b16 v[180:181], v10 offset:0
    ds_read_b64_tr_b16 v[182:183], v10 offset:1024
    s_add_u32 m0, s40, 1024
    s_add_u32 s45, s57, 16384
    buffer_load_dwordx4 v2, s[8:11], s45 offen lds
    v_mfma_f32_32x32x16_bf16 a[96:111], v[216:219], v[204:207], a[96:111]
    ds_read_b128 v[184:187], v11
    ds_read_b128 v[188:191], v13 offset:0
    v_mfma_f32_32x32x16_bf16 a[48:63], v[220:223], v[200:203], a[48:63]
    v_mfma_f32_32x32x16_bf16 a[112:127], v[220:223], v[204:207], a[112:127]
    s_add_u32 m0, s40, 2048
    s_add_u32 s45, s57, 131072
    buffer_load_dwordx4 v2, s[8:11], s45 offen lds
    v_mfma_f32_32x32x16_bf16 a[128:143], v[224:227], v[200:203], a[128:143]
    v_mfma_f32_32x32x16_bf16 a[144:159], v[224:227], v[204:207], a[144:159]
    v_mfma_f32_32x32x16_bf16 a[160:175], v[228:231], v[200:203], a[160:175]
    s_add_u32 m0, s40, 3072
    s_add_u32 s45, s57, 147456
    buffer_load_dwordx4 v2, s[8:11], s45 offen lds
    s_add_u32 s57, s57, 64
    s_and_b32 s57, s57, 0xfffffbff
    v_mfma_f32_32x32x16_bf16 a[176:191], v[228:231], v[204:207], a[176:191]
    s_sub_u32 s41, s41, 1
    s_cmp_lg_u32 s41, 0
    s_cbranch_scc1 L_h_p2a
    s_waitcnt lgkmcnt(0)
    v_mfma_f32_32x32x16_bf16 a[0:15], v[168:171], v[160:163], a[0:15]
    ds_read_b128 v[200:203], v6 offset:0
    ds_read_b128 v[204:207], v6 offset:2048
    v_mfma_f32_32x32x16_bf16 a[64:79], v[168:171], v[164:167], a[64:79]
    ds_read_b64_tr_b16 v[208:209], v7 offset:4096
    ds_read_b64_tr_b16 v[210:211], v7 offset:5120
    s_add_u32 m0, s40, 16384
    s_mov_b32 s46, s37
    buffer_load_dwordx4 v4, s[16:19], s46 offen lds
    v_mfma_f32_32x32x16_bf16 a[16:31], v[172:175], v[160:163], a[16:31]
    ds_read_b64_tr_b16 v[212:213], v8 offset:4096
    ds_read_b64_tr_b16 v[214:215], v8 offset:5120
    v_mfma_f32_32x32x16_bf16 a[80:95], v[172:175], v[164:167], a[80:95]
    ds_read_b64_tr_b16 v[216:217], v9 offset:4096
    ds_read_b64_tr_b16 v[218:219], v9 offset:5120
    v_mfma_f32_32x32x16_bf16 a[32:47], v[176:179], v[160:163], a[32:47]
    ds_read_b64_tr_b16 v[220:221], v10 offset:4096
    ds_read_b64_tr_b16 v[222:223], v10 offset:5120
    s_add_u32 m0, s40, 17408
    s_add_u32 s46, s46, s38
    buffer_load_dwordx4 v4, s[16:19], s46 offen lds
    v_mfma_f32_32x32x16_bf16 a[96:111], v[176:179], v[164:167], a[96:111]
    ds_read_b128 v[224:227], v12
    ds_read_b128 v[228:231], v13 offset:32
    v_add_u32 v5, 0x8000, v5
    v_and_b32 v5, 0x1ffff, v5
    v_add_u32 v6, 0x8000, v6
    v_and_b32 v6, 0x1ffff, v6
    v_add_u32 v7, 0x8000, v7
    v_mfma_f32_32x32x16_bf16 a[48:63], v[180:183], v[160:163], a[48:63]
    v_and_b32 v7, 0x1ffff, v7
    v_add_u32 v8, 0x8000, v8
    v_and_b32 v8, 0x1ffff, v8
    v_add_u32 v9, 0x8000, v9
    v_and_b32 v9, 0x1ffff, v9
    v_mfma_f32_32x32x16_bf16 a[112:127], v[180:183], v[164:167], a[112:127]
    s_add_u32 m0, s40, 18432
    s_add_u32 s46, s46, s38
    buffer_load_dwordx4 v4, s[16:19], s46 offen lds
    v_mfma_f32_32x32x16_bf16 a[128:143], v[184:187], v[160:163], a[128:143]
    v_add_u32 v10, 0x8000, v10
    v_and_b32 v10, 0x1ffff, v10
    v_add_u32 v11, 0x8000, v11
    v_and_b32 v11, 0x1ffff, v11
    v_add_u32 v12, 0x8000, v12
    v_mfma_f32_32x32x16_bf16 a[144:159], v[184:187], v[164:167], a[144:159]
    v_and_b32 v12, 0x1ffff, v12
    v_add_u32 v13, 64, v13
    v_mfma_f32_32x32x16_bf16 a[160:175], v[188:191], v[160:163], a[160:175]
    s_add_u32 m0, s40, 19456
    s_add_u32 s46, s46, s38
    buffer_load_dwordx4 v4, s[16:19], s46 offen lds
    s_add_u32 s37, s37, s39
    s_add_u32 s40, s40, 32768
    s_and_b32 s40, s40, 0x1ffff
    v_mfma_f32_32x32x16_bf16 a[176:191], v[188:191], v[164:167], a[176:191]
    s_waitcnt vmcnt(16) lgkmcnt(0)
    s_barrier
    v_mfma_f32_32x32x16_bf16 a[0:15], v[208:211], v[200:203], a[0:15]
    ds_read_b128 v[160:163], v5 offset:0
    ds_read_b128 v[164:167], v5 offset:2048
    v_mfma_f32_32x32x16_bf16 a[64:79], v[208:211], v[204:207], a[64:79]
    ds_read_b64_tr_b16 v[168:169], v7 offset:0
    ds_read_b64_tr_b16 v[170:171], v7 offset:1024
    s_add_u32 m0, s40, 0
    s_add_u32 s45, s49, 0
    buffer_load_dwordx4 v20, s[20:23], s45 offen lds
    v_mfma_f32_32x32x16_bf16 a[16:31], v[212:215], v[200:203], a[16:31]
    ds_read_b64_tr_b16 v[172:173], v8 offset:0
    ds_read_b64_tr_b16 v[174:175], v8 offset:1024
    v_mfma_f32_32x32x16_bf16 a[80:95], v[212:215], v[204:207], a[80:95]
    ds_read_b64_tr_b16 v[176:177], v9 offset:0
    ds_read_b64_tr_b16 v[178:179], v9 offset:1024
    v_mfma_f32_32x32x16_bf16 a[32:47], v[216:219], v[200:203], a[32:47]
    ds_read_b64_tr_b16 v[180:181], v10 offset:0
    ds_read_b64_tr_b16 v[182:183], v10 offset:1024
    s_add_u32 m0, s40, 1024
    s_add_u32 s45, s49, 1024
    buffer_load_dwordx4 v21, s[20:23], s45 offen lds
    v_mfma_f32_32x32x16_bf16 a[96:111], v[216:219], v[204:207], a[96:111]
    ds_read_b128 v[184:187], v11
    ds_read_b128 v[188:191], v13 offset:0
    v_mfma_f32_32x32x16_bf16 a[48:63], v[220:223], v[200:203], a[48:63]
    v_mfma_f32_32x32x16_bf16 a[112:127], v[220:223], v[204:207], a[112:127]
    s_add_u32 m0, s40, 2048
    s_add_u32 s45, s49, 2048
    buffer_load_dwordx4 v22, s[20:23], s45 offen lds
    v_mfma_f32_32x32x16_bf16 a[128:143], v[224:227], v[200:203], a[128:143]
    v_mfma_f32_32x32x16_bf16 a[144:159], v[224:227], v[204:207], a[144:159]
    v_mfma_f32_32x32x16_bf16 a[160:175], v[228:231], v[200:203], a[160:175]
    s_add_u32 m0, s40, 3072
    s_add_u32 s45, s49, 3072
    buffer_load_dwordx4 v23, s[20:23], s45 offen lds
    v_mfma_f32_32x32x16_bf16 a[176:191], v[228:231], v[204:207], a[176:191]
    s_mov_b32 s41, 3
L_h_p2b:
    s_waitcnt lgkmcnt(0)
    v_mfma_f32_32x32x16_bf16 a[0:15], v[168:171], v[160:163], a[0:15]
    ds_read_b128 v[200:203], v6 offset:0
    ds_read_b128 v[204:207], v6 offset:2048
    v_mfma_f32_32x32x16_bf16 a[64:79], v[168:171], v[164:167], a[64:79]
    ds_read_b64_tr_b16 v[208:209], v7 offset:4096
    ds_read_b64_tr_b16 v[210:211], v7 offset:5120
    s_add_u32 m0, s40, 16384
    s_add_u32 s45, s49, 16384
    buffer_load_dwordx4 v20, s[20:23], s45 offen lds
    v_mfma_f32_32x32x16_bf16 a[16:31], v[172:175], v[160:163], a[16:31]
    ds_read_b64_tr_b16 v[212:213], v8 offset:4096
    ds_read_b64_tr_b16 v[214:215], v8 offset:5120
    v_mfma_f32_32x32x16_bf16 a[80:95], v[172:175], v[164:167], a[80:95]
    ds_read_b64_tr_b16 v[216:217], v9 offset:4096
    ds_read_b64_tr_b16 v[218:219], v9 offset:5120
    v_mfma_f32_32x32x16_bf16 a[32:47], v[176:179], v[160:163], a[32:47]
    ds_read_b64_tr_b16 v[220:221], v10 offset:4096
    ds_read_b64_tr_b16 v[222:223], v10 offset:5120
    s_add_u32 m0, s40, 17408
    s_add_u32 s45, s49, 17408
    buffer_load_dwordx4 v21, s[20:23], s45 offen lds
    v_mfma_f32_32x32x16_bf16 a[96:111], v[176:179], v[164:167], a[96:111]
    ds_read_b128 v[224:227], v12
    ds_read_b128 v[228:231], v13 offset:32
    v_add_u32 v5, 0x8000, v5
    v_and_b32 v5, 0x1ffff, v5
    v_add_u32 v6, 0x8000, v6
    v_and_b32 v6, 0x1ffff, v6
    v_add_u32 v7, 0x8000, v7
    v_mfma_f32_32x32x16_bf16 a[48:63], v[180:183], v[160:163], a[48:63]
    v_and_b32 v7, 0x1ffff, v7
    v_add_u32 v8, 0x8000, v8
    v_and_b32 v8, 0x1ffff, v8
    v_add_u32 v9, 0x8000, v9
    v_and_b32 v9, 0x1ffff, v9
    v_mfma_f32_32x32x16_bf16 a[112:127], v[180:183], v[164:167], a[112:127]
    s_add_u32 m0, s40, 18432
    s_add_u32 s45, s49, 18432
    buffer_load_dwordx4 v22, s[20:23], s45 offen lds
    v_mfma_f32_32x32x16_bf16 a[128:143], v[184:187], v[160:163], a[128:143]
    v_add_u32 v10, 0x8000, v10
    v_and_b32 v10, 0x1ffff, v10
    v_add_u32 v11, 0x8000, v11
    v_and_b32 v11, 0x1ffff, v11
    v_add_u32 v12, 0x8000, v12
    v_mfma_f32_32x32x16_bf16 a[144:159], v[184:187], v[164:167], a[144:159]
    v_and_b32 v12, 0x1ffff, v12
    v_add_u32 v13, 64, v13
    v_mfma_f32_32x32x16_bf16 a[160:175], v[188:191], v[160:163], a[160:175]
    s_add_u32 m0, s40, 19456
    s_add_u32 s45, s49, 19456
    buffer_load_dwordx4 v23, s[20:23], s45 offen lds
    s_add_u32 s49, s49, 32768
    s_add_u32 s40, s40, 32768
    s_and_b32 s40, s40, 0x1ffff
    v_mfma_f32_32x32x16_bf16 a[176:191], v[188:191], v[164:167], a[176:191]
    s_waitcnt vmcnt(16) lgkmcnt(0)
    s_barrier
    v_mfma_f32_32x32x16_bf16 a[0:15], v[208:211], v[200:203], a[0:15]
    ds_read_b128 v[160:163], v5 offset:0
    ds_read_b128 v[164:167], v5 offset:2048
    v_mfma_f32_32x32x16_bf16 a[64:79], v[208:211], v[204:207], a[64:79]
    ds_read_b64_tr_b16 v[168:169], v7 offset:0
    ds_read_b64_tr_b16 v[170:171], v7 offset:1024
    s_add_u32 m0, s40, 0
    s_add_u32 s45, s49, 0
    buffer_load_dwordx4 v20, s[20:23], s45 offen lds
    v_mfma_f32_32x32x16_bf16 a[16:31], v[212:215], v[200:203], a[16:31]
    ds_read_b64_tr_b16 v[172:173], v8 offset:0
    ds_read_b64_tr_b16 v[174:175], v8 offset:1024
    v_mfma_f32_32x32x16_bf16 a[80:95], v[212:215], v[204:207], a[80:95]
    ds_read_b64_tr_b16 v[176:177], v9 offset:0
    ds_read_b64_tr_b16 v[178:179], v9 offset:1024
    v_mfma_f32_32x32x16_bf16 a[32:47], v[216:219], v[200:203], a[32:47]
    ds_read_b64_tr_b16 v[180:181], v10 offset:0
    ds_read_b64_tr_b16 v[182:183], v10 offset:1024
    s_add_u32 m0, s40, 1024
    s_add_u32 s45, s49, 1024
    buffer_load_dwordx4 v21, s[20:23], s45 offen lds
    v_mfma_f32_32x32x16_bf16 a[96:111], v[216:219], v[204:207], a[96:111]
    ds_read_b128 v[184:187], v11
    ds_read_b128 v[188:191], v13 offset:0
    v_mfma_f32_32x32x16_bf16 a[48:63], v[220:223], v[200:203], a[48:63]
    v_mfma_f32_32x32x16_bf16 a[112:127], v[220:223], v[204:207], a[112:127]
    s_add_u32 m0, s40, 2048
    s_add_u32 s45, s49, 2048
    buffer_load_dwordx4 v22, s[20:23], s45 offen lds
    v_mfma_f32_32x32x16_bf16 a[128:143], v[224:227], v[200:203], a[128:143]
    v_mfma_f32_32x32x16_bf16 a[144:159], v[224:227], v[204:207], a[144:159]
    v_mfma_f32_32x32x16_bf16 a[160:175], v[228:231], v[200:203], a[160:175]
    s_add_u32 m0, s40, 3072
    s_add_u32 s45, s49, 3072
    buffer_load_dwordx4 v23, s[20:23], s45 offen lds
    v_mfma_f32_32x32x16_bf16 a[176:191], v[228:231], v[204:207], a[176:191]
    s_sub_u32 s41, s41, 1
    s_cmp_lg_u32 s41, 0
    s_cbranch_scc1 L_h_p2b
    s_add_u32 m0, s40, 16384
    s_add_u32 s45, s49, 16384
    buffer_load_dwordx4 v20, s[20:23], s45 offen lds
    s_add_u32 m0, s40, 17408
    s_add_u32 s45, s49, 17408
    buffer_load_dwordx4 v21, s[20:23], s45 offen lds
    s_add_u32 m0, s40, 18432
    s_add_u32 s45, s49, 18432
    buffer_load_dwordx4 v22, s[20:23], s45 offen lds
    s_add_u32 m0, s40, 19456
    s_add_u32 s45, s49, 19456
    buffer_load_dwordx4 v23, s[20:23], s45 offen lds
    s_add_u32 s49, s49, 32768
    s_add_u32 s40, s40, 32768
    s_and_b32 s40, s40, 0x1ffff
    s_waitcnt lgkmcnt(0)
    s_nop 7
    v_accvgpr_read_b32 v240, a0
    v_accvgpr_read_b32 v241, a1
    v_accvgpr_read_b32 v242, a2
    v_accvgpr_read_b32 v243, a3
    v_accvgpr_read_b32 v244, a4
    v_accvgpr_read_b32 v245, a5
    v_accvgpr_read_b32 v246, a6
    v_accvgpr_read_b32 v247, a7
    v_accvgpr_read_b32 v248, a8
    v_accvgpr_read_b32 v249, a9
    v_accvgpr_read_b32 v250, a10
    v_accvgpr_read_b32 v251, a11
    v_accvgpr_read_b32 v252, a12
    v_accvgpr_read_b32 v253, a13
    v_accvgpr_read_b32 v254, a14
    v_accvgpr_read_b32 v255, a15
    v_cvt_pk_bf16_f32 v160, v240, v241
    v_cvt_pk_bf16_f32 v161, v242, v243
    v_cvt_pk_bf16_f32 v162, v244, v245
    v_cvt_pk_bf16_f32 v163, v246, v247
    v_cvt_pk_bf16_f32 v164, v248, v249
    v_cvt_pk_bf16_f32 v165, v250, v251
    v_cvt_pk_bf16_f32 v166, v252, v253
    v_cvt_pk_bf16_f32 v167, v254, v255
    v_accvgpr_read_b32 v240, a16
    v_accvgpr_read_b32 v241, a17
    v_accvgpr_read_b32 v242, a18
    v_accvgpr_read_b32 v243, a19
    v_accvgpr_read_b32 v244, a20
    v_accvgpr_read_b32 v245, a21
    v_accvgpr_read_b32 v246, a22
    v_accvgpr_read_b32 v247, a23
    v_accvgpr_read_b32 v248, a24
    v_accvgpr_read_b32 v249, a25
    v_accvgpr_read_b32 v250, a26
    v_accvgpr_read_b32 v251, a27
    v_accvgpr_read_b32 v252, a28
    v_accvgpr_read_b32 v253, a29
    v_accvgpr_read_b32 v254, a30
    v_accvgpr_read_b32 v255, a31
    v_cvt_pk_bf16_f32 v168, v240, v241
    v_cvt_pk_bf16_f32 v169, v242, v243
    v_cvt_pk_bf16_f32 v170, v244, v245
    v_cvt_pk_bf16_f32 v171, v246, v247
    v_cvt_pk_bf16_f32 v172, v248, v249
    v_cvt_pk_bf16_f32 v173, v250, v251
    v_cvt_pk_bf16_f32 v174, v252, v253
    v_cvt_pk_bf16_f32 v175, v254, v255
    v_accvgpr_read_b32 v240, a32
    v_accvgpr_read_b32 v241, a33
    v_accvgpr_read_b32 v242, a34
    v_accvgpr_read_b32 v243, a35
    v_accvgpr_read_b32 v244, a36
    v_accvgpr_read_b32 v245, a37
    v_accvgpr_read_b32 v246, a38
    v_accvgpr_read_b32 v247, a39
    v_accvgpr_read_b32 v248, a40
    v_accvgpr_read_b32 v249, a41
    v_accvgpr_read_b32 v250, a42
    v_accvgpr_read_b32 v251, a43
    v_accvgpr_read_b32 v252, a44
    v_accvgpr_read_b32 v253, a45
    v_accvgpr_read_b32 v254, a46
    v_accvgpr_read_b32 v255, a47
    v_cvt_pk_bf16_f32 v176, v240, v241
    v_cvt_pk_bf16_f32 v177, v242, v243
    v_cvt_pk_bf16_f32 v178, v244, v245
    v_cvt_pk_bf16_f32 v179, v246, v247
    v_cvt_pk_bf16_f32 v180, v248, v249
    v_cvt_pk_bf16_f32 v181, v250, v251
    v_cvt_pk_bf16_f32 v182, v252, v253
    v_cvt_pk_bf16_f32 v183, v254, v255
    v_accvgpr_read_b32 v240, a48
    v_accvgpr_read_b32 v241, a49
    v_accvgpr_read_b32 v242, a50
    v_accvgpr_read_b32 v243, a51
    v_accvgpr_read_b32 v244, a52
    v_accvgpr_read_b32 v245, a53
    v_accvgpr_read_b32 v246, a54
    v_accvgpr_read_b32 v247, a55
    v_accvgpr_read_b32 v248, a56
    v_accvgpr_read_b32 v249, a57
    v_accvgpr_read_b32 v250, a58
    v_accvgpr_read_b32 v251, a59
    v_accvgpr_read_b32 v252, a60
    v_accvgpr_read_b32 v253, a61
    v_accvgpr_read_b32 v254, a62
    v_accvgpr_read_b32 v255, a63
    v_cvt_pk_bf16_f32 v184, v240, v241
    v_cvt_pk_bf16_f32 v185, v242, v243
    v_cvt_pk_bf16_f32 v186, v244, v245
    v_cvt_pk_bf16_f32 v187, v246, v247
    v_cvt_pk_bf16_f32 v188, v248, v249
    v_cvt_pk_bf16_f32 v189, v250, v251
    v_cvt_pk_bf16_f32 v190, v252, v253
    v_cvt_pk_bf16_f32 v191, v254, v255
    v_accvgpr_read_b32 v240, a64
    v_accvgpr_read_b32 v241, a65
    v_accvgpr_read_b32 v242, a66
    v_accvgpr_read_b32 v243, a67
    v_accvgpr_read_b32 v244, a68
    v_accvgpr_read_b32 v245, a69
    v_accvgpr_read_b32 v246, a70
    v_accvgpr_read_b32 v247, a71
    v_accvgpr_read_b32 v248, a72
    v_accvgpr_read_b32 v249, a73
    v_accvgpr_read_b32 v250, a74
    v_accvgpr_read_b32 v251, a75
    v_accvgpr_read_b32 v252, a76
    v_accvgpr_read_b32 v253, a77
    v_accvgpr_read_b32 v254, a78
    v_accvgpr_read_b32 v255, a79
    v_cvt_pk_bf16_f32 v192, v240, v241
    v_cvt_pk_bf16_f32 v193, v242, v243
    v_cvt_pk_bf16_f32 v194, v244, v245
    v_cvt_pk_bf16_f32 v195, v246, v247
    v_cvt_pk_bf16_f32 v196, v248, v249
    v_cvt_pk_bf16_f32 v197, v250, v251
    v_cvt_pk_bf16_f32 v198, v252, v253
    v_cvt_pk_bf16_f32 v199, v254, v255
    v_accvgpr_read_b32 v240, a80
    v_accvgpr_read_b32 v241, a81
    v_accvgpr_read_b32 v242, a82
    v_accvgpr_read_b32 v243, a83
    v_accvgpr_read_b32 v244, a84
    v_accvgpr_read_b32 v245, a85
    v_accvgpr_read_b32 v246, a86
    v_accvgpr_read_b32 v247, a87
    v_accvgpr_read_b32 v248, a88
    v_accvgpr_read_b32 v249, a89
    v_accvgpr_read_b32 v250, a90
    v_accvgpr_read_b32 v251, a91
    v_accvgpr_read_b32 v252, a92
    v_accvgpr_read_b32 v253, a93
    v_accvgpr_read_b32 v254, a94
    v_accvgpr_read_b32 v255, a95
    v_cvt_pk_bf16_f32 v200, v240, v241
    v_cvt_pk_bf16_f32 v201, v242, v243
    v_cvt_pk_bf16_f32 v202, v244, v245
    v_cvt_pk_bf16_f32 v203, v246, v247
    v_cvt_pk_bf16_f32 v204, v248, v249
    v_cvt_pk_bf16_f32 v205, v250, v251
    v_cvt_pk_bf16_f32 v206, v252, v253
    v_cvt_pk_bf16_f32 v207, v254, v255
    v_accvgpr_read_b32 v240, a96
    v_accvgpr_read_b32 v241, a97
    v_accvgpr_read_b32 v242, a98
    v_accvgpr_read_b32 v243, a99
    v_accvgpr_read_b32 v244, a100
    v_accvgpr_read_b32 v245, a101
    v_accvgpr_read_b32 v246, a102
    v_accvgpr_read_b32 v247, a103
    v_accvgpr_read_b32 v248, a104
    v_accvgpr_read_b32 v249, a105
    v_accvgpr_read_b32 v250, a106
    v_accvgpr_read_b32 v251, a107
    v_accvgpr_read_b32 v252, a108
    v_accvgpr_read_b32 v253, a109
    v_accvgpr_read_b32 v254, a110
    v_accvgpr_read_b32 v255, a111
    v_cvt_pk_bf16_f32 v208, v240, v241
    v_cvt_pk_bf16_f32 v209, v242, v243
    v_cvt_pk_bf16_f32 v210, v244, v245
    v_cvt_pk_bf16_f32 v211, v246, v247
    v_cvt_pk_bf16_f32 v212, v248, v249
    v_cvt_pk_bf16_f32 v213, v250, v251
    v_cvt_pk_bf16_f32 v214, v252, v253
    v_cvt_pk_bf16_f32 v215, v254, v255
    v_accvgpr_read_b32 v240, a112
    v_accvgpr_read_b32 v241, a113
    v_accvgpr_read_b32 v242, a114
    v_accvgpr_read_b32 v243, a115
    v_accvgpr_read_b32 v244, a116
    v_accvgpr_read_b32 v245, a117
    v_accvgpr_read_b32 v246, a118
    v_accvgpr_read_b32 v247, a119
    v_accvgpr_read_b32 v248, a120
    v_accvgpr_read_b32 v249, a121
    v_accvgpr_read_b32 v250, a122
    v_accvgpr_read_b32 v251, a123
    v_accvgpr_read_b32 v252, a124
    v_accvgpr_read_b32 v253, a125
    v_accvgpr_read_b32 v254, a126
    v_accvgpr_read_b32 v255, a127
    v_cvt_pk_bf16_f32 v216, v240, v241
    v_cvt_pk_bf16_f32 v217, v242, v243
    v_cvt_pk_bf16_f32 v218, v244, v245
    v_cvt_pk_bf16_f32 v219, v246, v247
    v_cvt_pk_bf16_f32 v220, v248, v249
    v_cvt_pk_bf16_f32 v221, v250, v251
    v_cvt_pk_bf16_f32 v222, v252, v253
    v_cvt_pk_bf16_f32 v223, v254, v255
    v_bfe_u32 v29, v0, 2, 1
    v_bfe_u32 v30, v0, 3, 1
    v_and_b32 v31, 0x13, v0
    v_lshl_add_u32 v31, v30, 2, v31
    v_lshl_add_u32 v31, v29, 3, v31
    v_lshlrev_b32 v31, 10, v31
    s_lshl_b32 s45, s32, 5
    v_lshl_add_u32 v30, v17, 4, s45
    s_lshl_b32 s45, s33, 17
    v_add3_u32 v11, v31, v30, s45
    v_mfma_f32_32x32x16_bf16 v[224:239], v[32:35], v[160:163], 0
    v_mfma_f32_32x32x16_bf16 v[224:239], v[36:39], v[164:167], v[224:239]
    v_mfma_f32_32x32x16_bf16 v[224:239], v[40:43], v[168:171], v[224:239]
    v_mfma_f32_32x32x16_bf16 v[224:239], v[44:47], v[172:175], v[224:239]
    v_mfma_f32_32x32x16_bf16 v[224:239], v[48:51], v[176:179], v[224:239]
    v_mfma_f32_32x32x16_bf16 v[224:239], v[52:55], v[180:183], v[224:239]
    v_mfma_f32_32x32x16_bf16 v[224:239], v[56:59], v[184:187], v[224:239]
    v_mfma_f32_32x32x16_bf16 v[224:239], v[60:63], v[188:191], v[224:239]
    v_mfma_f32_32x32x16_bf16 v[240:255], v[64:67], v[192:195], 0
    v_mfma_f32_32x32x16_bf16 v[240:255], v[68:71], v[196:199], v[240:255]
    v_mfma_f32_32x32x16_bf16 v[240:255], v[72:75], v[200:203], v[240:255]
    v_mfma_f32_32x32x16_bf16 v[240:255], v[76:79], v[204:207], v[240:255]
    v_mfma_f32_32x32x16_bf16 v[240:255], v[80:83], v[208:211], v[240:255]
    v_mfma_f32_32x32x16_bf16 v[240:255], v[84:87], v[212:215], v[240:255]
    v_mfma_f32_32x32x16_bf16 v[240:255], v[88:91], v[216:219], v[240:255]
    v_mfma_f32_32x32x16_bf16 v[240:255], v[92:95], v[220:223], v[240:255]
    v_accvgpr_read_b32 v32, a128
    v_accvgpr_read_b32 v33, a129
    v_accvgpr_read_b32 v34, a130
    v_accvgpr_read_b32 v35, a131
    v_accvgpr_read_b32 v36, a132
    v_accvgpr_read_b32 v37, a133
    v_accvgpr_read_b32 v38, a134
    v_accvgpr_read_b32 v39, a135
    v_accvgpr_read_b32 v40, a136
    v_accvgpr_read_b32 v41, a137
    v_accvgpr_read_b32 v42, a138
    v_accvgpr_read_b32 v43, a139
    v_accvgpr_read_b32 v44, a140
    v_accvgpr_read_b32 v45, a141
    v_accvgpr_read_b32 v46, a142
    v_accvgpr_read_b32 v47, a143
    v_accvgpr_read_b32 v48, a144
    v_accvgpr_read_b32 v49, a145
    v_accvgpr_read_b32 v50, a146
    v_accvgpr_read_b32 v51, a147
    v_accvgpr_read_b32 v52, a148
    v_accvgpr_read_b32 v53, a149
    v_accvgpr_read_b32 v54, a150
    v_accvgpr_read_b32 v55, a151
    v_accvgpr_read_b32 v56, a152
    v_accvgpr_read_b32 v57, a153
    v_accvgpr_read_b32 v58, a154
    v_accvgpr_read_b32 v59, a155
    v_accvgpr_read_b32 v60, a156
    v_accvgpr_read_b32 v61, a157
    v_accvgpr_read_b32 v62, a158
    v_accvgpr_read_b32 v63, a159
    v_accvgpr_read_b32 v15, a160
    v_accvgpr_read_b32 v28, a176
    global_load_dwordx4 v[80:83], v30, s[58:59]
    global_load_dwordx4 v[84:87], v30, s[62:63]
    global_load_dwordx4 v[88:91], v30, s[64:65]
    v_mul_f32 v15, 0xbfb8aa3b, v15
    v_mul_f32 v28, 0xbfb8aa3b, v28
    v_exp_f32 v15, v15
    v_exp_f32 v28, v28
    s_nop 0
    v_add_f32 v15, 1.0, v15
    v_add_f32 v28, 1.0, v28
    v_rcp_f32 v15, v15
    v_rcp_f32 v28, v28
    v_lshlrev_b32 v29, 4, v17
    v_sub_u32 v29, v16, v29
    v_mov_b32 v31, 0xff800000
    v_cmp_le_i32 vcc, 0, v29
    s_nop 1
    v_cndmask_b32 v224, v31, v224, vcc
    v_cndmask_b32 v240, v31, v240, vcc
    v_cmp_le_i32 vcc, 1, v29
    s_nop 1
    v_cndmask_b32 v225, v31, v225, vcc
    v_cndmask_b32 v241, v31, v241, vcc
    v_cmp_le_i32 vcc, 2, v29
    s_nop 1
    v_cndmask_b32 v226, v31, v226, vcc
    v_cndmask_b32 v242, v31, v242, vcc
    v_cmp_le_i32 vcc, 3, v29
    s_nop 1
    v_cndmask_b32 v227, v31, v227, vcc
    v_cndmask_b32 v243, v31, v243, vcc
    v_cmp_le_i32 vcc, 4, v29
    s_nop 1
    v_cndmask_b32 v228, v31, v228, vcc
    v_cndmask_b32 v244, v31, v244, vcc
    v_cmp_le_i32 vcc, 5, v29
    s_nop 1
    v_cndmask_b32 v229, v31, v229, vcc
    v_cndmask_b32 v245, v31, v245, vcc
    v_cmp_le_i32 vcc, 6, v29
    s_nop 1
    v_cndmask_b32 v230, v31, v230, vcc
    v_cndmask_b32 v246, v31, v246, vcc
    v_cmp_le_i32 vcc, 7, v29
    s_nop 1
    v_cndmask_b32 v231, v31, v231, vcc
    v_cndmask_b32 v247, v31, v247, vcc
    v_cmp_le_i32 vcc, 8, v29
    s_nop 1
    v_cndmask_b32 v232, v31, v232, vcc
    v_cndmask_b32 v248, v31, v248, vcc
    v_cmp_le_i32 vcc, 9, v29
    s_nop 1
    v_cndmask_b32 v233, v31, v233, vcc
    v_cndmask_b32 v249, v31, v249, vcc
    v_cmp_le_i32 vcc, 10, v29
    s_nop 1
    v_cndmask_b32 v234, v31, v234, vcc
    v_cndmask_b32 v250, v31, v250, vcc
    v_cmp_le_i32 vcc, 11, v29
    s_nop 1
    v_cndmask_b32 v235, v31, v235, vcc
    v_cndmask_b32 v251, v31, v251, vcc
    v_cmp_le_i32 vcc, 12, v29
    s_nop 1
    v_cndmask_b32 v236, v31, v236, vcc
    v_cndmask_b32 v252, v31, v252, vcc
    v_cmp_le_i32 vcc, 13, v29
    s_nop 1
    v_cndmask_b32 v237, v31, v237, vcc
    v_cndmask_b32 v253, v31, v253, vcc
    v_cmp_le_i32 vcc, 14, v29
    s_nop 1
    v_cndmask_b32 v238, v31, v238, vcc
    v_cndmask_b32 v254, v31, v254, vcc
    v_cmp_le_i32 vcc, 15, v29
    s_nop 1
    v_cndmask_b32 v239, v31, v239, vcc
    v_cndmask_b32 v255, v31, v255, vcc
    v_accvgpr_write_b32 a128, v192
    v_accvgpr_write_b32 a160, v128
    v_accvgpr_write_b32 a129, v193
    v_accvgpr_write_b32 a161, v129
    v_accvgpr_write_b32 a130, v194
    v_accvgpr_write_b32 a162, v130
    v_accvgpr_write_b32 a131, v195
    v_accvgpr_write_b32 a163, v131
    v_accvgpr_write_b32 a132, v196
    v_accvgpr_write_b32 a164, v132
    v_accvgpr_write_b32 a133, v197
    v_accvgpr_write_b32 a165, v133
    v_accvgpr_write_b32 a134, v198
    v_accvgpr_write_b32 a166, v134
    v_accvgpr_write_b32 a135, v199
    v_accvgpr_write_b32 a167, v135
    v_accvgpr_write_b32 a136, v200
    v_accvgpr_write_b32 a168, v136
    v_accvgpr_write_b32 a137, v201
    v_accvgpr_write_b32 a169, v137
    v_accvgpr_write_b32 a138, v202
    v_accvgpr_write_b32 a170, v138
    v_accvgpr_write_b32 a139, v203
    v_accvgpr_write_b32 a171, v139
    v_accvgpr_write_b32 a140, v204
    v_accvgpr_write_b32 a172, v140
    v_accvgpr_write_b32 a141, v205
    v_accvgpr_write_b32 a173, v141
    v_accvgpr_write_b32 a142, v206
    v_accvgpr_write_b32 a174, v142
    v_accvgpr_write_b32 a143, v207
    v_accvgpr_write_b32 a175, v143
    v_accvgpr_write_b32 a144, v208
    v_accvgpr_write_b32 a176, v144
    v_accvgpr_write_b32 a145, v209
    v_accvgpr_write_b32 a177, v145
    v_accvgpr_write_b32 a146, v210
    v_accvgpr_write_b32 a178, v146
    v_accvgpr_write_b32 a147, v211
    v_accvgpr_write_b32 a179, v147
    v_accvgpr_write_b32 a148, v212
    v_accvgpr_write_b32 a180, v148
    v_accvgpr_write_b32 a149, v213
    v_accvgpr_write_b32 a181, v149
    v_accvgpr_write_b32 a150, v214
    v_accvgpr_write_b32 a182, v150
    v_accvgpr_write_b32 a151, v215
    v_accvgpr_write_b32 a183, v151
    v_accvgpr_write_b32 a152, v216
    v_accvgpr_write_b32 a184, v152
    v_accvgpr_write_b32 a153, v217
    v_accvgpr_write_b32 a185, v153
    v_accvgpr_write_b32 a154, v218
    v_accvgpr_write_b32 a186, v154
    v_accvgpr_write_b32 a155, v219
    v_accvgpr_write_b32 a187, v155
    v_accvgpr_write_b32 a156, v220
    v_accvgpr_write_b32 a188, v156
    v_accvgpr_write_b32 a157, v221
    v_accvgpr_write_b32 a189, v157
    v_accvgpr_write_b32 a158, v222
    v_accvgpr_write_b32 a190, v158
    v_accvgpr_write_b32 a159, v223
    v_accvgpr_write_b32 a191, v159
    v_accvgpr_write_b32 a192, v240
    v_accvgpr_write_b32 a193, v241
    v_accvgpr_write_b32 a194, v242
    v_accvgpr_write_b32 a195, v243
    v_accvgpr_write_b32 a196, v244
    v_accvgpr_write_b32 a197, v245
    v_accvgpr_write_b32 a198, v246
    v_accvgpr_write_b32 a199, v247
    v_accvgpr_write_b32 a200, v248
    v_accvgpr_write_b32 a201, v249
    v_accvgpr_write_b32 a202, v250
    v_accvgpr_write_b32 a203, v251
    v_accvgpr_write_b32 a204, v252
    v_accvgpr_write_b32 a205, v253
    v_accvgpr_write_b32 a206, v254
    v_accvgpr_write_b32 a207, v255
    v_accvgpr_write_b32 a216, v28
    v_and_b32 v29, 15, v0
    s_lshl_b32 s45, s32, 5
    v_lshl_add_u32 v31, v29, 1, s45
    global_load_ushort v192, v31, s[58:59]
    global_load_ushort v193, v31, s[62:63]
    global_load_ushort v194, v31, s[64:65]
    global_load_dwordx4 a[220:223], v11, s[70:71]
    global_load_dwordx4 a[224:227], v11, s[72:73]
    v_add_u32 v11, 32768, v11
    global_load_dwordx4 a[228:231], v11, s[70:71]
    global_load_dwordx4 a[232:235], v11, s[72:73]
    v_add_u32 v11, 32768, v11
    global_load_dwordx4 a[236:239], v11, s[70:71]
    global_load_dwordx4 a[240:243], v11, s[72:73]
    v_add_u32 v11, 32768, v11
    global_load_dwordx4 a[244:247], v11, s[70:71]
    global_load_dwordx4 a[248:251], v11, s[72:73]
    s_lshl_b32 s45, s33, 12
    v_add_u32 v12, 137216, v1
    v_add_u32 v13, s45, v12
    s_waitcnt vmcnt(8)
    v_lshlrev_b32 v136, 16, v80
    v_and_b32 v137, 0xffff0000, v80
    v_lshlrev_b32 v138, 16, v81
    v_and_b32 v139, 0xffff0000, v81
    v_lshlrev_b32 v140, 16, v82
    v_and_b32 v141, 0xffff0000, v82
    v_lshlrev_b32 v142, 16, v83
    v_and_b32 v143, 0xffff0000, v83
    v_lshlrev_b32 v144, 16, v84
    v_and_b32 v145, 0xffff0000, v84
    v_lshlrev_b32 v146, 16, v85
    v_and_b32 v147, 0xffff0000, v85
    v_lshlrev_b32 v148, 16, v86
    v_and_b32 v149, 0xffff0000, v86
    v_lshlrev_b32 v150, 16, v87
    v_and_b32 v151, 0xffff0000, v87
    v_lshlrev_b32 v128, 16, v88
    v_and_b32 v129, 0xffff0000, v88
    v_lshlrev_b32 v130, 16, v89
    v_and_b32 v131, 0xffff0000, v89
    v_lshlrev_b32 v132, 16, v90
    v_and_b32 v133, 0xffff0000, v90
    v_lshlrev_b32 v134, 16, v91
    v_and_b32 v135, 0xffff0000, v91
    v_mov_b32 v64, v136
    v_mov_b32 v72, v144
    v_mov_b32 v65, v137
    v_mov_b32 v73, v145
    v_mov_b32 v66, v138
    v_mov_b32 v74, v146
    v_mov_b32 v67, v139
    v_mov_b32 v75, v147
    v_mov_b32 v68, v140
    v_mov_b32 v76, v148
    v_mov_b32 v69, v141
    v_mov_b32 v77, v149
    v_mov_b32 v70, v142
    v_mov_b32 v78, v150
    v_mov_b32 v71, v143
    v_mov_b32 v79, v151
    v_mul_f32 v128, 1069066811, v128
    v_mul_f32 v129, 1069066811, v129
    v_mul_f32 v130, 1069066811, v130
    v_mul_f32 v131, 1069066811, v131
    v_mul_f32 v132, 1069066811, v132
    v_mul_f32 v133, 1069066811, v133
    v_mul_f32 v134, 1069066811, v134
    v_mul_f32 v135, 1069066811, v135
    v_exp_f32 v128, v128
    v_exp_f32 v129, v129
    v_exp_f32 v130, v130
    v_exp_f32 v131, v131
    v_exp_f32 v132, v132
    v_exp_f32 v133, v133
    v_exp_f32 v134, v134
    v_exp_f32 v135, v135
    s_nop 0
    v_cvt_pk_bf16_f32 v128, v128, v128
    v_cvt_pk_bf16_f32 v129, v129, v129
    v_cvt_pk_bf16_f32 v130, v130, v130
    v_cvt_pk_bf16_f32 v131, v131, v131
    v_cvt_pk_bf16_f32 v132, v132, v132
    v_cvt_pk_bf16_f32 v133, v133, v133
    v_cvt_pk_bf16_f32 v134, v134, v134
    v_cvt_pk_bf16_f32 v135, v135, v135
    v_and_b32 v128, 0xffff0000, v128
    v_and_b32 v129, 0xffff0000, v129
    v_and_b32 v130, 0xffff0000, v130
    v_and_b32 v131, 0xffff0000, v131
    v_and_b32 v132, 0xffff0000, v132
    v_and_b32 v133, 0xffff0000, v133
    v_and_b32 v134, 0xffff0000, v134
    v_and_b32 v135, 0xffff0000, v135
    v_mul_f32 v64, v128, v64
    v_mul_f32 v72, v128, v72
    v_mul_f32 v64, 1069066811, v64
    v_mul_f32 v72, 0.15915494, v72
    v_mul_f32 v65, v129, v65
    v_mul_f32 v73, v129, v73
    v_mul_f32 v65, 1069066811, v65
    v_mul_f32 v73, 0.15915494, v73
    v_mul_f32 v66, v130, v66
    v_mul_f32 v74, v130, v74
    v_mul_f32 v66, 1069066811, v66
    v_mul_f32 v74, 0.15915494, v74
    v_mul_f32 v67, v131, v67
    v_mul_f32 v75, v131, v75
    v_mul_f32 v67, 1069066811, v67
    v_mul_f32 v75, 0.15915494, v75
    v_mul_f32 v68, v132, v68
    v_mul_f32 v76, v132, v76
    v_mul_f32 v68, 1069066811, v68
    v_mul_f32 v76, 0.15915494, v76
    v_mul_f32 v69, v133, v69
    v_mul_f32 v77, v133, v77
    v_mul_f32 v69, 1069066811, v69
    v_mul_f32 v77, 0.15915494, v77
    v_mul_f32 v70, v134, v70
    v_mul_f32 v78, v134, v78
    v_mul_f32 v70, 1069066811, v70
    v_mul_f32 v78, 0.15915494, v78
    v_mul_f32 v71, v135, v71
    v_mul_f32 v79, v135, v79
    v_mul_f32 v71, 1069066811, v71
    v_mul_f32 v79, 0.15915494, v79
    v_exp_f32 v128, v64
    v_fract_f32 v88, v72
    v_exp_f32 v129, v65
    v_fract_f32 v89, v73
    v_exp_f32 v130, v66
    v_fract_f32 v90, v74
    v_exp_f32 v131, v67
    v_fract_f32 v91, v75
    v_exp_f32 v132, v68
    v_fract_f32 v92, v76
    v_exp_f32 v133, v69
    v_fract_f32 v93, v77
    v_exp_f32 v134, v70
    v_fract_f32 v94, v78
    v_exp_f32 v135, v71
    v_fract_f32 v95, v79
    v_cos_f32 v80, v88
    v_sin_f32 v88, v88
    v_cos_f32 v81, v89
    v_sin_f32 v89, v89
    v_cos_f32 v82, v90
    v_sin_f32 v90, v90
    v_cos_f32 v83, v91
    v_sin_f32 v91, v91
    v_cos_f32 v84, v92
    v_sin_f32 v92, v92
    v_cos_f32 v85, v93
    v_sin_f32 v93, v93
    v_cos_f32 v86, v94
    v_sin_f32 v94, v94
    v_cos_f32 v87, v95
    v_sin_f32 v95, v95
    s_nop 0
    v_mul_f32 v80, v80, v128
    v_mul_f32 v88, v88, v128
    v_mul_f32 v81, v81, v129
    v_mul_f32 v89, v89, v129
    v_mul_f32 v82, v82, v130
    v_mul_f32 v90, v90, v130
    v_mul_f32 v83, v83, v131
    v_mul_f32 v91, v91, v131
    v_mul_f32 v84, v84, v132
    v_mul_f32 v92, v92, v132
    v_mul_f32 v85, v85, v133
    v_mul_f32 v93, v93, v133
    v_mul_f32 v86, v86, v134
    v_mul_f32 v94, v94, v134
    v_mul_f32 v87, v87, v135
    v_mul_f32 v95, v95, v135
    v_mul_f32 v128, v136, v136
    v_fmac_f32 v128, v144, v144
    v_rcp_f32 v128, v128
    v_add_f32 v129, -1.0, v80
    v_mul_f32 v130, v129, v136
    v_fmac_f32 v130, v88, v144
    v_mul_f32 v131, v88, v136
    v_fma_f32 v131, -v129, v144, v131
    v_mul_f32 v136, v130, v128
    v_mul_f32 v144, v131, v128
    v_mul_f32 v128, v137, v137
    v_fmac_f32 v128, v145, v145
    v_rcp_f32 v128, v128
    v_add_f32 v129, -1.0, v81
    v_mul_f32 v130, v129, v137
    v_fmac_f32 v130, v89, v145
    v_mul_f32 v131, v89, v137
    v_fma_f32 v131, -v129, v145, v131
    v_mul_f32 v137, v130, v128
    v_mul_f32 v145, v131, v128
    v_mul_f32 v128, v138, v138
    v_fmac_f32 v128, v146, v146
    v_rcp_f32 v128, v128
    v_add_f32 v129, -1.0, v82
    v_mul_f32 v130, v129, v138
    v_fmac_f32 v130, v90, v146
    v_mul_f32 v131, v90, v138
    v_fma_f32 v131, -v129, v146, v131
    v_mul_f32 v138, v130, v128
    v_mul_f32 v146, v131, v128
    v_mul_f32 v128, v139, v139
    v_fmac_f32 v128, v147, v147
    v_rcp_f32 v128, v128
    v_add_f32 v129, -1.0, v83
    v_mul_f32 v130, v129, v139
    v_fmac_f32 v130, v91, v147
    v_mul_f32 v131, v91, v139
    v_fma_f32 v131, -v129, v147, v131
    v_mul_f32 v139, v130, v128
    v_mul_f32 v147, v131, v128
    v_mul_f32 v128, v140, v140
    v_fmac_f32 v128, v148, v148
    v_rcp_f32 v128, v128
    v_add_f32 v129, -1.0, v84
    v_mul_f32 v130, v129, v140
    v_fmac_f32 v130, v92, v148
    v_mul_f32 v131, v92, v140
    v_fma_f32 v131, -v129, v148, v131
    v_mul_f32 v140, v130, v128
    v_mul_f32 v148, v131, v128
    v_mul_f32 v128, v141, v141
    v_fmac_f32 v128, v149, v149
    v_rcp_f32 v128, v128
    v_add_f32 v129, -1.0, v85
    v_mul_f32 v130, v129, v141
    v_fmac_f32 v130, v93, v149
    v_mul_f32 v131, v93, v141
    v_fma_f32 v131, -v129, v149, v131
    v_mul_f32 v141, v130, v128
    v_mul_f32 v149, v131, v128
    v_mul_f32 v128, v142, v142
    v_fmac_f32 v128, v150, v150
    v_rcp_f32 v128, v128
    v_add_f32 v129, -1.0, v86
    v_mul_f32 v130, v129, v142
    v_fmac_f32 v130, v94, v150
    v_mul_f32 v131, v94, v142
    v_fma_f32 v131, -v129, v150, v131
    v_mul_f32 v142, v130, v128
    v_mul_f32 v150, v131, v128
    v_mul_f32 v128, v143, v143
    v_fmac_f32 v128, v151, v151
    v_rcp_f32 v128, v128
    v_add_f32 v129, -1.0, v87
    v_mul_f32 v130, v129, v143
    v_fmac_f32 v130, v95, v151
    v_mul_f32 v131, v95, v143
    v_fma_f32 v131, -v129, v151, v131
    v_mul_f32 v143, v130, v128
    v_mul_f32 v151, v131, v128
    v_mov_b32 v128, v32
    v_mov_b32 v129, v33
    v_mov_b32 v130, v34
    v_mov_b32 v131, v35
    v_mov_b32 v132, v36
    v_mov_b32 v133, v37
    v_mov_b32 v134, v38
    v_mov_b32 v135, v39
    v_fmac_f32_dpp v32, v32, v80 row_shr:1 row_mask:0xf bank_mask:0xf bound_ctrl:1
    v_fmac_f32_dpp v33, v33, v81 row_shr:1 row_mask:0xf bank_mask:0xf bound_ctrl:1
    v_fmac_f32_dpp v34, v34, v82 row_shr:1 row_mask:0xf bank_mask:0xf bound_ctrl:1
    v_fmac_f32_dpp v35, v35, v83 row_shr:1 row_mask:0xf bank_mask:0xf bound_ctrl:1
    v_fmac_f32_dpp v36, v36, v84 row_shr:1 row_mask:0xf bank_mask:0xf bound_ctrl:1
    v_fmac_f32_dpp v37, v37, v85 row_shr:1 row_mask:0xf bank_mask:0xf bound_ctrl:1
    v_fmac_f32_dpp v38, v38, v86 row_shr:1 row_mask:0xf bank_mask:0xf bound_ctrl:1
    v_fmac_f32_dpp v39, v39, v87 row_shr:1 row_mask:0xf bank_mask:0xf bound_ctrl:1
    v_fmac_f32_dpp v32, -v40, v88 row_shr:1 row_mask:0xf bank_mask:0xf bound_ctrl:1
    v_fmac_f32_dpp v33, -v41, v89 row_shr:1 row_mask:0xf bank_mask:0xf bound_ctrl:1
    v_fmac_f32_dpp v34, -v42, v90 row_shr:1 row_mask:0xf bank_mask:0xf bound_ctrl:1
    v_fmac_f32_dpp v35, -v43, v91 row_shr:1 row_mask:0xf bank_mask:0xf bound_ctrl:1
    v_fmac_f32_dpp v36, -v44, v92 row_shr:1 row_mask:0xf bank_mask:0xf bound_ctrl:1
    v_fmac_f32_dpp v37, -v45, v93 row_shr:1 row_mask:0xf bank_mask:0xf bound_ctrl:1
    v_fmac_f32_dpp v38, -v46, v94 row_shr:1 row_mask:0xf bank_mask:0xf bound_ctrl:1
    v_fmac_f32_dpp v39, -v47, v95 row_shr:1 row_mask:0xf bank_mask:0xf bound_ctrl:1
    v_fmac_f32_dpp v40, v40, v80 row_shr:1 row_mask:0xf bank_mask:0xf bound_ctrl:1
    v_fmac_f32_dpp v41, v41, v81 row_shr:1 row_mask:0xf bank_mask:0xf bound_ctrl:1
    v_fmac_f32_dpp v42, v42, v82 row_shr:1 row_mask:0xf bank_mask:0xf bound_ctrl:1
    v_fmac_f32_dpp v43, v43, v83 row_shr:1 row_mask:0xf bank_mask:0xf bound_ctrl:1
    v_fmac_f32_dpp v44, v44, v84 row_shr:1 row_mask:0xf bank_mask:0xf bound_ctrl:1
    v_fmac_f32_dpp v45, v45, v85 row_shr:1 row_mask:0xf bank_mask:0xf bound_ctrl:1
    v_fmac_f32_dpp v46, v46, v86 row_shr:1 row_mask:0xf bank_mask:0xf bound_ctrl:1
    v_fmac_f32_dpp v47, v47, v87 row_shr:1 row_mask:0xf bank_mask:0xf bound_ctrl:1
    v_fmac_f32_dpp v40, v128, v88 row_shr:1 row_mask:0xf bank_mask:0xf bound_ctrl:1
    v_fmac_f32_dpp v41, v129, v89 row_shr:1 row_mask:0xf bank_mask:0xf bound_ctrl:1
    v_fmac_f32_dpp v42, v130, v90 row_shr:1 row_mask:0xf bank_mask:0xf bound_ctrl:1
    v_fmac_f32_dpp v43, v131, v91 row_shr:1 row_mask:0xf bank_mask:0xf bound_ctrl:1
    v_fmac_f32_dpp v44, v132, v92 row_shr:1 row_mask:0xf bank_mask:0xf bound_ctrl:1
    v_fmac_f32_dpp v45, v133, v93 row_shr:1 row_mask:0xf bank_mask:0xf bound_ctrl:1
    v_fmac_f32_dpp v46, v134, v94 row_shr:1 row_mask:0xf bank_mask:0xf bound_ctrl:1
    v_fmac_f32_dpp v47, v135, v95 row_shr:1 row_mask:0xf bank_mask:0xf bound_ctrl:1
    v_mov_b32 v128, v48
    v_mov_b32 v129, v49
    v_mov_b32 v130, v50
    v_mov_b32 v131, v51
    v_mov_b32 v132, v52
    v_mov_b32 v133, v53
    v_mov_b32 v134, v54
    v_mov_b32 v135, v55
    v_fmac_f32_dpp v48, v48, v80 row_shr:1 row_mask:0xf bank_mask:0xf bound_ctrl:1
    v_fmac_f32_dpp v49, v49, v81 row_shr:1 row_mask:0xf bank_mask:0xf bound_ctrl:1
    v_fmac_f32_dpp v50, v50, v82 row_shr:1 row_mask:0xf bank_mask:0xf bound_ctrl:1
    v_fmac_f32_dpp v51, v51, v83 row_shr:1 row_mask:0xf bank_mask:0xf bound_ctrl:1
    v_fmac_f32_dpp v52, v52, v84 row_shr:1 row_mask:0xf bank_mask:0xf bound_ctrl:1
    v_fmac_f32_dpp v53, v53, v85 row_shr:1 row_mask:0xf bank_mask:0xf bound_ctrl:1
    v_fmac_f32_dpp v54, v54, v86 row_shr:1 row_mask:0xf bank_mask:0xf bound_ctrl:1
    v_fmac_f32_dpp v55, v55, v87 row_shr:1 row_mask:0xf bank_mask:0xf bound_ctrl:1
    v_fmac_f32_dpp v48, -v56, v88 row_shr:1 row_mask:0xf bank_mask:0xf bound_ctrl:1
    v_fmac_f32_dpp v49, -v57, v89 row_shr:1 row_mask:0xf bank_mask:0xf bound_ctrl:1
    v_fmac_f32_dpp v50, -v58, v90 row_shr:1 row_mask:0xf bank_mask:0xf bound_ctrl:1
    v_fmac_f32_dpp v51, -v59, v91 row_shr:1 row_mask:0xf bank_mask:0xf bound_ctrl:1
    v_fmac_f32_dpp v52, -v60, v92 row_shr:1 row_mask:0xf bank_mask:0xf bound_ctrl:1
    v_fmac_f32_dpp v53, -v61, v93 row_shr:1 row_mask:0xf bank_mask:0xf bound_ctrl:1
    v_fmac_f32_dpp v54, -v62, v94 row_shr:1 row_mask:0xf bank_mask:0xf bound_ctrl:1
    v_fmac_f32_dpp v55, -v63, v95 row_shr:1 row_mask:0xf bank_mask:0xf bound_ctrl:1
    v_fmac_f32_dpp v56, v56, v80 row_shr:1 row_mask:0xf bank_mask:0xf bound_ctrl:1
    v_fmac_f32_dpp v57, v57, v81 row_shr:1 row_mask:0xf bank_mask:0xf bound_ctrl:1
    v_fmac_f32_dpp v58, v58, v82 row_shr:1 row_mask:0xf bank_mask:0xf bound_ctrl:1
    v_fmac_f32_dpp v59, v59, v83 row_shr:1 row_mask:0xf bank_mask:0xf bound_ctrl:1
    v_fmac_f32_dpp v60, v60, v84 row_shr:1 row_mask:0xf bank_mask:0xf bound_ctrl:1
    v_fmac_f32_dpp v61, v61, v85 row_shr:1 row_mask:0xf bank_mask:0xf bound_ctrl:1
    v_fmac_f32_dpp v62, v62, v86 row_shr:1 row_mask:0xf bank_mask:0xf bound_ctrl:1
    v_fmac_f32_dpp v63, v63, v87 row_shr:1 row_mask:0xf bank_mask:0xf bound_ctrl:1
    v_fmac_f32_dpp v56, v128, v88 row_shr:1 row_mask:0xf bank_mask:0xf bound_ctrl:1
    v_fmac_f32_dpp v57, v129, v89 row_shr:1 row_mask:0xf bank_mask:0xf bound_ctrl:1
    v_fmac_f32_dpp v58, v130, v90 row_shr:1 row_mask:0xf bank_mask:0xf bound_ctrl:1
    v_fmac_f32_dpp v59, v131, v91 row_shr:1 row_mask:0xf bank_mask:0xf bound_ctrl:1
    v_fmac_f32_dpp v60, v132, v92 row_shr:1 row_mask:0xf bank_mask:0xf bound_ctrl:1
    v_fmac_f32_dpp v61, v133, v93 row_shr:1 row_mask:0xf bank_mask:0xf bound_ctrl:1
    v_fmac_f32_dpp v62, v134, v94 row_shr:1 row_mask:0xf bank_mask:0xf bound_ctrl:1
    v_fmac_f32_dpp v63, v135, v95 row_shr:1 row_mask:0xf bank_mask:0xf bound_ctrl:1
    v_mul_f32 v128, v88, v88
    v_add_f32 v129, v80, v80
    v_fma_f32 v80, v80, v80, -v128
    v_mul_f32 v88, v129, v88
    v_mul_f32 v128, v89, v89
    v_add_f32 v129, v81, v81
    v_fma_f32 v81, v81, v81, -v128
    v_mul_f32 v89, v129, v89
    v_mul_f32 v128, v90, v90
    v_add_f32 v129, v82, v82
    v_fma_f32 v82, v82, v82, -v128
    v_mul_f32 v90, v129, v90
    v_mul_f32 v128, v91, v91
    v_add_f32 v129, v83, v83
    v_fma_f32 v83, v83, v83, -v128
    v_mul_f32 v91, v129, v91
    v_mul_f32 v128, v92, v92
    v_add_f32 v129, v84, v84
    v_fma_f32 v84, v84, v84, -v128
    v_mul_f32 v92, v129, v92
    v_mul_f32 v128, v93, v93
    v_add_f32 v129, v85, v85
    v_fma_f32 v85, v85, v85, -v128
    v_mul_f32 v93, v129, v93
    v_mul_f32 v128, v94, v94
    v_add_f32 v129, v86, v86
    v_fma_f32 v86, v86, v86, -v128
    v_mul_f32 v94, v129, v94
    v_mul_f32 v128, v95, v95
    v_add_f32 v129, v87, v87
    v_fma_f32 v87, v87, v87, -v128
    v_mul_f32 v95, v129, v95
    v_mov_b32 v128, v32
    v_mov_b32 v129, v33
    v_mov_b32 v130, v34
    v_mov_b32 v131, v35
    v_mov_b32 v132, v36
    v_mov_b32 v133, v37
    v_mov_b32 v134, v38
    v_mov_b32 v135, v39
    v_fmac_f32_dpp v32, v32, v80 row_shr:2 row_mask:0xf bank_mask:0xf bound_ctrl:1
    v_fmac_f32_dpp v33, v33, v81 row_shr:2 row_mask:0xf bank_mask:0xf bound_ctrl:1
    v_fmac_f32_dpp v34, v34, v82 row_shr:2 row_mask:0xf bank_mask:0xf bound_ctrl:1
    v_fmac_f32_dpp v35, v35, v83 row_shr:2 row_mask:0xf bank_mask:0xf bound_ctrl:1
    v_fmac_f32_dpp v36, v36, v84 row_shr:2 row_mask:0xf bank_mask:0xf bound_ctrl:1
    v_fmac_f32_dpp v37, v37, v85 row_shr:2 row_mask:0xf bank_mask:0xf bound_ctrl:1
    v_fmac_f32_dpp v38, v38, v86 row_shr:2 row_mask:0xf bank_mask:0xf bound_ctrl:1
    v_fmac_f32_dpp v39, v39, v87 row_shr:2 row_mask:0xf bank_mask:0xf bound_ctrl:1
    v_fmac_f32_dpp v32, -v40, v88 row_shr:2 row_mask:0xf bank_mask:0xf bound_ctrl:1
    v_fmac_f32_dpp v33, -v41, v89 row_shr:2 row_mask:0xf bank_mask:0xf bound_ctrl:1
    v_fmac_f32_dpp v34, -v42, v90 row_shr:2 row_mask:0xf bank_mask:0xf bound_ctrl:1
    v_fmac_f32_dpp v35, -v43, v91 row_shr:2 row_mask:0xf bank_mask:0xf bound_ctrl:1
    v_fmac_f32_dpp v36, -v44, v92 row_shr:2 row_mask:0xf bank_mask:0xf bound_ctrl:1
    v_fmac_f32_dpp v37, -v45, v93 row_shr:2 row_mask:0xf bank_mask:0xf bound_ctrl:1
    v_fmac_f32_dpp v38, -v46, v94 row_shr:2 row_mask:0xf bank_mask:0xf bound_ctrl:1
    v_fmac_f32_dpp v39, -v47, v95 row_shr:2 row_mask:0xf bank_mask:0xf bound_ctrl:1
    v_fmac_f32_dpp v40, v40, v80 row_shr:2 row_mask:0xf bank_mask:0xf bound_ctrl:1
    v_fmac_f32_dpp v41, v41, v81 row_shr:2 row_mask:0xf bank_mask:0xf bound_ctrl:1
    v_fmac_f32_dpp v42, v42, v82 row_shr:2 row_mask:0xf bank_mask:0xf bound_ctrl:1
    v_fmac_f32_dpp v43, v43, v83 row_shr:2 row_mask:0xf bank_mask:0xf bound_ctrl:1
    v_fmac_f32_dpp v44, v44, v84 row_shr:2 row_mask:0xf bank_mask:0xf bound_ctrl:1
    v_fmac_f32_dpp v45, v45, v85 row_shr:2 row_mask:0xf bank_mask:0xf bound_ctrl:1
    v_fmac_f32_dpp v46, v46, v86 row_shr:2 row_mask:0xf bank_mask:0xf bound_ctrl:1
    v_fmac_f32_dpp v47, v47, v87 row_shr:2 row_mask:0xf bank_mask:0xf bound_ctrl:1
    v_fmac_f32_dpp v40, v128, v88 row_shr:2 row_mask:0xf bank_mask:0xf bound_ctrl:1
    v_fmac_f32_dpp v41, v129, v89 row_shr:2 row_mask:0xf bank_mask:0xf bound_ctrl:1
    v_fmac_f32_dpp v42, v130, v90 row_shr:2 row_mask:0xf bank_mask:0xf bound_ctrl:1
    v_fmac_f32_dpp v43, v131, v91 row_shr:2 row_mask:0xf bank_mask:0xf bound_ctrl:1
    v_fmac_f32_dpp v44, v132, v92 row_shr:2 row_mask:0xf bank_mask:0xf bound_ctrl:1
    v_fmac_f32_dpp v45, v133, v93 row_shr:2 row_mask:0xf bank_mask:0xf bound_ctrl:1
    v_fmac_f32_dpp v46, v134, v94 row_shr:2 row_mask:0xf bank_mask:0xf bound_ctrl:1
    v_fmac_f32_dpp v47, v135, v95 row_shr:2 row_mask:0xf bank_mask:0xf bound_ctrl:1
    v_mov_b32 v128, v48
    v_mov_b32 v129, v49
    v_mov_b32 v130, v50
    v_mov_b32 v131, v51
    v_mov_b32 v132, v52
    v_mov_b32 v133, v53
    v_mov_b32 v134, v54
    v_mov_b32 v135, v55
    v_fmac_f32_dpp v48, v48, v80 row_shr:2 row_mask:0xf bank_mask:0xf bound_ctrl:1
    v_fmac_f32_dpp v49, v49, v81 row_shr:2 row_mask:0xf bank_mask:0xf bound_ctrl:1
    v_fmac_f32_dpp v50, v50, v82 row_shr:2 row_mask:0xf bank_mask:0xf bound_ctrl:1
    v_fmac_f32_dpp v51, v51, v83 row_shr:2 row_mask:0xf bank_mask:0xf bound_ctrl:1
    v_fmac_f32_dpp v52, v52, v84 row_shr:2 row_mask:0xf bank_mask:0xf bound_ctrl:1
    v_fmac_f32_dpp v53, v53, v85 row_shr:2 row_mask:0xf bank_mask:0xf bound_ctrl:1
    v_fmac_f32_dpp v54, v54, v86 row_shr:2 row_mask:0xf bank_mask:0xf bound_ctrl:1
    v_fmac_f32_dpp v55, v55, v87 row_shr:2 row_mask:0xf bank_mask:0xf bound_ctrl:1
    v_fmac_f32_dpp v48, -v56, v88 row_shr:2 row_mask:0xf bank_mask:0xf bound_ctrl:1
    v_fmac_f32_dpp v49, -v57, v89 row_shr:2 row_mask:0xf bank_mask:0xf bound_ctrl:1
    v_fmac_f32_dpp v50, -v58, v90 row_shr:2 row_mask:0xf bank_mask:0xf bound_ctrl:1
    v_fmac_f32_dpp v51, -v59, v91 row_shr:2 row_mask:0xf bank_mask:0xf bound_ctrl:1
    v_fmac_f32_dpp v52, -v60, v92 row_shr:2 row_mask:0xf bank_mask:0xf bound_ctrl:1
    v_fmac_f32_dpp v53, -v61, v93 row_shr:2 row_mask:0xf bank_mask:0xf bound_ctrl:1
    v_fmac_f32_dpp v54, -v62, v94 row_shr:2 row_mask:0xf bank_mask:0xf bound_ctrl:1
    v_fmac_f32_dpp v55, -v63, v95 row_shr:2 row_mask:0xf bank_mask:0xf bound_ctrl:1
    v_fmac_f32_dpp v56, v56, v80 row_shr:2 row_mask:0xf bank_mask:0xf bound_ctrl:1
    v_fmac_f32_dpp v57, v57, v81 row_shr:2 row_mask:0xf bank_mask:0xf bound_ctrl:1
    v_fmac_f32_dpp v58, v58, v82 row_shr:2 row_mask:0xf bank_mask:0xf bound_ctrl:1
    v_fmac_f32_dpp v59, v59, v83 row_shr:2 row_mask:0xf bank_mask:0xf bound_ctrl:1
    v_fmac_f32_dpp v60, v60, v84 row_shr:2 row_mask:0xf bank_mask:0xf bound_ctrl:1
    v_fmac_f32_dpp v61, v61, v85 row_shr:2 row_mask:0xf bank_mask:0xf bound_ctrl:1
    v_fmac_f32_dpp v62, v62, v86 row_shr:2 row_mask:0xf bank_mask:0xf bound_ctrl:1
    v_fmac_f32_dpp v63, v63, v87 row_shr:2 row_mask:0xf bank_mask:0xf bound_ctrl:1
    v_fmac_f32_dpp v56, v128, v88 row_shr:2 row_mask:0xf bank_mask:0xf bound_ctrl:1
    v_fmac_f32_dpp v57, v129, v89 row_shr:2 row_mask:0xf bank_mask:0xf bound_ctrl:1
    v_fmac_f32_dpp v58, v130, v90 row_shr:2 row_mask:0xf bank_mask:0xf bound_ctrl:1
    v_fmac_f32_dpp v59, v131, v91 row_shr:2 row_mask:0xf bank_mask:0xf bound_ctrl:1
    v_fmac_f32_dpp v60, v132, v92 row_shr:2 row_mask:0xf bank_mask:0xf bound_ctrl:1
    v_fmac_f32_dpp v61, v133, v93 row_shr:2 row_mask:0xf bank_mask:0xf bound_ctrl:1
    v_fmac_f32_dpp v62, v134, v94 row_shr:2 row_mask:0xf bank_mask:0xf bound_ctrl:1
    v_fmac_f32_dpp v63, v135, v95 row_shr:2 row_mask:0xf bank_mask:0xf bound_ctrl:1
    v_mul_f32 v128, v88, v88
    v_add_f32 v129, v80, v80
    v_fma_f32 v80, v80, v80, -v128
    v_mul_f32 v88, v129, v88
    v_mul_f32 v128, v89, v89
    v_add_f32 v129, v81, v81
    v_fma_f32 v81, v81, v81, -v128
    v_mul_f32 v89, v129, v89
    v_mul_f32 v128, v90, v90
    v_add_f32 v129, v82, v82
    v_fma_f32 v82, v82, v82, -v128
    v_mul_f32 v90, v129, v90
    v_mul_f32 v128, v91, v91
    v_add_f32 v129, v83, v83
    v_fma_f32 v83, v83, v83, -v128
    v_mul_f32 v91, v129, v91
    v_mul_f32 v128, v92, v92
    v_add_f32 v129, v84, v84
    v_fma_f32 v84, v84, v84, -v128
    v_mul_f32 v92, v129, v92
    v_mul_f32 v128, v93, v93
    v_add_f32 v129, v85, v85
    v_fma_f32 v85, v85, v85, -v128
    v_mul_f32 v93, v129, v93
    v_mul_f32 v128, v94, v94
    v_add_f32 v129, v86, v86
    v_fma_f32 v86, v86, v86, -v128
    v_mul_f32 v94, v129, v94
    v_mul_f32 v128, v95, v95
    v_add_f32 v129, v87, v87
    v_fma_f32 v87, v87, v87, -v128
    v_mul_f32 v95, v129, v95
    v_mov_b32 v128, v32
    v_mov_b32 v129, v33
    v_mov_b32 v130, v34
    v_mov_b32 v131, v35
    v_mov_b32 v132, v36
    v_mov_b32 v133, v37
    v_mov_b32 v134, v38
    v_mov_b32 v135, v39
    v_fmac_f32_dpp v32, v32, v80 row_shr:4 row_mask:0xf bank_mask:0xf bound_ctrl:1
    v_fmac_f32_dpp v33, v33, v81 row_shr:4 row_mask:0xf bank_mask:0xf bound_ctrl:1
    v_fmac_f32_dpp v34, v34, v82 row_shr:4 row_mask:0xf bank_mask:0xf bound_ctrl:1
    v_fmac_f32_dpp v35, v35, v83 row_shr:4 row_mask:0xf bank_mask:0xf bound_ctrl:1
    v_fmac_f32_dpp v36, v36, v84 row_shr:4 row_mask:0xf bank_mask:0xf bound_ctrl:1
    v_fmac_f32_dpp v37, v37, v85 row_shr:4 row_mask:0xf bank_mask:0xf bound_ctrl:1
    v_fmac_f32_dpp v38, v38, v86 row_shr:4 row_mask:0xf bank_mask:0xf bound_ctrl:1
    v_fmac_f32_dpp v39, v39, v87 row_shr:4 row_mask:0xf bank_mask:0xf bound_ctrl:1
    v_fmac_f32_dpp v32, -v40, v88 row_shr:4 row_mask:0xf bank_mask:0xf bound_ctrl:1
    v_fmac_f32_dpp v33, -v41, v89 row_shr:4 row_mask:0xf bank_mask:0xf bound_ctrl:1
    v_fmac_f32_dpp v34, -v42, v90 row_shr:4 row_mask:0xf bank_mask:0xf bound_ctrl:1
    v_fmac_f32_dpp v35, -v43, v91 row_shr:4 row_mask:0xf bank_mask:0xf bound_ctrl:1
    v_fmac_f32_dpp v36, -v44, v92 row_shr:4 row_mask:0xf bank_mask:0xf bound_ctrl:1
    v_fmac_f32_dpp v37, -v45, v93 row_shr:4 row_mask:0xf bank_mask:0xf bound_ctrl:1
    v_fmac_f32_dpp v38, -v46, v94 row_shr:4 row_mask:0xf bank_mask:0xf bound_ctrl:1
    v_fmac_f32_dpp v39, -v47, v95 row_shr:4 row_mask:0xf bank_mask:0xf bound_ctrl:1
    v_fmac_f32_dpp v40, v40, v80 row_shr:4 row_mask:0xf bank_mask:0xf bound_ctrl:1
    v_fmac_f32_dpp v41, v41, v81 row_shr:4 row_mask:0xf bank_mask:0xf bound_ctrl:1
    v_fmac_f32_dpp v42, v42, v82 row_shr:4 row_mask:0xf bank_mask:0xf bound_ctrl:1
    v_fmac_f32_dpp v43, v43, v83 row_shr:4 row_mask:0xf bank_mask:0xf bound_ctrl:1
    v_fmac_f32_dpp v44, v44, v84 row_shr:4 row_mask:0xf bank_mask:0xf bound_ctrl:1
    v_fmac_f32_dpp v45, v45, v85 row_shr:4 row_mask:0xf bank_mask:0xf bound_ctrl:1
    v_fmac_f32_dpp v46, v46, v86 row_shr:4 row_mask:0xf bank_mask:0xf bound_ctrl:1
    v_fmac_f32_dpp v47, v47, v87 row_shr:4 row_mask:0xf bank_mask:0xf bound_ctrl:1
    v_fmac_f32_dpp v40, v128, v88 row_shr:4 row_mask:0xf bank_mask:0xf bound_ctrl:1
    v_fmac_f32_dpp v41, v129, v89 row_shr:4 row_mask:0xf bank_mask:0xf bound_ctrl:1
    v_fmac_f32_dpp v42, v130, v90 row_shr:4 row_mask:0xf bank_mask:0xf bound_ctrl:1
    v_fmac_f32_dpp v43, v131, v91 row_shr:4 row_mask:0xf bank_mask:0xf bound_ctrl:1
    v_fmac_f32_dpp v44, v132, v92 row_shr:4 row_mask:0xf bank_mask:0xf bound_ctrl:1
    v_fmac_f32_dpp v45, v133, v93 row_shr:4 row_mask:0xf bank_mask:0xf bound_ctrl:1
    v_fmac_f32_dpp v46, v134, v94 row_shr:4 row_mask:0xf bank_mask:0xf bound_ctrl:1
    v_fmac_f32_dpp v47, v135, v95 row_shr:4 row_mask:0xf bank_mask:0xf bound_ctrl:1
    v_mov_b32 v128, v48
    v_mov_b32 v129, v49
    v_mov_b32 v130, v50
    v_mov_b32 v131, v51
    v_mov_b32 v132, v52
    v_mov_b32 v133, v53
    v_mov_b32 v134, v54
    v_mov_b32 v135, v55
    v_fmac_f32_dpp v48, v48, v80 row_shr:4 row_mask:0xf bank_mask:0xf bound_ctrl:1
    v_fmac_f32_dpp v49, v49, v81 row_shr:4 row_mask:0xf bank_mask:0xf bound_ctrl:1
    v_fmac_f32_dpp v50, v50, v82 row_shr:4 row_mask:0xf bank_mask:0xf bound_ctrl:1
    v_fmac_f32_dpp v51, v51, v83 row_shr:4 row_mask:0xf bank_mask:0xf bound_ctrl:1
    v_fmac_f32_dpp v52, v52, v84 row_shr:4 row_mask:0xf bank_mask:0xf bound_ctrl:1
    v_fmac_f32_dpp v53, v53, v85 row_shr:4 row_mask:0xf bank_mask:0xf bound_ctrl:1
    v_fmac_f32_dpp v54, v54, v86 row_shr:4 row_mask:0xf bank_mask:0xf bound_ctrl:1
    v_fmac_f32_dpp v55, v55, v87 row_shr:4 row_mask:0xf bank_mask:0xf bound_ctrl:1
    v_fmac_f32_dpp v48, -v56, v88 row_shr:4 row_mask:0xf bank_mask:0xf bound_ctrl:1
    v_fmac_f32_dpp v49, -v57, v89 row_shr:4 row_mask:0xf bank_mask:0xf bound_ctrl:1
    v_fmac_f32_dpp v50, -v58, v90 row_shr:4 row_mask:0xf bank_mask:0xf bound_ctrl:1
    v_fmac_f32_dpp v51, -v59, v91 row_shr:4 row_mask:0xf bank_mask:0xf bound_ctrl:1
    v_fmac_f32_dpp v52, -v60, v92 row_shr:4 row_mask:0xf bank_mask:0xf bound_ctrl:1
    v_fmac_f32_dpp v53, -v61, v93 row_shr:4 row_mask:0xf bank_mask:0xf bound_ctrl:1
    v_fmac_f32_dpp v54, -v62, v94 row_shr:4 row_mask:0xf bank_mask:0xf bound_ctrl:1
    v_fmac_f32_dpp v55, -v63, v95 row_shr:4 row_mask:0xf bank_mask:0xf bound_ctrl:1
    v_fmac_f32_dpp v56, v56, v80 row_shr:4 row_mask:0xf bank_mask:0xf bound_ctrl:1
    v_fmac_f32_dpp v57, v57, v81 row_shr:4 row_mask:0xf bank_mask:0xf bound_ctrl:1
    v_fmac_f32_dpp v58, v58, v82 row_shr:4 row_mask:0xf bank_mask:0xf bound_ctrl:1
    v_fmac_f32_dpp v59, v59, v83 row_shr:4 row_mask:0xf bank_mask:0xf bound_ctrl:1
    v_fmac_f32_dpp v60, v60, v84 row_shr:4 row_mask:0xf bank_mask:0xf bound_ctrl:1
    v_fmac_f32_dpp v61, v61, v85 row_shr:4 row_mask:0xf bank_mask:0xf bound_ctrl:1
    v_fmac_f32_dpp v62, v62, v86 row_shr:4 row_mask:0xf bank_mask:0xf bound_ctrl:1
    v_fmac_f32_dpp v63, v63, v87 row_shr:4 row_mask:0xf bank_mask:0xf bound_ctrl:1
    v_fmac_f32_dpp v56, v128, v88 row_shr:4 row_mask:0xf bank_mask:0xf bound_ctrl:1
    v_fmac_f32_dpp v57, v129, v89 row_shr:4 row_mask:0xf bank_mask:0xf bound_ctrl:1
    v_fmac_f32_dpp v58, v130, v90 row_shr:4 row_mask:0xf bank_mask:0xf bound_ctrl:1
    v_fmac_f32_dpp v59, v131, v91 row_shr:4 row_mask:0xf bank_mask:0xf bound_ctrl:1
    v_fmac_f32_dpp v60, v132, v92 row_shr:4 row_mask:0xf bank_mask:0xf bound_ctrl:1
    v_fmac_f32_dpp v61, v133, v93 row_shr:4 row_mask:0xf bank_mask:0xf bound_ctrl:1
    v_fmac_f32_dpp v62, v134, v94 row_shr:4 row_mask:0xf bank_mask:0xf bound_ctrl:1
    v_fmac_f32_dpp v63, v135, v95 row_shr:4 row_mask:0xf bank_mask:0xf bound_ctrl:1
    v_mul_f32 v128, v88, v88
    v_add_f32 v129, v80, v80
    v_fma_f32 v80, v80, v80, -v128
    v_mul_f32 v88, v129, v88
    v_mul_f32 v128, v89, v89
    v_add_f32 v129, v81, v81
    v_fma_f32 v81, v81, v81, -v128
    v_mul_f32 v89, v129, v89
    v_mul_f32 v128, v90, v90
    v_add_f32 v129, v82, v82
    v_fma_f32 v82, v82, v82, -v128
    v_mul_f32 v90, v129, v90
    v_mul_f32 v128, v91, v91
    v_add_f32 v129, v83, v83
    v_fma_f32 v83, v83, v83, -v128
    v_mul_f32 v91, v129, v91
    v_mul_f32 v128, v92, v92
    v_add_f32 v129, v84, v84
    v_fma_f32 v84, v84, v84, -v128
    v_mul_f32 v92, v129, v92
    v_mul_f32 v128, v93, v93
    v_add_f32 v129, v85, v85
    v_fma_f32 v85, v85, v85, -v128
    v_mul_f32 v93, v129, v93
    v_mul_f32 v128, v94, v94
    v_add_f32 v129, v86, v86
    v_fma_f32 v86, v86, v86, -v128
    v_mul_f32 v94, v129, v94
    v_mul_f32 v128, v95, v95
    v_add_f32 v129, v87, v87
    v_fma_f32 v87, v87, v87, -v128
    v_mul_f32 v95, v129, v95
    v_mov_b32 v128, v32
    v_mov_b32 v129, v33
    v_mov_b32 v130, v34
    v_mov_b32 v131, v35
    v_mov_b32 v132, v36
    v_mov_b32 v133, v37
    v_mov_b32 v134, v38
    v_mov_b32 v135, v39
    v_fmac_f32_dpp v32, v32, v80 row_shr:8 row_mask:0xf bank_mask:0xf bound_ctrl:1
    v_fmac_f32_dpp v33, v33, v81 row_shr:8 row_mask:0xf bank_mask:0xf bound_ctrl:1
    v_fmac_f32_dpp v34, v34, v82 row_shr:8 row_mask:0xf bank_mask:0xf bound_ctrl:1
    v_fmac_f32_dpp v35, v35, v83 row_shr:8 row_mask:0xf bank_mask:0xf bound_ctrl:1
    v_fmac_f32_dpp v36, v36, v84 row_shr:8 row_mask:0xf bank_mask:0xf bound_ctrl:1
    v_fmac_f32_dpp v37, v37, v85 row_shr:8 row_mask:0xf bank_mask:0xf bound_ctrl:1
    v_fmac_f32_dpp v38, v38, v86 row_shr:8 row_mask:0xf bank_mask:0xf bound_ctrl:1
    v_fmac_f32_dpp v39, v39, v87 row_shr:8 row_mask:0xf bank_mask:0xf bound_ctrl:1
    v_fmac_f32_dpp v32, -v40, v88 row_shr:8 row_mask:0xf bank_mask:0xf bound_ctrl:1
    v_fmac_f32_dpp v33, -v41, v89 row_shr:8 row_mask:0xf bank_mask:0xf bound_ctrl:1
    v_fmac_f32_dpp v34, -v42, v90 row_shr:8 row_mask:0xf bank_mask:0xf bound_ctrl:1
    v_fmac_f32_dpp v35, -v43, v91 row_shr:8 row_mask:0xf bank_mask:0xf bound_ctrl:1
    v_fmac_f32_dpp v36, -v44, v92 row_shr:8 row_mask:0xf bank_mask:0xf bound_ctrl:1
    v_fmac_f32_dpp v37, -v45, v93 row_shr:8 row_mask:0xf bank_mask:0xf bound_ctrl:1
    v_fmac_f32_dpp v38, -v46, v94 row_shr:8 row_mask:0xf bank_mask:0xf bound_ctrl:1
    v_fmac_f32_dpp v39, -v47, v95 row_shr:8 row_mask:0xf bank_mask:0xf bound_ctrl:1
    v_fmac_f32_dpp v40, v40, v80 row_shr:8 row_mask:0xf bank_mask:0xf bound_ctrl:1
    v_fmac_f32_dpp v41, v41, v81 row_shr:8 row_mask:0xf bank_mask:0xf bound_ctrl:1
    v_fmac_f32_dpp v42, v42, v82 row_shr:8 row_mask:0xf bank_mask:0xf bound_ctrl:1
    v_fmac_f32_dpp v43, v43, v83 row_shr:8 row_mask:0xf bank_mask:0xf bound_ctrl:1
    v_fmac_f32_dpp v44, v44, v84 row_shr:8 row_mask:0xf bank_mask:0xf bound_ctrl:1
    v_fmac_f32_dpp v45, v45, v85 row_shr:8 row_mask:0xf bank_mask:0xf bound_ctrl:1
    v_fmac_f32_dpp v46, v46, v86 row_shr:8 row_mask:0xf bank_mask:0xf bound_ctrl:1
    v_fmac_f32_dpp v47, v47, v87 row_shr:8 row_mask:0xf bank_mask:0xf bound_ctrl:1
    v_fmac_f32_dpp v40, v128, v88 row_shr:8 row_mask:0xf bank_mask:0xf bound_ctrl:1
    v_fmac_f32_dpp v41, v129, v89 row_shr:8 row_mask:0xf bank_mask:0xf bound_ctrl:1
    v_fmac_f32_dpp v42, v130, v90 row_shr:8 row_mask:0xf bank_mask:0xf bound_ctrl:1
    v_fmac_f32_dpp v43, v131, v91 row_shr:8 row_mask:0xf bank_mask:0xf bound_ctrl:1
    v_fmac_f32_dpp v44, v132, v92 row_shr:8 row_mask:0xf bank_mask:0xf bound_ctrl:1
    v_fmac_f32_dpp v45, v133, v93 row_shr:8 row_mask:0xf bank_mask:0xf bound_ctrl:1
    v_fmac_f32_dpp v46, v134, v94 row_shr:8 row_mask:0xf bank_mask:0xf bound_ctrl:1
    v_fmac_f32_dpp v47, v135, v95 row_shr:8 row_mask:0xf bank_mask:0xf bound_ctrl:1
    v_mov_b32 v128, v48
    v_mov_b32 v129, v49
    v_mov_b32 v130, v50
    v_mov_b32 v131, v51
    v_mov_b32 v132, v52
    v_mov_b32 v133, v53
    v_mov_b32 v134, v54
    v_mov_b32 v135, v55
    v_fmac_f32_dpp v48, v48, v80 row_shr:8 row_mask:0xf bank_mask:0xf bound_ctrl:1
    v_fmac_f32_dpp v49, v49, v81 row_shr:8 row_mask:0xf bank_mask:0xf bound_ctrl:1
    v_fmac_f32_dpp v50, v50, v82 row_shr:8 row_mask:0xf bank_mask:0xf bound_ctrl:1
    v_fmac_f32_dpp v51, v51, v83 row_shr:8 row_mask:0xf bank_mask:0xf bound_ctrl:1
    v_fmac_f32_dpp v52, v52, v84 row_shr:8 row_mask:0xf bank_mask:0xf bound_ctrl:1
    v_fmac_f32_dpp v53, v53, v85 row_shr:8 row_mask:0xf bank_mask:0xf bound_ctrl:1
    v_fmac_f32_dpp v54, v54, v86 row_shr:8 row_mask:0xf bank_mask:0xf bound_ctrl:1
    v_fmac_f32_dpp v55, v55, v87 row_shr:8 row_mask:0xf bank_mask:0xf bound_ctrl:1
    v_fmac_f32_dpp v48, -v56, v88 row_shr:8 row_mask:0xf bank_mask:0xf bound_ctrl:1
    v_fmac_f32_dpp v49, -v57, v89 row_shr:8 row_mask:0xf bank_mask:0xf bound_ctrl:1
    v_fmac_f32_dpp v50, -v58, v90 row_shr:8 row_mask:0xf bank_mask:0xf bound_ctrl:1
    v_fmac_f32_dpp v51, -v59, v91 row_shr:8 row_mask:0xf bank_mask:0xf bound_ctrl:1
    v_fmac_f32_dpp v52, -v60, v92 row_shr:8 row_mask:0xf bank_mask:0xf bound_ctrl:1
    v_fmac_f32_dpp v53, -v61, v93 row_shr:8 row_mask:0xf bank_mask:0xf bound_ctrl:1
    v_fmac_f32_dpp v54, -v62, v94 row_shr:8 row_mask:0xf bank_mask:0xf bound_ctrl:1
    v_fmac_f32_dpp v55, -v63, v95 row_shr:8 row_mask:0xf bank_mask:0xf bound_ctrl:1
    v_fmac_f32_dpp v56, v56, v80 row_shr:8 row_mask:0xf bank_mask:0xf bound_ctrl:1
    v_fmac_f32_dpp v57, v57, v81 row_shr:8 row_mask:0xf bank_mask:0xf bound_ctrl:1
    v_fmac_f32_dpp v58, v58, v82 row_shr:8 row_mask:0xf bank_mask:0xf bound_ctrl:1
    v_fmac_f32_dpp v59, v59, v83 row_shr:8 row_mask:0xf bank_mask:0xf bound_ctrl:1
    v_fmac_f32_dpp v60, v60, v84 row_shr:8 row_mask:0xf bank_mask:0xf bound_ctrl:1
    v_fmac_f32_dpp v61, v61, v85 row_shr:8 row_mask:0xf bank_mask:0xf bound_ctrl:1
    v_fmac_f32_dpp v62, v62, v86 row_shr:8 row_mask:0xf bank_mask:0xf bound_ctrl:1
    v_fmac_f32_dpp v63, v63, v87 row_shr:8 row_mask:0xf bank_mask:0xf bound_ctrl:1
    v_fmac_f32_dpp v56, v128, v88 row_shr:8 row_mask:0xf bank_mask:0xf bound_ctrl:1
    v_fmac_f32_dpp v57, v129, v89 row_shr:8 row_mask:0xf bank_mask:0xf bound_ctrl:1
    v_fmac_f32_dpp v58, v130, v90 row_shr:8 row_mask:0xf bank_mask:0xf bound_ctrl:1
    v_fmac_f32_dpp v59, v131, v91 row_shr:8 row_mask:0xf bank_mask:0xf bound_ctrl:1
    v_fmac_f32_dpp v60, v132, v92 row_shr:8 row_mask:0xf bank_mask:0xf bound_ctrl:1
    v_fmac_f32_dpp v61, v133, v93 row_shr:8 row_mask:0xf bank_mask:0xf bound_ctrl:1
    v_fmac_f32_dpp v62, v134, v94 row_shr:8 row_mask:0xf bank_mask:0xf bound_ctrl:1
    v_fmac_f32_dpp v63, v135, v95 row_shr:8 row_mask:0xf bank_mask:0xf bound_ctrl:1
    v_and_b32 v31, 15, v0
    v_add_u32 v31, 1, v31
    v_cvt_f32_u32 v31, v31
    v_mul_f32 v128, v31, v64
    v_mul_f32 v88, v31, v72
    v_exp_f32 v128, v128
    v_fract_f32 v88, v88
    v_mul_f32 v129, v31, v65
    v_mul_f32 v89, v31, v73
    v_exp_f32 v129, v129
    v_fract_f32 v89, v89
    v_mul_f32 v130, v31, v66
    v_mul_f32 v90, v31, v74
    v_exp_f32 v130, v130
    v_fract_f32 v90, v90
    v_mul_f32 v131, v31, v67
    v_mul_f32 v91, v31, v75
    v_exp_f32 v131, v131
    v_fract_f32 v91, v91
    v_mul_f32 v132, v31, v68
    v_mul_f32 v92, v31, v76
    v_exp_f32 v132, v132
    v_fract_f32 v92, v92
    v_mul_f32 v133, v31, v69
    v_mul_f32 v93, v31, v77
    v_exp_f32 v133, v133
    v_fract_f32 v93, v93
    v_mul_f32 v134, v31, v70
    v_mul_f32 v94, v31, v78
    v_exp_f32 v134, v134
    v_fract_f32 v94, v94
    v_mul_f32 v135, v31, v71
    v_mul_f32 v95, v31, v79
    v_exp_f32 v135, v135
    v_fract_f32 v95, v95
    v_cos_f32 v80, v88
    v_sin_f32 v88, v88
    v_cos_f32 v81, v89
    v_sin_f32 v89, v89
    v_cos_f32 v82, v90
    v_sin_f32 v90, v90
    v_cos_f32 v83, v91
    v_sin_f32 v91, v91
    v_cos_f32 v84, v92
    v_sin_f32 v92, v92
    v_cos_f32 v85, v93
    v_sin_f32 v93, v93
    v_cos_f32 v86, v94
    v_sin_f32 v94, v94
    v_cos_f32 v87, v95
    v_sin_f32 v95, v95
    s_nop 0
    v_mul_f32 v80, v80, v128
    v_mul_f32 v88, v88, v128
    v_mul_f32 v81, v81, v129
    v_mul_f32 v89, v89, v129
    v_mul_f32 v82, v82, v130
    v_mul_f32 v90, v90, v130
    v_mul_f32 v83, v83, v131
    v_mul_f32 v91, v91, v131
    v_mul_f32 v84, v84, v132
    v_mul_f32 v92, v92, v132
    v_mul_f32 v85, v85, v133
    v_mul_f32 v93, v93, v133
    v_mul_f32 v86, v86, v134
    v_mul_f32 v94, v94, v134
    v_mul_f32 v87, v87, v135
    v_mul_f32 v95, v95, v135
    v_fmac_f32_dpp v32, v32, v80 row_bcast:15 row_mask:0xa bank_mask:0xf
    v_fmac_f32_dpp v33, v33, v81 row_bcast:15 row_mask:0xa bank_mask:0xf
    v_fmac_f32_dpp v34, v34, v82 row_bcast:15 row_mask:0xa bank_mask:0xf
    v_fmac_f32_dpp v35, v35, v83 row_bcast:15 row_mask:0xa bank_mask:0xf
    v_fmac_f32_dpp v36, v36, v84 row_bcast:15 row_mask:0xa bank_mask:0xf
    v_fmac_f32_dpp v37, v37, v85 row_bcast:15 row_mask:0xa bank_mask:0xf
    v_fmac_f32_dpp v38, v38, v86 row_bcast:15 row_mask:0xa bank_mask:0xf
    v_fmac_f32_dpp v39, v39, v87 row_bcast:15 row_mask:0xa bank_mask:0xf
    v_fmac_f32_dpp v32, -v40, v88 row_bcast:15 row_mask:0xa bank_mask:0xf
    v_fmac_f32_dpp v33, -v41, v89 row_bcast:15 row_mask:0xa bank_mask:0xf
    v_fmac_f32_dpp v34, -v42, v90 row_bcast:15 row_mask:0xa bank_mask:0xf
    v_fmac_f32_dpp v35, -v43, v91 row_bcast:15 row_mask:0xa bank_mask:0xf
    v_fmac_f32_dpp v36, -v44, v92 row_bcast:15 row_mask:0xa bank_mask:0xf
    v_fmac_f32_dpp v37, -v45, v93 row_bcast:15 row_mask:0xa bank_mask:0xf
    v_fmac_f32_dpp v38, -v46, v94 row_bcast:15 row_mask:0xa bank_mask:0xf
    v_fmac_f32_dpp v39, -v47, v95 row_bcast:15 row_mask:0xa bank_mask:0xf
    v_fmac_f32_dpp v40, v40, v80 row_bcast:15 row_mask:0xa bank_mask:0xf
    v_fmac_f32_dpp v41, v41, v81 row_bcast:15 row_mask:0xa bank_mask:0xf
    v_fmac_f32_dpp v42, v42, v82 row_bcast:15 row_mask:0xa bank_mask:0xf
    v_fmac_f32_dpp v43, v43, v83 row_bcast:15 row_mask:0xa bank_mask:0xf
    v_fmac_f32_dpp v44, v44, v84 row_bcast:15 row_mask:0xa bank_mask:0xf
    v_fmac_f32_dpp v45, v45, v85 row_bcast:15 row_mask:0xa bank_mask:0xf
    v_fmac_f32_dpp v46, v46, v86 row_bcast:15 row_mask:0xa bank_mask:0xf
    v_fmac_f32_dpp v47, v47, v87 row_bcast:15 row_mask:0xa bank_mask:0xf
    v_fmac_f32_dpp v40, v32, v88 row_bcast:15 row_mask:0xa bank_mask:0xf
    v_fmac_f32_dpp v41, v33, v89 row_bcast:15 row_mask:0xa bank_mask:0xf
    v_fmac_f32_dpp v42, v34, v90 row_bcast:15 row_mask:0xa bank_mask:0xf
    v_fmac_f32_dpp v43, v35, v91 row_bcast:15 row_mask:0xa bank_mask:0xf
    v_fmac_f32_dpp v44, v36, v92 row_bcast:15 row_mask:0xa bank_mask:0xf
    v_fmac_f32_dpp v45, v37, v93 row_bcast:15 row_mask:0xa bank_mask:0xf
    v_fmac_f32_dpp v46, v38, v94 row_bcast:15 row_mask:0xa bank_mask:0xf
    v_fmac_f32_dpp v47, v39, v95 row_bcast:15 row_mask:0xa bank_mask:0xf
    v_fmac_f32_dpp v48, v48, v80 row_bcast:15 row_mask:0xa bank_mask:0xf
    v_fmac_f32_dpp v49, v49, v81 row_bcast:15 row_mask:0xa bank_mask:0xf
    v_fmac_f32_dpp v50, v50, v82 row_bcast:15 row_mask:0xa bank_mask:0xf
    v_fmac_f32_dpp v51, v51, v83 row_bcast:15 row_mask:0xa bank_mask:0xf
    v_fmac_f32_dpp v52, v52, v84 row_bcast:15 row_mask:0xa bank_mask:0xf
    v_fmac_f32_dpp v53, v53, v85 row_bcast:15 row_mask:0xa bank_mask:0xf
    v_fmac_f32_dpp v54, v54, v86 row_bcast:15 row_mask:0xa bank_mask:0xf
    v_fmac_f32_dpp v55, v55, v87 row_bcast:15 row_mask:0xa bank_mask:0xf
    v_fmac_f32_dpp v48, -v56, v88 row_bcast:15 row_mask:0xa bank_mask:0xf
    v_fmac_f32_dpp v49, -v57, v89 row_bcast:15 row_mask:0xa bank_mask:0xf
    v_fmac_f32_dpp v50, -v58, v90 row_bcast:15 row_mask:0xa bank_mask:0xf
    v_fmac_f32_dpp v51, -v59, v91 row_bcast:15 row_mask:0xa bank_mask:0xf
    v_fmac_f32_dpp v52, -v60, v92 row_bcast:15 row_mask:0xa bank_mask:0xf
    v_fmac_f32_dpp v53, -v61, v93 row_bcast:15 row_mask:0xa bank_mask:0xf
    v_fmac_f32_dpp v54, -v62, v94 row_bcast:15 row_mask:0xa bank_mask:0xf
    v_fmac_f32_dpp v55, -v63, v95 row_bcast:15 row_mask:0xa bank_mask:0xf
    v_fmac_f32_dpp v56, v56, v80 row_bcast:15 row_mask:0xa bank_mask:0xf
    v_fmac_f32_dpp v57, v57, v81 row_bcast:15 row_mask:0xa bank_mask:0xf
    v_fmac_f32_dpp v58, v58, v82 row_bcast:15 row_mask:0xa bank_mask:0xf
    v_fmac_f32_dpp v59, v59, v83 row_bcast:15 row_mask:0xa bank_mask:0xf
    v_fmac_f32_dpp v60, v60, v84 row_bcast:15 row_mask:0xa bank_mask:0xf
    v_fmac_f32_dpp v61, v61, v85 row_bcast:15 row_mask:0xa bank_mask:0xf
    v_fmac_f32_dpp v62, v62, v86 row_bcast:15 row_mask:0xa bank_mask:0xf
    v_fmac_f32_dpp v63, v63, v87 row_bcast:15 row_mask:0xa bank_mask:0xf
    v_fmac_f32_dpp v56, v48, v88 row_bcast:15 row_mask:0xa bank_mask:0xf
    v_fmac_f32_dpp v57, v49, v89 row_bcast:15 row_mask:0xa bank_mask:0xf
    v_fmac_f32_dpp v58, v50, v90 row_bcast:15 row_mask:0xa bank_mask:0xf
    v_fmac_f32_dpp v59, v51, v91 row_bcast:15 row_mask:0xa bank_mask:0xf
    v_fmac_f32_dpp v60, v52, v92 row_bcast:15 row_mask:0xa bank_mask:0xf
    v_fmac_f32_dpp v61, v53, v93 row_bcast:15 row_mask:0xa bank_mask:0xf
    v_fmac_f32_dpp v62, v54, v94 row_bcast:15 row_mask:0xa bank_mask:0xf
    v_fmac_f32_dpp v63, v55, v95 row_bcast:15 row_mask:0xa bank_mask:0xf
    s_lshl_b32 s45, s33, 7
    s_add_u32 s45, s45, 132096
    v_lshl_add_u32 v31, v17, 5, s45
    s_mov_b32 exec_lo, 0x80000000
    s_mov_b32 exec_hi, 0x80000000
    ds_write_b128 v31, v[32:35] offset:0
    ds_write_b128 v31, v[36:39] offset:16
    ds_write_b128 v31, v[40:43] offset:64
    ds_write_b128 v31, v[44:47] offset:80
    ds_write_b128 v31, v[48:51] offset:512
    ds_write_b128 v31, v[52:55] offset:528
    ds_write_b128 v31, v[56:59] offset:576
    ds_write_b128 v31, v[60:63] offset:592
    s_mov_b64 exec, -1
    v_lshlrev_b32 v192, 16, v192
    v_lshlrev_b32 v193, 16, v193
    v_lshlrev_b32 v194, 16, v194
    v_mul_f32 v194, 1069066811, v194
    v_exp_f32 v194, v194
    s_nop 0
    v_cvt_pk_bf16_f32 v194, v194, v194
    v_and_b32 v194, 0xffff0000, v194
    v_mul_f32 v192, v194, v192
    v_mul_f32 v193, v194, v193
    v_mul_f32 v192, 1069066811, v192
    v_mul_f32 v193, 0.15915494, v193
    v_mul_f32 v194, 0x42000000, v192
    v_mul_f32 v197, 0x42000000, v193
    v_exp_f32 v194, v194
    v_fract_f32 v197, v197
    v_cos_f32 v196, v197
    v_sin_f32 v197, v197
    s_nop 0
    v_mul_f32 v196, v196, v194
    v_mul_f32 v197, v197, v194
    v_mul_f32 v194, 0x43800000, v192
    v_mul_f32 v199, 0x43800000, v193
    v_exp_f32 v194, v194
    v_fract_f32 v199, v199
    v_cos_f32 v198, v199
    v_sin_f32 v199, v199
    s_nop 0
    v_mul_f32 v198, v198, v194
    v_mul_f32 v199, v199, v194
    v_add_u32 v31, 1, v16
    v_cvt_f32_u32 v31, v31
    v_mul_f32 v128, v31, v64
    v_mul_f32 v88, v31, v72
    v_exp_f32 v128, v128
    v_fract_f32 v88, v88
    v_mul_f32 v129, v31, v65
    v_mul_f32 v89, v31, v73
    v_exp_f32 v129, v129
    v_fract_f32 v89, v89
    v_mul_f32 v130, v31, v66
    v_mul_f32 v90, v31, v74
    v_exp_f32 v130, v130
    v_fract_f32 v90, v90
    v_mul_f32 v131, v31, v67
    v_mul_f32 v91, v31, v75
    v_exp_f32 v131, v131
    v_fract_f32 v91, v91
    v_mul_f32 v132, v31, v68
    v_mul_f32 v92, v31, v76
    v_exp_f32 v132, v132
    v_fract_f32 v92, v92
    v_mul_f32 v133, v31, v69
    v_mul_f32 v93, v31, v77
    v_exp_f32 v133, v133
    v_fract_f32 v93, v93
    v_mul_f32 v134, v31, v70
    v_mul_f32 v94, v31, v78
    v_exp_f32 v134, v134
    v_fract_f32 v94, v94
    v_mul_f32 v135, v31, v71
    v_mul_f32 v95, v31, v79
    v_exp_f32 v135, v135
    v_fract_f32 v95, v95
    v_cos_f32 v80, v88
    v_sin_f32 v88, v88
    v_cos_f32 v81, v89
    v_sin_f32 v89, v89
    v_cos_f32 v82, v90
    v_sin_f32 v90, v90
    v_cos_f32 v83, v91
    v_sin_f32 v91, v91
    v_cos_f32 v84, v92
    v_sin_f32 v92, v92
    v_cos_f32 v85, v93
    v_sin_f32 v93, v93
    v_cos_f32 v86, v94
    v_sin_f32 v94, v94
    v_cos_f32 v87, v95
    v_sin_f32 v95, v95
    s_nop 0
    v_mul_f32 v80, v80, v128
    v_mul_f32 v88, v88, v128
    v_mul_f32 v81, v81, v129
    v_mul_f32 v89, v89, v129
    v_mul_f32 v82, v82, v130
    v_mul_f32 v90, v90, v130
    v_mul_f32 v83, v83, v131
    v_mul_f32 v91, v91, v131
    v_mul_f32 v84, v84, v132
    v_mul_f32 v92, v92, v132
    v_mul_f32 v85, v85, v133
    v_mul_f32 v93, v93, v133
    v_mul_f32 v86, v86, v134
    v_mul_f32 v94, v94, v134
    v_mul_f32 v87, v87, v135
    v_mul_f32 v95, v95, v135
    v_lshlrev_b32 v29, 2, v29
    v_add_u32 v31, 132096, v29
    s_waitcnt vmcnt(0)
    ds_write_b128 v13, a[220:223] offset:0
    ds_write_b128 v13, a[228:231] offset:1024
    ds_write_b128 v13, a[236:239] offset:2048
    ds_write_b128 v13, a[244:247] offset:3072
    s_waitcnt lgkmcnt(0)
    s_barrier
    ds_read_b128 a[0:3], v12 offset:0
    ds_read_b128 a[8:11], v12 offset:1024
    ds_read_b128 a[16:19], v12 offset:2048
    ds_read_b128 a[24:27], v12 offset:3072
    ds_read_b128 a[32:35], v12 offset:4096
    ds_read_b128 a[40:43], v12 offset:5120
    ds_read_b128 a[48:51], v12 offset:6144
    ds_read_b128 a[56:59], v12 offset:7168
    ds_read_b128 a[64:67], v12 offset:8192
    ds_read_b128 a[72:75], v12 offset:9216
    ds_read_b128 a[80:83], v12 offset:10240
    ds_read_b128 a[88:91], v12 offset:11264
    ds_read_b128 a[96:99], v12 offset:12288
    ds_read_b128 a[104:107], v12 offset:13312
    ds_read_b128 a[112:115], v12 offset:14336
    ds_read_b128 a[120:123], v12 offset:15360
    s_waitcnt lgkmcnt(0)
    s_barrier
    ds_write_b128 v13, a[224:227] offset:0
    ds_write_b128 v13, a[232:235] offset:1024
    ds_write_b128 v13, a[240:243] offset:2048
    ds_write_b128 v13, a[248:251] offset:3072
    s_waitcnt lgkmcnt(0)
    s_barrier
    ds_read_b128 a[4:7], v12 offset:0
    ds_read_b128 a[12:15], v12 offset:1024
    ds_read_b128 a[20:23], v12 offset:2048
    ds_read_b128 a[28:31], v12 offset:3072
    ds_read_b128 a[36:39], v12 offset:4096
    ds_read_b128 a[44:47], v12 offset:5120
    ds_read_b128 a[52:55], v12 offset:6144
    ds_read_b128 a[60:63], v12 offset:7168
    ds_read_b128 a[68:71], v12 offset:8192
    ds_read_b128 a[76:79], v12 offset:9216
    ds_read_b128 a[84:87], v12 offset:10240
    ds_read_b128 a[92:95], v12 offset:11264
    ds_read_b128 a[100:103], v12 offset:12288
    ds_read_b128 a[108:111], v12 offset:13312
    ds_read_b128 a[116:119], v12 offset:14336
    ds_read_b128 a[124:127], v12 offset:15360
    s_waitcnt lgkmcnt(0)
    s_barrier
    ds_read2_b32 v[200:201], v31 offset0:0 offset1:16
    ds_read2_b32 v[202:203], v31 offset0:32 offset1:48
    ds_read2_b32 v[204:205], v31 offset0:64 offset1:80
    ds_read2_b32 v[206:207], v31 offset0:96 offset1:112
    ds_read2_b32 v[208:209], v31 offset0:128 offset1:144
    ds_read2_b32 v[210:211], v31 offset0:160 offset1:176
    ds_read2_b32 v[212:213], v31 offset0:192 offset1:208
    ds_read2_b32 v[214:215], v31 offset0:224 offset1:240
    s_waitcnt lgkmcnt(0)
    v_mov_b32 v216, v200
    v_mov_b32 v217, v201
    v_fma_f32 v218, v196, v216, v202
    v_fma_f32 v219, v196, v217, v203
    v_fma_f32 v218, -v197, v217, v218
    v_fma_f32 v217, v197, v216, v219
    v_mov_b32 v216, v218
    v_fma_f32 v218, v196, v216, v204
    v_fma_f32 v219, v196, v217, v205
    v_fma_f32 v218, -v197, v217, v218
    v_fma_f32 v217, v197, v216, v219
    v_mov_b32 v216, v218
    v_fma_f32 v218, v196, v216, v206
    v_fma_f32 v219, v196, v217, v207
    v_fma_f32 v218, -v197, v217, v218
    v_fma_f32 v217, v197, v216, v219
    v_mov_b32 v216, v218
    v_fma_f32 v218, v196, v216, v208
    v_fma_f32 v219, v196, v217, v209
    v_fma_f32 v218, -v197, v217, v218
    v_fma_f32 v217, v197, v216, v219
    v_mov_b32 v216, v218
    v_fma_f32 v218, v196, v216, v210
    v_fma_f32 v219, v196, v217, v211
    v_fma_f32 v218, -v197, v217, v218
    v_fma_f32 v217, v197, v216, v219
    v_mov_b32 v216, v218
    v_fma_f32 v218, v196, v216, v212
    v_fma_f32 v219, v196, v217, v213
    v_fma_f32 v218, -v197, v217, v218
    v_fma_f32 v217, v197, v216, v219
    v_mov_b32 v216, v218
    v_fma_f32 v218, v196, v216, v214
    v_fma_f32 v219, v196, v217, v215
    v_fma_f32 v218, -v197, v217, v218
    v_fma_f32 v217, v197, v216, v219
    v_mov_b32 v216, v218
    v_min_u32 v216, -2, v216
    v_min_u32 v217, -2, v217
    v_lshlrev_b32 v30, 1, v29
    s_lshl_b32 s47, s32, 7
    s_add_u32 s47, s47, 52428800
    s_lshl_b32 s45, s34, 12
    s_add_u32 s45, s45, s47
    s_cmp_eq_u32 s33, 0
    s_cselect_b32 s45, s45, 0x70000000
    buffer_store_dwordx2 v[216:217], v30, s[4:7], s45 offen sc1
    v_and_b32 v31, 7, v0
    v_cmp_ge_u32 s[50:51], s34, v31
    v_lshlrev_b32 v31, 2, v31
    v_mov_b32 v216, 0
    v_mov_b32 v217, 0
    s_mov_b32 s41, 0
L_h_wk:
    buffer_load_dword v218, v31, s[24:27], 0 offen offset:140 sc1
    s_waitcnt vmcnt(0)
    v_cmp_gt_u32 vcc, 32, v218
    s_and_b64 vcc, vcc, s[50:51]
    s_cbranch_vccz L_h_wa
    s_add_u32 s43, s43, 1
    s_cmp_gt_u32 s43, 1000000
    s_cbranch_scc1 L_end
    s_sleep 4
    s_branch L_h_wk
L_h_wa:
    s_cmp_ge_u32 s41, s34
    s_cbranch_scc1 L_h_wd
    buffer_load_dwordx2 v[220:221], v30, s[4:7], s47 offen sc1
    s_waitcnt vmcnt(0)
    v_max_u32 v218, v220, v221
    v_cmp_eq_u32 vcc, -1, v218
    s_cbranch_vccz L_h_wb
    s_add_u32 s43, s43, 1
    s_cmp_gt_u32 s43, 1000000
    s_cbranch_scc1 L_end
    s_sleep 4
    s_branch L_h_wa
L_h_wb:
    v_fma_f32 v218, v198, v216, v220
    v_fma_f32 v219, v198, v217, v221
    v_fma_f32 v218, -v199, v217, v218
    v_fma_f32 v217, v199, v216, v219
    v_mov_b32 v216, v218
    s_add_u32 s41, s41, 1
    s_add_u32 s47, s47, 4096
    s_branch L_h_wa
L_h_wd:
    s_lshl_b32 s45, s33, 10
    s_add_u32 s45, s45, 133120
    v_add_u32 v31, s45, v29
    ds_write2_b32 v31, v216, v217 offset0:0 offset1:16
    v_fma_f32 v218, v196, v216, v200
    v_fma_f32 v219, v196, v217, v201
    v_fma_f32 v218, -v197, v217, v218
    v_fma_f32 v217, v197, v216, v219
    v_mov_b32 v216, v218
    ds_write2_b32 v31, v216, v217 offset0:32 offset1:48
    v_fma_f32 v218, v196, v216, v202
    v_fma_f32 v219, v196, v217, v203
    v_fma_f32 v218, -v197, v217, v218
    v_fma_f32 v217, v197, v216, v219
    v_mov_b32 v216, v218
    ds_write2_b32 v31, v216, v217 offset0:64 offset1:80
    v_fma_f32 v218, v196, v216, v204
    v_fma_f32 v219, v196, v217, v205
    v_fma_f32 v218, -v197, v217, v218
    v_fma_f32 v217, v197, v216, v219
    v_mov_b32 v216, v218
    ds_write2_b32 v31, v216, v217 offset0:96 offset1:112
    v_fma_f32 v218, v196, v216, v206
    v_fma_f32 v219, v196, v217, v207
    v_fma_f32 v218, -v197, v217, v218
    v_fma_f32 v217, v197, v216, v219
    v_mov_b32 v216, v218
    ds_write2_b32 v31, v216, v217 offset0:128 offset1:144
    v_fma_f32 v218, v196, v216, v208
    v_fma_f32 v219, v196, v217, v209
    v_fma_f32 v218, -v197, v217, v218
    v_fma_f32 v217, v197, v216, v219
    v_mov_b32 v216, v218
    ds_write2_b32 v31, v216, v217 offset0:160 offset1:176
    v_fma_f32 v218, v196, v216, v210
    v_fma_f32 v219, v196, v217, v211
    v_fma_f32 v218, -v197, v217, v218
    v_fma_f32 v217, v197, v216, v219
    v_mov_b32 v216, v218
    ds_write2_b32 v31, v216, v217 offset0:192 offset1:208
    v_fma_f32 v218, v196, v216, v212
    v_fma_f32 v219, v196, v217, v213
    v_fma_f32 v218, -v197, v217, v218
    v_fma_f32 v217, v197, v216, v219
    v_mov_b32 v216, v218
    ds_write2_b32 v31, v216, v217 offset0:224 offset1:240
    s_lshl_b32 s46, s33, 7
    s_add_u32 s45, s45, s46
    v_lshl_add_u32 v31, v17, 5, s45
    s_waitcnt lgkmcnt(0)
    ds_read_b128 v[192:195], v31 offset:0
    ds_read_b128 v[196:199], v31 offset:16
    ds_read_b128 v[200:203], v31 offset:64
    ds_read_b128 v[204:207], v31 offset:80
    ds_read_b128 v[208:211], v31 offset:512
    ds_read_b128 v[212:215], v31 offset:528
    ds_read_b128 v[216:219], v31 offset:576
    ds_read_b128 v[220:223], v31 offset:592
    v_add_f32 v29, v15, v15
    v_add_f32 v30, v28, v28
    s_waitcnt lgkmcnt(0)
    v_fmac_f32 v32, v80, v192
    v_fmac_f32 v40, v80, v200
    v_fma_f32 v32, -v88, v200, v32
    v_fmac_f32 v40, v88, v192
    v_mul_f32 v192, v32, v136
    v_mul_f32 v200, v32, v144
    v_fma_f32 v192, -v40, v144, v192
    v_fmac_f32 v200, v40, v136
    v_mul_f32 v192, v192, v29
    v_mul_f32_e64 v200, -v200, v29
    v_fmac_f32 v33, v81, v193
    v_fmac_f32 v41, v81, v201
    v_fma_f32 v33, -v89, v201, v33
    v_fmac_f32 v41, v89, v193
    v_mul_f32 v193, v33, v137
    v_mul_f32 v201, v33, v145
    v_fma_f32 v193, -v41, v145, v193
    v_fmac_f32 v201, v41, v137
    v_mul_f32 v193, v193, v29
    v_mul_f32_e64 v201, -v201, v29
    v_fmac_f32 v34, v82, v194
    v_fmac_f32 v42, v82, v202
    v_fma_f32 v34, -v90, v202, v34
    v_fmac_f32 v42, v90, v194
    v_mul_f32 v194, v34, v138
    v_mul_f32 v202, v34, v146
    v_fma_f32 v194, -v42, v146, v194
    v_fmac_f32 v202, v42, v138
    v_mul_f32 v194, v194, v29
    v_mul_f32_e64 v202, -v202, v29
    v_fmac_f32 v35, v83, v195
    v_fmac_f32 v43, v83, v203
    v_fma_f32 v35, -v91, v203, v35
    v_fmac_f32 v43, v91, v195
    v_mul_f32 v195, v35, v139
    v_mul_f32 v203, v35, v147
    v_fma_f32 v195, -v43, v147, v195
    v_fmac_f32 v203, v43, v139
    v_mul_f32 v195, v195, v29
    v_mul_f32_e64 v203, -v203, v29
    v_fmac_f32 v36, v84, v196
    v_fmac_f32 v44, v84, v204
    v_fma_f32 v36, -v92, v204, v36
    v_fmac_f32 v44, v92, v196
    v_mul_f32 v196, v36, v140
    v_mul_f32 v204, v36, v148
    v_fma_f32 v196, -v44, v148, v196
    v_fmac_f32 v204, v44, v140
    v_mul_f32 v196, v196, v29
    v_mul_f32_e64 v204, -v204, v29
    v_fmac_f32 v37, v85, v197
    v_fmac_f32 v45, v85, v205
    v_fma_f32 v37, -v93, v205, v37
    v_fmac_f32 v45, v93, v197
    v_mul_f32 v197, v37, v141
    v_mul_f32 v205, v37, v149
    v_fma_f32 v197, -v45, v149, v197
    v_fmac_f32 v205, v45, v141
    v_mul_f32 v197, v197, v29
    v_mul_f32_e64 v205, -v205, v29
    v_fmac_f32 v38, v86, v198
    v_fmac_f32 v46, v86, v206
    v_fma_f32 v38, -v94, v206, v38
    v_fmac_f32 v46, v94, v198
    v_mul_f32 v198, v38, v142
    v_mul_f32 v206, v38, v150
    v_fma_f32 v198, -v46, v150, v198
    v_fmac_f32 v206, v46, v142
    v_mul_f32 v198, v198, v29
    v_mul_f32_e64 v206, -v206, v29
    v_fmac_f32 v39, v87, v199
    v_fmac_f32 v47, v87, v207
    v_fma_f32 v39, -v95, v207, v39
    v_fmac_f32 v47, v95, v199
    v_mul_f32 v199, v39, v143
    v_mul_f32 v207, v39, v151
    v_fma_f32 v199, -v47, v151, v199
    v_fmac_f32 v207, v47, v143
    v_mul_f32 v199, v199, v29
    v_mul_f32_e64 v207, -v207, v29
    v_cvt_pk_bf16_f32 v240, v192, v193
    v_cvt_pk_bf16_f32 v241, v194, v195
    v_cvt_pk_bf16_f32 v242, v196, v197
    v_cvt_pk_bf16_f32 v243, v198, v199
    v_cvt_pk_bf16_f32 v244, v200, v201
    v_cvt_pk_bf16_f32 v245, v202, v203
    v_cvt_pk_bf16_f32 v246, v204, v205
    v_cvt_pk_bf16_f32 v247, v206, v207
    v_fmac_f32 v48, v80, v208
    v_fmac_f32 v56, v80, v216
    v_fma_f32 v48, -v88, v216, v48
    v_fmac_f32 v56, v88, v208
    v_mul_f32 v208, v48, v136
    v_mul_f32 v216, v48, v144
    v_fma_f32 v208, -v56, v144, v208
    v_fmac_f32 v216, v56, v136
    v_mul_f32 v208, v208, v30
    v_mul_f32_e64 v216, -v216, v30
    v_fmac_f32 v49, v81, v209
    v_fmac_f32 v57, v81, v217
    v_fma_f32 v49, -v89, v217, v49
    v_fmac_f32 v57, v89, v209
    v_mul_f32 v209, v49, v137
    v_mul_f32 v217, v49, v145
    v_fma_f32 v209, -v57, v145, v209
    v_fmac_f32 v217, v57, v137
    v_mul_f32 v209, v209, v30
    v_mul_f32_e64 v217, -v217, v30
    v_fmac_f32 v50, v82, v210
    v_fmac_f32 v58, v82, v218
    v_fma_f32 v50, -v90, v218, v50
    v_fmac_f32 v58, v90, v210
    v_mul_f32 v210, v50, v138
    v_mul_f32 v218, v50, v146
    v_fma_f32 v210, -v58, v146, v210
    v_fmac_f32 v218, v58, v138
    v_mul_f32 v210, v210, v30
    v_mul_f32_e64 v218, -v218, v30
    v_fmac_f32 v51, v83, v211
    v_fmac_f32 v59, v83, v219
    v_fma_f32 v51, -v91, v219, v51
    v_fmac_f32 v59, v91, v211
    v_mul_f32 v211, v51, v139
    v_mul_f32 v219, v51, v147
    v_fma_f32 v211, -v59, v147, v211
    v_fmac_f32 v219, v59, v139
    v_mul_f32 v211, v211, v30
    v_mul_f32_e64 v219, -v219, v30
    v_fmac_f32 v52, v84, v212
    v_fmac_f32 v60, v84, v220
    v_fma_f32 v52, -v92, v220, v52
    v_fmac_f32 v60, v92, v212
    v_mul_f32 v212, v52, v140
    v_mul_f32 v220, v52, v148
    v_fma_f32 v212, -v60, v148, v212
    v_fmac_f32 v220, v60, v140
    v_mul_f32 v212, v212, v30
    v_mul_f32_e64 v220, -v220, v30
    v_fmac_f32 v53, v85, v213
    v_fmac_f32 v61, v85, v221
    v_fma_f32 v53, -v93, v221, v53
    v_fmac_f32 v61, v93, v213
    v_mul_f32 v213, v53, v141
    v_mul_f32 v221, v53, v149
    v_fma_f32 v213, -v61, v149, v213
    v_fmac_f32 v221, v61, v141
    v_mul_f32 v213, v213, v30
    v_mul_f32_e64 v221, -v221, v30
    v_fmac_f32 v54, v86, v214
    v_fmac_f32 v62, v86, v222
    v_fma_f32 v54, -v94, v222, v54
    v_fmac_f32 v62, v94, v214
    v_mul_f32 v214, v54, v142
    v_mul_f32 v222, v54, v150
    v_fma_f32 v214, -v62, v150, v214
    v_fmac_f32 v222, v62, v142
    v_mul_f32 v214, v214, v30
    v_mul_f32_e64 v222, -v222, v30
    v_fmac_f32 v55, v87, v215
    v_fmac_f32 v63, v87, v223
    v_fma_f32 v55, -v95, v223, v55
    v_fmac_f32 v63, v95, v215
    v_mul_f32 v215, v55, v143
    v_mul_f32 v223, v55, v151
    v_fma_f32 v215, -v63, v151, v215
    v_fmac_f32 v223, v63, v143
    v_mul_f32 v215, v215, v30
    v_mul_f32_e64 v223, -v223, v30
    v_cvt_pk_bf16_f32 v248, v208, v209
    v_cvt_pk_bf16_f32 v249, v210, v211
    v_cvt_pk_bf16_f32 v250, v212, v213
    v_cvt_pk_bf16_f32 v251, v214, v215
    v_cvt_pk_bf16_f32 v252, v216, v217
    v_cvt_pk_bf16_f32 v253, v218, v219
    v_cvt_pk_bf16_f32 v254, v220, v221
    v_cvt_pk_bf16_f32 v255, v222, v223
    v_accvgpr_write_b32 a208, v248
    v_accvgpr_write_b32 a209, v249
    v_accvgpr_write_b32 a210, v250
    v_accvgpr_write_b32 a211, v251
    v_accvgpr_write_b32 a212, v252
    v_accvgpr_write_b32 a213, v253
    v_accvgpr_write_b32 a214, v254
    v_accvgpr_write_b32 a215, v255
    v_bfe_u32 v36, v0, 2, 2
    v_bfe_u32 v37, v0, 4, 1
    v_and_b32 v38, 1, v0
    v_bfe_u32 v39, v0, 1, 1
    v_lshl_add_u32 v40, v38, 1, v39
    v_lshl_add_u32 v40, v37, 2, v40
    v_lshlrev_b32 v40, 3, v40
    v_lshl_add_u32 v41, v17, 4, v36
    v_lshl_add_u32 v40, v41, 10, v40
    v_lshl_add_u32 v20, v36, 6, v40
    v_xor_b32 v21, 64, v20
    v_xor_b32 v22, 128, v20
    v_xor_b32 v23, 192, v20
    v_add_u32 v24, 0x10000, v20
    v_add_u32 v25, 0x10000, v21
    v_add_u32 v26, 0x10000, v22
    v_add_u32 v27, 0x10000, v23
    s_mov_b32 s44, 0
    s_cmp_lg_u32 s34, 7
    s_cbranch_scc1 L_h_nsd
    s_lshl_b32 s46, s33, 5
    s_add_u32 s46, s46, s32
    s_mul_i32 s46, s46, 23552
    s_add_u32 s46, s46, 54525952
    buffer_store_dwordx4 a[128:131], v1, s[4:7], s46 offen offset:0 sc1
    buffer_store_dwordx4 a[132:135], v1, s[4:7], s46 offen offset:1024 sc1
    buffer_store_dwordx4 a[136:139], v1, s[4:7], s46 offen offset:2048 sc1
    buffer_store_dwordx4 a[140:143], v1, s[4:7], s46 offen offset:3072 sc1
    s_add_u32 s46, s46, 4096
    buffer_store_dwordx4 a[144:147], v1, s[4:7], s46 offen offset:0 sc1
    buffer_store_dwordx4 a[148:151], v1, s[4:7], s46 offen offset:1024 sc1
    buffer_store_dwordx4 a[152:155], v1, s[4:7], s46 offen offset:2048 sc1
    buffer_store_dwordx4 a[156:159], v1, s[4:7], s46 offen offset:3072 sc1
    s_add_u32 s46, s46, 4096
    buffer_store_dwordx4 a[160:163], v1, s[4:7], s46 offen offset:0 sc1
    buffer_store_dwordx4 a[164:167], v1, s[4:7], s46 offen offset:1024 sc1
    buffer_store_dwordx4 a[168:171], v1, s[4:7], s46 offen offset:2048 sc1
    buffer_store_dwordx4 a[172:175], v1, s[4:7], s46 offen offset:3072 sc1
    s_add_u32 s46, s46, 4096
    buffer_store_dwordx4 a[176:179], v1, s[4:7], s46 offen offset:0 sc1
    buffer_store_dwordx4 a[180:183], v1, s[4:7], s46 offen offset:1024 sc1
    buffer_store_dwordx4 a[184:187], v1, s[4:7], s46 offen offset:2048 sc1
    buffer_store_dwordx4 a[188:191], v1, s[4:7], s46 offen offset:3072 sc1
    s_add_u32 s46, s46, 4096
    buffer_store_dwordx4 a[192:195], v1, s[4:7], s46 offen offset:0 sc1
    buffer_store_dwordx4 a[196:199], v1, s[4:7], s46 offen offset:1024 sc1
    buffer_store_dwordx4 a[200:203], v1, s[4:7], s46 offen offset:2048 sc1
    buffer_store_dwordx4 a[204:207], v1, s[4:7], s46 offen offset:3072 sc1
    s_add_u32 s46, s46, 4096
    buffer_store_dwordx4 a[208:211], v1, s[4:7], s46 offen offset:0 sc1
    buffer_store_dwordx4 a[212:215], v1, s[4:7], s46 offen offset:1024 sc1
    buffer_store_dwordx4 a[216:219], v1, s[4:7], s46 offen offset:2048 sc1
    s_waitcnt vmcnt(0)
    s_barrier
    s_cmp_lg_u32 s33, 0
    s_cbranch_scc1 L_h_nsd
    s_lshl_b32 s45, s34, 2
    v_mov_b32 v29, 1
    s_mov_b64 exec, 1
    buffer_atomic_add v29, off, s[24:27], 0 offset:8 sc0
    v_mov_b32 v30, 32
    s_waitcnt vmcnt(0)
    v_cmp_eq_u32 vcc, 31, v29
    s_cbranch_vccz L_h_ngd
    buffer_store_dword v30, off, s[24:27], 0 offset:136 sc1
L_h_ngd:
    s_mov_b64 exec, -1
L_h_nsd:
L_h_seg:
    v_max3_f32 v28, v224, v225, v226
    v_max3_f32 v28, v28, v227, v228
    v_max3_f32 v28, v28, v229, v230
    v_max3_f32 v28, v28, v231, v232
    v_max3_f32 v28, v28, v233, v234
    v_max3_f32 v28, v28, v235, v236
    v_max3_f32 v28, v28, v237, v238
    v_max_f32 v28, v28, v239
    s_lshl_b32 s45, s42, 17
    s_lshl_b32 s46, s32, 12
    s_add_u32 s45, s45, s46
    s_add_u32 s45, s45, 35717120
    s_sub_u32 s46, s42, 0
    s_cmp_lt_u32 s46, 48
    s_cselect_b32 s46, 7, 3
    s_cmp_lt_u32 s42, 56
    s_cselect_b32 s46, s46, 3
    s_cmp_lt_u32 s42, 60
    s_cselect_b32 s46, s46, 0
    s_or_b32 s46, s46, s42
    s_min_u32 s46, s46, 62
    s_sub_i32 s46, s46, s42
    s_lshl_b32 s46, s46, 17
    s_add_u32 s46, s45, s46
    s_mov_b32 s48, 0x3e0293ee
    s_lshl_b32 s47, s33, 12
    s_add_u32 s47, s47, 137216
    v_add_u32 v30, s47, v1
    v_add_u32 v31, 2048, v18
    v_mov_b64 v[66:67], 0
    v_mov_b64 v[70:71], 0
    v_mov_b64 v[74:75], 0
    v_mov_b64 v[78:79], 0
    v_mov_b64 v[130:131], 0
L_h_pr:
    buffer_load_dword v29, off, s[4:7], s46 offset:3072 sc1
    s_waitcnt vmcnt(0)
    v_cmp_eq_u32 vcc, -1, v29
    s_cbranch_vccz L_h_ld
    s_add_u32 s43, s43, 1
    s_cmp_gt_u32 s43, 1000000
    s_cbranch_scc1 L_end
    s_sleep 4
    s_branch L_h_pr
L_h_pf:
    s_add_u32 s43, s43, 1
    s_cmp_gt_u32 s43, 1000000
    s_cbranch_scc1 L_end
L_h_ld:
    buffer_load_dwordx4 v[192:195], v1, s[4:7], s45 offen offset:0 sc1
    buffer_load_dwordx4 v[196:199], v1, s[4:7], s45 offen offset:1024 sc1
    buffer_load_dwordx4 v[200:203], v1, s[4:7], s45 offen offset:2048 sc1
    buffer_load_dwordx4 v[204:207], v1, s[4:7], s45 offen offset:3072 sc1
    s_waitcnt vmcnt(0)
    ds_write_b128 v30, v[192:195] offset:0
    ds_write_b128 v30, v[196:199] offset:1024
    ds_write_b128 v30, v[200:203] offset:2048
    ds_write_b128 v30, v[204:207] offset:3072
    v_max3_u32 v29, v192, v193, v194
    v_max3_u32 v29, v29, v195, v196
    v_max3_u32 v29, v29, v197, v198
    v_max3_u32 v29, v29, v199, v200
    v_max3_u32 v29, v29, v201, v202
    v_max3_u32 v29, v29, v203, v204
    v_max3_u32 v29, v29, v205, v206
    v_max_u32 v29, v29, v207
    v_cmp_eq_u32 vcc, -1, v29
    s_cbranch_vccnz L_h_pf
    ds_read2_b64 v[32:35], v18 offset0:0 offset1:16
    ds_read2_b64 v[36:39], v18 offset0:32 offset1:48
    ds_read2_b64 v[40:43], v18 offset0:128 offset1:144
    ds_read2_b64 v[44:47], v18 offset0:160 offset1:176
    ds_read2_b64 v[48:51], v31 offset0:0 offset1:16
    ds_read2_b64 v[52:55], v31 offset0:32 offset1:48
    ds_read2_b64 v[56:59], v31 offset0:128 offset1:144
    ds_read2_b64 v[60:63], v31 offset0:160 offset1:176
    ds_read2st64_b32 v[64:65], v19 offset0:0 offset1:2
    ds_read2st64_b32 v[68:69], v19 offset0:4 offset1:6
    ds_read2st64_b32 v[72:73], v19 offset0:8 offset1:10
    ds_read2st64_b32 v[76:77], v19 offset0:12 offset1:14
    s_waitcnt lgkmcnt(11)
    v_mfma_f32_32x32x16_bf16 v[80:95], v[32:35], v[160:163], 0
    s_waitcnt lgkmcnt(10)
    v_mfma_f32_32x32x16_bf16 v[80:95], v[36:39], v[164:167], v[80:95]
    s_waitcnt lgkmcnt(9)
    v_mfma_f32_32x32x16_bf16 v[80:95], v[40:43], v[168:171], v[80:95]
    s_waitcnt lgkmcnt(8)
    v_mfma_f32_32x32x16_bf16 v[80:95], v[44:47], v[172:175], v[80:95]
    s_waitcnt lgkmcnt(7)
    v_mfma_f32_32x32x16_bf16 v[80:95], v[48:51], v[176:179], v[80:95]
    s_waitcnt lgkmcnt(6)
    v_mfma_f32_32x32x16_bf16 v[80:95], v[52:55], v[180:183], v[80:95]
    s_waitcnt lgkmcnt(5)
    v_mfma_f32_32x32x16_bf16 v[80:95], v[56:59], v[184:187], v[80:95]
    s_waitcnt lgkmcnt(4)
    v_mfma_f32_32x32x16_bf16 v[80:95], v[60:63], v[188:191], v[80:95]
    s_waitcnt lgkmcnt(0)
    s_nop 11
    v_max3_f32 v29, v28, v80, v81
    v_max3_f32 v29, v29, v82, v83
    v_mov_b32 v30, v29
    s_nop 1
    v_permlane32_swap_b32 v29, v30
    v_max_f32 v29, v29, v30
    v_mul_f32 v29, s48, v29
    v_fma_f32 v80, v80, s48, -v29
    v_fma_f32 v81, v81, s48, -v29
    v_fma_f32 v82, v82, s48, -v29
    v_fma_f32 v83, v83, s48, -v29
    v_fma_f32 v224, v224, s48, -v29
    v_fma_f32 v225, v225, s48, -v29
    v_fma_f32 v226, v226, s48, -v29
    v_fma_f32 v227, v227, s48, -v29
    v_fma_f32 v228, v228, s48, -v29
    v_fma_f32 v229, v229, s48, -v29
    v_fma_f32 v230, v230, s48, -v29
    v_fma_f32 v231, v231, s48, -v29
    v_fma_f32 v232, v232, s48, -v29
    v_fma_f32 v233, v233, s48, -v29
    v_fma_f32 v234, v234, s48, -v29
    v_fma_f32 v235, v235, s48, -v29
    v_fma_f32 v236, v236, s48, -v29
    v_fma_f32 v237, v237, s48, -v29
    v_fma_f32 v238, v238, s48, -v29
    v_fma_f32 v239, v239, s48, -v29
    v_exp_f32 v80, v80
    v_exp_f32 v81, v81
    v_exp_f32 v82, v82
    v_exp_f32 v83, v83
    v_exp_f32 v224, v224
    v_exp_f32 v225, v225
    v_exp_f32 v226, v226
    v_exp_f32 v227, v227
    v_exp_f32 v228, v228
    v_exp_f32 v229, v229
    v_exp_f32 v230, v230
    v_exp_f32 v231, v231
    v_exp_f32 v232, v232
    v_exp_f32 v233, v233
    v_exp_f32 v234, v234
    v_exp_f32 v235, v235
    v_exp_f32 v236, v236
    v_exp_f32 v237, v237
    v_exp_f32 v238, v238
    v_exp_f32 v239, v239
    v_cvt_pk_bf16_f32 v128, v80, v81
    v_cvt_pk_bf16_f32 v129, v82, v83
    v_cvt_pk_bf16_f32 v248, v224, v225
    v_cvt_pk_bf16_f32 v249, v226, v227
    v_cvt_pk_bf16_f32 v250, v228, v229
    v_cvt_pk_bf16_f32 v251, v230, v231
    v_cvt_pk_bf16_f32 v252, v232, v233
    v_cvt_pk_bf16_f32 v253, v234, v235
    v_cvt_pk_bf16_f32 v254, v236, v237
    v_cvt_pk_bf16_f32 v255, v238, v239
    v_mfma_f32_32x32x16_bf16 v[192:207], v[64:67], v[128:131], 0
    ds_read_b64_tr_b16 v[32:33], v20 offset:0
    ds_read_b64_tr_b16 v[34:35], v20 offset:4096
    v_add_f32 v29, v80, v81
    v_add_f32 v29, v29, v82
    v_add_f32 v29, v29, v83
    v_add_f32 v29, v29, v224
    v_add_f32 v29, v29, v225
    v_add_f32 v29, v29, v226
    v_mfma_f32_32x32x16_bf16 v[192:207], v[96:99], v[248:251], v[192:207]
    ds_read_b64_tr_b16 v[36:37], v20 offset:8192
    ds_read_b64_tr_b16 v[38:39], v20 offset:12288
    v_add_f32 v29, v29, v227
    v_add_f32 v29, v29, v228
    v_add_f32 v29, v29, v229
    v_add_f32 v29, v29, v230
    v_add_f32 v29, v29, v231
    v_add_f32 v29, v29, v232
    v_mfma_f32_32x32x16_bf16 v[192:207], v[100:103], v[252:255], v[192:207]
    ds_read_b64_tr_b16 v[40:41], v20 offset:32768
    ds_read_b64_tr_b16 v[42:43], v20 offset:36864
    v_add_f32 v29, v29, v233
    v_add_f32 v29, v29, v234
    v_add_f32 v29, v29, v235
    v_add_f32 v29, v29, v236
    v_add_f32 v29, v29, v237
    v_add_f32 v29, v29, v238
    v_mfma_f32_32x32x16_bf16 v[208:223], v[68:71], v[128:131], 0
    ds_read_b64_tr_b16 v[44:45], v20 offset:40960
    ds_read_b64_tr_b16 v[46:47], v20 offset:45056
    v_add_f32 v29, v29, v239
    v_mov_b32 v30, v29
    v_sub_f32 v31, 1.0, v15
    s_nop 0
    v_permlane32_swap_b32 v29, v30
    v_add_f32 v29, v29, v30
    v_mfma_f32_32x32x16_bf16 v[208:223], v[104:107], v[248:251], v[208:223]
    ds_read_b64_tr_b16 v[48:49], v24 offset:0
    ds_read_b64_tr_b16 v[50:51], v24 offset:4096
    v_rcp_f32 v29, v29
    s_nop 0
    v_mul_f32 v29, v29, v31
    v_mfma_f32_32x32x16_bf16 v[208:223], v[108:111], v[252:255], v[208:223]
    ds_read_b64_tr_b16 v[52:53], v24 offset:8192
    ds_read_b64_tr_b16 v[54:55], v24 offset:12288
    v_mfma_f32_32x32x16_bf16 v[132:147], v[72:75], v[128:131], 0
    ds_read_b64_tr_b16 v[56:57], v24 offset:32768
    ds_read_b64_tr_b16 v[58:59], v24 offset:36864
    v_mul_f32 v192, v192, v29
    v_mul_f32 v193, v193, v29
    v_mul_f32 v194, v194, v29
    v_mul_f32 v195, v195, v29
    v_mul_f32 v196, v196, v29
    v_mul_f32 v197, v197, v29
    v_mfma_f32_32x32x16_bf16 v[132:147], v[112:115], v[248:251], v[132:147]
    ds_read_b64_tr_b16 v[60:61], v24 offset:40960
    ds_read_b64_tr_b16 v[62:63], v24 offset:45056
    v_mul_f32 v198, v198, v29
    v_mul_f32 v199, v199, v29
    v_mul_f32 v200, v200, v29
    v_mul_f32 v201, v201, v29
    v_mul_f32 v202, v202, v29
    v_mul_f32 v203, v203, v29
    v_mfma_f32_32x32x16_bf16 v[132:147], v[116:119], v[252:255], v[132:147]
    v_mul_f32 v204, v204, v29
    v_mul_f32 v205, v205, v29
    v_mul_f32 v206, v206, v29
    v_mul_f32 v207, v207, v29
    v_cvt_pk_bf16_f32 v160, v192, v193
    v_cvt_pk_bf16_f32 v161, v194, v195
    v_mfma_f32_32x32x16_bf16 v[80:95], v[76:79], v[128:131], 0
    v_cvt_pk_bf16_f32 v162, v196, v197
    v_cvt_pk_bf16_f32 v163, v198, v199
    v_cvt_pk_bf16_f32 v164, v200, v201
    v_cvt_pk_bf16_f32 v165, v202, v203
    v_cvt_pk_bf16_f32 v166, v204, v205
    v_cvt_pk_bf16_f32 v167, v206, v207
    v_mfma_f32_32x32x16_bf16 v[80:95], v[120:123], v[248:251], v[80:95]
    v_mul_f32 v208, v208, v29
    v_mul_f32 v209, v209, v29
    v_mul_f32 v210, v210, v29
    v_mul_f32 v211, v211, v29
    v_mul_f32 v212, v212, v29
    v_mul_f32 v213, v213, v29
    v_mfma_f32_32x32x16_bf16 v[80:95], v[124:127], v[252:255], v[80:95]
    v_mul_f32 v214, v214, v29
    v_mul_f32 v215, v215, v29
    v_mul_f32 v216, v216, v29
    v_mul_f32 v217, v217, v29
    v_mul_f32 v218, v218, v29
    v_mul_f32 v219, v219, v29
    v_mul_f32 v220, v220, v29
    v_mul_f32 v221, v221, v29
    v_mul_f32 v222, v222, v29
    v_mul_f32 v223, v223, v29
    v_cvt_pk_bf16_f32 v168, v208, v209
    v_cvt_pk_bf16_f32 v169, v210, v211
    v_cvt_pk_bf16_f32 v170, v212, v213
    v_cvt_pk_bf16_f32 v171, v214, v215
    v_cvt_pk_bf16_f32 v172, v216, v217
    v_cvt_pk_bf16_f32 v173, v218, v219
    v_cvt_pk_bf16_f32 v174, v220, v221
    v_cvt_pk_bf16_f32 v175, v222, v223
    v_mul_f32 v132, v132, v29
    v_mul_f32 v133, v133, v29
    v_mul_f32 v134, v134, v29
    v_mul_f32 v135, v135, v29
    v_mul_f32 v136, v136, v29
    v_mul_f32 v137, v137, v29
    v_mul_f32 v138, v138, v29
    v_mul_f32 v139, v139, v29
    v_mul_f32 v140, v140, v29
    v_mul_f32 v141, v141, v29
    v_mul_f32 v142, v142, v29
    v_mul_f32 v143, v143, v29
    v_mul_f32 v144, v144, v29
    v_mul_f32 v145, v145, v29
    v_mul_f32 v146, v146, v29
    v_mul_f32 v147, v147, v29
    v_cvt_pk_bf16_f32 v176, v132, v133
    v_cvt_pk_bf16_f32 v177, v134, v135
    v_cvt_pk_bf16_f32 v178, v136, v137
    v_cvt_pk_bf16_f32 v179, v138, v139
    v_cvt_pk_bf16_f32 v180, v140, v141
    v_cvt_pk_bf16_f32 v181, v142, v143
    v_cvt_pk_bf16_f32 v182, v144, v145
    v_cvt_pk_bf16_f32 v183, v146, v147
    v_mul_f32 v80, v80, v29
    v_mul_f32 v81, v81, v29
    v_mul_f32 v82, v82, v29
    v_mul_f32 v83, v83, v29
    v_mul_f32 v84, v84, v29
    v_mul_f32 v85, v85, v29
    v_mul_f32 v86, v86, v29
    v_mul_f32 v87, v87, v29
    v_mul_f32 v88, v88, v29
    v_mul_f32 v89, v89, v29
    v_mul_f32 v90, v90, v29
    v_mul_f32 v91, v91, v29
    v_mul_f32 v92, v92, v29
    v_mul_f32 v93, v93, v29
    v_mul_f32 v94, v94, v29
    v_mul_f32 v95, v95, v29
    v_cvt_pk_bf16_f32 v184, v80, v81
    v_cvt_pk_bf16_f32 v185, v82, v83
    v_cvt_pk_bf16_f32 v186, v84, v85
    v_cvt_pk_bf16_f32 v187, v86, v87
    v_cvt_pk_bf16_f32 v188, v88, v89
    v_cvt_pk_bf16_f32 v189, v90, v91
    v_cvt_pk_bf16_f32 v190, v92, v93
    v_cvt_pk_bf16_f32 v191, v94, v95
    s_lshl_b32 s45, s42, 20
    s_lshl_b32 s46, s32, 10
    s_add_u32 s45, s45, s46
    s_add_u32 s45, s45, 67108864
    v_mfma_f32_32x32x16_bf16 v[192:207], a[0:3], v[240:243], 0
    v_mfma_f32_32x32x16_bf16 v[192:207], a[4:7], v[244:247], v[192:207]
    s_waitcnt lgkmcnt(0)
    v_mfma_f32_32x32x16_bf16 v[192:207], v[32:35], v[160:163], v[192:207]
    ds_read_b64_tr_b16 v[64:65], v21 offset:0
    ds_read_b64_tr_b16 v[66:67], v21 offset:4096
    v_mfma_f32_32x32x16_bf16 v[192:207], v[36:39], v[164:167], v[192:207]
    ds_read_b64_tr_b16 v[68:69], v21 offset:8192
    ds_read_b64_tr_b16 v[70:71], v21 offset:12288
    v_mfma_f32_32x32x16_bf16 v[192:207], v[40:43], v[168:171], v[192:207]
    ds_read_b64_tr_b16 v[72:73], v21 offset:32768
    ds_read_b64_tr_b16 v[74:75], v21 offset:36864
    v_mfma_f32_32x32x16_bf16 v[192:207], v[44:47], v[172:175], v[192:207]
    ds_read_b64_tr_b16 v[76:77], v21 offset:40960
    ds_read_b64_tr_b16 v[78:79], v21 offset:45056
    v_mfma_f32_32x32x16_bf16 v[192:207], v[48:51], v[176:179], v[192:207]
    ds_read_b64_tr_b16 v[80:81], v25 offset:0
    ds_read_b64_tr_b16 v[82:83], v25 offset:4096
    v_mfma_f32_32x32x16_bf16 v[192:207], v[52:55], v[180:183], v[192:207]
    ds_read_b64_tr_b16 v[84:85], v25 offset:8192
    ds_read_b64_tr_b16 v[86:87], v25 offset:12288
    v_mfma_f32_32x32x16_bf16 v[192:207], v[56:59], v[184:187], v[192:207]
    ds_read_b64_tr_b16 v[88:89], v25 offset:32768
    ds_read_b64_tr_b16 v[90:91], v25 offset:36864
    v_mfma_f32_32x32x16_bf16 v[192:207], v[60:63], v[188:191], v[192:207]
    ds_read_b64_tr_b16 v[92:93], v25 offset:40960
    ds_read_b64_tr_b16 v[94:95], v25 offset:45056
    v_mfma_f32_32x32x16_bf16 v[208:223], a[8:11], v[240:243], 0
    v_mfma_f32_32x32x16_bf16 v[208:223], a[12:15], v[244:247], v[208:223]
    v_cvt_pk_bf16_f32 v128, v192, v193
    v_min_u32 v128, -2, v128
    v_cvt_pk_bf16_f32 v129, v194, v195
    v_min_u32 v129, -2, v129
    s_waitcnt lgkmcnt(0)
    v_mfma_f32_32x32x16_bf16 v[208:223], v[64:67], v[160:163], v[208:223]
    ds_read_b64_tr_b16 v[32:33], v22 offset:0
    ds_read_b64_tr_b16 v[34:35], v22 offset:4096
    v_cvt_pk_bf16_f32 v130, v196, v197
    v_min_u32 v130, -2, v130
    v_cvt_pk_bf16_f32 v131, v198, v199
    v_min_u32 v131, -2, v131
    v_mfma_f32_32x32x16_bf16 v[208:223], v[68:71], v[164:167], v[208:223]
    ds_read_b64_tr_b16 v[36:37], v22 offset:8192
    ds_read_b64_tr_b16 v[38:39], v22 offset:12288
    v_cvt_pk_bf16_f32 v132, v200, v201
    v_min_u32 v132, -2, v132
    v_cvt_pk_bf16_f32 v133, v202, v203
    v_min_u32 v133, -2, v133
    v_mfma_f32_32x32x16_bf16 v[208:223], v[72:75], v[168:171], v[208:223]
    ds_read_b64_tr_b16 v[40:41], v22 offset:32768
    ds_read_b64_tr_b16 v[42:43], v22 offset:36864
    v_cvt_pk_bf16_f32 v134, v204, v205
    v_min_u32 v134, -2, v134
    v_cvt_pk_bf16_f32 v135, v206, v207
    v_min_u32 v135, -2, v135
    v_mfma_f32_32x32x16_bf16 v[208:223], v[76:79], v[172:175], v[208:223]
    ds_read_b64_tr_b16 v[44:45], v22 offset:40960
    ds_read_b64_tr_b16 v[46:47], v22 offset:45056
    v_mfma_f32_32x32x16_bf16 v[208:223], v[80:83], v[176:179], v[208:223]
    ds_read_b64_tr_b16 v[48:49], v26 offset:0
    ds_read_b64_tr_b16 v[50:51], v26 offset:4096
    buffer_store_dwordx4 v[128:131], v1, s[4:7], s45 offen sc1
    s_add_u32 s45, s45, 32768
    v_mfma_f32_32x32x16_bf16 v[208:223], v[84:87], v[180:183], v[208:223]
    ds_read_b64_tr_b16 v[52:53], v26 offset:8192
    ds_read_b64_tr_b16 v[54:55], v26 offset:12288
    buffer_store_dwordx4 v[132:135], v1, s[4:7], s45 offen sc1
    s_add_u32 s45, s45, 32768
    v_mfma_f32_32x32x16_bf16 v[208:223], v[88:91], v[184:187], v[208:223]
    ds_read_b64_tr_b16 v[56:57], v26 offset:32768
    ds_read_b64_tr_b16 v[58:59], v26 offset:36864
    v_mfma_f32_32x32x16_bf16 v[208:223], v[92:95], v[188:191], v[208:223]
    ds_read_b64_tr_b16 v[60:61], v26 offset:40960
    ds_read_b64_tr_b16 v[62:63], v26 offset:45056
    v_mfma_f32_32x32x16_bf16 v[192:207], a[16:19], v[240:243], 0
    v_mfma_f32_32x32x16_bf16 v[192:207], a[20:23], v[244:247], v[192:207]
    v_cvt_pk_bf16_f32 v136, v208, v209
    v_min_u32 v136, -2, v136
    v_cvt_pk_bf16_f32 v137, v210, v211
    v_min_u32 v137, -2, v137
    s_waitcnt lgkmcnt(0)
    v_mfma_f32_32x32x16_bf16 v[192:207], v[32:35], v[160:163], v[192:207]
    ds_read_b64_tr_b16 v[64:65], v23 offset:0
    ds_read_b64_tr_b16 v[66:67], v23 offset:4096
    v_cvt_pk_bf16_f32 v138, v212, v213
    v_min_u32 v138, -2, v138
    v_cvt_pk_bf16_f32 v139, v214, v215
    v_min_u32 v139, -2, v139
    v_mfma_f32_32x32x16_bf16 v[192:207], v[36:39], v[164:167], v[192:207]
    ds_read_b64_tr_b16 v[68:69], v23 offset:8192
    ds_read_b64_tr_b16 v[70:71], v23 offset:12288
    v_cvt_pk_bf16_f32 v140, v216, v217
    v_min_u32 v140, -2, v140
    v_cvt_pk_bf16_f32 v141, v218, v219
    v_min_u32 v141, -2, v141
    v_mfma_f32_32x32x16_bf16 v[192:207], v[40:43], v[168:171], v[192:207]
    ds_read_b64_tr_b16 v[72:73], v23 offset:32768
    ds_read_b64_tr_b16 v[74:75], v23 offset:36864
    v_cvt_pk_bf16_f32 v142, v220, v221
    v_min_u32 v142, -2, v142
    v_cvt_pk_bf16_f32 v143, v222, v223
    v_min_u32 v143, -2, v143
    v_mfma_f32_32x32x16_bf16 v[192:207], v[44:47], v[172:175], v[192:207]
    ds_read_b64_tr_b16 v[76:77], v23 offset:40960
    ds_read_b64_tr_b16 v[78:79], v23 offset:45056
    v_mfma_f32_32x32x16_bf16 v[192:207], v[48:51], v[176:179], v[192:207]
    ds_read_b64_tr_b16 v[80:81], v27 offset:0
    ds_read_b64_tr_b16 v[82:83], v27 offset:4096
    buffer_store_dwordx4 v[136:139], v1, s[4:7], s45 offen sc1
    s_add_u32 s45, s45, 32768
    v_mfma_f32_32x32x16_bf16 v[192:207], v[52:55], v[180:183], v[192:207]
    ds_read_b64_tr_b16 v[84:85], v27 offset:8192
    ds_read_b64_tr_b16 v[86:87], v27 offset:12288
    buffer_store_dwordx4 v[140:143], v1, s[4:7], s45 offen sc1
    s_add_u32 s45, s45, 32768
    v_mfma_f32_32x32x16_bf16 v[192:207], v[56:59], v[184:187], v[192:207]
    ds_read_b64_tr_b16 v[88:89], v27 offset:32768
    ds_read_b64_tr_b16 v[90:91], v27 offset:36864
    v_mfma_f32_32x32x16_bf16 v[192:207], v[60:63], v[188:191], v[192:207]
    ds_read_b64_tr_b16 v[92:93], v27 offset:40960
    ds_read_b64_tr_b16 v[94:95], v27 offset:45056
    v_mfma_f32_32x32x16_bf16 v[208:223], a[24:27], v[240:243], 0
    v_mfma_f32_32x32x16_bf16 v[208:223], a[28:31], v[244:247], v[208:223]
    v_cvt_pk_bf16_f32 v128, v192, v193
    v_min_u32 v128, -2, v128
    v_cvt_pk_bf16_f32 v129, v194, v195
    v_min_u32 v129, -2, v129
    s_waitcnt lgkmcnt(0)
    v_mfma_f32_32x32x16_bf16 v[208:223], v[64:67], v[160:163], v[208:223]
    ds_read_b64_tr_b16 v[32:33], v20 offset:256
    ds_read_b64_tr_b16 v[34:35], v20 offset:4352
    v_cvt_pk_bf16_f32 v130, v196, v197
    v_min_u32 v130, -2, v130
    v_cvt_pk_bf16_f32 v131, v198, v199
    v_min_u32 v131, -2, v131
    v_mfma_f32_32x32x16_bf16 v[208:223], v[68:71], v[164:167], v[208:223]
    ds_read_b64_tr_b16 v[36:37], v20 offset:8448
    ds_read_b64_tr_b16 v[38:39], v20 offset:12544
    v_cvt_pk_bf16_f32 v132, v200, v201
    v_min_u32 v132, -2, v132
    v_cvt_pk_bf16_f32 v133, v202, v203
    v_min_u32 v133, -2, v133
    v_mfma_f32_32x32x16_bf16 v[208:223], v[72:75], v[168:171], v[208:223]
    ds_read_b64_tr_b16 v[40:41], v20 offset:33024
    ds_read_b64_tr_b16 v[42:43], v20 offset:37120
    v_cvt_pk_bf16_f32 v134, v204, v205
    v_min_u32 v134, -2, v134
    v_cvt_pk_bf16_f32 v135, v206, v207
    v_min_u32 v135, -2, v135
    v_mfma_f32_32x32x16_bf16 v[208:223], v[76:79], v[172:175], v[208:223]
    ds_read_b64_tr_b16 v[44:45], v20 offset:41216
    ds_read_b64_tr_b16 v[46:47], v20 offset:45312
    v_mfma_f32_32x32x16_bf16 v[208:223], v[80:83], v[176:179], v[208:223]
    ds_read_b64_tr_b16 v[48:49], v24 offset:256
    ds_read_b64_tr_b16 v[50:51], v24 offset:4352
    buffer_store_dwordx4 v[128:131], v1, s[4:7], s45 offen sc1
    s_add_u32 s45, s45, 32768
    v_mfma_f32_32x32x16_bf16 v[208:223], v[84:87], v[180:183], v[208:223]
    ds_read_b64_tr_b16 v[52:53], v24 offset:8448
    ds_read_b64_tr_b16 v[54:55], v24 offset:12544
    buffer_store_dwordx4 v[132:135], v1, s[4:7], s45 offen sc1
    s_add_u32 s45, s45, 32768
    v_mfma_f32_32x32x16_bf16 v[208:223], v[88:91], v[184:187], v[208:223]
    ds_read_b64_tr_b16 v[56:57], v24 offset:33024
    ds_read_b64_tr_b16 v[58:59], v24 offset:37120
    v_mfma_f32_32x32x16_bf16 v[208:223], v[92:95], v[188:191], v[208:223]
    ds_read_b64_tr_b16 v[60:61], v24 offset:41216
    ds_read_b64_tr_b16 v[62:63], v24 offset:45312
    v_mfma_f32_32x32x16_bf16 v[192:207], a[32:35], v[240:243], 0
    v_mfma_f32_32x32x16_bf16 v[192:207], a[36:39], v[244:247], v[192:207]
    v_cvt_pk_bf16_f32 v136, v208, v209
    v_min_u32 v136, -2, v136
    v_cvt_pk_bf16_f32 v137, v210, v211
    v_min_u32 v137, -2, v137
    s_waitcnt lgkmcnt(0)
    v_mfma_f32_32x32x16_bf16 v[192:207], v[32:35], v[160:163], v[192:207]
    ds_read_b64_tr_b16 v[64:65], v21 offset:256
    ds_read_b64_tr_b16 v[66:67], v21 offset:4352
    v_cvt_pk_bf16_f32 v138, v212, v213
    v_min_u32 v138, -2, v138
    v_cvt_pk_bf16_f32 v139, v214, v215
    v_min_u32 v139, -2, v139
    v_mfma_f32_32x32x16_bf16 v[192:207], v[36:39], v[164:167], v[192:207]
    ds_read_b64_tr_b16 v[68:69], v21 offset:8448
    ds_read_b64_tr_b16 v[70:71], v21 offset:12544
    v_cvt_pk_bf16_f32 v140, v216, v217
    v_min_u32 v140, -2, v140
    v_cvt_pk_bf16_f32 v141, v218, v219
    v_min_u32 v141, -2, v141
    v_mfma_f32_32x32x16_bf16 v[192:207], v[40:43], v[168:171], v[192:207]
    ds_read_b64_tr_b16 v[72:73], v21 offset:33024
    ds_read_b64_tr_b16 v[74:75], v21 offset:37120
    v_cvt_pk_bf16_f32 v142, v220, v221
    v_min_u32 v142, -2, v142
    v_cvt_pk_bf16_f32 v143, v222, v223
    v_min_u32 v143, -2, v143
    v_mfma_f32_32x32x16_bf16 v[192:207], v[44:47], v[172:175], v[192:207]
    ds_read_b64_tr_b16 v[76:77], v21 offset:41216
    ds_read_b64_tr_b16 v[78:79], v21 offset:45312
    v_mfma_f32_32x32x16_bf16 v[192:207], v[48:51], v[176:179], v[192:207]
    ds_read_b64_tr_b16 v[80:81], v25 offset:256
    ds_read_b64_tr_b16 v[82:83], v25 offset:4352
    buffer_store_dwordx4 v[136:139], v1, s[4:7], s45 offen sc1
    s_add_u32 s45, s45, 32768
    v_mfma_f32_32x32x16_bf16 v[192:207], v[52:55], v[180:183], v[192:207]
    ds_read_b64_tr_b16 v[84:85], v25 offset:8448
    ds_read_b64_tr_b16 v[86:87], v25 offset:12544
    buffer_store_dwordx4 v[140:143], v1, s[4:7], s45 offen sc1
    s_add_u32 s45, s45, 32768
    v_mfma_f32_32x32x16_bf16 v[192:207], v[56:59], v[184:187], v[192:207]
    ds_read_b64_tr_b16 v[88:89], v25 offset:33024
    ds_read_b64_tr_b16 v[90:91], v25 offset:37120
    v_mfma_f32_32x32x16_bf16 v[192:207], v[60:63], v[188:191], v[192:207]
    ds_read_b64_tr_b16 v[92:93], v25 offset:41216
    ds_read_b64_tr_b16 v[94:95], v25 offset:45312
    v_mfma_f32_32x32x16_bf16 v[208:223], a[40:43], v[240:243], 0
    v_mfma_f32_32x32x16_bf16 v[208:223], a[44:47], v[244:247], v[208:223]
    v_cvt_pk_bf16_f32 v128, v192, v193
    v_min_u32 v128, -2, v128
    v_cvt_pk_bf16_f32 v129, v194, v195
    v_min_u32 v129, -2, v129
    s_waitcnt lgkmcnt(0)
    v_mfma_f32_32x32x16_bf16 v[208:223], v[64:67], v[160:163], v[208:223]
    ds_read_b64_tr_b16 v[32:33], v22 offset:256
    ds_read_b64_tr_b16 v[34:35], v22 offset:4352
    v_cvt_pk_bf16_f32 v130, v196, v197
    v_min_u32 v130, -2, v130
    v_cvt_pk_bf16_f32 v131, v198, v199
    v_min_u32 v131, -2, v131
    v_mfma_f32_32x32x16_bf16 v[208:223], v[68:71], v[164:167], v[208:223]
    ds_read_b64_tr_b16 v[36:37], v22 offset:8448
    ds_read_b64_tr_b16 v[38:39], v22 offset:12544
    v_cvt_pk_bf16_f32 v132, v200, v201
    v_min_u32 v132, -2, v132
    v_cvt_pk_bf16_f32 v133, v202, v203
    v_min_u32 v133, -2, v133
    v_mfma_f32_32x32x16_bf16 v[208:223], v[72:75], v[168:171], v[208:223]
    ds_read_b64_tr_b16 v[40:41], v22 offset:33024
    ds_read_b64_tr_b16 v[42:43], v22 offset:37120
    v_cvt_pk_bf16_f32 v134, v204, v205
    v_min_u32 v134, -2, v134
    v_cvt_pk_bf16_f32 v135, v206, v207
    v_min_u32 v135, -2, v135
    v_mfma_f32_32x32x16_bf16 v[208:223], v[76:79], v[172:175], v[208:223]
    ds_read_b64_tr_b16 v[44:45], v22 offset:41216
    ds_read_b64_tr_b16 v[46:47], v22 offset:45312
    v_mfma_f32_32x32x16_bf16 v[208:223], v[80:83], v[176:179], v[208:223]
    ds_read_b64_tr_b16 v[48:49], v26 offset:256
    ds_read_b64_tr_b16 v[50:51], v26 offset:4352
    buffer_store_dwordx4 v[128:131], v1, s[4:7], s45 offen sc1
    s_add_u32 s45, s45, 32768
    v_mfma_f32_32x32x16_bf16 v[208:223], v[84:87], v[180:183], v[208:223]
    ds_read_b64_tr_b16 v[52:53], v26 offset:8448
    ds_read_b64_tr_b16 v[54:55], v26 offset:12544
    buffer_store_dwordx4 v[132:135], v1, s[4:7], s45 offen sc1
    s_add_u32 s45, s45, 32768
    v_mfma_f32_32x32x16_bf16 v[208:223], v[88:91], v[184:187], v[208:223]
    ds_read_b64_tr_b16 v[56:57], v26 offset:33024
    ds_read_b64_tr_b16 v[58:59], v26 offset:37120
    v_mfma_f32_32x32x16_bf16 v[208:223], v[92:95], v[188:191], v[208:223]
    ds_read_b64_tr_b16 v[60:61], v26 offset:41216
    ds_read_b64_tr_b16 v[62:63], v26 offset:45312
    v_mfma_f32_32x32x16_bf16 v[192:207], a[48:51], v[240:243], 0
    v_mfma_f32_32x32x16_bf16 v[192:207], a[52:55], v[244:247], v[192:207]
    v_cvt_pk_bf16_f32 v136, v208, v209
    v_min_u32 v136, -2, v136
    v_cvt_pk_bf16_f32 v137, v210, v211
    v_min_u32 v137, -2, v137
    s_waitcnt lgkmcnt(0)
    v_mfma_f32_32x32x16_bf16 v[192:207], v[32:35], v[160:163], v[192:207]
    ds_read_b64_tr_b16 v[64:65], v23 offset:256
    ds_read_b64_tr_b16 v[66:67], v23 offset:4352
    v_cvt_pk_bf16_f32 v138, v212, v213
    v_min_u32 v138, -2, v138
    v_cvt_pk_bf16_f32 v139, v214, v215
    v_min_u32 v139, -2, v139
    v_mfma_f32_32x32x16_bf16 v[192:207], v[36:39], v[164:167], v[192:207]
    ds_read_b64_tr_b16 v[68:69], v23 offset:8448
    ds_read_b64_tr_b16 v[70:71], v23 offset:12544
    v_cvt_pk_bf16_f32 v140, v216, v217
    v_min_u32 v140, -2, v140
    v_cvt_pk_bf16_f32 v141, v218, v219
    v_min_u32 v141, -2, v141
    v_mfma_f32_32x32x16_bf16 v[192:207], v[40:43], v[168:171], v[192:207]
    ds_read_b64_tr_b16 v[72:73], v23 offset:33024
    ds_read_b64_tr_b16 v[74:75], v23 offset:37120
    v_cvt_pk_bf16_f32 v142, v220, v221
    v_min_u32 v142, -2, v142
    v_cvt_pk_bf16_f32 v143, v222, v223
    v_min_u32 v143, -2, v143
    v_mfma_f32_32x32x16_bf16 v[192:207], v[44:47], v[172:175], v[192:207]
    ds_read_b64_tr_b16 v[76:77], v23 offset:41216
    ds_read_b64_tr_b16 v[78:79], v23 offset:45312
    v_mfma_f32_32x32x16_bf16 v[192:207], v[48:51], v[176:179], v[192:207]
    ds_read_b64_tr_b16 v[80:81], v27 offset:256
    ds_read_b64_tr_b16 v[82:83], v27 offset:4352
    buffer_store_dwordx4 v[136:139], v1, s[4:7], s45 offen sc1
    s_add_u32 s45, s45, 32768
    v_mfma_f32_32x32x16_bf16 v[192:207], v[52:55], v[180:183], v[192:207]
    ds_read_b64_tr_b16 v[84:85], v27 offset:8448
    ds_read_b64_tr_b16 v[86:87], v27 offset:12544
    buffer_store_dwordx4 v[140:143], v1, s[4:7], s45 offen sc1
    s_add_u32 s45, s45, 32768
    v_mfma_f32_32x32x16_bf16 v[192:207], v[56:59], v[184:187], v[192:207]
    ds_read_b64_tr_b16 v[88:89], v27 offset:33024
    ds_read_b64_tr_b16 v[90:91], v27 offset:37120
    v_mfma_f32_32x32x16_bf16 v[192:207], v[60:63], v[188:191], v[192:207]
    ds_read_b64_tr_b16 v[92:93], v27 offset:41216
    ds_read_b64_tr_b16 v[94:95], v27 offset:45312
    v_mfma_f32_32x32x16_bf16 v[208:223], a[56:59], v[240:243], 0
    v_mfma_f32_32x32x16_bf16 v[208:223], a[60:63], v[244:247], v[208:223]
    v_cvt_pk_bf16_f32 v128, v192, v193
    v_min_u32 v128, -2, v128
    v_cvt_pk_bf16_f32 v129, v194, v195
    v_min_u32 v129, -2, v129
    s_waitcnt lgkmcnt(0)
    v_mfma_f32_32x32x16_bf16 v[208:223], v[64:67], v[160:163], v[208:223]
    ds_read_b64_tr_b16 v[32:33], v20 offset:512
    ds_read_b64_tr_b16 v[34:35], v20 offset:4608
    v_cvt_pk_bf16_f32 v130, v196, v197
    v_min_u32 v130, -2, v130
    v_cvt_pk_bf16_f32 v131, v198, v199
    v_min_u32 v131, -2, v131
    v_mfma_f32_32x32x16_bf16 v[208:223], v[68:71], v[164:167], v[208:223]
    ds_read_b64_tr_b16 v[36:37], v20 offset:8704
    ds_read_b64_tr_b16 v[38:39], v20 offset:12800
    v_cvt_pk_bf16_f32 v132, v200, v201
    v_min_u32 v132, -2, v132
    v_cvt_pk_bf16_f32 v133, v202, v203
    v_min_u32 v133, -2, v133
    v_mfma_f32_32x32x16_bf16 v[208:223], v[72:75], v[168:171], v[208:223]
    ds_read_b64_tr_b16 v[40:41], v20 offset:33280
    ds_read_b64_tr_b16 v[42:43], v20 offset:37376
    v_cvt_pk_bf16_f32 v134, v204, v205
    v_min_u32 v134, -2, v134
    v_cvt_pk_bf16_f32 v135, v206, v207
    v_min_u32 v135, -2, v135
    v_mfma_f32_32x32x16_bf16 v[208:223], v[76:79], v[172:175], v[208:223]
    ds_read_b64_tr_b16 v[44:45], v20 offset:41472
    ds_read_b64_tr_b16 v[46:47], v20 offset:45568
    v_mfma_f32_32x32x16_bf16 v[208:223], v[80:83], v[176:179], v[208:223]
    ds_read_b64_tr_b16 v[48:49], v24 offset:512
    ds_read_b64_tr_b16 v[50:51], v24 offset:4608
    buffer_store_dwordx4 v[128:131], v1, s[4:7], s45 offen sc1
    s_add_u32 s45, s45, 32768
    v_mfma_f32_32x32x16_bf16 v[208:223], v[84:87], v[180:183], v[208:223]
    ds_read_b64_tr_b16 v[52:53], v24 offset:8704
    ds_read_b64_tr_b16 v[54:55], v24 offset:12800
    buffer_store_dwordx4 v[132:135], v1, s[4:7], s45 offen sc1
    s_add_u32 s45, s45, 32768
    v_mfma_f32_32x32x16_bf16 v[208:223], v[88:91], v[184:187], v[208:223]
    ds_read_b64_tr_b16 v[56:57], v24 offset:33280
    ds_read_b64_tr_b16 v[58:59], v24 offset:37376
    v_mfma_f32_32x32x16_bf16 v[208:223], v[92:95], v[188:191], v[208:223]
    ds_read_b64_tr_b16 v[60:61], v24 offset:41472
    ds_read_b64_tr_b16 v[62:63], v24 offset:45568
    v_mfma_f32_32x32x16_bf16 v[192:207], a[64:67], v[240:243], 0
    v_mfma_f32_32x32x16_bf16 v[192:207], a[68:71], v[244:247], v[192:207]
    v_cvt_pk_bf16_f32 v136, v208, v209
    v_min_u32 v136, -2, v136
    v_cvt_pk_bf16_f32 v137, v210, v211
    v_min_u32 v137, -2, v137
    s_waitcnt lgkmcnt(0)
    v_mfma_f32_32x32x16_bf16 v[192:207], v[32:35], v[160:163], v[192:207]
    ds_read_b64_tr_b16 v[64:65], v21 offset:512
    ds_read_b64_tr_b16 v[66:67], v21 offset:4608
    v_cvt_pk_bf16_f32 v138, v212, v213
    v_min_u32 v138, -2, v138
    v_cvt_pk_bf16_f32 v139, v214, v215
    v_min_u32 v139, -2, v139
    v_mfma_f32_32x32x16_bf16 v[192:207], v[36:39], v[164:167], v[192:207]
    ds_read_b64_tr_b16 v[68:69], v21 offset:8704
    ds_read_b64_tr_b16 v[70:71], v21 offset:12800
    v_cvt_pk_bf16_f32 v140, v216, v217
    v_min_u32 v140, -2, v140
    v_cvt_pk_bf16_f32 v141, v218, v219
    v_min_u32 v141, -2, v141
    v_mfma_f32_32x32x16_bf16 v[192:207], v[40:43], v[168:171], v[192:207]
    ds_read_b64_tr_b16 v[72:73], v21 offset:33280
    ds_read_b64_tr_b16 v[74:75], v21 offset:37376
    v_cvt_pk_bf16_f32 v142, v220, v221
    v_min_u32 v142, -2, v142
    v_cvt_pk_bf16_f32 v143, v222, v223
    v_min_u32 v143, -2, v143
    v_mfma_f32_32x32x16_bf16 v[192:207], v[44:47], v[172:175], v[192:207]
    ds_read_b64_tr_b16 v[76:77], v21 offset:41472
    ds_read_b64_tr_b16 v[78:79], v21 offset:45568
    v_mfma_f32_32x32x16_bf16 v[192:207], v[48:51], v[176:179], v[192:207]
    ds_read_b64_tr_b16 v[80:81], v25 offset:512
    ds_read_b64_tr_b16 v[82:83], v25 offset:4608
    buffer_store_dwordx4 v[136:139], v1, s[4:7], s45 offen sc1
    s_add_u32 s45, s45, 32768
    v_mfma_f32_32x32x16_bf16 v[192:207], v[52:55], v[180:183], v[192:207]
    ds_read_b64_tr_b16 v[84:85], v25 offset:8704
    ds_read_b64_tr_b16 v[86:87], v25 offset:12800
    buffer_store_dwordx4 v[140:143], v1, s[4:7], s45 offen sc1
    s_add_u32 s45, s45, 32768
    v_mfma_f32_32x32x16_bf16 v[192:207], v[56:59], v[184:187], v[192:207]
    ds_read_b64_tr_b16 v[88:89], v25 offset:33280
    ds_read_b64_tr_b16 v[90:91], v25 offset:37376
    v_mfma_f32_32x32x16_bf16 v[192:207], v[60:63], v[188:191], v[192:207]
    ds_read_b64_tr_b16 v[92:93], v25 offset:41472
    ds_read_b64_tr_b16 v[94:95], v25 offset:45568
    v_mfma_f32_32x32x16_bf16 v[208:223], a[72:75], v[240:243], 0
    v_mfma_f32_32x32x16_bf16 v[208:223], a[76:79], v[244:247], v[208:223]
    v_cvt_pk_bf16_f32 v128, v192, v193
    v_min_u32 v128, -2, v128
    v_cvt_pk_bf16_f32 v129, v194, v195
    v_min_u32 v129, -2, v129
    s_waitcnt lgkmcnt(0)
    v_mfma_f32_32x32x16_bf16 v[208:223], v[64:67], v[160:163], v[208:223]
    ds_read_b64_tr_b16 v[32:33], v22 offset:512
    ds_read_b64_tr_b16 v[34:35], v22 offset:4608
    v_cvt_pk_bf16_f32 v130, v196, v197
    v_min_u32 v130, -2, v130
    v_cvt_pk_bf16_f32 v131, v198, v199
    v_min_u32 v131, -2, v131
    v_mfma_f32_32x32x16_bf16 v[208:223], v[68:71], v[164:167], v[208:223]
    ds_read_b64_tr_b16 v[36:37], v22 offset:8704
    ds_read_b64_tr_b16 v[38:39], v22 offset:12800
    v_cvt_pk_bf16_f32 v132, v200, v201
    v_min_u32 v132, -2, v132
    v_cvt_pk_bf16_f32 v133, v202, v203
    v_min_u32 v133, -2, v133
    v_mfma_f32_32x32x16_bf16 v[208:223], v[72:75], v[168:171], v[208:223]
    ds_read_b64_tr_b16 v[40:41], v22 offset:33280
    ds_read_b64_tr_b16 v[42:43], v22 offset:37376
    v_cvt_pk_bf16_f32 v134, v204, v205
    v_min_u32 v134, -2, v134
    v_cvt_pk_bf16_f32 v135, v206, v207
    v_min_u32 v135, -2, v135
    v_mfma_f32_32x32x16_bf16 v[208:223], v[76:79], v[172:175], v[208:223]
    ds_read_b64_tr_b16 v[44:45], v22 offset:41472
    ds_read_b64_tr_b16 v[46:47], v22 offset:45568
    v_mfma_f32_32x32x16_bf16 v[208:223], v[80:83], v[176:179], v[208:223]
    ds_read_b64_tr_b16 v[48:49], v26 offset:512
    ds_read_b64_tr_b16 v[50:51], v26 offset:4608
    buffer_store_dwordx4 v[128:131], v1, s[4:7], s45 offen sc1
    s_add_u32 s45, s45, 32768
    v_mfma_f32_32x32x16_bf16 v[208:223], v[84:87], v[180:183], v[208:223]
    ds_read_b64_tr_b16 v[52:53], v26 offset:8704
    ds_read_b64_tr_b16 v[54:55], v26 offset:12800
    buffer_store_dwordx4 v[132:135], v1, s[4:7], s45 offen sc1
    s_add_u32 s45, s45, 32768
    v_mfma_f32_32x32x16_bf16 v[208:223], v[88:91], v[184:187], v[208:223]
    ds_read_b64_tr_b16 v[56:57], v26 offset:33280
    ds_read_b64_tr_b16 v[58:59], v26 offset:37376
    v_mfma_f32_32x32x16_bf16 v[208:223], v[92:95], v[188:191], v[208:223]
    ds_read_b64_tr_b16 v[60:61], v26 offset:41472
    ds_read_b64_tr_b16 v[62:63], v26 offset:45568
    v_mfma_f32_32x32x16_bf16 v[192:207], a[80:83], v[240:243], 0
    v_mfma_f32_32x32x16_bf16 v[192:207], a[84:87], v[244:247], v[192:207]
    v_cvt_pk_bf16_f32 v136, v208, v209
    v_min_u32 v136, -2, v136
    v_cvt_pk_bf16_f32 v137, v210, v211
    v_min_u32 v137, -2, v137
    s_waitcnt lgkmcnt(0)
    v_mfma_f32_32x32x16_bf16 v[192:207], v[32:35], v[160:163], v[192:207]
    ds_read_b64_tr_b16 v[64:65], v23 offset:512
    ds_read_b64_tr_b16 v[66:67], v23 offset:4608
    v_cvt_pk_bf16_f32 v138, v212, v213
    v_min_u32 v138, -2, v138
    v_cvt_pk_bf16_f32 v139, v214, v215
    v_min_u32 v139, -2, v139
    v_mfma_f32_32x32x16_bf16 v[192:207], v[36:39], v[164:167], v[192:207]
    ds_read_b64_tr_b16 v[68:69], v23 offset:8704
    ds_read_b64_tr_b16 v[70:71], v23 offset:12800
    v_cvt_pk_bf16_f32 v140, v216, v217
    v_min_u32 v140, -2, v140
    v_cvt_pk_bf16_f32 v141, v218, v219
    v_min_u32 v141, -2, v141
    v_mfma_f32_32x32x16_bf16 v[192:207], v[40:43], v[168:171], v[192:207]
    ds_read_b64_tr_b16 v[72:73], v23 offset:33280
    ds_read_b64_tr_b16 v[74:75], v23 offset:37376
    v_cvt_pk_bf16_f32 v142, v220, v221
    v_min_u32 v142, -2, v142
    v_cvt_pk_bf16_f32 v143, v222, v223
    v_min_u32 v143, -2, v143
    v_mfma_f32_32x32x16_bf16 v[192:207], v[44:47], v[172:175], v[192:207]
    ds_read_b64_tr_b16 v[76:77], v23 offset:41472
    ds_read_b64_tr_b16 v[78:79], v23 offset:45568
    v_mfma_f32_32x32x16_bf16 v[192:207], v[48:51], v[176:179], v[192:207]
    ds_read_b64_tr_b16 v[80:81], v27 offset:512
    ds_read_b64_tr_b16 v[82:83], v27 offset:4608
    buffer_store_dwordx4 v[136:139], v1, s[4:7], s45 offen sc1
    s_add_u32 s45, s45, 32768
    v_mfma_f32_32x32x16_bf16 v[192:207], v[52:55], v[180:183], v[192:207]
    ds_read_b64_tr_b16 v[84:85], v27 offset:8704
    ds_read_b64_tr_b16 v[86:87], v27 offset:12800
    buffer_store_dwordx4 v[140:143], v1, s[4:7], s45 offen sc1
    s_add_u32 s45, s45, 32768
    v_mfma_f32_32x32x16_bf16 v[192:207], v[56:59], v[184:187], v[192:207]
    ds_read_b64_tr_b16 v[88:89], v27 offset:33280
    ds_read_b64_tr_b16 v[90:91], v27 offset:37376
    v_mfma_f32_32x32x16_bf16 v[192:207], v[60:63], v[188:191], v[192:207]
    ds_read_b64_tr_b16 v[92:93], v27 offset:41472
    ds_read_b64_tr_b16 v[94:95], v27 offset:45568
    v_mfma_f32_32x32x16_bf16 v[208:223], a[88:91], v[240:243], 0
    v_mfma_f32_32x32x16_bf16 v[208:223], a[92:95], v[244:247], v[208:223]
    v_cvt_pk_bf16_f32 v128, v192, v193
    v_min_u32 v128, -2, v128
    v_cvt_pk_bf16_f32 v129, v194, v195
    v_min_u32 v129, -2, v129
    s_waitcnt lgkmcnt(0)
    v_mfma_f32_32x32x16_bf16 v[208:223], v[64:67], v[160:163], v[208:223]
    ds_read_b64_tr_b16 v[32:33], v20 offset:768
    ds_read_b64_tr_b16 v[34:35], v20 offset:4864
    v_cvt_pk_bf16_f32 v130, v196, v197
    v_min_u32 v130, -2, v130
    v_cvt_pk_bf16_f32 v131, v198, v199
    v_min_u32 v131, -2, v131
    v_mfma_f32_32x32x16_bf16 v[208:223], v[68:71], v[164:167], v[208:223]
    ds_read_b64_tr_b16 v[36:37], v20 offset:8960
    ds_read_b64_tr_b16 v[38:39], v20 offset:13056
    v_cvt_pk_bf16_f32 v132, v200, v201
    v_min_u32 v132, -2, v132
    v_cvt_pk_bf16_f32 v133, v202, v203
    v_min_u32 v133, -2, v133
    v_mfma_f32_32x32x16_bf16 v[208:223], v[72:75], v[168:171], v[208:223]
    ds_read_b64_tr_b16 v[40:41], v20 offset:33536
    ds_read_b64_tr_b16 v[42:43], v20 offset:37632
    v_cvt_pk_bf16_f32 v134, v204, v205
    v_min_u32 v134, -2, v134
    v_cvt_pk_bf16_f32 v135, v206, v207
    v_min_u32 v135, -2, v135
    v_mfma_f32_32x32x16_bf16 v[208:223], v[76:79], v[172:175], v[208:223]
    ds_read_b64_tr_b16 v[44:45], v20 offset:41728
    ds_read_b64_tr_b16 v[46:47], v20 offset:45824
    v_mfma_f32_32x32x16_bf16 v[208:223], v[80:83], v[176:179], v[208:223]
    ds_read_b64_tr_b16 v[48:49], v24 offset:768
    ds_read_b64_tr_b16 v[50:51], v24 offset:4864
    buffer_store_dwordx4 v[128:131], v1, s[4:7], s45 offen sc1
    s_add_u32 s45, s45, 32768
    v_mfma_f32_32x32x16_bf16 v[208:223], v[84:87], v[180:183], v[208:223]
    ds_read_b64_tr_b16 v[52:53], v24 offset:8960
    ds_read_b64_tr_b16 v[54:55], v24 offset:13056
    buffer_store_dwordx4 v[132:135], v1, s[4:7], s45 offen sc1
    s_add_u32 s45, s45, 32768
    v_mfma_f32_32x32x16_bf16 v[208:223], v[88:91], v[184:187], v[208:223]
    ds_read_b64_tr_b16 v[56:57], v24 offset:33536
    ds_read_b64_tr_b16 v[58:59], v24 offset:37632
    v_mfma_f32_32x32x16_bf16 v[208:223], v[92:95], v[188:191], v[208:223]
    ds_read_b64_tr_b16 v[60:61], v24 offset:41728
    ds_read_b64_tr_b16 v[62:63], v24 offset:45824
    v_mfma_f32_32x32x16_bf16 v[192:207], a[96:99], v[240:243], 0
    v_mfma_f32_32x32x16_bf16 v[192:207], a[100:103], v[244:247], v[192:207]
    v_cvt_pk_bf16_f32 v136, v208, v209
    v_min_u32 v136, -2, v136
    v_cvt_pk_bf16_f32 v137, v210, v211
    v_min_u32 v137, -2, v137
    s_waitcnt lgkmcnt(0)
    v_mfma_f32_32x32x16_bf16 v[192:207], v[32:35], v[160:163], v[192:207]
    ds_read_b64_tr_b16 v[64:65], v21 offset:768
    ds_read_b64_tr_b16 v[66:67], v21 offset:4864
    v_cvt_pk_bf16_f32 v138, v212, v213
    v_min_u32 v138, -2, v138
    v_cvt_pk_bf16_f32 v139, v214, v215
    v_min_u32 v139, -2, v139
    v_mfma_f32_32x32x16_bf16 v[192:207], v[36:39], v[164:167], v[192:207]
    ds_read_b64_tr_b16 v[68:69], v21 offset:8960
    ds_read_b64_tr_b16 v[70:71], v21 offset:13056
    v_cvt_pk_bf16_f32 v140, v216, v217
    v_min_u32 v140, -2, v140
    v_cvt_pk_bf16_f32 v141, v218, v219
    v_min_u32 v141, -2, v141
    v_mfma_f32_32x32x16_bf16 v[192:207], v[40:43], v[168:171], v[192:207]
    ds_read_b64_tr_b16 v[72:73], v21 offset:33536
    ds_read_b64_tr_b16 v[74:75], v21 offset:37632
    v_cvt_pk_bf16_f32 v142, v220, v221
    v_min_u32 v142, -2, v142
    v_cvt_pk_bf16_f32 v143, v222, v223
    v_min_u32 v143, -2, v143
    v_mfma_f32_32x32x16_bf16 v[192:207], v[44:47], v[172:175], v[192:207]
    ds_read_b64_tr_b16 v[76:77], v21 offset:41728
    ds_read_b64_tr_b16 v[78:79], v21 offset:45824
    v_mfma_f32_32x32x16_bf16 v[192:207], v[48:51], v[176:179], v[192:207]
    ds_read_b64_tr_b16 v[80:81], v25 offset:768
    ds_read_b64_tr_b16 v[82:83], v25 offset:4864
    buffer_store_dwordx4 v[136:139], v1, s[4:7], s45 offen sc1
    s_add_u32 s45, s45, 32768
    v_mfma_f32_32x32x16_bf16 v[192:207], v[52:55], v[180:183], v[192:207]
    ds_read_b64_tr_b16 v[84:85], v25 offset:8960
    ds_read_b64_tr_b16 v[86:87], v25 offset:13056
    buffer_store_dwordx4 v[140:143], v1, s[4:7], s45 offen sc1
    s_add_u32 s45, s45, 32768
    v_mfma_f32_32x32x16_bf16 v[192:207], v[56:59], v[184:187], v[192:207]
    ds_read_b64_tr_b16 v[88:89], v25 offset:33536
    ds_read_b64_tr_b16 v[90:91], v25 offset:37632
    v_mfma_f32_32x32x16_bf16 v[192:207], v[60:63], v[188:191], v[192:207]
    ds_read_b64_tr_b16 v[92:93], v25 offset:41728
    ds_read_b64_tr_b16 v[94:95], v25 offset:45824
    v_mfma_f32_32x32x16_bf16 v[208:223], a[104:107], v[240:243], 0
    v_mfma_f32_32x32x16_bf16 v[208:223], a[108:111], v[244:247], v[208:223]
    v_cvt_pk_bf16_f32 v128, v192, v193
    v_min_u32 v128, -2, v128
    v_cvt_pk_bf16_f32 v129, v194, v195
    v_min_u32 v129, -2, v129
    s_waitcnt lgkmcnt(0)
    v_mfma_f32_32x32x16_bf16 v[208:223], v[64:67], v[160:163], v[208:223]
    ds_read_b64_tr_b16 v[32:33], v22 offset:768
    ds_read_b64_tr_b16 v[34:35], v22 offset:4864
    v_cvt_pk_bf16_f32 v130, v196, v197
    v_min_u32 v130, -2, v130
    v_cvt_pk_bf16_f32 v131, v198, v199
    v_min_u32 v131, -2, v131
    v_mfma_f32_32x32x16_bf16 v[208:223], v[68:71], v[164:167], v[208:223]
    ds_read_b64_tr_b16 v[36:37], v22 offset:8960
    ds_read_b64_tr_b16 v[38:39], v22 offset:13056
    v_cvt_pk_bf16_f32 v132, v200, v201
    v_min_u32 v132, -2, v132
    v_cvt_pk_bf16_f32 v133, v202, v203
    v_min_u32 v133, -2, v133
    v_mfma_f32_32x32x16_bf16 v[208:223], v[72:75], v[168:171], v[208:223]
    ds_read_b64_tr_b16 v[40:41], v22 offset:33536
    ds_read_b64_tr_b16 v[42:43], v22 offset:37632
    v_cvt_pk_bf16_f32 v134, v204, v205
    v_min_u32 v134, -2, v134
    v_cvt_pk_bf16_f32 v135, v206, v207
    v_min_u32 v135, -2, v135
    v_mfma_f32_32x32x16_bf16 v[208:223], v[76:79], v[172:175], v[208:223]
    ds_read_b64_tr_b16 v[44:45], v22 offset:41728
    ds_read_b64_tr_b16 v[46:47], v22 offset:45824
    v_mfma_f32_32x32x16_bf16 v[208:223], v[80:83], v[176:179], v[208:223]
    ds_read_b64_tr_b16 v[48:49], v26 offset:768
    ds_read_b64_tr_b16 v[50:51], v26 offset:4864
    buffer_store_dwordx4 v[128:131], v1, s[4:7], s45 offen sc1
    s_add_u32 s45, s45, 32768
    v_mfma_f32_32x32x16_bf16 v[208:223], v[84:87], v[180:183], v[208:223]
    ds_read_b64_tr_b16 v[52:53], v26 offset:8960
    ds_read_b64_tr_b16 v[54:55], v26 offset:13056
    buffer_store_dwordx4 v[132:135], v1, s[4:7], s45 offen sc1
    s_add_u32 s45, s45, 32768
    v_mfma_f32_32x32x16_bf16 v[208:223], v[88:91], v[184:187], v[208:223]
    ds_read_b64_tr_b16 v[56:57], v26 offset:33536
    ds_read_b64_tr_b16 v[58:59], v26 offset:37632
    v_mfma_f32_32x32x16_bf16 v[208:223], v[92:95], v[188:191], v[208:223]
    ds_read_b64_tr_b16 v[60:61], v26 offset:41728
    ds_read_b64_tr_b16 v[62:63], v26 offset:45824
    v_mfma_f32_32x32x16_bf16 v[192:207], a[112:115], v[240:243], 0
    v_mfma_f32_32x32x16_bf16 v[192:207], a[116:119], v[244:247], v[192:207]
    v_cvt_pk_bf16_f32 v136, v208, v209
    v_min_u32 v136, -2, v136
    v_cvt_pk_bf16_f32 v137, v210, v211
    v_min_u32 v137, -2, v137
    s_waitcnt lgkmcnt(0)
    v_mfma_f32_32x32x16_bf16 v[192:207], v[32:35], v[160:163], v[192:207]
    ds_read_b64_tr_b16 v[64:65], v23 offset:768
    ds_read_b64_tr_b16 v[66:67], v23 offset:4864
    v_cvt_pk_bf16_f32 v138, v212, v213
    v_min_u32 v138, -2, v138
    v_cvt_pk_bf16_f32 v139, v214, v215
    v_min_u32 v139, -2, v139
    v_mfma_f32_32x32x16_bf16 v[192:207], v[36:39], v[164:167], v[192:207]
    ds_read_b64_tr_b16 v[68:69], v23 offset:8960
    ds_read_b64_tr_b16 v[70:71], v23 offset:13056
    v_cvt_pk_bf16_f32 v140, v216, v217
    v_min_u32 v140, -2, v140
    v_cvt_pk_bf16_f32 v141, v218, v219
    v_min_u32 v141, -2, v141
    v_mfma_f32_32x32x16_bf16 v[192:207], v[40:43], v[168:171], v[192:207]
    ds_read_b64_tr_b16 v[72:73], v23 offset:33536
    ds_read_b64_tr_b16 v[74:75], v23 offset:37632
    v_cvt_pk_bf16_f32 v142, v220, v221
    v_min_u32 v142, -2, v142
    v_cvt_pk_bf16_f32 v143, v222, v223
    v_min_u32 v143, -2, v143
    v_mfma_f32_32x32x16_bf16 v[192:207], v[44:47], v[172:175], v[192:207]
    ds_read_b64_tr_b16 v[76:77], v23 offset:41728
    ds_read_b64_tr_b16 v[78:79], v23 offset:45824
    v_mfma_f32_32x32x16_bf16 v[192:207], v[48:51], v[176:179], v[192:207]
    ds_read_b64_tr_b16 v[80:81], v27 offset:768
    ds_read_b64_tr_b16 v[82:83], v27 offset:4864
    buffer_store_dwordx4 v[136:139], v1, s[4:7], s45 offen sc1
    s_add_u32 s45, s45, 32768
    v_mfma_f32_32x32x16_bf16 v[192:207], v[52:55], v[180:183], v[192:207]
    ds_read_b64_tr_b16 v[84:85], v27 offset:8960
    ds_read_b64_tr_b16 v[86:87], v27 offset:13056
    buffer_store_dwordx4 v[140:143], v1, s[4:7], s45 offen sc1
    s_add_u32 s45, s45, 32768
    v_mfma_f32_32x32x16_bf16 v[192:207], v[56:59], v[184:187], v[192:207]
    ds_read_b64_tr_b16 v[88:89], v27 offset:33536
    ds_read_b64_tr_b16 v[90:91], v27 offset:37632
    v_mfma_f32_32x32x16_bf16 v[192:207], v[60:63], v[188:191], v[192:207]
    ds_read_b64_tr_b16 v[92:93], v27 offset:41728
    ds_read_b64_tr_b16 v[94:95], v27 offset:45824
    v_mfma_f32_32x32x16_bf16 v[208:223], a[120:123], v[240:243], 0
    v_mfma_f32_32x32x16_bf16 v[208:223], a[124:127], v[244:247], v[208:223]
    v_cvt_pk_bf16_f32 v128, v192, v193
    v_min_u32 v128, -2, v128
    v_cvt_pk_bf16_f32 v129, v194, v195
    v_min_u32 v129, -2, v129
    s_waitcnt lgkmcnt(0)
    v_mfma_f32_32x32x16_bf16 v[208:223], v[64:67], v[160:163], v[208:223]
    v_cvt_pk_bf16_f32 v130, v196, v197
    v_min_u32 v130, -2, v130
    v_cvt_pk_bf16_f32 v131, v198, v199
    v_min_u32 v131, -2, v131
    v_mfma_f32_32x32x16_bf16 v[208:223], v[68:71], v[164:167], v[208:223]
    v_cvt_pk_bf16_f32 v132, v200, v201
    v_min_u32 v132, -2, v132
    v_cvt_pk_bf16_f32 v133, v202, v203
    v_min_u32 v133, -2, v133
    v_mfma_f32_32x32x16_bf16 v[208:223], v[72:75], v[168:171], v[208:223]
    v_cvt_pk_bf16_f32 v134, v204, v205
    v_min_u32 v134, -2, v134
    v_cvt_pk_bf16_f32 v135, v206, v207
    v_min_u32 v135, -2, v135
    v_mfma_f32_32x32x16_bf16 v[208:223], v[76:79], v[172:175], v[208:223]
    v_mfma_f32_32x32x16_bf16 v[208:223], v[80:83], v[176:179], v[208:223]
    buffer_store_dwordx4 v[128:131], v1, s[4:7], s45 offen sc1
    s_add_u32 s45, s45, 32768
    v_mfma_f32_32x32x16_bf16 v[208:223], v[84:87], v[180:183], v[208:223]
    buffer_store_dwordx4 v[132:135], v1, s[4:7], s45 offen sc1
    s_add_u32 s45, s45, 32768
    v_mfma_f32_32x32x16_bf16 v[208:223], v[88:91], v[184:187], v[208:223]
    v_mfma_f32_32x32x16_bf16 v[208:223], v[92:95], v[188:191], v[208:223]
    s_nop 12
    v_cvt_pk_bf16_f32 v136, v208, v209
    v_min_u32 v136, -2, v136
    v_cvt_pk_bf16_f32 v137, v210, v211
    v_min_u32 v137, -2, v137
    v_cvt_pk_bf16_f32 v138, v212, v213
    v_min_u32 v138, -2, v138
    v_cvt_pk_bf16_f32 v139, v214, v215
    v_min_u32 v139, -2, v139
    v_cvt_pk_bf16_f32 v140, v216, v217
    v_min_u32 v140, -2, v140
    v_cvt_pk_bf16_f32 v141, v218, v219
    v_min_u32 v141, -2, v141
    v_cvt_pk_bf16_f32 v142, v220, v221
    v_min_u32 v142, -2, v142
    v_cvt_pk_bf16_f32 v143, v222, v223
    v_min_u32 v143, -2, v143
    buffer_store_dwordx4 v[136:139], v1, s[4:7], s45 offen sc1
    s_add_u32 s45, s45, 32768
    buffer_store_dwordx4 v[140:143], v1, s[4:7], s45 offen sc1
    s_add_u32 s45, s45, 32768
    s_lshl_b32 s48, s42, 7
    s_add_u32 s48, s48, 52494336
    v_mov_b32 v220, 1
    s_cmp_eq_u32 s34, 7
    s_cselect_b32 s44, 3, s44
    s_cbranch_scc1 L_h_s7
    s_cmp_lg_u32 s44, 0
    s_cbranch_scc1 L_h_sg
    v_accvgpr_read_b32 v160, a128
    v_accvgpr_read_b32 v96, a160
    v_accvgpr_read_b32 v161, a129
    v_accvgpr_read_b32 v97, a161
    v_accvgpr_read_b32 v162, a130
    v_accvgpr_read_b32 v98, a162
    v_accvgpr_read_b32 v163, a131
    v_accvgpr_read_b32 v99, a163
    v_accvgpr_read_b32 v164, a132
    v_accvgpr_read_b32 v100, a164
    v_accvgpr_read_b32 v165, a133
    v_accvgpr_read_b32 v101, a165
    v_accvgpr_read_b32 v166, a134
    v_accvgpr_read_b32 v102, a166
    v_accvgpr_read_b32 v167, a135
    v_accvgpr_read_b32 v103, a167
    v_accvgpr_read_b32 v168, a136
    v_accvgpr_read_b32 v104, a168
    v_accvgpr_read_b32 v169, a137
    v_accvgpr_read_b32 v105, a169
    v_accvgpr_read_b32 v170, a138
    v_accvgpr_read_b32 v106, a170
    v_accvgpr_read_b32 v171, a139
    v_accvgpr_read_b32 v107, a171
    v_accvgpr_read_b32 v172, a140
    v_accvgpr_read_b32 v108, a172
    v_accvgpr_read_b32 v173, a141
    v_accvgpr_read_b32 v109, a173
    v_accvgpr_read_b32 v174, a142
    v_accvgpr_read_b32 v110, a174
    v_accvgpr_read_b32 v175, a143
    v_accvgpr_read_b32 v111, a175
    v_accvgpr_read_b32 v176, a144
    v_accvgpr_read_b32 v112, a176
    v_accvgpr_read_b32 v177, a145
    v_accvgpr_read_b32 v113, a177
    v_accvgpr_read_b32 v178, a146
    v_accvgpr_read_b32 v114, a178
    v_accvgpr_read_b32 v179, a147
    v_accvgpr_read_b32 v115, a179
    v_accvgpr_read_b32 v180, a148
    v_accvgpr_read_b32 v116, a180
    v_accvgpr_read_b32 v181, a149
    v_accvgpr_read_b32 v117, a181
    v_accvgpr_read_b32 v182, a150
    v_accvgpr_read_b32 v118, a182
    v_accvgpr_read_b32 v183, a151
    v_accvgpr_read_b32 v119, a183
    v_accvgpr_read_b32 v184, a152
    v_accvgpr_read_b32 v120, a184
    v_accvgpr_read_b32 v185, a153
    v_accvgpr_read_b32 v121, a185
    v_accvgpr_read_b32 v186, a154
    v_accvgpr_read_b32 v122, a186
    v_accvgpr_read_b32 v187, a155
    v_accvgpr_read_b32 v123, a187
    v_accvgpr_read_b32 v188, a156
    v_accvgpr_read_b32 v124, a188
    v_accvgpr_read_b32 v189, a157
    v_accvgpr_read_b32 v125, a189
    v_accvgpr_read_b32 v190, a158
    v_accvgpr_read_b32 v126, a190
    v_accvgpr_read_b32 v191, a159
    v_accvgpr_read_b32 v127, a191
    v_accvgpr_read_b32 v224, a192
    v_accvgpr_read_b32 v225, a193
    v_accvgpr_read_b32 v226, a194
    v_accvgpr_read_b32 v227, a195
    v_accvgpr_read_b32 v228, a196
    v_accvgpr_read_b32 v229, a197
    v_accvgpr_read_b32 v230, a198
    v_accvgpr_read_b32 v231, a199
    v_accvgpr_read_b32 v232, a200
    v_accvgpr_read_b32 v233, a201
    v_accvgpr_read_b32 v234, a202
    v_accvgpr_read_b32 v235, a203
    v_accvgpr_read_b32 v236, a204
    v_accvgpr_read_b32 v237, a205
    v_accvgpr_read_b32 v238, a206
    v_accvgpr_read_b32 v239, a207
    v_accvgpr_read_b32 v240, a208
    v_accvgpr_read_b32 v241, a209
    v_accvgpr_read_b32 v242, a210
    v_accvgpr_read_b32 v243, a211
    v_accvgpr_read_b32 v244, a212
    v_accvgpr_read_b32 v245, a213
    v_accvgpr_read_b32 v246, a214
    v_accvgpr_read_b32 v247, a215
L_h_sg:
    v_accvgpr_read_b32 v29, a216
    v_accvgpr_write_b32 a216, v15
    s_xor_b32 s42, s42, 4
    s_add_u32 s44, s44, 1
    v_mov_b32 v15, v29
    s_waitcnt vmcnt(0)
    s_mov_b64 exec, 1
    buffer_atomic_add v220, off, s[4:7], s48
    s_mov_b64 exec, -1
    s_cmp_eq_u32 s44, 1
    s_cbranch_scc1 L_h_seg
L_h_s7:
    s_waitcnt vmcnt(0)
    s_lshl_b32 s46, s32, 5
    v_lshlrev_b32 v30, 4, v17
    v_lshl_add_u32 v31, v16, 10, v30
    v_add_u32 v30, s46, v30
    global_load_dwordx4 v[212:215], v30, s[66:67]
    v_lshlrev_b32 v28, 1, v31
    v_bfe_u32 v32, v0, 2, 1
    v_bfe_u32 v33, v0, 3, 2
    v_and_b32 v34, 3, v0
    v_lshl_add_u32 v33, v33, 2, v34
    v_cmp_eq_u32 vcc, v32, v17
    v_mov_b32 v35, 64
    s_mov_b32 s46, 0x3f80
    v_cndmask_b32 v33, v35, v33, vcc
    v_and_b32 v34, 1, v33
    v_lshlrev_b32 v34, 4, v34
    v_lshlrev_b32 v34, v34, s46
    v_lshrrev_b32 v33, 1, v33
    v_cmp_eq_u32 vcc, 0, v33
    s_nop 1
    v_cndmask_b32 v216, 0, v34, vcc
    v_cmp_eq_u32 vcc, 1, v33
    s_nop 1
    v_cndmask_b32 v217, 0, v34, vcc
    v_cmp_eq_u32 vcc, 2, v33
    s_nop 1
    v_cndmask_b32 v218, 0, v34, vcc
    v_cmp_eq_u32 vcc, 3, v33
    s_nop 1
    v_cndmask_b32 v219, 0, v34, vcc
L_h_red:
    s_lshl_b32 s47, s42, 15
    s_lshl_b32 s46, s32, 5
    s_add_u32 s47, s47, s46
    buffer_load_dwordx4 v[208:211], v31, s[8:11], s47 offen
    s_lshl_b32 s48, s42, 7
    s_add_u32 s48, s48, 52494336
    s_lshl_b32 s45, s42, 20
    s_lshl_b32 s46, s32, 15
    s_add_u32 s45, s45, s46
    s_add_u32 s45, s45, 67108864
    s_lshl_b32 s47, s47, 1
    v_lshlrev_b32 v221, 10, v16
    s_cmp_ge_u32 s42, 56
    s_cbranch_scc1 L_h_rf
L_h_wc:
    buffer_load_dword v220, off, s[4:7], s48 sc1
    s_waitcnt vmcnt(0)
    v_cmp_gt_u32 vcc, 32, v220
    s_cbranch_vccz L_h_rd
    s_add_u32 s43, s43, 1
    s_cmp_gt_u32 s43, 1000000
    s_cbranch_scc1 L_end
    s_sleep 2
    s_branch L_h_wc
L_h_rf:
    s_mov_b64 exec, 0xffffffff
    buffer_load_dword v220, v221, s[4:7], s45 offen offset:1020 sc1
    s_add_u32 s43, s43, 1
    s_cmp_gt_u32 s43, 1000000
    s_cbranch_scc1 L_end
    s_waitcnt vmcnt(0)
    v_cmp_eq_u32 vcc, -1, v220
    s_mov_b64 exec, -1
    s_cbranch_vccz L_h_rd
    s_sleep 2
    s_branch L_h_rf
L_h_rd:
    s_add_u32 s46, s45, 0
    buffer_load_dwordx4 v[32:35], v1, s[4:7], s46 offen offset:0 sc1
    buffer_load_dwordx4 v[36:39], v1, s[4:7], s46 offen offset:1024 sc1
    buffer_load_dwordx4 v[40:43], v1, s[4:7], s46 offen offset:2048 sc1
    buffer_load_dwordx4 v[44:47], v1, s[4:7], s46 offen offset:3072 sc1
    s_add_u32 s46, s45, 4096
    buffer_load_dwordx4 v[48:51], v1, s[4:7], s46 offen offset:0 sc1
    buffer_load_dwordx4 v[52:55], v1, s[4:7], s46 offen offset:1024 sc1
    buffer_load_dwordx4 v[56:59], v1, s[4:7], s46 offen offset:2048 sc1
    buffer_load_dwordx4 v[60:63], v1, s[4:7], s46 offen offset:3072 sc1
    s_add_u32 s46, s45, 8192
    buffer_load_dwordx4 v[64:67], v1, s[4:7], s46 offen offset:0 sc1
    buffer_load_dwordx4 v[68:71], v1, s[4:7], s46 offen offset:1024 sc1
    buffer_load_dwordx4 v[72:75], v1, s[4:7], s46 offen offset:2048 sc1
    buffer_load_dwordx4 v[76:79], v1, s[4:7], s46 offen offset:3072 sc1
    s_add_u32 s46, s45, 12288
    buffer_load_dwordx4 v[80:83], v1, s[4:7], s46 offen offset:0 sc1
    buffer_load_dwordx4 v[84:87], v1, s[4:7], s46 offen offset:1024 sc1
    buffer_load_dwordx4 v[88:91], v1, s[4:7], s46 offen offset:2048 sc1
    buffer_load_dwordx4 v[92:95], v1, s[4:7], s46 offen offset:3072 sc1
    s_add_u32 s46, s45, 16384
    buffer_load_dwordx4 v[96:99], v1, s[4:7], s46 offen offset:0 sc1
    buffer_load_dwordx4 v[100:103], v1, s[4:7], s46 offen offset:1024 sc1
    buffer_load_dwordx4 v[104:107], v1, s[4:7], s46 offen offset:2048 sc1
    buffer_load_dwordx4 v[108:111], v1, s[4:7], s46 offen offset:3072 sc1
    s_add_u32 s46, s45, 20480
    buffer_load_dwordx4 v[112:115], v1, s[4:7], s46 offen offset:0 sc1
    buffer_load_dwordx4 v[116:119], v1, s[4:7], s46 offen offset:1024 sc1
    buffer_load_dwordx4 v[120:123], v1, s[4:7], s46 offen offset:2048 sc1
    buffer_load_dwordx4 v[124:127], v1, s[4:7], s46 offen offset:3072 sc1
    s_add_u32 s46, s45, 24576
    buffer_load_dwordx4 v[128:131], v1, s[4:7], s46 offen offset:0 sc1
    buffer_load_dwordx4 v[132:135], v1, s[4:7], s46 offen offset:1024 sc1
    buffer_load_dwordx4 v[136:139], v1, s[4:7], s46 offen offset:2048 sc1
    buffer_load_dwordx4 v[140:143], v1, s[4:7], s46 offen offset:3072 sc1
    s_add_u32 s46, s45, 28672
    buffer_load_dwordx4 v[144:147], v1, s[4:7], s46 offen offset:0 sc1
    buffer_load_dwordx4 v[148:151], v1, s[4:7], s46 offen offset:1024 sc1
    buffer_load_dwordx4 v[152:155], v1, s[4:7], s46 offen offset:2048 sc1
    buffer_load_dwordx4 v[156:159], v1, s[4:7], s46 offen offset:3072 sc1
    s_waitcnt vmcnt(32)
    v_lshlrev_b32 v224, 16, v208
    v_and_b32 v225, 0xffff0000, v208
    v_lshlrev_b32 v226, 16, v209
    v_and_b32 v227, 0xffff0000, v209
    v_lshlrev_b32 v228, 16, v210
    v_and_b32 v229, 0xffff0000, v210
    v_lshlrev_b32 v230, 16, v211
    v_and_b32 v231, 0xffff0000, v211
    v_lshlrev_b32 v232, 16, v212
    v_and_b32 v233, 0xffff0000, v212
    v_lshlrev_b32 v234, 16, v213
    v_and_b32 v235, 0xffff0000, v213
    v_lshlrev_b32 v236, 16, v214
    v_and_b32 v237, 0xffff0000, v214
    v_lshlrev_b32 v238, 16, v215
    v_and_b32 v239, 0xffff0000, v215
    v_mul_f32 v224, v224, v232
    v_mul_f32 v225, v225, v233
    v_mul_f32 v226, v226, v234
    v_mul_f32 v227, v227, v235
    v_mul_f32 v228, v228, v236
    v_mul_f32 v229, v229, v237
    v_mul_f32 v230, v230, v238
    v_mul_f32 v231, v231, v239
    v_mov_b32 v29, 0
    s_waitcnt vmcnt(31)
    v_mfma_f32_32x32x16_bf16 v[192:207], v[216:219], v[32:35], 0
    v_max3_u32 v29, v29, v32, v33
    v_max3_u32 v29, v29, v34, v35
    s_waitcnt vmcnt(30)
    v_mfma_f32_32x32x16_bf16 v[192:207], v[216:219], v[36:39], v[192:207]
    v_max3_u32 v29, v29, v36, v37
    v_max3_u32 v29, v29, v38, v39
    s_waitcnt vmcnt(29)
    v_mfma_f32_32x32x16_bf16 v[192:207], v[216:219], v[40:43], v[192:207]
    v_max3_u32 v29, v29, v40, v41
    v_max3_u32 v29, v29, v42, v43
    s_waitcnt vmcnt(28)
    v_mfma_f32_32x32x16_bf16 v[192:207], v[216:219], v[44:47], v[192:207]
    v_max3_u32 v29, v29, v44, v45
    v_max3_u32 v29, v29, v46, v47
    s_waitcnt vmcnt(27)
    v_mfma_f32_32x32x16_bf16 v[192:207], v[216:219], v[48:51], v[192:207]
    v_max3_u32 v29, v29, v48, v49
    v_max3_u32 v29, v29, v50, v51
    s_waitcnt vmcnt(26)
    v_mfma_f32_32x32x16_bf16 v[192:207], v[216:219], v[52:55], v[192:207]
    v_max3_u32 v29, v29, v52, v53
    v_max3_u32 v29, v29, v54, v55
    s_waitcnt vmcnt(25)
    v_mfma_f32_32x32x16_bf16 v[192:207], v[216:219], v[56:59], v[192:207]
    v_max3_u32 v29, v29, v56, v57
    v_max3_u32 v29, v29, v58, v59
    s_waitcnt vmcnt(24)
    v_mfma_f32_32x32x16_bf16 v[192:207], v[216:219], v[60:63], v[192:207]
    v_max3_u32 v29, v29, v60, v61
    v_max3_u32 v29, v29, v62, v63
    s_waitcnt vmcnt(23)
    v_mfma_f32_32x32x16_bf16 v[192:207], v[216:219], v[64:67], v[192:207]
    v_max3_u32 v29, v29, v64, v65
    v_max3_u32 v29, v29, v66, v67
    s_waitcnt vmcnt(22)
    v_mfma_f32_32x32x16_bf16 v[192:207], v[216:219], v[68:71], v[192:207]
    v_max3_u32 v29, v29, v68, v69
    v_max3_u32 v29, v29, v70, v71
    s_waitcnt vmcnt(21)
    v_mfma_f32_32x32x16_bf16 v[192:207], v[216:219], v[72:75], v[192:207]
    v_max3_u32 v29, v29, v72, v73
    v_max3_u32 v29, v29, v74, v75
    s_waitcnt vmcnt(20)
    v_mfma_f32_32x32x16_bf16 v[192:207], v[216:219], v[76:79], v[192:207]
    v_max3_u32 v29, v29, v76, v77
    v_max3_u32 v29, v29, v78, v79
    s_waitcnt vmcnt(19)
    v_mfma_f32_32x32x16_bf16 v[192:207], v[216:219], v[80:83], v[192:207]
    v_max3_u32 v29, v29, v80, v81
    v_max3_u32 v29, v29, v82, v83
    s_waitcnt vmcnt(18)
    v_mfma_f32_32x32x16_bf16 v[192:207], v[216:219], v[84:87], v[192:207]
    v_max3_u32 v29, v29, v84, v85
    v_max3_u32 v29, v29, v86, v87
    s_waitcnt vmcnt(17)
    v_mfma_f32_32x32x16_bf16 v[192:207], v[216:219], v[88:91], v[192:207]
    v_max3_u32 v29, v29, v88, v89
    v_max3_u32 v29, v29, v90, v91
    s_waitcnt vmcnt(16)
    v_mfma_f32_32x32x16_bf16 v[192:207], v[216:219], v[92:95], v[192:207]
    v_max3_u32 v29, v29, v92, v93
    v_max3_u32 v29, v29, v94, v95
    s_waitcnt vmcnt(15)
    v_mfma_f32_32x32x16_bf16 v[192:207], v[216:219], v[96:99], v[192:207]
    v_max3_u32 v29, v29, v96, v97
    v_max3_u32 v29, v29, v98, v99
    s_waitcnt vmcnt(14)
    v_mfma_f32_32x32x16_bf16 v[192:207], v[216:219], v[100:103], v[192:207]
    v_max3_u32 v29, v29, v100, v101
    v_max3_u32 v29, v29, v102, v103
    s_waitcnt vmcnt(13)
    v_mfma_f32_32x32x16_bf16 v[192:207], v[216:219], v[104:107], v[192:207]
    v_max3_u32 v29, v29, v104, v105
    v_max3_u32 v29, v29, v106, v107
    s_waitcnt vmcnt(12)
    v_mfma_f32_32x32x16_bf16 v[192:207], v[216:219], v[108:111], v[192:207]
    v_max3_u32 v29, v29, v108, v109
    v_max3_u32 v29, v29, v110, v111
    s_waitcnt vmcnt(11)
    v_mfma_f32_32x32x16_bf16 v[192:207], v[216:219], v[112:115], v[192:207]
    v_max3_u32 v29, v29, v112, v113
    v_max3_u32 v29, v29, v114, v115
    s_waitcnt vmcnt(10)
    v_mfma_f32_32x32x16_bf16 v[192:207], v[216:219], v[116:119], v[192:207]
    v_max3_u32 v29, v29, v116, v117
    v_max3_u32 v29, v29, v118, v119
    s_waitcnt vmcnt(9)
    v_mfma_f32_32x32x16_bf16 v[192:207], v[216:219], v[120:123], v[192:207]
    v_max3_u32 v29, v29, v120, v121
    v_max3_u32 v29, v29, v122, v123
    s_waitcnt vmcnt(8)
    v_mfma_f32_32x32x16_bf16 v[192:207], v[216:219], v[124:127], v[192:207]
    v_max3_u32 v29, v29, v124, v125
    v_max3_u32 v29, v29, v126, v127
    s_waitcnt vmcnt(7)
    v_mfma_f32_32x32x16_bf16 v[192:207], v[216:219], v[128:131], v[192:207]
    v_max3_u32 v29, v29, v128, v129
    v_max3_u32 v29, v29, v130, v131
    s_waitcnt vmcnt(6)
    v_mfma_f32_32x32x16_bf16 v[192:207], v[216:219], v[132:135], v[192:207]
    v_max3_u32 v29, v29, v132, v133
    v_max3_u32 v29, v29, v134, v135
    s_waitcnt vmcnt(5)
    v_mfma_f32_32x32x16_bf16 v[192:207], v[216:219], v[136:139], v[192:207]
    v_max3_u32 v29, v29, v136, v137
    v_max3_u32 v29, v29, v138, v139
    s_waitcnt vmcnt(4)
    v_mfma_f32_32x32x16_bf16 v[192:207], v[216:219], v[140:143], v[192:207]
    v_max3_u32 v29, v29, v140, v141
    v_max3_u32 v29, v29, v142, v143
    s_waitcnt vmcnt(3)
    v_mfma_f32_32x32x16_bf16 v[192:207], v[216:219], v[144:147], v[192:207]
    v_max3_u32 v29, v29, v144, v145
    v_max3_u32 v29, v29, v146, v147
    s_waitcnt vmcnt(2)
    v_mfma_f32_32x32x16_bf16 v[192:207], v[216:219], v[148:151], v[192:207]
    v_max3_u32 v29, v29, v148, v149
    v_max3_u32 v29, v29, v150, v151
    s_waitcnt vmcnt(1)
    v_mfma_f32_32x32x16_bf16 v[192:207], v[216:219], v[152:155], v[192:207]
    v_max3_u32 v29, v29, v152, v153
    v_max3_u32 v29, v29, v154, v155
    s_waitcnt vmcnt(0)
    v_mfma_f32_32x32x16_bf16 v[192:207], v[216:219], v[156:159], v[192:207]
    v_max3_u32 v29, v29, v156, v157
    v_max3_u32 v29, v29, v158, v159
    v_cmp_eq_u32 vcc, -1, v29
    s_cbranch_vccnz L_h_rf
    s_nop 7
    v_fmac_f32 v192, v224, v15
    v_fmac_f32 v193, v225, v15
    v_fmac_f32 v194, v226, v15
    v_fmac_f32 v195, v227, v15
    v_fmac_f32 v196, v228, v15
    v_fmac_f32 v197, v229, v15
    v_fmac_f32 v198, v230, v15
    v_fmac_f32 v199, v231, v15
    buffer_store_dwordx4 v[192:195], v28, s[28:31], s47 offen
    buffer_store_dwordx4 v[196:199], v28, s[28:31], s47 offen offset:16
    v_accvgpr_read_b32 v15, a216
    s_xor_b32 s42, s42, 4
    s_add_u32 s44, s44, 1
    s_cmp_eq_u32 s44, 3
    s_cbranch_scc1 L_h_red
L_h_done:
    s_cmp_ge_u32 s34, 2
    s_cbranch_scc1 L_h_mini
    s_add_u32 s34, s34, 6
    s_waitcnt vmcnt(0)
    s_branch L_h_again
L_h_mini:
    s_sub_u32 s47, s34, 2
    s_cmp_ge_u32 s47, 4
    s_cbranch_scc1 L_end
    s_add_u32 s42, s34, 58
    s_add_u32 s34, s34, 6
    s_mov_b32 s43, 0
    s_lshl_b32 s45, s33, 8
    v_add_u32 v20, s45, v20
    v_add_u32 v21, s45, v21
    v_add_u32 v22, s45, v22
    v_add_u32 v23, s45, v23
    v_add_u32 v24, s45, v24
    v_add_u32 v25, s45, v25
    v_add_u32 v26, s45, v26
    v_add_u32 v27, s45, v27
    ds_read_b64_tr_b16 a[0:1], v20 offset:0
    ds_read_b64_tr_b16 a[2:3], v20 offset:4096
    ds_read_b64_tr_b16 a[4:5], v20 offset:8192
    ds_read_b64_tr_b16 a[6:7], v20 offset:12288
    ds_read_b64_tr_b16 a[8:9], v20 offset:32768
    ds_read_b64_tr_b16 a[10:11], v20 offset:36864
    ds_read_b64_tr_b16 a[12:13], v20 offset:40960
    ds_read_b64_tr_b16 a[14:15], v20 offset:45056
    ds_read_b64_tr_b16 a[16:17], v24 offset:0
    ds_read_b64_tr_b16 a[18:19], v24 offset:4096
    ds_read_b64_tr_b16 a[20:21], v24 offset:8192
    ds_read_b64_tr_b16 a[22:23], v24 offset:12288
    ds_read_b64_tr_b16 a[24:25], v24 offset:32768
    ds_read_b64_tr_b16 a[26:27], v24 offset:36864
    ds_read_b64_tr_b16 a[28:29], v24 offset:40960
    ds_read_b64_tr_b16 a[30:31], v24 offset:45056
    ds_read_b64_tr_b16 a[32:33], v21 offset:0
    ds_read_b64_tr_b16 a[34:35], v21 offset:4096
    ds_read_b64_tr_b16 a[36:37], v21 offset:8192
    ds_read_b64_tr_b16 a[38:39], v21 offset:12288
    ds_read_b64_tr_b16 a[40:41], v21 offset:32768
    ds_read_b64_tr_b16 a[42:43], v21 offset:36864
    ds_read_b64_tr_b16 a[44:45], v21 offset:40960
    ds_read_b64_tr_b16 a[46:47], v21 offset:45056
    ds_read_b64_tr_b16 a[48:49], v25 offset:0
    ds_read_b64_tr_b16 a[50:51], v25 offset:4096
    ds_read_b64_tr_b16 a[52:53], v25 offset:8192
    ds_read_b64_tr_b16 a[54:55], v25 offset:12288
    ds_read_b64_tr_b16 a[56:57], v25 offset:32768
    ds_read_b64_tr_b16 a[58:59], v25 offset:36864
    ds_read_b64_tr_b16 a[60:61], v25 offset:40960
    ds_read_b64_tr_b16 a[62:63], v25 offset:45056
    ds_read_b64_tr_b16 a[64:65], v22 offset:0
    ds_read_b64_tr_b16 a[66:67], v22 offset:4096
    ds_read_b64_tr_b16 a[68:69], v22 offset:8192
    ds_read_b64_tr_b16 a[70:71], v22 offset:12288
    ds_read_b64_tr_b16 a[72:73], v22 offset:32768
    ds_read_b64_tr_b16 a[74:75], v22 offset:36864
    ds_read_b64_tr_b16 a[76:77], v22 offset:40960
    ds_read_b64_tr_b16 a[78:79], v22 offset:45056
    ds_read_b64_tr_b16 a[80:81], v26 offset:0
    ds_read_b64_tr_b16 a[82:83], v26 offset:4096
    ds_read_b64_tr_b16 a[84:85], v26 offset:8192
    ds_read_b64_tr_b16 a[86:87], v26 offset:12288
    ds_read_b64_tr_b16 a[88:89], v26 offset:32768
    ds_read_b64_tr_b16 a[90:91], v26 offset:36864
    ds_read_b64_tr_b16 a[92:93], v26 offset:40960
    ds_read_b64_tr_b16 a[94:95], v26 offset:45056
    ds_read_b64_tr_b16 a[96:97], v23 offset:0
    ds_read_b64_tr_b16 a[98:99], v23 offset:4096
    ds_read_b64_tr_b16 a[100:101], v23 offset:8192
    ds_read_b64_tr_b16 a[102:103], v23 offset:12288
    ds_read_b64_tr_b16 a[104:105], v23 offset:32768
    ds_read_b64_tr_b16 a[106:107], v23 offset:36864
    ds_read_b64_tr_b16 a[108:109], v23 offset:40960
    ds_read_b64_tr_b16 a[110:111], v23 offset:45056
    ds_read_b64_tr_b16 a[112:113], v27 offset:0
    ds_read_b64_tr_b16 a[114:115], v27 offset:4096
    ds_read_b64_tr_b16 a[116:117], v27 offset:8192
    ds_read_b64_tr_b16 a[118:119], v27 offset:12288
    ds_read_b64_tr_b16 a[120:121], v27 offset:32768
    ds_read_b64_tr_b16 a[122:123], v27 offset:36864
    ds_read_b64_tr_b16 a[124:125], v27 offset:40960
    ds_read_b64_tr_b16 a[126:127], v27 offset:45056
    s_waitcnt lgkmcnt(0)
    s_lshl_b32 s46, s32, 5
    v_lshlrev_b32 v30, 4, v17
    v_lshl_add_u32 v31, v16, 10, v30
    v_add_u32 v30, s46, v30
    global_load_dwordx4 v[244:247], v30, s[66:67]
    v_lshlrev_b32 v28, 1, v31
    v_bfe_u32 v32, v0, 2, 1
    v_bfe_u32 v33, v0, 3, 2
    v_and_b32 v34, 3, v0
    v_lshl_add_u32 v33, v33, 2, v34
    v_cmp_eq_u32 vcc, v32, v17
    v_mov_b32 v35, 64
    s_mov_b32 s46, 0x3f80
    v_cndmask_b32 v33, v35, v33, vcc
    v_and_b32 v34, 1, v33
    v_lshlrev_b32 v34, 4, v34
    v_lshlrev_b32 v34, v34, s46
    v_lshrrev_b32 v33, 1, v33
    v_cmp_eq_u32 vcc, 0, v33
    s_nop 1
    v_cndmask_b32 v20, 0, v34, vcc
    v_cmp_eq_u32 vcc, 1, v33
    s_nop 1
    v_cndmask_b32 v21, 0, v34, vcc
    v_cmp_eq_u32 vcc, 2, v33
    s_nop 1
    v_cndmask_b32 v22, 0, v34, vcc
    v_cmp_eq_u32 vcc, 3, v33
    s_nop 1
    v_cndmask_b32 v23, 0, v34, vcc
    s_lshl_b32 s49, s42, 15
    s_lshl_b32 s46, s32, 5
    s_add_u32 s49, s49, s46
    buffer_load_dwordx4 v[240:243], v31, s[8:11], s49 offen
    s_lshl_b32 s49, s49, 1
    s_lshl_b32 s45, s33, 4
    v_add_u32 v14, s45, v28
    s_cmp_lg_u32 s33, 0
    s_cbranch_scc1 L_m_st
L_m_w0:
    buffer_load_dword v29, off, s[24:27], 0 offset:136 sc1
    s_waitcnt vmcnt(0)
    v_cmp_eq_u32 vcc, 0, v29
    s_cbranch_vccz L_m_st
    s_add_u32 s43, s43, 1
    s_cmp_gt_u32 s43, 1000000
    s_cbranch_scc1 L_end
    s_sleep 16
    s_branch L_m_w0
L_m_st:
    s_waitcnt vmcnt(0)
    s_barrier
    s_lshl_b32 s46, s47, 5
    s_add_u32 s46, s46, s32
    s_mul_i32 s46, s46, 23552
    s_add_u32 s46, s46, 54525952
    buffer_load_dwordx4 a[128:131], v1, s[4:7], s46 offen offset:0 sc1
    buffer_load_dwordx4 a[132:135], v1, s[4:7], s46 offen offset:1024 sc1
    buffer_load_dwordx4 a[136:139], v1, s[4:7], s46 offen offset:2048 sc1
    buffer_load_dwordx4 a[140:143], v1, s[4:7], s46 offen offset:3072 sc1
    s_add_u32 s46, s46, 4096
    buffer_load_dwordx4 a[144:147], v1, s[4:7], s46 offen offset:0 sc1
    buffer_load_dwordx4 a[148:151], v1, s[4:7], s46 offen offset:1024 sc1
    buffer_load_dwordx4 a[152:155], v1, s[4:7], s46 offen offset:2048 sc1
    buffer_load_dwordx4 a[156:159], v1, s[4:7], s46 offen offset:3072 sc1
    s_add_u32 s46, s46, 4096
    buffer_load_dwordx4 a[160:163], v1, s[4:7], s46 offen offset:0 sc1
    buffer_load_dwordx4 a[164:167], v1, s[4:7], s46 offen offset:1024 sc1
    buffer_load_dwordx4 a[168:171], v1, s[4:7], s46 offen offset:2048 sc1
    buffer_load_dwordx4 a[172:175], v1, s[4:7], s46 offen offset:3072 sc1
    s_add_u32 s46, s46, 4096
    buffer_load_dwordx4 a[176:179], v1, s[4:7], s46 offen offset:0 sc1
    buffer_load_dwordx4 a[180:183], v1, s[4:7], s46 offen offset:1024 sc1
    buffer_load_dwordx4 a[184:187], v1, s[4:7], s46 offen offset:2048 sc1
    buffer_load_dwordx4 a[188:191], v1, s[4:7], s46 offen offset:3072 sc1
    s_add_u32 s46, s46, 4096
    buffer_load_dwordx4 v[224:227], v1, s[4:7], s46 offen offset:0 sc1
    buffer_load_dwordx4 v[228:231], v1, s[4:7], s46 offen offset:1024 sc1
    buffer_load_dwordx4 v[232:235], v1, s[4:7], s46 offen offset:2048 sc1
    buffer_load_dwordx4 v[236:239], v1, s[4:7], s46 offen offset:3072 sc1
    s_add_u32 s46, s46, 4096
    buffer_load_dwordx4 a[192:195], v1, s[4:7], s46 offen offset:0 sc1
    buffer_load_dwordx4 a[196:199], v1, s[4:7], s46 offen offset:1024 sc1
    buffer_load_dwordx4 v[248:251], v1, s[4:7], s46 offen offset:2048 sc1
    v_lshlrev_b32 v32, 16, v240
    v_and_b32 v33, 0xffff0000, v240
    v_lshlrev_b32 v34, 16, v241
    v_and_b32 v35, 0xffff0000, v241
    v_lshlrev_b32 v36, 16, v242
    v_and_b32 v37, 0xffff0000, v242
    v_lshlrev_b32 v38, 16, v243
    v_and_b32 v39, 0xffff0000, v243
    v_lshlrev_b32 v40, 16, v244
    v_and_b32 v41, 0xffff0000, v244
    v_lshlrev_b32 v42, 16, v245
    v_and_b32 v43, 0xffff0000, v245
    v_lshlrev_b32 v44, 16, v246
    v_and_b32 v45, 0xffff0000, v246
    v_lshlrev_b32 v46, 16, v247
    v_and_b32 v47, 0xffff0000, v247
    v_mul_f32 v32, v32, v40
    v_mul_f32 v33, v33, v41
    v_mul_f32 v34, v34, v42
    v_mul_f32 v35, v35, v43
    v_mul_f32 v36, v36, v44
    v_mul_f32 v37, v37, v45
    v_mul_f32 v38, v38, v46
    v_mul_f32 v39, v39, v47
    s_bitcmp1_b32 s33, 0
    s_cselect_b64 vcc, -1, 0
    s_mov_b32 s48, 0x3e0293ee
    s_waitcnt vmcnt(0)
    v_mov_b32 v15, v248
    v_cndmask_b32 v24, v32, v36, vcc
    v_cndmask_b32 v25, v33, v37, vcc
    v_cndmask_b32 v26, v34, v38, vcc
    v_cndmask_b32 v27, v35, v39, vcc
    v_mul_f32 v24, v24, v15
    v_mul_f32 v25, v25, v15
    v_mul_f32 v26, v26, v15
    v_mul_f32 v27, v27, v15
    v_max3_f32 v28, v224, v225, v226
    v_max3_f32 v28, v28, v227, v228
    v_max3_f32 v28, v28, v229, v230
    v_max3_f32 v28, v28, v231, v232
    v_max3_f32 v28, v28, v233, v234
    v_max3_f32 v28, v28, v235, v236
    v_max3_f32 v28, v28, v237, v238
    v_max_f32 v28, v28, v239
    v_mov_b32 v30, v28
    s_nop 1
    v_permlane32_swap_b32 v28, v30
    v_max_f32 v28, v28, v30
    v_mul_f32 v29, s48, v28
    v_fma_f32 v224, v224, s48, -v29
    v_fma_f32 v225, v225, s48, -v29
    v_fma_f32 v226, v226, s48, -v29
    v_fma_f32 v227, v227, s48, -v29
    v_fma_f32 v228, v228, s48, -v29
    v_fma_f32 v229, v229, s48, -v29
    v_fma_f32 v230, v230, s48, -v29
    v_fma_f32 v231, v231, s48, -v29
    v_fma_f32 v232, v232, s48, -v29
    v_fma_f32 v233, v233, s48, -v29
    v_fma_f32 v234, v234, s48, -v29
    v_fma_f32 v235, v235, s48, -v29
    v_fma_f32 v236, v236, s48, -v29
    v_fma_f32 v237, v237, s48, -v29
    v_fma_f32 v238, v238, s48, -v29
    v_fma_f32 v239, v239, s48, -v29
    v_exp_f32 v224, v224
    v_exp_f32 v225, v225
    v_exp_f32 v226, v226
    v_exp_f32 v227, v227
    v_exp_f32 v228, v228
    v_exp_f32 v229, v229
    v_exp_f32 v230, v230
    v_exp_f32 v231, v231
    v_exp_f32 v232, v232
    v_exp_f32 v233, v233
    v_exp_f32 v234, v234
    v_exp_f32 v235, v235
    v_exp_f32 v236, v236
    v_exp_f32 v237, v237
    v_exp_f32 v238, v238
    v_exp_f32 v239, v239
    v_cvt_pk_bf16_f32 v248, v224, v225
    v_cvt_pk_bf16_f32 v249, v226, v227
    v_cvt_pk_bf16_f32 v250, v228, v229
    v_cvt_pk_bf16_f32 v251, v230, v231
    v_cvt_pk_bf16_f32 v252, v232, v233
    v_cvt_pk_bf16_f32 v253, v234, v235
    v_cvt_pk_bf16_f32 v254, v236, v237
    v_cvt_pk_bf16_f32 v255, v238, v239
    v_add_f32 v5, v224, v225
    v_add_f32 v5, v5, v226
    v_add_f32 v5, v5, v227
    v_add_f32 v5, v5, v228
    v_add_f32 v5, v5, v229
    v_add_f32 v5, v5, v230
    v_add_f32 v5, v5, v231
    v_add_f32 v5, v5, v232
    v_add_f32 v5, v5, v233
    v_add_f32 v5, v5, v234
    v_add_f32 v5, v5, v235
    v_add_f32 v5, v5, v236
    v_add_f32 v5, v5, v237
    v_add_f32 v5, v5, v238
    v_add_f32 v5, v5, v239
    v_mfma_f32_32x32x16_bf16 v[32:47], a[160:163], v[248:251], 0
    v_mfma_f32_32x32x16_bf16 v[32:47], a[164:167], v[252:255], v[32:47]
    v_mfma_f32_32x32x16_bf16 v[48:63], a[168:171], v[248:251], 0
    v_mfma_f32_32x32x16_bf16 v[48:63], a[172:175], v[252:255], v[48:63]
    v_mfma_f32_32x32x16_bf16 v[64:79], a[176:179], v[248:251], 0
    v_mfma_f32_32x32x16_bf16 v[64:79], a[180:183], v[252:255], v[64:79]
    v_mfma_f32_32x32x16_bf16 v[80:95], a[184:187], v[248:251], 0
    v_mfma_f32_32x32x16_bf16 v[80:95], a[188:191], v[252:255], v[80:95]
    s_nop 12
    v_cvt_pk_bf16_f32 v96, v32, v33
    v_cvt_pk_bf16_f32 v97, v34, v35
    v_cvt_pk_bf16_f32 v98, v36, v37
    v_cvt_pk_bf16_f32 v99, v38, v39
    v_cvt_pk_bf16_f32 v100, v40, v41
    v_cvt_pk_bf16_f32 v101, v42, v43
    v_cvt_pk_bf16_f32 v102, v44, v45
    v_cvt_pk_bf16_f32 v103, v46, v47
    v_cvt_pk_bf16_f32 v104, v48, v49
    v_cvt_pk_bf16_f32 v105, v50, v51
    v_cvt_pk_bf16_f32 v106, v52, v53
    v_cvt_pk_bf16_f32 v107, v54, v55
    v_cvt_pk_bf16_f32 v108, v56, v57
    v_cvt_pk_bf16_f32 v109, v58, v59
    v_cvt_pk_bf16_f32 v110, v60, v61
    v_cvt_pk_bf16_f32 v111, v62, v63
    v_cvt_pk_bf16_f32 v112, v64, v65
    v_cvt_pk_bf16_f32 v113, v66, v67
    v_cvt_pk_bf16_f32 v114, v68, v69
    v_cvt_pk_bf16_f32 v115, v70, v71
    v_cvt_pk_bf16_f32 v116, v72, v73
    v_cvt_pk_bf16_f32 v117, v74, v75
    v_cvt_pk_bf16_f32 v118, v76, v77
    v_cvt_pk_bf16_f32 v119, v78, v79
    v_cvt_pk_bf16_f32 v120, v80, v81
    v_cvt_pk_bf16_f32 v121, v82, v83
    v_cvt_pk_bf16_f32 v122, v84, v85
    v_cvt_pk_bf16_f32 v123, v86, v87
    v_cvt_pk_bf16_f32 v124, v88, v89
    v_cvt_pk_bf16_f32 v125, v90, v91
    v_cvt_pk_bf16_f32 v126, v92, v93
    v_cvt_pk_bf16_f32 v127, v94, v95
    s_nop 1
    v_mfma_f32_32x32x16_bf16 v[160:175], a[0:3], v[96:99], 0
    v_mfma_f32_32x32x16_bf16 v[160:175], a[4:7], v[100:103], v[160:175]
    v_mfma_f32_32x32x16_bf16 v[160:175], a[8:11], v[104:107], v[160:175]
    v_mfma_f32_32x32x16_bf16 v[160:175], a[12:15], v[108:111], v[160:175]
    v_mfma_f32_32x32x16_bf16 v[160:175], a[16:19], v[112:115], v[160:175]
    v_mfma_f32_32x32x16_bf16 v[160:175], a[20:23], v[116:119], v[160:175]
    v_mfma_f32_32x32x16_bf16 v[160:175], a[24:27], v[120:123], v[160:175]
    v_mfma_f32_32x32x16_bf16 v[160:175], a[28:31], v[124:127], v[160:175]
    v_mfma_f32_32x32x16_bf16 v[176:191], a[32:35], v[96:99], 0
    v_mfma_f32_32x32x16_bf16 v[176:191], a[36:39], v[100:103], v[176:191]
    v_mfma_f32_32x32x16_bf16 v[176:191], a[40:43], v[104:107], v[176:191]
    v_mfma_f32_32x32x16_bf16 v[176:191], a[44:47], v[108:111], v[176:191]
    v_mfma_f32_32x32x16_bf16 v[176:191], a[48:51], v[112:115], v[176:191]
    v_mfma_f32_32x32x16_bf16 v[176:191], a[52:55], v[116:119], v[176:191]
    v_mfma_f32_32x32x16_bf16 v[176:191], a[56:59], v[120:123], v[176:191]
    v_mfma_f32_32x32x16_bf16 v[176:191], a[60:63], v[124:127], v[176:191]
    v_mfma_f32_32x32x16_bf16 v[192:207], a[64:67], v[96:99], 0
    v_mfma_f32_32x32x16_bf16 v[192:207], a[68:71], v[100:103], v[192:207]
    v_mfma_f32_32x32x16_bf16 v[192:207], a[72:75], v[104:107], v[192:207]
    v_mfma_f32_32x32x16_bf16 v[192:207], a[76:79], v[108:111], v[192:207]
    v_mfma_f32_32x32x16_bf16 v[192:207], a[80:83], v[112:115], v[192:207]
    v_mfma_f32_32x32x16_bf16 v[192:207], a[84:87], v[116:119], v[192:207]
    v_mfma_f32_32x32x16_bf16 v[192:207], a[88:91], v[120:123], v[192:207]
    v_mfma_f32_32x32x16_bf16 v[192:207], a[92:95], v[124:127], v[192:207]
    v_mfma_f32_32x32x16_bf16 v[208:223], a[96:99], v[96:99], 0
    v_mfma_f32_32x32x16_bf16 v[208:223], a[100:103], v[100:103], v[208:223]
    v_mfma_f32_32x32x16_bf16 v[208:223], a[104:107], v[104:107], v[208:223]
    v_mfma_f32_32x32x16_bf16 v[208:223], a[108:111], v[108:111], v[208:223]
    v_mfma_f32_32x32x16_bf16 v[208:223], a[112:115], v[112:115], v[208:223]
    v_mfma_f32_32x32x16_bf16 v[208:223], a[116:119], v[116:119], v[208:223]
    v_mfma_f32_32x32x16_bf16 v[208:223], a[120:123], v[120:123], v[208:223]
    v_mfma_f32_32x32x16_bf16 v[208:223], a[124:127], v[124:127], v[208:223]
    s_nop 7
    v_mfma_f32_32x32x16_bf16 v[96:111], a[220:223], a[192:195], 0
    v_mfma_f32_32x32x16_bf16 v[96:111], a[224:227], a[196:199], v[96:111]
    v_mfma_f32_32x32x16_bf16 v[112:127], a[228:231], a[192:195], 0
    v_mfma_f32_32x32x16_bf16 v[112:127], a[232:235], a[196:199], v[112:127]
    v_mfma_f32_32x32x16_bf16 v[128:143], a[236:239], a[192:195], 0
    v_mfma_f32_32x32x16_bf16 v[128:143], a[240:243], a[196:199], v[128:143]
    v_mfma_f32_32x32x16_bf16 v[144:159], a[244:247], a[192:195], 0
    v_mfma_f32_32x32x16_bf16 v[144:159], a[248:251], a[196:199], v[144:159]
    s_lshl_b32 s45, s42, 17
    s_lshl_b32 s46, s32, 12
    s_add_u32 s45, s45, s46
    s_add_u32 s45, s45, 35717120
    s_cmp_ge_u32 s42, 63
    s_cselect_b32 s46, 131072, 0
    s_sub_u32 s46, s45, s46
    s_lshl_b32 s47, s33, 10
    s_add_u32 s45, s45, s47
    s_add_u32 s47, s47, 137216
    v_add_u32 v6, s47, v1
    s_lshl_b32 s47, s33, 12
    v_subrev_u32 v18, s47, v18
    v_subrev_u32 v19, s47, v19
    v_add_u32 v31, 2048, v18
    v_sub_f32 v15, 1.0, v15
    s_lshl_b32 s36, s42, 20
    s_add_u32 s36, s36, 67108864
    s_lshl_b32 s47, s32, 15
    s_add_u32 s37, s36, s47
    s_lshl_b32 s47, s33, 13
    s_add_u32 s37, s37, s47
    s_add_u32 s40, s37, 4096
    s_lshl_b32 s47, s32, 10
    s_add_u32 s36, s36, s47
    s_lshl_b32 s47, s33, 18
    s_add_u32 s36, s36, s47
    v_mov_b64 v[66:67], 0
    v_mov_b64 v[70:71], 0
    v_mov_b64 v[74:75], 0
    v_mov_b64 v[78:79], 0
    v_mov_b64 v[242:243], 0
    s_getpc_b64 s[60:61]
L_m_pc:
    v_lshlrev_b32 v29, 3, v1
    v_min_u32 v29, L_m_fin-L_m_pc, v29
    global_load_dword v29, v29, s[60:61]
L_m_pr:
    buffer_load_dword v29, off, s[4:7], s46 offset:3072 sc1
    s_waitcnt vmcnt(0)
    v_cmp_eq_u32 vcc, -1, v29
    s_cbranch_vccz L_m_ld
    s_add_u32 s43, s43, 1
    s_cmp_gt_u32 s43, 1000000
    s_cbranch_scc1 L_end
    s_sleep 2
    s_branch L_m_pr
L_m_pf:
    s_add_u32 s43, s43, 1
    s_cmp_gt_u32 s43, 1000000
    s_cbranch_scc1 L_end
L_m_ld:
    buffer_load_dwordx4 v[244:247], v1, s[4:7], s45 offen sc1
    s_waitcnt vmcnt(0)
    ds_write_b128 v6, v[244:247]
    v_max3_u32 v29, v244, v245, v246
    v_max_u32 v29, v29, v247
    v_cmp_eq_u32 vcc, -1, v29
    s_cbranch_vccnz L_m_pf
    s_waitcnt lgkmcnt(0)
    s_barrier
    ds_read2_b64 v[32:35], v18 offset0:0 offset1:16
    ds_read2_b64 v[36:39], v18 offset0:32 offset1:48
    ds_read2_b64 v[40:43], v18 offset0:128 offset1:144
    ds_read2_b64 v[44:47], v18 offset0:160 offset1:176
    ds_read2_b64 v[48:51], v31 offset0:0 offset1:16
    ds_read2_b64 v[52:55], v31 offset0:32 offset1:48
    ds_read2_b64 v[56:59], v31 offset0:128 offset1:144
    ds_read2_b64 v[60:63], v31 offset0:160 offset1:176
    ds_read2st64_b32 v[64:65], v19 offset0:0 offset1:2
    ds_read2st64_b32 v[68:69], v19 offset0:4 offset1:6
    ds_read2st64_b32 v[72:73], v19 offset0:8 offset1:10
    ds_read2st64_b32 v[76:77], v19 offset0:12 offset1:14
    s_waitcnt lgkmcnt(11)
    v_mfma_f32_32x32x16_bf16 v[80:95], v[32:35], a[128:131], 0
    s_waitcnt lgkmcnt(10)
    v_mfma_f32_32x32x16_bf16 v[80:95], v[36:39], a[132:135], v[80:95]
    s_waitcnt lgkmcnt(9)
    v_mfma_f32_32x32x16_bf16 v[80:95], v[40:43], a[136:139], v[80:95]
    s_waitcnt lgkmcnt(8)
    v_mfma_f32_32x32x16_bf16 v[80:95], v[44:47], a[140:143], v[80:95]
    s_waitcnt lgkmcnt(7)
    v_mfma_f32_32x32x16_bf16 v[80:95], v[48:51], a[144:147], v[80:95]
    s_waitcnt lgkmcnt(6)
    v_mfma_f32_32x32x16_bf16 v[80:95], v[52:55], a[148:151], v[80:95]
    s_waitcnt lgkmcnt(5)
    v_mfma_f32_32x32x16_bf16 v[80:95], v[56:59], a[152:155], v[80:95]
    s_waitcnt lgkmcnt(4)
    v_mfma_f32_32x32x16_bf16 v[80:95], v[60:63], a[156:159], v[80:95]
    s_waitcnt lgkmcnt(0)
    s_nop 11
    v_max3_f32 v29, v28, v80, v81
    v_max3_f32 v29, v29, v82, v83
    v_mov_b32 v30, v29
    s_nop 1
    v_permlane32_swap_b32 v29, v30
    v_max_f32 v29, v29, v30
    v_mul_f32 v29, s48, v29
    v_fma_f32 v80, v80, s48, -v29
    v_fma_f32 v81, v81, s48, -v29
    v_fma_f32 v82, v82, s48, -v29
    v_fma_f32 v83, v83, s48, -v29
    v_fma_f32 v28, v28, s48, -v29
    v_exp_f32 v80, v80
    v_exp_f32 v81, v81
    v_exp_f32 v82, v82
    v_exp_f32 v83, v83
    v_exp_f32 v28, v28
    v_add_f32 v29, v80, v81
    v_add_f32 v30, v82, v83
    v_fmac_f32 v29, v5, v28
    v_add_f32 v29, v29, v30
    v_mov_b32 v30, v29
    s_nop 1
    v_permlane32_swap_b32 v29, v30
    v_add_f32 v29, v29, v30
    v_rcp_f32 v29, v29
    s_nop 0
    v_mul_f32 v29, v29, v15
    v_mul_f32 v80, v80, v29
    v_mul_f32 v81, v81, v29
    v_mul_f32 v82, v82, v29
    v_mul_f32 v83, v83, v29
    v_cvt_pk_bf16_f32 v240, v80, v81
    v_cvt_pk_bf16_f32 v241, v82, v83
    v_mul_f32 v28, v28, v29
    v_fmac_f32 v96, v160, v28
    v_mfma_f32_32x32x16_bf16 v[32:47], v[64:67], v[240:243], 0
    v_fmac_f32 v97, v161, v28
    v_fmac_f32 v98, v162, v28
    v_fmac_f32 v99, v163, v28
    v_fmac_f32 v100, v164, v28
    v_fmac_f32 v101, v165, v28
    v_fmac_f32 v102, v166, v28
    v_mfma_f32_32x32x16_bf16 v[48:63], v[68:71], v[240:243], 0
    v_fmac_f32 v103, v167, v28
    v_fmac_f32 v104, v168, v28
    v_fmac_f32 v105, v169, v28
    v_fmac_f32 v106, v170, v28
    v_fmac_f32 v107, v171, v28
    v_fmac_f32 v108, v172, v28
    v_mfma_f32_32x32x16_bf16 v[80:95], v[72:75], v[240:243], 0
    v_fmac_f32 v109, v173, v28
    v_fmac_f32 v110, v174, v28
    v_fmac_f32 v111, v175, v28
    v_fmac_f32 v112, v176, v28
    v_fmac_f32 v113, v177, v28
    v_fmac_f32 v114, v178, v28
    v_mfma_f32_32x32x16_bf16 v[224:239], v[76:79], v[240:243], 0
    v_fmac_f32 v115, v179, v28
    v_fmac_f32 v116, v180, v28
    v_fmac_f32 v117, v181, v28
    v_fmac_f32 v118, v182, v28
    v_fmac_f32 v119, v183, v28
    v_fmac_f32 v120, v184, v28
    v_fmac_f32 v121, v185, v28
    v_fmac_f32 v122, v186, v28
    v_fmac_f32 v123, v187, v28
    v_fmac_f32 v124, v188, v28
    v_fmac_f32 v125, v189, v28
    v_fmac_f32 v126, v190, v28
    v_fmac_f32 v127, v191, v28
    v_cvt_pk_bf16_f32 v160, v32, v33
    v_cvt_pk_bf16_f32 v161, v34, v35
    v_cvt_pk_bf16_f32 v162, v36, v37
    v_cvt_pk_bf16_f32 v163, v38, v39
    v_cvt_pk_bf16_f32 v164, v40, v41
    v_cvt_pk_bf16_f32 v165, v42, v43
    v_cvt_pk_bf16_f32 v166, v44, v45
    v_cvt_pk_bf16_f32 v167, v46, v47
    v_cvt_pk_bf16_f32 v168, v48, v49
    v_cvt_pk_bf16_f32 v169, v50, v51
    v_mfma_f32_32x32x16_bf16 v[96:111], a[0:3], v[160:163], v[96:111]
    v_cvt_pk_bf16_f32 v170, v52, v53
    v_cvt_pk_bf16_f32 v171, v54, v55
    v_cvt_pk_bf16_f32 v172, v56, v57
    v_cvt_pk_bf16_f32 v173, v58, v59
    v_cvt_pk_bf16_f32 v174, v60, v61
    v_cvt_pk_bf16_f32 v175, v62, v63
    v_mfma_f32_32x32x16_bf16 v[112:127], a[32:35], v[160:163], v[112:127]
    v_cvt_pk_bf16_f32 v176, v80, v81
    v_cvt_pk_bf16_f32 v177, v82, v83
    v_cvt_pk_bf16_f32 v178, v84, v85
    v_cvt_pk_bf16_f32 v179, v86, v87
    v_cvt_pk_bf16_f32 v180, v88, v89
    v_cvt_pk_bf16_f32 v181, v90, v91
    v_mfma_f32_32x32x16_bf16 v[96:111], a[4:7], v[164:167], v[96:111]
    v_cvt_pk_bf16_f32 v182, v92, v93
    v_cvt_pk_bf16_f32 v183, v94, v95
    v_cvt_pk_bf16_f32 v184, v224, v225
    v_cvt_pk_bf16_f32 v185, v226, v227
    v_cvt_pk_bf16_f32 v186, v228, v229
    v_cvt_pk_bf16_f32 v187, v230, v231
    v_mfma_f32_32x32x16_bf16 v[112:127], a[36:39], v[164:167], v[112:127]
    v_cvt_pk_bf16_f32 v188, v232, v233
    v_cvt_pk_bf16_f32 v189, v234, v235
    v_cvt_pk_bf16_f32 v190, v236, v237
    v_cvt_pk_bf16_f32 v191, v238, v239
    v_fmac_f32 v128, v192, v28
    v_fmac_f32 v129, v193, v28
    v_mfma_f32_32x32x16_bf16 v[96:111], a[8:11], v[168:171], v[96:111]
    v_fmac_f32 v130, v194, v28
    v_fmac_f32 v131, v195, v28
    v_fmac_f32 v132, v196, v28
    v_fmac_f32 v133, v197, v28
    v_fmac_f32 v134, v198, v28
    v_fmac_f32 v135, v199, v28
    v_mfma_f32_32x32x16_bf16 v[112:127], a[40:43], v[168:171], v[112:127]
    v_fmac_f32 v136, v200, v28
    v_fmac_f32 v137, v201, v28
    v_fmac_f32 v138, v202, v28
    v_fmac_f32 v139, v203, v28
    v_fmac_f32 v140, v204, v28
    v_fmac_f32 v141, v205, v28
    v_mfma_f32_32x32x16_bf16 v[96:111], a[12:15], v[172:175], v[96:111]
    v_fmac_f32 v142, v206, v28
    v_fmac_f32 v143, v207, v28
    v_fmac_f32 v144, v208, v28
    v_fmac_f32 v145, v209, v28
    v_fmac_f32 v146, v210, v28
    v_fmac_f32 v147, v211, v28
    v_mfma_f32_32x32x16_bf16 v[112:127], a[44:47], v[172:175], v[112:127]
    v_fmac_f32 v148, v212, v28
    v_fmac_f32 v149, v213, v28
    v_fmac_f32 v150, v214, v28
    v_fmac_f32 v151, v215, v28
    v_fmac_f32 v152, v216, v28
    v_fmac_f32 v153, v217, v28
    v_mfma_f32_32x32x16_bf16 v[96:111], a[16:19], v[176:179], v[96:111]
    v_fmac_f32 v154, v218, v28
    v_fmac_f32 v155, v219, v28
    v_fmac_f32 v156, v220, v28
    v_fmac_f32 v157, v221, v28
    v_fmac_f32 v158, v222, v28
    v_fmac_f32 v159, v223, v28
    v_mfma_f32_32x32x16_bf16 v[112:127], a[48:51], v[176:179], v[112:127]
    v_mfma_f32_32x32x16_bf16 v[96:111], a[20:23], v[180:183], v[96:111]
    v_mfma_f32_32x32x16_bf16 v[112:127], a[52:55], v[180:183], v[112:127]
    v_mfma_f32_32x32x16_bf16 v[96:111], a[24:27], v[184:187], v[96:111]
    v_mfma_f32_32x32x16_bf16 v[112:127], a[56:59], v[184:187], v[112:127]
    v_mfma_f32_32x32x16_bf16 v[96:111], a[28:31], v[188:191], v[96:111]
    v_mfma_f32_32x32x16_bf16 v[112:127], a[60:63], v[188:191], v[112:127]
    v_mfma_f32_32x32x16_bf16 v[128:143], a[64:67], v[160:163], v[128:143]
    v_mfma_f32_32x32x16_bf16 v[128:143], a[68:71], v[164:167], v[128:143]
    v_cvt_pk_bf16_f32 v32, v96, v97
    v_min_u32 v32, -2, v32
    v_cvt_pk_bf16_f32 v33, v98, v99
    v_min_u32 v33, -2, v33
    v_cvt_pk_bf16_f32 v34, v100, v101
    v_min_u32 v34, -2, v34
    v_mfma_f32_32x32x16_bf16 v[128:143], a[72:75], v[168:171], v[128:143]
    v_cvt_pk_bf16_f32 v35, v102, v103
    v_min_u32 v35, -2, v35
    v_cvt_pk_bf16_f32 v36, v104, v105
    v_min_u32 v36, -2, v36
    v_cvt_pk_bf16_f32 v37, v106, v107
    v_min_u32 v37, -2, v37
    v_mfma_f32_32x32x16_bf16 v[128:143], a[76:79], v[172:175], v[128:143]
    v_cvt_pk_bf16_f32 v38, v108, v109
    v_min_u32 v38, -2, v38
    v_cvt_pk_bf16_f32 v39, v110, v111
    v_min_u32 v39, -2, v39
    buffer_store_dwordx4 v[32:35], v1, s[4:7], s36 offen sc1
    s_add_u32 s36, s36, 32768
    v_mfma_f32_32x32x16_bf16 v[128:143], a[80:83], v[176:179], v[128:143]
    buffer_store_dwordx4 v[36:39], v1, s[4:7], s36 offen sc1
    s_add_u32 s36, s36, 32768
    v_cvt_pk_bf16_f32 v40, v112, v113
    v_min_u32 v40, -2, v40
    v_cvt_pk_bf16_f32 v41, v114, v115
    v_min_u32 v41, -2, v41
    v_mfma_f32_32x32x16_bf16 v[128:143], a[84:87], v[180:183], v[128:143]
    v_cvt_pk_bf16_f32 v42, v116, v117
    v_min_u32 v42, -2, v42
    v_cvt_pk_bf16_f32 v43, v118, v119
    v_min_u32 v43, -2, v43
    v_cvt_pk_bf16_f32 v44, v120, v121
    v_min_u32 v44, -2, v44
    v_mfma_f32_32x32x16_bf16 v[128:143], a[88:91], v[184:187], v[128:143]
    v_cvt_pk_bf16_f32 v45, v122, v123
    v_min_u32 v45, -2, v45
    v_cvt_pk_bf16_f32 v46, v124, v125
    v_min_u32 v46, -2, v46
    v_cvt_pk_bf16_f32 v47, v126, v127
    v_min_u32 v47, -2, v47
    v_mfma_f32_32x32x16_bf16 v[128:143], a[92:95], v[188:191], v[128:143]
    buffer_store_dwordx4 v[40:43], v1, s[4:7], s36 offen sc1
    s_add_u32 s36, s36, 32768
    buffer_store_dwordx4 v[44:47], v1, s[4:7], s36 offen sc1
    s_add_u32 s36, s36, 32768
    v_mfma_f32_32x32x16_bf16 v[144:159], a[96:99], v[160:163], v[144:159]
    v_mfma_f32_32x32x16_bf16 v[144:159], a[100:103], v[164:167], v[144:159]
    v_cvt_pk_bf16_f32 v48, v128, v129
    v_min_u32 v48, -2, v48
    v_cvt_pk_bf16_f32 v49, v130, v131
    v_min_u32 v49, -2, v49
    v_cvt_pk_bf16_f32 v50, v132, v133
    v_min_u32 v50, -2, v50
    v_mfma_f32_32x32x16_bf16 v[144:159], a[104:107], v[168:171], v[144:159]
    v_cvt_pk_bf16_f32 v51, v134, v135
    v_min_u32 v51, -2, v51
    v_cvt_pk_bf16_f32 v52, v136, v137
    v_min_u32 v52, -2, v52
    v_cvt_pk_bf16_f32 v53, v138, v139
    v_min_u32 v53, -2, v53
    v_mfma_f32_32x32x16_bf16 v[144:159], a[108:111], v[172:175], v[144:159]
    v_cvt_pk_bf16_f32 v54, v140, v141
    v_min_u32 v54, -2, v54
    v_cvt_pk_bf16_f32 v55, v142, v143
    v_min_u32 v55, -2, v55
    buffer_store_dwordx4 v[48:51], v1, s[4:7], s36 offen sc1
    s_add_u32 s36, s36, 32768
    v_mfma_f32_32x32x16_bf16 v[144:159], a[112:115], v[176:179], v[144:159]
    buffer_store_dwordx4 v[52:55], v1, s[4:7], s36 offen sc1
    s_add_u32 s36, s36, 32768
    v_mfma_f32_32x32x16_bf16 v[144:159], a[116:119], v[180:183], v[144:159]
    v_mfma_f32_32x32x16_bf16 v[144:159], a[120:123], v[184:187], v[144:159]
    v_mfma_f32_32x32x16_bf16 v[144:159], a[124:127], v[188:191], v[144:159]
    s_nop 12
    v_cvt_pk_bf16_f32 v56, v144, v145
    v_min_u32 v56, -2, v56
    v_cvt_pk_bf16_f32 v57, v146, v147
    v_min_u32 v57, -2, v57
    v_cvt_pk_bf16_f32 v58, v148, v149
    v_min_u32 v58, -2, v58
    v_cvt_pk_bf16_f32 v59, v150, v151
    v_min_u32 v59, -2, v59
    v_cvt_pk_bf16_f32 v60, v152, v153
    v_min_u32 v60, -2, v60
    v_cvt_pk_bf16_f32 v61, v154, v155
    v_min_u32 v61, -2, v61
    v_cvt_pk_bf16_f32 v62, v156, v157
    v_min_u32 v62, -2, v62
    v_cvt_pk_bf16_f32 v63, v158, v159
    v_min_u32 v63, -2, v63
    buffer_store_dwordx4 v[56:59], v1, s[4:7], s36 offen sc1
    s_add_u32 s36, s36, 32768
    buffer_store_dwordx4 v[60:63], v1, s[4:7], s36 offen sc1
    s_add_u32 s36, s36, 32768
    s_lshl_b32 s47, s33, 11
    s_add_u32 s47, s47, 141312
    v_add_u32 v30, s47, v1
    s_lshl_b32 s47, s33, 10
    s_add_u32 s47, s47, 141312
    v_add_u32 v31, s47, v1
    v_and_b32 v28, 7, v0
    v_lshlrev_b32 v28, 10, v28
    s_waitcnt vmcnt(0)
    s_cmp_ge_u32 s42, 60
    s_cbranch_scc1 L_m_rf
    s_barrier
    s_cmp_lg_u32 s33, 0
    s_cbranch_scc1 L_m_c1
    s_lshl_b32 s48, s42, 7
    s_add_u32 s48, s48, 52494336
    v_mov_b32 v29, 1
    s_mov_b64 exec, 1
    buffer_atomic_add v29, off, s[4:7], s48
    s_mov_b64 exec, -1
L_m_c0:
    buffer_load_dword v29, off, s[4:7], s48 sc1
    s_waitcnt vmcnt(0)
    v_cmp_gt_u32 vcc, 32, v29
    s_cbranch_vccz L_m_c1
    s_add_u32 s43, s43, 1
    s_cmp_gt_u32 s43, 1000000
    s_cbranch_scc1 L_end
    s_sleep 2
    s_branch L_m_c0
L_m_c1:
    s_barrier
    s_branch L_m_rd
L_m_rf:
    s_mov_b64 exec, 0xff
    buffer_load_dword v29, v28, s[4:7], s37 offen offset:1020 sc1
    s_add_u32 s43, s43, 1
    s_cmp_gt_u32 s43, 1000000
    s_cbranch_scc1 L_end
    s_waitcnt vmcnt(0)
    v_cmp_eq_u32 vcc, -1, v29
    s_mov_b64 exec, -1
    s_cbranch_vccz L_m_rd
    s_sleep 1
    s_branch L_m_rf
L_m_rd:
    buffer_load_dwordx4 v[96:99], v1, s[4:7], s37 offen offset:0 sc1
    buffer_load_dwordx4 v[100:103], v1, s[4:7], s37 offen offset:1024 sc1
    buffer_load_dwordx4 v[104:107], v1, s[4:7], s37 offen offset:2048 sc1
    buffer_load_dwordx4 v[108:111], v1, s[4:7], s37 offen offset:3072 sc1
    buffer_load_dwordx4 v[112:115], v1, s[4:7], s40 offen offset:0 sc1
    buffer_load_dwordx4 v[116:119], v1, s[4:7], s40 offen offset:1024 sc1
    buffer_load_dwordx4 v[120:123], v1, s[4:7], s40 offen offset:2048 sc1
    buffer_load_dwordx4 v[124:127], v1, s[4:7], s40 offen offset:3072 sc1
    v_mov_b32 v29, 0
    s_waitcnt vmcnt(7)
    v_mfma_f32_32x32x16_bf16 v[64:79], v[20:23], v[96:99], 0
    v_max3_u32 v29, v29, v96, v97
    v_max3_u32 v29, v29, v98, v99
    s_waitcnt vmcnt(6)
    v_mfma_f32_32x32x16_bf16 v[64:79], v[20:23], v[100:103], v[64:79]
    v_max3_u32 v29, v29, v100, v101
    v_max3_u32 v29, v29, v102, v103
    s_waitcnt vmcnt(5)
    v_mfma_f32_32x32x16_bf16 v[64:79], v[20:23], v[104:107], v[64:79]
    v_max3_u32 v29, v29, v104, v105
    v_max3_u32 v29, v29, v106, v107
    s_waitcnt vmcnt(4)
    v_mfma_f32_32x32x16_bf16 v[64:79], v[20:23], v[108:111], v[64:79]
    v_max3_u32 v29, v29, v108, v109
    v_max3_u32 v29, v29, v110, v111
    s_waitcnt vmcnt(3)
    v_mfma_f32_32x32x16_bf16 v[64:79], v[20:23], v[112:115], v[64:79]
    v_max3_u32 v29, v29, v112, v113
    v_max3_u32 v29, v29, v114, v115
    s_waitcnt vmcnt(2)
    v_mfma_f32_32x32x16_bf16 v[64:79], v[20:23], v[116:119], v[64:79]
    v_max3_u32 v29, v29, v116, v117
    v_max3_u32 v29, v29, v118, v119
    s_waitcnt vmcnt(1)
    v_mfma_f32_32x32x16_bf16 v[64:79], v[20:23], v[120:123], v[64:79]
    v_max3_u32 v29, v29, v120, v121
    v_max3_u32 v29, v29, v122, v123
    s_waitcnt vmcnt(0)
    v_mfma_f32_32x32x16_bf16 v[64:79], v[20:23], v[124:127], v[64:79]
    v_max3_u32 v29, v29, v124, v125
    v_max3_u32 v29, v29, v126, v127
    v_cmp_eq_u32 vcc, -1, v29
    s_cbranch_vccnz L_m_rf
    s_nop 7
    ds_write_b128 v30, v[64:67]
    ds_write_b128 v30, v[68:71] offset:1024
    s_waitcnt lgkmcnt(0)
    s_barrier
    s_cmp_ge_u32 s33, 2
    s_cbranch_scc1 L_m_fin
    ds_read_b128 v[96:99], v31 offset:0
    ds_read_b128 v[100:103], v31 offset:2048
    ds_read_b128 v[104:107], v31 offset:4096
    ds_read_b128 v[108:111], v31 offset:6144
    s_waitcnt lgkmcnt(3)
    v_pk_add_f32 v[24:25], v[24:25], v[96:97]
    v_pk_add_f32 v[26:27], v[26:27], v[98:99]
    s_waitcnt lgkmcnt(2)
    v_pk_add_f32 v[24:25], v[24:25], v[100:101]
    v_pk_add_f32 v[26:27], v[26:27], v[102:103]
    s_waitcnt lgkmcnt(1)
    v_pk_add_f32 v[24:25], v[24:25], v[104:105]
    v_pk_add_f32 v[26:27], v[26:27], v[106:107]
    s_waitcnt lgkmcnt(0)
    v_pk_add_f32 v[24:25], v[24:25], v[108:109]
    v_pk_add_f32 v[26:27], v[26:27], v[110:111]
    buffer_store_dwordx4 v[24:27], v14, s[28:31], s49 offen
L_m_fin:
    s_branch L_end
L_end:
    s_endpgm
.section .rodata,"a"
.p2align 6
.amdhsa_kernel gated_mix__ssm_conv_s5__memory_aug_recurrent_mem_tr__prompt_kernel
  .amdhsa_next_free_vgpr 512
  .amdhsa_next_free_sgpr 102
  .amdhsa_accum_offset 256
  .amdhsa_group_segment_fixed_size 0
  .amdhsa_kernarg_size 160
  .amdhsa_user_sgpr_count 2
  .amdhsa_user_sgpr_kernarg_segment_ptr 1
  .amdhsa_system_sgpr_workgroup_id_x 1
  .amdhsa_float_denorm_mode_32 3
.end_amdhsa_kernel
```
